```python
import torch

def _softmax(x, axis=-1):
    return torch.softmax(x, dim=axis)
def _gelu(x):
    return torch.nn.functional.gelu(x, approximate="tanh")
def _silu(x):
    return torch.nn.functional.silu(x)
def _sigmoid(x):
    return torch.sigmoid(x)
def _layernorm(x, axis=-1, eps=1e-5):
    m = x.mean(dim=axis, keepdim=True)
    v = x.var(dim=axis, keepdim=True, unbiased=False)
    return (x - m) / torch.sqrt(v + eps)
def _scatter_add(tgt, idx, src, axis=0):
    return tgt.clone().index_add_(axis, idx, src)
def _segment_sum(src, seg, n):
    out = torch.zeros((n,) + src.shape[1:], dtype=src.dtype)
    return out.index_add_(0, seg, src)
def _pad(x, pw):
    flat = tuple(v for pair in reversed(pw) for v in pair)
    return torch.nn.functional.pad(x, flat)

kernel_name = 'recurrent_scan__compressed_kv_cla__mixer_s_mlp__prompt'

def setup_inputs():

    _w = (lambda a: (lambda t: t.to(torch.bfloat16) if t.is_floating_point() else t)(torch.as_tensor(a)))
    def _A_setup():
        B, H, Sq, Sk, D, M = 1, 32, 2048, 2048, 128, 640
        Dc = 4 * D
        return {
            "x": _w((lambda *s: torch.randn(*s, dtype=torch.bfloat16) * 0.05)(B, Sq, M)),
            "c_kv": _w((lambda *s: torch.randn(*s, dtype=torch.bfloat16) * 0.2)(B, Sk, Dc)),
            "w_q": _w((lambda *s: torch.randn(*s, dtype=torch.bfloat16) * 3.2)(M, H, D) * (M ** -0.5)),
            "w_uk": _w((lambda *s: torch.randn(*s, dtype=torch.bfloat16) * 3.2)(Dc, H, D) * (Dc ** -0.5)),
            "w_uv": _w((lambda *s: torch.randn(*s, dtype=torch.bfloat16) * 0.2)(Dc, H, D) * (Dc ** -0.5)),
            "w_o": _w((lambda *s: torch.randn(*s, dtype=torch.bfloat16) * 0.2)(H, D, M) * ((H * D) ** -0.5)),
        }
    _A_in = _A_setup()

    def _B_setup():
        B, S, D, F = 1, 2048, 640, 1728
        return {
            "x":  _w((lambda *s: torch.randn(*s, dtype=torch.bfloat16) * 0.05)(B, S, D)),
            "w1": _w((lambda *s: torch.randn(*s, dtype=torch.bfloat16) * 3.2)(D, D) * (D ** -0.5)),
            "w2": _w((lambda *s: torch.randn(*s, dtype=torch.bfloat16) * 3.2)(D, D) * (D ** -0.5)),
            "w3": _w((lambda *s: torch.randn(*s, dtype=torch.bfloat16) * 3.2)(D, F) * (D ** -0.5)),
            "w4": _w((lambda *s: torch.randn(*s, dtype=torch.bfloat16) * 1.6)(F, D) * (F ** -0.5)),
        }
    _B_in = _B_setup()

    return {
        "A_x": _A_in["x"],
        "A_c_kv": _A_in["c_kv"],
        "A_w_q": _A_in["w_q"],
        "A_w_uk": _A_in["w_uk"],
        "A_w_uv": _A_in["w_uv"],
        "A_w_o": _A_in["w_o"],
        "B_x": _B_in["x"],
        "B_w1": _B_in["w1"],
        "B_w2": _B_in["w2"],
        "B_w3": _B_in["w3"],
        "B_w4": _B_in["w4"],
    }

def reference(A_x, A_c_kv, A_w_q, A_w_uk, A_w_uv, A_w_o, B_x, B_w1, B_w2, B_w3, B_w4):
    def _A_ref(x, c_kv, w_q, w_uk, w_uv, w_o):
        B, Sq, M = x.shape[0], x.shape[1], x.shape[2]
        Sk = c_kv.shape[1]
        H, D = w_q.shape[1], w_q.shape[2]
        q = torch.einsum("bqm,mhd->bhqd", x, w_q)
        k = torch.einsum("bkc,chd->bhkd", c_kv, w_uk)
        v = torch.einsum("bkc,chd->bhkd", c_kv, w_uv)
        scores = torch.einsum("bhqd,bhkd->bhqk", q, k) * (D ** -0.5)
        off = Sk - Sq
        qi = torch.arange(Sq)[:, None]
        kj = torch.arange(Sk)[None, :]
        cmask = kj <= (qi + off)
        scores = torch.where(cmask[None, None], scores, -1e9)
        p = _softmax(scores, axis=-1)
        ctx = torch.einsum("bhqk,bhkd->bhqd", p, v)
        return torch.einsum("bhqd,hdm->bqm", ctx, w_o)

    def _B_ref(x, w1, w2, w3, w4):
        B, S, D = x.shape
        h = _gelu(_layernorm(x, axis=-1) @ w1)
        c = D // 4
        g0 = _pad(h[:, :, 0*c:1*c], ((0, 0), (1, 0), (0, 0)))[:, :S, :]
        g1 = _pad(h[:, :, 1*c:2*c], ((0, 0), (0, 1), (0, 0)))[:, 1:, :]
        g2 = _pad(h[:, :, 2*c:3*c], ((0, 0), (2, 0), (0, 0)))[:, :S, :]
        g3 = _pad(h[:, :, 3*c:   ], ((0, 0), (0, 2), (0, 0)))[:, 2:, :]
        hs = torch.concatenate([g0, g1, g2, g3], axis=-1) @ w2
        x1 = x + hs
        h2 = _gelu(_layernorm(x1, axis=-1) @ w3) @ w4
        return x1 + h2

    x = A_x
    xn = _layernorm(x, axis=-1)
    s = _A_ref(xn, A_c_kv, A_w_q, A_w_uk, A_w_uv, A_w_o)
    g = _silu(_B_ref(xn, B_w1, B_w2, B_w3, B_w4))
    return x + s * g
```

```asm
; @launch kernel=rs_kf_kernel grid=(256,1,1) block=(512,1,1) lds=163840
.amdgcn_target "amdgcn-amd-amdhsa--gfx950"
.text
.globl rs_kf_kernel
.p2align 8
.type rs_kf_kernel,@function
rs_kf_kernel:
s_cmp_lt_u32 s2, 256
s_cbranch_scc1 .kfgo_1004
s_endpgm
.kfgo_1004:
v_lshrrev_b32 v1, 6, v0
v_and_b32 v0, 63, v0
v_readfirstlane_b32 s20, v1
s_cmp_ge_u32 s2, 224
s_cbranch_scc1 .kfb_1002
s_load_dwordx2 s[4:5], s[0:1], 8
s_load_dwordx4 s[24:27], s[0:1], 24
s_load_dwordx2 s[28:29], s[0:1], 104
s_load_dwordx2 s[38:39], s[0:1], 16
s_load_dwordx2 s[40:41], s[0:1], 40
s_load_dwordx2 s[42:43], s[0:1], 64
s_load_dwordx4 s[44:47], s[0:1], 72
s_and_b32 s16, s2, 7
s_lshl_b32 s16, s16, 2
s_bfe_u32 s3, s2, 0x20003
s_add_u32 s16, s16, s3
s_lshr_b32 s17, s2, 5
s_mul_i32 s18, s17, 9
s_add_u32 s19, s18, 10
s_min_u32 s21, s17, 1
s_add_u32 s18, s18, s21
s_lshr_b32 s21, s20, 2
s_and_b32 s22, s20, 3
v_lshrrev_b32 v14, 3, v0
v_lshrrev_b32 v15, 4, v0
s_add_u32 s23, s20, s17
s_and_b32 s23, s23, 7
s_lshl_b32 s23, s23, 7
s_lshl_b32 s34, s17, 19
s_lshl_b32 s33, s20, 12
v_lshl_add_u32 v14, v14, 10, s23
s_add_u32 s30, s3, 0
s_and_b32 s30, s30, 3
v_lshl_add_u32 v48, s30, 2, v15
v_xor_b32 v48, v48, v0
v_and_b32 v48, 7, v48
v_lshl_add_u32 v48, v48, 4, v14
v_lshl_add_u32 v1, s30, 13, v48
s_lshl_b32 s30, s30, 10
s_add_u32 s60, s30, s33
s_add_u32 s30, s3, 1
s_and_b32 s30, s30, 3
v_lshl_add_u32 v48, s30, 2, v15
v_xor_b32 v48, v48, v0
v_and_b32 v48, 7, v48
v_lshl_add_u32 v48, v48, 4, v14
v_lshl_add_u32 v2, s30, 13, v48
s_lshl_b32 s30, s30, 10
s_add_u32 s61, s30, s33
s_add_u32 s30, s3, 2
s_and_b32 s30, s30, 3
v_lshl_add_u32 v48, s30, 2, v15
v_xor_b32 v48, v48, v0
v_and_b32 v48, 7, v48
v_lshl_add_u32 v48, v48, 4, v14
v_lshl_add_u32 v3, s30, 13, v48
s_lshl_b32 s30, s30, 10
s_add_u32 s62, s30, s33
s_add_u32 s30, s3, 3
s_and_b32 s30, s30, 3
v_lshl_add_u32 v48, s30, 2, v15
v_xor_b32 v48, v48, v0
v_and_b32 v48, 7, v48
v_lshl_add_u32 v48, v48, 4, v14
v_lshl_add_u32 v4, s30, 13, v48
s_lshl_b32 s30, s30, 10
s_add_u32 s63, s30, s33
v_lshrrev_b32 v14, 2, v0
v_and_b32 v15, 3, v0
v_lshlrev_b32 v15, 4, v15
v_lshl_add_u32 v11, v14, 13, v15
s_lshl_b32 s23, s16, 8
s_lshl_b32 s30, s22, 6
s_add_u32 s23, s23, s30
v_add_u32 v11, s23, v11
s_lshl_b32 s6, s19, 15
s_mov_b32 s7, 0x00020000
s_mov_b32 s10, 4194304
s_mov_b32 s11, 0x00020000
s_lshl_b32 s64, s18, 15
s_add_u32 s65, s64, 32768
s_add_u32 s66, s64, 65536
s_add_u32 s67, s64, 98304
s_add_u32 s31, s64, 0x20000
s_cmp_eq_u32 s21, 0
s_waitcnt lgkmcnt(0)
s_cselect_b32 s8, s24, s26
s_cselect_b32 s9, s25, s27
s_add_u32 m0, s60, 0
s_nop 0
buffer_load_dwordx4 v1, s[4:7], s64 offen lds
s_add_u32 m0, s60, 32768
s_nop 0
buffer_load_dwordx4 v1, s[4:7], s65 offen lds
buffer_load_dwordx4 v[128:131], v11, s[8:11], s34 offen
s_add_u32 s34, s34, 0x20000
buffer_load_dwordx4 v[132:135], v11, s[8:11], s34 offen
s_add_u32 s34, s34, 0x20000
buffer_load_dwordx4 v[136:139], v11, s[8:11], s34 offen
s_add_u32 s34, s34, 0x20000
buffer_load_dwordx4 v[140:143], v11, s[8:11], s34 offen
s_add_u32 s34, s34, 0x20000
s_and_b32 s34, s34, 0x3fffff
s_add_u32 m0, s60, 65536
s_nop 0
buffer_load_dwordx4 v1, s[4:7], s66 offen lds
s_add_u32 m0, s60, 98304
s_nop 0
buffer_load_dwordx4 v1, s[4:7], s67 offen lds
s_barrier
s_add_u32 m0, s61, 0
s_nop 0
buffer_load_dwordx4 v2, s[4:7], s64 offen lds
s_add_u32 m0, s61, 32768
s_nop 0
buffer_load_dwordx4 v2, s[4:7], s65 offen lds
s_add_u32 m0, s62, 0
s_nop 0
buffer_load_dwordx4 v3, s[4:7], s64 offen lds
s_add_u32 m0, s62, 32768
s_nop 0
buffer_load_dwordx4 v3, s[4:7], s65 offen lds
s_add_u32 m0, s63, 0
s_nop 0
buffer_load_dwordx4 v4, s[4:7], s64 offen lds
s_add_u32 m0, s63, 32768
s_nop 0
buffer_load_dwordx4 v4, s[4:7], s65 offen lds
buffer_load_dwordx4 v[144:147], v11, s[8:11], s34 offen
s_add_u32 s34, s34, 0x20000
buffer_load_dwordx4 v[148:151], v11, s[8:11], s34 offen
s_add_u32 s34, s34, 0x20000
buffer_load_dwordx4 v[152:155], v11, s[8:11], s34 offen
s_add_u32 s34, s34, 0x20000
buffer_load_dwordx4 v[156:159], v11, s[8:11], s34 offen
s_add_u32 s34, s34, 0x20000
s_and_b32 s34, s34, 0x3fffff
buffer_load_dwordx4 v[160:163], v11, s[8:11], s34 offen
s_add_u32 s34, s34, 0x20000
buffer_load_dwordx4 v[164:167], v11, s[8:11], s34 offen
s_add_u32 s34, s34, 0x20000
buffer_load_dwordx4 v[168:171], v11, s[8:11], s34 offen
s_add_u32 s34, s34, 0x20000
buffer_load_dwordx4 v[172:175], v11, s[8:11], s34 offen
s_add_u32 s34, s34, 0x20000
s_and_b32 s34, s34, 0x3fffff
buffer_load_dwordx4 v[176:179], v11, s[8:11], s34 offen
s_add_u32 s34, s34, 0x20000
buffer_load_dwordx4 v[180:183], v11, s[8:11], s34 offen
s_add_u32 s34, s34, 0x20000
buffer_load_dwordx4 v[184:187], v11, s[8:11], s34 offen
s_add_u32 s34, s34, 0x20000
buffer_load_dwordx4 v[188:191], v11, s[8:11], s34 offen
s_add_u32 s34, s34, 0x20000
s_and_b32 s34, s34, 0x3fffff
v_and_b32 v14, 31, v0
v_lshlrev_b32 v14, 7, v14
v_lshrrev_b32 v15, 5, v0
v_bfe_u32 v48, v0, 1, 3
v_xor_b32 v15, v15, v48
v_xor_b32 v48, 0, v15
v_lshl_add_u32 v5, v48, 4, v14
v_xor_b32 v48, 2, v15
v_lshl_add_u32 v6, v48, 4, v14
v_xor_b32 v48, 4, v15
v_lshl_add_u32 v7, v48, 4, v14
v_xor_b32 v48, 6, v15
v_lshl_add_u32 v8, v48, 4, v14
s_add_u32 s23, s33, 131072
v_lshlrev_b32 v106, 4, v0
v_add_u32 v12, s23, v106
v_lshrrev_b32 v101, 5, v0
v_bfe_u32 v102, v0, 4, 1
v_bfe_u32 v15, v0, 2, 2
v_and_b32 v14, 3, v0
v_lshl_add_u32 v14, v14, 3, s23
v_lshl_add_u32 v103, v15, 7, v14
v_lshl_add_u32 v14, v15, 6, v14
v_lshl_add_u32 v14, v101, 9, v14
v_lshl_add_u32 v13, v102, 5, v14
v_lshrrev_b32 v104, 3, v0
v_and_b32 v105, 7, v0
v_lshlrev_b32 v105, 4, v105
s_lshl_b32 s23, s3, 3
s_add_u32 s23, s23, s20
s_lshl_b32 s23, s23, 13
v_lshl_add_u32 v107, v0, 7, s23
s_mul_i32 s23, s21, 16777216
s_add_u32 s23, s23, 14942208
s_add_u32 s12, s28, s23
s_addc_u32 s13, s29, 0
s_mov_b32 s14, 16777216
s_mov_b32 s15, 0x00020000
s_cmp_eq_u32 s21, 0
s_cselect_b32 s23, 11, 10
s_cselect_b32 s30, 10, 12
s_lshl_b32 s30, 1, s30
s_lshl_b32 s23, s22, s23
v_add_u32 v9, s23, v106
v_add_u32 v10, s30, v9
s_lshl_b32 s35, s16, 6
s_add_u32 s35, s35, s18
s_lshl_b32 s35, s35, 13
s_sub_u32 s36, s19, s18
s_sub_u32 s36, s36, 2
s_mov_b32 s37, 0xfffe8000
s_mov_b32 s32, 0x8000
s_lshl_b32 s23, s2, 3
s_add_u32 s23, s23, s20
s_mov_b32 s48, s38
s_mov_b32 s49, s39
s_mov_b32 s50, 0
s_mov_b32 s53, 0
s_mov_b32 s52, 0
s_mov_b32 s54, 1073741824
s_mov_b32 s55, 1073741824
s_cmp_ge_u32 s23, 1280
s_cbranch_scc1 .rl_com_1005
s_add_u32 s30, s23, 0
s_mul_i32 s52, s30, 1024
s_lshr_b32 s52, s52, 16
s_mul_i32 s55, s52, 64
s_sub_u32 s30, s30, s55
s_mul_i32 s52, s52, 262144
s_lshl_b32 s54, s30, 11
s_add_u32 s54, s54, s52
s_add_u32 s54, s54, 72728576
s_add_u32 s55, s54, 131072
s_mov_b32 s53, 0
s_lshl_b32 s30, s30, 7
s_add_u32 s30, s30, s52
s_add_u32 s48, s38, s30
s_addc_u32 s49, s39, 0
s_sub_u32 s50, 5242880, s30
s_mov_b32 s52, 8192
.rl_com_1005:
s_mov_b32 s86, s38
s_mov_b32 s87, s39
s_mov_b32 s88, 0
s_mov_b32 s91, 0
s_mov_b32 s90, 0
s_mov_b32 s92, 1073741824
s_mov_b32 s93, 1073741824
s_sub_u32 s23, s23, 1280
s_cselect_b32 s30, 1792, 0
s_add_u32 s23, s23, s30
s_cmp_ge_u32 s23, 960
s_cbranch_scc1 .rl_com_1007
s_cmp_ge_u32 s23, 200
s_cbranch_scc1 .rl_nx_1008
s_add_u32 s30, s23, 0
s_mul_i32 s90, s30, 6554
s_lshr_b32 s90, s90, 16
s_mul_i32 s93, s90, 10
s_sub_u32 s30, s30, s93
s_mul_i32 s90, s90, 40960
s_lshl_b32 s92, s30, 11
s_add_u32 s92, s92, s90
s_add_u32 s92, s92, 77971456
s_add_u32 s93, s92, 20480
s_mov_b32 s91, 0
s_lshl_b32 s30, s30, 7
s_add_u32 s30, s30, s90
s_add_u32 s86, s42, s30
s_addc_u32 s87, s43, 0
s_sub_u32 s88, 819200, s30
s_mov_b32 s90, 1280
s_branch .rl_com_1007
.rl_nx_1008:
s_cmp_ge_u32 s23, 740
s_cbranch_scc1 .rl_nx_1009
s_add_u32 s30, s23, 4294967096
s_mul_i32 s90, s30, 2428
s_lshr_b32 s90, s90, 16
s_mul_i32 s93, s90, 27
s_sub_u32 s30, s30, s93
s_mul_i32 s90, s90, 110592
s_lshl_b32 s92, s30, 11
s_add_u32 s92, s92, s90
s_add_u32 s92, s92, 78790656
s_add_u32 s93, s92, 55296
s_mov_b32 s91, 0
s_lshl_b32 s30, s30, 7
s_add_u32 s30, s30, s90
s_add_u32 s86, s44, s30
s_addc_u32 s87, s45, 0
s_sub_u32 s88, 2211840, s30
s_mov_b32 s90, 3456
s_branch .rl_com_1007
.rl_nx_1009:
s_add_u32 s30, s23, 4294966556
s_mul_i32 s90, s30, 6554
s_lshr_b32 s90, s90, 16
s_mul_i32 s93, s90, 10
s_sub_u32 s30, s30, s93
s_mul_i32 s90, s90, 40960
s_lshl_b32 s92, s30, 12
s_add_u32 s92, s92, s90
s_add_u32 s92, s92, 65273856
s_add_u32 s93, s92, 2048
s_mov_b32 s91, 1
s_lshl_b32 s30, s30, 7
s_add_u32 s30, s30, s90
s_add_u32 s86, s40, s30
s_addc_u32 s87, s41, 0
s_sub_u32 s88, 5242880, s30
s_mov_b32 s90, 1280
.rl_com_1007:
s_mov_b32 s94, s38
s_mov_b32 s95, s39
s_mov_b32 s96, 0
s_mov_b32 s99, 0
s_mov_b32 s98, 0
s_mov_b32 s100, 1073741824
s_mov_b32 s101, 1073741824
s_sub_u32 s23, s23, 960
s_cselect_b32 s30, 1792, 0
s_add_u32 s23, s23, s30
s_cmp_ge_u32 s23, 800
s_cbranch_scc1 .rl_com_1011
s_add_u32 s30, s23, 220
s_mul_i32 s98, s30, 6554
s_lshr_b32 s98, s98, 16
s_mul_i32 s101, s98, 10
s_sub_u32 s30, s30, s101
s_mul_i32 s98, s98, 40960
s_lshl_b32 s100, s30, 12
s_add_u32 s100, s100, s98
s_add_u32 s100, s100, 65273856
s_add_u32 s101, s100, 2048
s_mov_b32 s99, 1
s_lshl_b32 s30, s30, 7
s_add_u32 s30, s30, s98
s_add_u32 s94, s40, s30
s_addc_u32 s95, s41, 0
s_sub_u32 s96, 5242880, s30
s_mov_b32 s98, 1280
.rl_com_1011:
s_mov_b32 s56, s38
s_mov_b32 s57, s39
s_mov_b32 s58, 0
s_mov_b32 s68, 0
s_mov_b32 s59, 0
s_mov_b32 s69, 1073741824
s_mov_b32 s17, 1073741824
s_sub_u32 s23, s23, 800
s_cselect_b32 s30, 1792, 0
s_add_u32 s23, s23, s30
s_cmp_ge_u32 s23, 800
s_cbranch_scc1 .rl_com_1013
s_cmp_ge_u32 s23, 260
s_cbranch_scc1 .rl_nx_1014
s_add_u32 s30, s23, 1020
s_mul_i32 s59, s30, 6554
s_lshr_b32 s59, s59, 16
s_mul_i32 s17, s59, 10
s_sub_u32 s30, s30, s17
s_mul_i32 s59, s59, 40960
s_lshl_b32 s69, s30, 12
s_add_u32 s69, s69, s59
s_add_u32 s69, s69, 65273856
s_add_u32 s17, s69, 2048
s_mov_b32 s68, 1
s_lshl_b32 s30, s30, 7
s_add_u32 s30, s30, s59
s_add_u32 s56, s40, s30
s_addc_u32 s57, s41, 0
s_sub_u32 s58, 5242880, s30
s_mov_b32 s59, 1280
s_branch .rl_com_1013
.rl_nx_1014:
s_add_u32 s30, s23, 4294967036
s_mul_i32 s59, s30, 6554
s_lshr_b32 s59, s59, 16
s_mul_i32 s17, s59, 10
s_sub_u32 s30, s30, s17
s_mul_i32 s59, s59, 40960
s_lshl_b32 s69, s30, 12
s_add_u32 s69, s69, s59
s_add_u32 s69, s69, 70516736
s_add_u32 s17, s69, 2048
s_mov_b32 s68, 1
s_lshl_b32 s30, s30, 7
s_add_u32 s30, s30, s59
s_add_u32 s56, s46, s30
s_addc_u32 s57, s47, 0
s_sub_u32 s58, 2211840, s30
s_mov_b32 s59, 1280
.rl_com_1013:
s_mov_b32 s38, s56
s_mov_b32 s39, s57
s_mov_b32 s40, s58
s_mov_b32 s42, s59
s_mov_b32 s43, s68
s_mov_b32 s44, s69
s_mov_b32 s45, s17
s_mov_b32 s51, 0x00020000
s_load_dwordx2 s[56:57], s[0:1], 96
s_mov_b32 s58, 256
s_mov_b32 s59, 0x00020000
s_lshr_b32 s46, s2, 5
s_lshl_b32 s46, s46, 2
s_add_u32 s46, s46, 160
s_waitcnt lgkmcnt(0)
s_add_u32 s24, s28, 0
s_addc_u32 s25, s29, 0
s_mov_b32 s26, 81002496
s_mov_b32 s27, 0x00020000
s_mov_b32 s16, 1
s_cmp_lg_u32 s21, 0
s_cbranch_scc1 .kv_v_1016
s_waitcnt vmcnt(23)
ds_write_b128 v12, v[128:131]
ds_read_b64_tr_b16 v[128:129], v13
ds_read_b64_tr_b16 v[130:131], v13 offset:256
s_waitcnt vmcnt(22)
ds_write_b128 v12, v[132:135]
ds_read_b64_tr_b16 v[132:133], v13
ds_read_b64_tr_b16 v[134:135], v13 offset:256
s_waitcnt vmcnt(12)
s_barrier
ds_read_b128 v[48:51], v5 offset:0
ds_read_b128 v[52:55], v5 offset:32768
ds_read_b128 v[56:59], v6 offset:0
ds_read_b128 v[60:63], v6 offset:32768
ds_read_b128 v[64:67], v7 offset:0
ds_read_b128 v[68:71], v7 offset:32768
ds_write_b128 v12, v[136:139]
ds_read_b64_tr_b16 v[136:137], v13
ds_read_b64_tr_b16 v[138:139], v13 offset:256
s_waitcnt lgkmcnt(7)
v_mfma_f32_32x32x16_bf16 v[16:31], v[128:131], v[48:51], 0
buffer_load_dwordx4 v[192:195], v11, s[8:11], s34 offen
s_add_u32 s34, s34, 0x20000
v_mfma_f32_32x32x16_bf16 v[32:47], v[128:131], v[52:55], 0
ds_read_b128 v[72:75], v8 offset:0
ds_read_b128 v[76:79], v8 offset:32768
ds_write_b128 v12, v[140:143]
ds_read_b64_tr_b16 v[140:141], v13
ds_read_b64_tr_b16 v[142:143], v13 offset:256
s_waitcnt lgkmcnt(10)
v_mfma_f32_32x32x16_bf16 v[16:31], v[132:135], v[56:59], v[16:31]
buffer_load_dwordx4 v[196:199], v11, s[8:11], s34 offen
s_add_u32 s34, s34, 0x20000
v_mfma_f32_32x32x16_bf16 v[32:47], v[132:135], v[60:63], v[32:47]
ds_read_b128 v[48:51], v5 offset:4096
ds_read_b128 v[52:55], v5 offset:36864
s_waitcnt vmcnt(13)
ds_write_b128 v12, v[144:147]
ds_read_b64_tr_b16 v[144:145], v13
ds_read_b64_tr_b16 v[146:147], v13 offset:256
s_waitcnt lgkmcnt(10)
v_mfma_f32_32x32x16_bf16 v[16:31], v[136:139], v[64:67], v[16:31]
buffer_load_dwordx4 v[200:203], v11, s[8:11], s34 offen
s_add_u32 s34, s34, 0x20000
v_mfma_f32_32x32x16_bf16 v[32:47], v[136:139], v[68:71], v[32:47]
ds_read_b128 v[56:59], v6 offset:4096
ds_read_b128 v[60:63], v6 offset:36864
s_waitcnt vmcnt(13)
ds_write_b128 v12, v[148:151]
ds_read_b64_tr_b16 v[148:149], v13
ds_read_b64_tr_b16 v[150:151], v13 offset:256
s_waitcnt lgkmcnt(10)
v_mfma_f32_32x32x16_bf16 v[16:31], v[140:143], v[72:75], v[16:31]
buffer_load_dwordx4 v[204:207], v11, s[8:11], s34 offen
s_add_u32 s34, s34, 0x20000
s_and_b32 s34, s34, 0x3fffff
v_mfma_f32_32x32x16_bf16 v[32:47], v[140:143], v[76:79], v[32:47]
ds_read_b128 v[64:67], v7 offset:4096
ds_read_b128 v[68:71], v7 offset:36864
s_waitcnt vmcnt(13)
ds_write_b128 v12, v[152:155]
ds_read_b64_tr_b16 v[152:153], v13
ds_read_b64_tr_b16 v[154:155], v13 offset:256
s_waitcnt lgkmcnt(10)
v_mfma_f32_32x32x16_bf16 v[16:31], v[144:147], v[48:51], v[16:31]
buffer_load_dwordx4 v[208:211], v11, s[8:11], s34 offen
s_add_u32 s34, s34, 0x20000
v_mfma_f32_32x32x16_bf16 v[32:47], v[144:147], v[52:55], v[32:47]
ds_read_b128 v[72:75], v8 offset:4096
ds_read_b128 v[76:79], v8 offset:36864
s_waitcnt vmcnt(13)
ds_write_b128 v12, v[156:159]
ds_read_b64_tr_b16 v[156:157], v13
ds_read_b64_tr_b16 v[158:159], v13 offset:256
s_waitcnt lgkmcnt(10)
v_mfma_f32_32x32x16_bf16 v[16:31], v[148:151], v[56:59], v[16:31]
buffer_load_dwordx4 v[212:215], v11, s[8:11], s34 offen
s_add_u32 s34, s34, 0x20000
v_mfma_f32_32x32x16_bf16 v[32:47], v[148:151], v[60:63], v[32:47]
ds_read_b128 v[48:51], v5 offset:8192
ds_read_b128 v[52:55], v5 offset:40960
s_waitcnt vmcnt(13)
ds_write_b128 v12, v[160:163]
ds_read_b64_tr_b16 v[160:161], v13
ds_read_b64_tr_b16 v[162:163], v13 offset:256
s_waitcnt lgkmcnt(10)
v_mfma_f32_32x32x16_bf16 v[16:31], v[152:155], v[64:67], v[16:31]
buffer_load_dwordx4 v[216:219], v11, s[8:11], s34 offen
s_add_u32 s34, s34, 0x20000
v_mfma_f32_32x32x16_bf16 v[32:47], v[152:155], v[68:71], v[32:47]
ds_read_b128 v[56:59], v6 offset:8192
ds_read_b128 v[60:63], v6 offset:40960
s_waitcnt vmcnt(13)
ds_write_b128 v12, v[164:167]
ds_read_b64_tr_b16 v[164:165], v13
ds_read_b64_tr_b16 v[166:167], v13 offset:256
s_waitcnt lgkmcnt(10)
v_mfma_f32_32x32x16_bf16 v[16:31], v[156:159], v[72:75], v[16:31]
buffer_load_dwordx4 v[220:223], v11, s[8:11], s34 offen
s_add_u32 s34, s34, 0x20000
s_and_b32 s34, s34, 0x3fffff
v_mfma_f32_32x32x16_bf16 v[32:47], v[156:159], v[76:79], v[32:47]
ds_read_b128 v[64:67], v7 offset:8192
ds_read_b128 v[68:71], v7 offset:40960
s_waitcnt vmcnt(13)
ds_write_b128 v12, v[168:171]
ds_read_b64_tr_b16 v[168:169], v13
ds_read_b64_tr_b16 v[170:171], v13 offset:256
s_waitcnt lgkmcnt(10)
v_mfma_f32_32x32x16_bf16 v[16:31], v[160:163], v[48:51], v[16:31]
buffer_load_dwordx4 v[224:227], v11, s[8:11], s34 offen
s_add_u32 s34, s34, 0x20000
v_mfma_f32_32x32x16_bf16 v[32:47], v[160:163], v[52:55], v[32:47]
ds_read_b128 v[72:75], v8 offset:8192
ds_read_b128 v[76:79], v8 offset:40960
s_waitcnt vmcnt(13)
ds_write_b128 v12, v[172:175]
ds_read_b64_tr_b16 v[172:173], v13
ds_read_b64_tr_b16 v[174:175], v13 offset:256
s_waitcnt lgkmcnt(10)
v_mfma_f32_32x32x16_bf16 v[16:31], v[164:167], v[56:59], v[16:31]
buffer_load_dwordx4 v[228:231], v11, s[8:11], s34 offen
s_add_u32 s34, s34, 0x20000
v_mfma_f32_32x32x16_bf16 v[32:47], v[164:167], v[60:63], v[32:47]
ds_read_b128 v[48:51], v5 offset:12288
ds_read_b128 v[52:55], v5 offset:45056
s_waitcnt vmcnt(13)
ds_write_b128 v12, v[176:179]
ds_read_b64_tr_b16 v[176:177], v13
ds_read_b64_tr_b16 v[178:179], v13 offset:256
s_waitcnt lgkmcnt(10)
v_mfma_f32_32x32x16_bf16 v[16:31], v[168:171], v[64:67], v[16:31]
buffer_load_dwordx4 v[232:235], v11, s[8:11], s34 offen
s_add_u32 s34, s34, 0x20000
v_mfma_f32_32x32x16_bf16 v[32:47], v[168:171], v[68:71], v[32:47]
ds_read_b128 v[56:59], v6 offset:12288
ds_read_b128 v[60:63], v6 offset:45056
s_waitcnt vmcnt(13)
ds_write_b128 v12, v[180:183]
ds_read_b64_tr_b16 v[180:181], v13
ds_read_b64_tr_b16 v[182:183], v13 offset:256
s_waitcnt lgkmcnt(10)
v_mfma_f32_32x32x16_bf16 v[16:31], v[172:175], v[72:75], v[16:31]
buffer_load_dwordx4 v[236:239], v11, s[8:11], s34 offen
s_add_u32 s34, s34, 0x20000
s_and_b32 s34, s34, 0x3fffff
v_mfma_f32_32x32x16_bf16 v[32:47], v[172:175], v[76:79], v[32:47]
ds_read_b128 v[64:67], v7 offset:12288
ds_read_b128 v[68:71], v7 offset:45056
s_waitcnt vmcnt(13)
ds_write_b128 v12, v[184:187]
ds_read_b64_tr_b16 v[184:185], v13
ds_read_b64_tr_b16 v[186:187], v13 offset:256
s_waitcnt lgkmcnt(10)
v_mfma_f32_32x32x16_bf16 v[16:31], v[176:179], v[48:51], v[16:31]
buffer_load_dwordx4 v[240:243], v11, s[8:11], s34 offen
s_add_u32 s34, s34, 0x20000
v_mfma_f32_32x32x16_bf16 v[32:47], v[176:179], v[52:55], v[32:47]
ds_read_b128 v[72:75], v8 offset:12288
ds_read_b128 v[76:79], v8 offset:45056
s_waitcnt vmcnt(13)
ds_write_b128 v12, v[188:191]
ds_read_b64_tr_b16 v[188:189], v13
ds_read_b64_tr_b16 v[190:191], v13 offset:256
s_waitcnt lgkmcnt(10)
v_mfma_f32_32x32x16_bf16 v[16:31], v[180:183], v[56:59], v[16:31]
buffer_load_dwordx4 v[244:247], v11, s[8:11], s34 offen
s_add_u32 s34, s34, 0x20000
v_mfma_f32_32x32x16_bf16 v[32:47], v[180:183], v[60:63], v[32:47]
ds_read_b128 v[48:51], v5 offset:16384
ds_read_b128 v[52:55], v5 offset:49152
s_waitcnt vmcnt(13)
ds_write_b128 v12, v[192:195]
ds_read_b64_tr_b16 v[192:193], v13
ds_read_b64_tr_b16 v[194:195], v13 offset:256
s_waitcnt lgkmcnt(10)
v_mfma_f32_32x32x16_bf16 v[16:31], v[184:187], v[64:67], v[16:31]
buffer_load_dwordx4 v[248:251], v11, s[8:11], s34 offen
s_add_u32 s34, s34, 0x20000
v_mfma_f32_32x32x16_bf16 v[32:47], v[184:187], v[68:71], v[32:47]
ds_read_b128 v[56:59], v6 offset:16384
ds_read_b128 v[60:63], v6 offset:49152
s_waitcnt vmcnt(13)
ds_write_b128 v12, v[196:199]
ds_read_b64_tr_b16 v[196:197], v13
ds_read_b64_tr_b16 v[198:199], v13 offset:256
s_waitcnt lgkmcnt(10)
v_mfma_f32_32x32x16_bf16 v[16:31], v[188:191], v[72:75], v[16:31]
buffer_load_dwordx4 v[252:255], v11, s[8:11], s34 offen
s_add_u32 s34, s34, 0x20000
s_and_b32 s34, s34, 0x3fffff
v_mfma_f32_32x32x16_bf16 v[32:47], v[188:191], v[76:79], v[32:47]
ds_read_b128 v[64:67], v7 offset:16384
ds_read_b128 v[68:71], v7 offset:49152
s_waitcnt vmcnt(13)
ds_write_b128 v12, v[200:203]
ds_read_b64_tr_b16 v[200:201], v13
ds_read_b64_tr_b16 v[202:203], v13 offset:256
s_waitcnt lgkmcnt(10)
s_add_u32 m0, s61, 65536
v_mfma_f32_32x32x16_bf16 v[16:31], v[192:195], v[48:51], v[16:31]
v_mfma_f32_32x32x16_bf16 v[32:47], v[192:195], v[52:55], v[32:47]
buffer_load_dwordx4 v2, s[4:7], s66 offen lds
ds_read_b128 v[72:75], v8 offset:16384
ds_read_b128 v[76:79], v8 offset:49152
s_waitcnt vmcnt(13)
ds_write_b128 v12, v[204:207]
ds_read_b64_tr_b16 v[204:205], v13
ds_read_b64_tr_b16 v[206:207], v13 offset:256
s_waitcnt lgkmcnt(10)
s_add_u32 m0, s62, 65536
v_mfma_f32_32x32x16_bf16 v[16:31], v[196:199], v[56:59], v[16:31]
v_mfma_f32_32x32x16_bf16 v[32:47], v[196:199], v[60:63], v[32:47]
buffer_load_dwordx4 v3, s[4:7], s66 offen lds
ds_read_b128 v[48:51], v5 offset:20480
ds_read_b128 v[52:55], v5 offset:53248
s_waitcnt vmcnt(13)
ds_write_b128 v12, v[208:211]
ds_read_b64_tr_b16 v[208:209], v13
ds_read_b64_tr_b16 v[210:211], v13 offset:256
s_waitcnt lgkmcnt(10)
s_add_u32 m0, s63, 65536
v_mfma_f32_32x32x16_bf16 v[16:31], v[200:203], v[64:67], v[16:31]
v_mfma_f32_32x32x16_bf16 v[32:47], v[200:203], v[68:71], v[32:47]
buffer_load_dwordx4 v4, s[4:7], s66 offen lds
ds_read_b128 v[56:59], v6 offset:20480
ds_read_b128 v[60:63], v6 offset:53248
s_waitcnt vmcnt(13)
ds_write_b128 v12, v[212:215]
ds_read_b64_tr_b16 v[212:213], v13
ds_read_b64_tr_b16 v[214:215], v13 offset:256
s_waitcnt lgkmcnt(10)
s_add_u32 m0, s61, 98304
v_mfma_f32_32x32x16_bf16 v[16:31], v[204:207], v[72:75], v[16:31]
v_mfma_f32_32x32x16_bf16 v[32:47], v[204:207], v[76:79], v[32:47]
buffer_load_dwordx4 v2, s[4:7], s67 offen lds
ds_read_b128 v[64:67], v7 offset:20480
ds_read_b128 v[68:71], v7 offset:53248
s_waitcnt vmcnt(13)
ds_write_b128 v12, v[216:219]
ds_read_b64_tr_b16 v[216:217], v13
ds_read_b64_tr_b16 v[218:219], v13 offset:256
s_waitcnt lgkmcnt(10)
s_add_u32 m0, s62, 98304
v_mfma_f32_32x32x16_bf16 v[16:31], v[208:211], v[48:51], v[16:31]
v_mfma_f32_32x32x16_bf16 v[32:47], v[208:211], v[52:55], v[32:47]
buffer_load_dwordx4 v3, s[4:7], s67 offen lds
ds_read_b128 v[72:75], v8 offset:20480
ds_read_b128 v[76:79], v8 offset:53248
s_waitcnt vmcnt(13)
ds_write_b128 v12, v[220:223]
ds_read_b64_tr_b16 v[220:221], v13
ds_read_b64_tr_b16 v[222:223], v13 offset:256
s_waitcnt lgkmcnt(10)
s_add_u32 m0, s63, 98304
v_mfma_f32_32x32x16_bf16 v[16:31], v[212:215], v[56:59], v[16:31]
v_mfma_f32_32x32x16_bf16 v[32:47], v[212:215], v[60:63], v[32:47]
buffer_load_dwordx4 v4, s[4:7], s67 offen lds
ds_read_b128 v[48:51], v5 offset:24576
ds_read_b128 v[52:55], v5 offset:57344
s_waitcnt vmcnt(13)
ds_write_b128 v12, v[224:227]
ds_read_b64_tr_b16 v[224:225], v13
ds_read_b64_tr_b16 v[226:227], v13 offset:256
s_waitcnt lgkmcnt(10)
v_mfma_f32_32x32x16_bf16 v[16:31], v[216:219], v[64:67], v[16:31]
v_mfma_f32_32x32x16_bf16 v[32:47], v[216:219], v[68:71], v[32:47]
buffer_load_dword v107, v107, s[4:7], s31 offen
ds_read_b128 v[56:59], v6 offset:24576
ds_read_b128 v[60:63], v6 offset:57344
s_waitcnt vmcnt(13)
ds_write_b128 v12, v[228:231]
ds_read_b64_tr_b16 v[228:229], v13
ds_read_b64_tr_b16 v[230:231], v13 offset:256
s_waitcnt lgkmcnt(10)
v_mfma_f32_32x32x16_bf16 v[16:31], v[220:223], v[72:75], v[16:31]
v_mad_u32_u24 v100, v104, s52, v105
s_lshl_b32 s17, s52, 3
s_lshl_b32 s18, s17, 1
s_add_u32 s19, s17, s18
v_mfma_f32_32x32x16_bf16 v[32:47], v[220:223], v[76:79], v[32:47]
buffer_load_dwordx4 v[80:83], v100, s[48:51], 0 offen
ds_read_b128 v[64:67], v7 offset:24576
ds_read_b128 v[68:71], v7 offset:57344
s_waitcnt vmcnt(13)
ds_write_b128 v12, v[232:235]
ds_read_b64_tr_b16 v[232:233], v13
ds_read_b64_tr_b16 v[234:235], v13 offset:256
s_waitcnt lgkmcnt(10)
v_mfma_f32_32x32x16_bf16 v[16:31], v[224:227], v[48:51], v[16:31]
buffer_load_dwordx4 v[84:87], v100, s[48:51], s17 offen
v_mfma_f32_32x32x16_bf16 v[32:47], v[224:227], v[52:55], v[32:47]
buffer_load_dwordx4 v[88:91], v100, s[48:51], s18 offen
ds_read_b128 v[72:75], v8 offset:24576
ds_read_b128 v[76:79], v8 offset:57344
s_waitcnt vmcnt(14)
ds_write_b128 v12, v[236:239]
ds_read_b64_tr_b16 v[236:237], v13
ds_read_b64_tr_b16 v[238:239], v13 offset:256
s_waitcnt lgkmcnt(10)
v_mfma_f32_32x32x16_bf16 v[16:31], v[228:231], v[56:59], v[16:31]
buffer_load_dwordx4 v[92:95], v100, s[48:51], s19 offen
v_mfma_f32_32x32x16_bf16 v[32:47], v[228:231], v[60:63], v[32:47]
s_mov_b64 s[22:23], s[54:55]
s_cmp_eq_u32 s53, 0
s_cselect_b32 s17, 9, 11
s_cselect_b32 s18, 5, 9
s_cselect_b32 s19, 64, 32
s_cselect_b32 s30, 0x800, 64
ds_read_b128 v[48:51], v5 offset:28672
ds_read_b128 v[52:55], v5 offset:61440
s_waitcnt vmcnt(14)
ds_write_b128 v12, v[240:243]
ds_read_b64_tr_b16 v[240:241], v13
ds_read_b64_tr_b16 v[242:243], v13 offset:256
s_waitcnt lgkmcnt(10)
v_mfma_f32_32x32x16_bf16 v[16:31], v[232:235], v[64:67], v[16:31]
v_lshlrev_b32 v97, s17, v101
v_lshlrev_b32 v98, s18, v102
v_add3_u32 v96, v97, v98, v103
v_mfma_f32_32x32x16_bf16 v[32:47], v[232:235], v[68:71], v[32:47]
v_add_u32 v97, s19, v96
v_add_u32 v98, s30, v96
v_add_u32 v99, s30, v97
ds_read_b128 v[56:59], v6 offset:28672
ds_read_b128 v[60:63], v6 offset:61440
s_waitcnt vmcnt(13)
ds_write_b128 v12, v[244:247]
ds_read_b64_tr_b16 v[244:245], v13
ds_read_b64_tr_b16 v[246:247], v13 offset:256
s_waitcnt lgkmcnt(10)
v_mfma_f32_32x32x16_bf16 v[16:31], v[236:239], v[72:75], v[16:31]
s_mov_b64 s[48:49], s[86:87]
s_mov_b32 s50, s88
s_mov_b64 s[52:53], s[90:91]
s_mov_b64 s[54:55], s[92:93]
v_mfma_f32_32x32x16_bf16 v[32:47], v[236:239], v[76:79], v[32:47]
s_mov_b64 s[86:87], s[94:95]
s_mov_b32 s88, s96
s_mov_b64 s[90:91], s[98:99]
s_mov_b64 s[92:93], s[100:101]
ds_read_b128 v[64:67], v7 offset:28672
ds_read_b128 v[68:71], v7 offset:61440
s_waitcnt vmcnt(12)
ds_write_b128 v12, v[248:251]
ds_read_b64_tr_b16 v[248:249], v13
ds_read_b64_tr_b16 v[250:251], v13 offset:256
s_waitcnt lgkmcnt(10)
v_mfma_f32_32x32x16_bf16 v[16:31], v[240:243], v[48:51], v[16:31]
s_mov_b64 s[94:95], s[38:39]
s_mov_b32 s96, s40
s_mov_b64 s[98:99], s[42:43]
s_mov_b64 s[100:101], s[44:45]
v_mfma_f32_32x32x16_bf16 v[32:47], v[240:243], v[52:55], v[32:47]
s_mov_b32 s40, 0
s_mov_b32 s44, 1073741824
s_mov_b32 s45, 1073741824
ds_read_b128 v[72:75], v8 offset:28672
ds_read_b128 v[76:79], v8 offset:61440
s_waitcnt vmcnt(11)
ds_write_b128 v12, v[252:255]
ds_read_b64_tr_b16 v[252:253], v13
ds_read_b64_tr_b16 v[254:255], v13 offset:256
s_waitcnt lgkmcnt(10)
v_mfma_f32_32x32x16_bf16 v[16:31], v[244:247], v[56:59], v[16:31]
v_mfma_f32_32x32x16_bf16 v[32:47], v[244:247], v[60:63], v[32:47]
s_waitcnt lgkmcnt(5)
v_mfma_f32_32x32x16_bf16 v[16:31], v[248:251], v[64:67], v[16:31]
v_mfma_f32_32x32x16_bf16 v[32:47], v[248:251], v[68:71], v[32:47]
s_waitcnt lgkmcnt(0)
v_mfma_f32_32x32x16_bf16 v[16:31], v[252:255], v[72:75], v[16:31]
v_mfma_f32_32x32x16_bf16 v[32:47], v[252:255], v[76:79], v[32:47]
v_add_u32 v5, 0x10000, v5
v_add_u32 v6, 0x10000, v6
v_add_u32 v7, 0x10000, v7
v_add_u32 v8, 0x10000, v8
s_waitcnt vmcnt(5)
s_barrier
ds_read_b128 v[48:51], v5 offset:0
ds_read_b128 v[52:55], v6 offset:0
ds_read_b128 v[56:59], v7 offset:0
ds_read_b128 v[60:63], v8 offset:0
ds_read_b128 v[64:67], v5 offset:4096
ds_read_b128 v[68:71], v6 offset:4096
s_mov_b32 m0, s60
v_cvt_pk_bf16_f32 v16, v16, v17
v_cvt_pk_bf16_f32 v17, v18, v19
buffer_load_dwordx4 v1, s[4:7], s31 offen lds
s_mov_b32 m0, s61
v_cvt_pk_bf16_f32 v18, v20, v21
v_cvt_pk_bf16_f32 v19, v22, v23
buffer_load_dwordx4 v2, s[4:7], s31 offen lds
s_mov_b32 m0, s62
v_cvt_pk_bf16_f32 v20, v24, v25
v_cvt_pk_bf16_f32 v21, v26, v27
buffer_load_dwordx4 v3, s[4:7], s31 offen lds
s_mov_b32 m0, s63
v_cvt_pk_bf16_f32 v22, v28, v29
v_cvt_pk_bf16_f32 v23, v30, v31
buffer_load_dwordx4 v4, s[4:7], s31 offen lds
s_add_u32 s31, s31, 0x8000
buffer_store_dwordx4 v[16:19], v9, s[12:15], s35 offen sc1
buffer_store_dwordx4 v[20:23], v10, s[12:15], s35 offen sc1
s_add_u32 s35, s35, 0x2000
.kv_loop_1018:
ds_read_b128 v[72:75], v7 offset:4096
s_waitcnt lgkmcnt(6)
v_mfma_f32_32x32x16_bf16 v[16:31], v[128:131], v[48:51], 0
ds_read_b128 v[76:79], v8 offset:4096
s_waitcnt lgkmcnt(6)
v_mfma_f32_32x32x16_bf16 v[16:31], v[132:135], v[52:55], v[16:31]
ds_read_b128 v[48:51], v5 offset:8192
s_waitcnt lgkmcnt(6)
v_mfma_f32_32x32x16_bf16 v[16:31], v[136:139], v[56:59], v[16:31]
s_sub_u32 s36, s36, 1
ds_read_b128 v[52:55], v6 offset:8192
s_waitcnt lgkmcnt(6)
v_mfma_f32_32x32x16_bf16 v[16:31], v[140:143], v[60:63], v[16:31]
v_cvt_pk_bf16_f32 v32, v32, v33
v_cvt_pk_bf16_f32 v33, v34, v35
ds_read_b128 v[56:59], v7 offset:8192
s_waitcnt lgkmcnt(6)
v_mfma_f32_32x32x16_bf16 v[16:31], v[144:147], v[64:67], v[16:31]
v_cvt_pk_bf16_f32 v34, v36, v37
v_cvt_pk_bf16_f32 v35, v38, v39
ds_read_b128 v[60:63], v8 offset:8192
s_waitcnt lgkmcnt(6)
v_mfma_f32_32x32x16_bf16 v[16:31], v[148:151], v[68:71], v[16:31]
v_cvt_pk_bf16_f32 v36, v40, v41
v_cvt_pk_bf16_f32 v37, v42, v43
ds_read_b128 v[64:67], v5 offset:12288
s_waitcnt lgkmcnt(6)
v_mfma_f32_32x32x16_bf16 v[16:31], v[152:155], v[72:75], v[16:31]
v_cvt_pk_bf16_f32 v38, v44, v45
v_cvt_pk_bf16_f32 v39, v46, v47
ds_read_b128 v[68:71], v6 offset:12288
s_waitcnt lgkmcnt(6)
v_mfma_f32_32x32x16_bf16 v[16:31], v[156:159], v[76:79], v[16:31]
buffer_store_dwordx4 v[32:35], v9, s[12:15], s35 offen sc1
ds_read_b128 v[72:75], v7 offset:12288
s_waitcnt lgkmcnt(6)
v_mfma_f32_32x32x16_bf16 v[16:31], v[160:163], v[48:51], v[16:31]
buffer_store_dwordx4 v[36:39], v10, s[12:15], s35 offen sc1
ds_read_b128 v[76:79], v8 offset:12288
s_waitcnt lgkmcnt(6)
v_mfma_f32_32x32x16_bf16 v[16:31], v[164:167], v[52:55], v[16:31]
s_add_u32 s35, s35, 0x2000
s_waitcnt vmcnt(8)
ds_write_b128 v12, v[80:83] offset:0
ds_write_b128 v12, v[84:87] offset:1024
ds_read_b128 v[48:51], v5 offset:16384
s_waitcnt lgkmcnt(8)
v_mfma_f32_32x32x16_bf16 v[16:31], v[168:171], v[56:59], v[16:31]
ds_write_b128 v12, v[88:91] offset:2048
ds_write_b128 v12, v[92:95] offset:3072
ds_read_b128 v[52:55], v6 offset:16384
s_waitcnt lgkmcnt(10)
v_mfma_f32_32x32x16_bf16 v[16:31], v[172:175], v[60:63], v[16:31]
ds_read_b64_tr_b16 v[80:81], v96
ds_read_b64_tr_b16 v[82:83], v96 offset:1024
ds_read_b128 v[56:59], v7 offset:16384
s_waitcnt lgkmcnt(12)
v_mfma_f32_32x32x16_bf16 v[16:31], v[176:179], v[64:67], v[16:31]
ds_read_b64_tr_b16 v[84:85], v97
ds_read_b64_tr_b16 v[86:87], v97 offset:1024
ds_read_b128 v[60:63], v8 offset:16384
s_waitcnt lgkmcnt(14)
v_mfma_f32_32x32x16_bf16 v[16:31], v[180:183], v[68:71], v[16:31]
ds_read_b64_tr_b16 v[88:89], v98
ds_read_b64_tr_b16 v[90:91], v98 offset:1024
ds_read_b128 v[64:67], v5 offset:20480
s_waitcnt lgkmcnt(15)
v_mfma_f32_32x32x16_bf16 v[16:31], v[184:187], v[72:75], v[16:31]
ds_read_b64_tr_b16 v[92:93], v99
ds_read_b64_tr_b16 v[94:95], v99 offset:1024
ds_read_b128 v[68:71], v6 offset:20480
v_mfma_f32_32x32x16_bf16 v[16:31], v[188:191], v[76:79], v[16:31]
ds_read_b128 v[72:75], v7 offset:20480
s_waitcnt lgkmcnt(15)
v_mfma_f32_32x32x16_bf16 v[16:31], v[192:195], v[48:51], v[16:31]
s_waitcnt lgkmcnt(11)
buffer_store_dwordx4 v[80:83], v106, s[24:27], s22 offen offset:0 sc1
ds_read_b128 v[76:79], v8 offset:20480
v_mfma_f32_32x32x16_bf16 v[16:31], v[196:199], v[52:55], v[16:31]
s_waitcnt lgkmcnt(9)
buffer_store_dwordx4 v[84:87], v106, s[24:27], s22 offen offset:1024 sc1
ds_read_b128 v[48:51], v5 offset:24576
v_mfma_f32_32x32x16_bf16 v[16:31], v[200:203], v[56:59], v[16:31]
s_waitcnt lgkmcnt(7)
buffer_store_dwordx4 v[88:91], v106, s[24:27], s23 offen offset:0 sc1
ds_read_b128 v[52:55], v6 offset:24576
v_mfma_f32_32x32x16_bf16 v[16:31], v[204:207], v[60:63], v[16:31]
s_waitcnt lgkmcnt(5)
buffer_store_dwordx4 v[92:95], v106, s[24:27], s23 offen offset:1024 sc1
ds_read_b128 v[56:59], v7 offset:24576
v_mfma_f32_32x32x16_bf16 v[16:31], v[208:211], v[64:67], v[16:31]
s_cmp_lg_u32 s16, 0
s_cbranch_scc1 .kv_sk_1022
.kv_sk_1022:
s_barrier
s_or_b32 s47, s20, s16
s_cbranch_scc1 .sig_1023
v_lshlrev_b32 v108, 12, v0
v_lshlrev_b32_e64 v109, s2, 1
buffer_atomic_or v109, v108, s[56:59], s46 offen offset:0 sc1
.sig_1023:
s_add_u32 s46, s46, 32
ds_read_b128 v[60:63], v8 offset:24576
s_waitcnt lgkmcnt(6)
s_add_u32 m0, s32, s60
v_mfma_f32_32x32x16_bf16 v[16:31], v[212:215], v[68:71], v[16:31]
buffer_load_dwordx4 v1, s[4:7], s31 offen lds
ds_read_b128 v[64:67], v5 offset:28672
s_waitcnt lgkmcnt(6)
s_add_u32 m0, s32, s61
v_mfma_f32_32x32x16_bf16 v[16:31], v[216:219], v[72:75], v[16:31]
buffer_load_dwordx4 v2, s[4:7], s31 offen lds
ds_read_b128 v[68:71], v6 offset:28672
s_waitcnt lgkmcnt(6)
s_add_u32 m0, s32, s62
v_mfma_f32_32x32x16_bf16 v[16:31], v[220:223], v[76:79], v[16:31]
buffer_load_dwordx4 v3, s[4:7], s31 offen lds
ds_read_b128 v[72:75], v7 offset:28672
s_waitcnt lgkmcnt(6)
s_add_u32 m0, s32, s63
v_mfma_f32_32x32x16_bf16 v[16:31], v[224:227], v[48:51], v[16:31]
buffer_load_dwordx4 v4, s[4:7], s31 offen lds
ds_read_b128 v[76:79], v8 offset:28672
s_waitcnt lgkmcnt(6)
v_mfma_f32_32x32x16_bf16 v[16:31], v[228:231], v[52:55], v[16:31]
s_add_u32 s31, s31, 0x8000
s_add_u32 s32, s32, 0x8000
s_and_b32 s32, s32, 0x1ffff
s_mov_b32 s16, 0
v_mad_u32_u24 v100, v104, s52, v105
s_lshl_b32 s17, s52, 3
s_lshl_b32 s18, s17, 1
s_add_u32 s19, s17, s18
buffer_load_dwordx4 v[80:83], v100, s[48:51], 0 offen
v_add_u32 v5, 0x8000, v5
v_add_u32 v6, 0x8000, v6
v_add_u32 v7, 0x8000, v7
v_add_u32 v8, 0x8000, v8
ds_read_b128 v[48:51], v5 offset:0
s_waitcnt lgkmcnt(6)
v_mfma_f32_32x32x16_bf16 v[16:31], v[232:235], v[56:59], v[16:31]
buffer_load_dwordx4 v[84:87], v100, s[48:51], s17 offen
buffer_load_dwordx4 v[88:91], v100, s[48:51], s18 offen
ds_read_b128 v[52:55], v6 offset:0
s_waitcnt lgkmcnt(6)
v_mfma_f32_32x32x16_bf16 v[16:31], v[236:239], v[60:63], v[16:31]
buffer_load_dwordx4 v[92:95], v100, s[48:51], s19 offen
s_mov_b64 s[22:23], s[54:55]
s_cmp_eq_u32 s53, 0
s_cselect_b32 s17, 9, 11
s_cselect_b32 s18, 5, 9
s_cselect_b32 s19, 64, 32
s_cselect_b32 s30, 0x800, 64
ds_read_b128 v[56:59], v7 offset:0
s_waitcnt lgkmcnt(6)
v_mfma_f32_32x32x16_bf16 v[16:31], v[240:243], v[64:67], v[16:31]
v_lshlrev_b32 v97, s17, v101
v_lshlrev_b32 v98, s18, v102
v_add3_u32 v96, v97, v98, v103
v_add_u32 v97, s19, v96
v_add_u32 v98, s30, v96
v_add_u32 v99, s30, v97
ds_read_b128 v[60:63], v8 offset:0
s_waitcnt lgkmcnt(6)
v_mfma_f32_32x32x16_bf16 v[16:31], v[244:247], v[68:71], v[16:31]
s_mov_b64 s[48:49], s[86:87]
s_mov_b32 s50, s88
s_mov_b64 s[52:53], s[90:91]
s_mov_b64 s[54:55], s[92:93]
s_mov_b64 s[86:87], s[94:95]
s_mov_b32 s88, s96
s_mov_b64 s[90:91], s[98:99]
s_mov_b64 s[92:93], s[100:101]
ds_read_b128 v[64:67], v5 offset:4096
s_waitcnt lgkmcnt(6)
v_mfma_f32_32x32x16_bf16 v[16:31], v[248:251], v[72:75], v[16:31]
s_mov_b64 s[94:95], s[38:39]
s_mov_b32 s96, s40
s_mov_b64 s[98:99], s[42:43]
s_mov_b64 s[100:101], s[44:45]
s_mov_b32 s40, 0
s_mov_b32 s44, 1073741824
s_mov_b32 s45, 1073741824
ds_read_b128 v[68:71], v6 offset:4096
s_waitcnt lgkmcnt(6)
v_mfma_f32_32x32x16_bf16 v[16:31], v[252:255], v[76:79], v[16:31]
s_cmp_eq_u32 s36, 0
s_cbranch_scc1 .kv_ex_1019
ds_read_b128 v[72:75], v7 offset:4096
s_waitcnt lgkmcnt(6)
v_mfma_f32_32x32x16_bf16 v[32:47], v[128:131], v[48:51], 0
ds_read_b128 v[76:79], v8 offset:4096
s_waitcnt lgkmcnt(6)
v_mfma_f32_32x32x16_bf16 v[32:47], v[132:135], v[52:55], v[32:47]
ds_read_b128 v[48:51], v5 offset:8192
s_waitcnt lgkmcnt(6)
v_mfma_f32_32x32x16_bf16 v[32:47], v[136:139], v[56:59], v[32:47]
s_sub_u32 s36, s36, 1
ds_read_b128 v[52:55], v6 offset:8192
s_waitcnt lgkmcnt(6)
v_mfma_f32_32x32x16_bf16 v[32:47], v[140:143], v[60:63], v[32:47]
v_cvt_pk_bf16_f32 v16, v16, v17
v_cvt_pk_bf16_f32 v17, v18, v19
ds_read_b128 v[56:59], v7 offset:8192
s_waitcnt lgkmcnt(6)
v_mfma_f32_32x32x16_bf16 v[32:47], v[144:147], v[64:67], v[32:47]
v_cvt_pk_bf16_f32 v18, v20, v21
v_cvt_pk_bf16_f32 v19, v22, v23
ds_read_b128 v[60:63], v8 offset:8192
s_waitcnt lgkmcnt(6)
v_mfma_f32_32x32x16_bf16 v[32:47], v[148:151], v[68:71], v[32:47]
v_cvt_pk_bf16_f32 v20, v24, v25
v_cvt_pk_bf16_f32 v21, v26, v27
ds_read_b128 v[64:67], v5 offset:12288
s_waitcnt lgkmcnt(6)
v_mfma_f32_32x32x16_bf16 v[32:47], v[152:155], v[72:75], v[32:47]
v_cvt_pk_bf16_f32 v22, v28, v29
v_cvt_pk_bf16_f32 v23, v30, v31
ds_read_b128 v[68:71], v6 offset:12288
s_waitcnt lgkmcnt(6)
v_mfma_f32_32x32x16_bf16 v[32:47], v[156:159], v[76:79], v[32:47]
buffer_store_dwordx4 v[16:19], v9, s[12:15], s35 offen sc1
ds_read_b128 v[72:75], v7 offset:12288
s_waitcnt lgkmcnt(6)
v_mfma_f32_32x32x16_bf16 v[32:47], v[160:163], v[48:51], v[32:47]
buffer_store_dwordx4 v[20:23], v10, s[12:15], s35 offen sc1
ds_read_b128 v[76:79], v8 offset:12288
s_waitcnt lgkmcnt(6)
v_mfma_f32_32x32x16_bf16 v[32:47], v[164:167], v[52:55], v[32:47]
s_add_u32 s35, s35, 0x2000
ds_read_b128 v[48:51], v5 offset:16384
s_waitcnt lgkmcnt(6)
v_mfma_f32_32x32x16_bf16 v[32:47], v[168:171], v[56:59], v[32:47]
ds_read_b128 v[52:55], v6 offset:16384
s_waitcnt lgkmcnt(6)
v_mfma_f32_32x32x16_bf16 v[32:47], v[172:175], v[60:63], v[32:47]
ds_read_b128 v[56:59], v7 offset:16384
s_waitcnt lgkmcnt(6)
v_mfma_f32_32x32x16_bf16 v[32:47], v[176:179], v[64:67], v[32:47]
ds_read_b128 v[60:63], v8 offset:16384
s_waitcnt lgkmcnt(6)
v_mfma_f32_32x32x16_bf16 v[32:47], v[180:183], v[68:71], v[32:47]
ds_read_b128 v[64:67], v5 offset:20480
s_waitcnt lgkmcnt(6)
v_mfma_f32_32x32x16_bf16 v[32:47], v[184:187], v[72:75], v[32:47]
ds_read_b128 v[68:71], v6 offset:20480
s_waitcnt lgkmcnt(6)
v_mfma_f32_32x32x16_bf16 v[32:47], v[188:191], v[76:79], v[32:47]
ds_read_b128 v[72:75], v7 offset:20480
s_waitcnt lgkmcnt(6)
v_mfma_f32_32x32x16_bf16 v[32:47], v[192:195], v[48:51], v[32:47]
ds_read_b128 v[76:79], v8 offset:20480
s_waitcnt lgkmcnt(6)
v_mfma_f32_32x32x16_bf16 v[32:47], v[196:199], v[52:55], v[32:47]
ds_read_b128 v[48:51], v5 offset:24576
s_waitcnt lgkmcnt(6)
v_mfma_f32_32x32x16_bf16 v[32:47], v[200:203], v[56:59], v[32:47]
ds_read_b128 v[52:55], v6 offset:24576
s_waitcnt lgkmcnt(6)
v_mfma_f32_32x32x16_bf16 v[32:47], v[204:207], v[60:63], v[32:47]
ds_read_b128 v[56:59], v7 offset:24576
s_waitcnt lgkmcnt(6)
v_mfma_f32_32x32x16_bf16 v[32:47], v[208:211], v[64:67], v[32:47]
s_waitcnt vmcnt(16)
s_barrier
ds_read_b128 v[60:63], v8 offset:24576
s_waitcnt lgkmcnt(6)
s_add_u32 m0, s32, s60
v_mfma_f32_32x32x16_bf16 v[32:47], v[212:215], v[68:71], v[32:47]
buffer_load_dwordx4 v1, s[4:7], s31 offen lds
ds_read_b128 v[64:67], v5 offset:28672
s_waitcnt lgkmcnt(6)
s_add_u32 m0, s32, s61
v_mfma_f32_32x32x16_bf16 v[32:47], v[216:219], v[72:75], v[32:47]
buffer_load_dwordx4 v2, s[4:7], s31 offen lds
ds_read_b128 v[68:71], v6 offset:28672
s_waitcnt lgkmcnt(6)
s_add_u32 m0, s32, s62
v_mfma_f32_32x32x16_bf16 v[32:47], v[220:223], v[76:79], v[32:47]
buffer_load_dwordx4 v3, s[4:7], s31 offen lds
ds_read_b128 v[72:75], v7 offset:28672
s_waitcnt lgkmcnt(6)
s_add_u32 m0, s32, s63
v_mfma_f32_32x32x16_bf16 v[32:47], v[224:227], v[48:51], v[32:47]
buffer_load_dwordx4 v4, s[4:7], s31 offen lds
ds_read_b128 v[76:79], v8 offset:28672
s_waitcnt lgkmcnt(6)
v_mfma_f32_32x32x16_bf16 v[32:47], v[228:231], v[52:55], v[32:47]
s_add_u32 s31, s31, 0x8000
s_add_u32 s32, s32, 0x8000
s_and_b32 s32, s32, 0x1ffff
s_mov_b32 s16, 0
v_add_u32 v5, s37, v5
v_add_u32 v6, s37, v6
v_add_u32 v7, s37, v7
v_add_u32 v8, s37, v8
s_xor_b32 s37, s37, 0xfffe0000
ds_read_b128 v[48:51], v5 offset:0
s_waitcnt lgkmcnt(6)
v_mfma_f32_32x32x16_bf16 v[32:47], v[232:235], v[56:59], v[32:47]
ds_read_b128 v[52:55], v6 offset:0
s_waitcnt lgkmcnt(6)
v_mfma_f32_32x32x16_bf16 v[32:47], v[236:239], v[60:63], v[32:47]
ds_read_b128 v[56:59], v7 offset:0
s_waitcnt lgkmcnt(6)
v_mfma_f32_32x32x16_bf16 v[32:47], v[240:243], v[64:67], v[32:47]
ds_read_b128 v[60:63], v8 offset:0
s_waitcnt lgkmcnt(6)
v_mfma_f32_32x32x16_bf16 v[32:47], v[244:247], v[68:71], v[32:47]
ds_read_b128 v[64:67], v5 offset:4096
s_waitcnt lgkmcnt(6)
v_mfma_f32_32x32x16_bf16 v[32:47], v[248:251], v[72:75], v[32:47]
ds_read_b128 v[68:71], v6 offset:4096
s_waitcnt lgkmcnt(6)
v_mfma_f32_32x32x16_bf16 v[32:47], v[252:255], v[76:79], v[32:47]
s_cmp_eq_u32 s36, 0
s_cbranch_scc0 .kv_loop_1018
s_cmp_lg_u32 s20, 0
s_cbranch_scc1 .pw_1024
s_mov_b32 s63, 0
s_mov_b32 s60, 0x0
s_mov_b32 s61, 0x7f8000
v_lshlrev_b32 v111, 2, v0
v_mov_b32 v110, 0
s_mov_b64 exec, s[60:61]
buffer_atomic_or v110, v111, s[56:59], 0 offen sc0 sc1
s_mov_b64 exec, -1
.pw_1024:
s_nop 7
v_cvt_pk_bf16_f32 v32, v32, v33
v_cvt_pk_bf16_f32 v33, v34, v35
v_cvt_pk_bf16_f32 v34, v36, v37
v_cvt_pk_bf16_f32 v35, v38, v39
v_cvt_pk_bf16_f32 v36, v40, v41
v_cvt_pk_bf16_f32 v37, v42, v43
v_cvt_pk_bf16_f32 v38, v44, v45
v_cvt_pk_bf16_f32 v39, v46, v47
buffer_store_dwordx4 v[32:35], v9, s[12:15], s35 offen sc1
buffer_store_dwordx4 v[36:39], v10, s[12:15], s35 offen sc1
s_branch .kv_done_1017
.kv_ex_1019:
s_cmp_lg_u32 s20, 0
s_cbranch_scc1 .pw_1025
s_mov_b32 s63, 0
s_mov_b32 s60, 0x0
s_mov_b32 s61, 0x7f8000
v_lshlrev_b32 v111, 2, v0
v_mov_b32 v110, 0
s_mov_b64 exec, s[60:61]
buffer_atomic_or v110, v111, s[56:59], 0 offen sc0 sc1
s_mov_b64 exec, -1
.pw_1025:
s_nop 7
v_cvt_pk_bf16_f32 v16, v16, v17
v_cvt_pk_bf16_f32 v17, v18, v19
v_cvt_pk_bf16_f32 v18, v20, v21
v_cvt_pk_bf16_f32 v19, v22, v23
v_cvt_pk_bf16_f32 v20, v24, v25
v_cvt_pk_bf16_f32 v21, v26, v27
v_cvt_pk_bf16_f32 v22, v28, v29
v_cvt_pk_bf16_f32 v23, v30, v31
buffer_store_dwordx4 v[16:19], v9, s[12:15], s35 offen sc1
buffer_store_dwordx4 v[20:23], v10, s[12:15], s35 offen sc1
s_branch .kv_done_1017
.kv_v_1016:
s_waitcnt vmcnt(23)
ds_write_b128 v12, v[128:131]
ds_read_b64_tr_b16 v[128:129], v13
ds_read_b64_tr_b16 v[130:131], v13 offset:256
s_waitcnt vmcnt(22)
ds_write_b128 v12, v[132:135]
ds_read_b64_tr_b16 v[132:133], v13
ds_read_b64_tr_b16 v[134:135], v13 offset:256
s_waitcnt vmcnt(12)
s_barrier
ds_read_b128 v[48:51], v5 offset:0
ds_read_b128 v[52:55], v5 offset:32768
ds_read_b128 v[56:59], v6 offset:0
ds_read_b128 v[60:63], v6 offset:32768
ds_read_b128 v[64:67], v7 offset:0
ds_read_b128 v[68:71], v7 offset:32768
ds_write_b128 v12, v[136:139]
ds_read_b64_tr_b16 v[136:137], v13
ds_read_b64_tr_b16 v[138:139], v13 offset:256
s_waitcnt lgkmcnt(7)
v_mfma_f32_32x32x16_bf16 v[16:31], v[48:51], v[128:131], 0
buffer_load_dwordx4 v[192:195], v11, s[8:11], s34 offen
s_add_u32 s34, s34, 0x20000
v_mfma_f32_32x32x16_bf16 v[32:47], v[52:55], v[128:131], 0
ds_read_b128 v[72:75], v8 offset:0
ds_read_b128 v[76:79], v8 offset:32768
ds_write_b128 v12, v[140:143]
ds_read_b64_tr_b16 v[140:141], v13
ds_read_b64_tr_b16 v[142:143], v13 offset:256
s_waitcnt lgkmcnt(10)
v_mfma_f32_32x32x16_bf16 v[16:31], v[56:59], v[132:135], v[16:31]
buffer_load_dwordx4 v[196:199], v11, s[8:11], s34 offen
s_add_u32 s34, s34, 0x20000
v_mfma_f32_32x32x16_bf16 v[32:47], v[60:63], v[132:135], v[32:47]
ds_read_b128 v[48:51], v5 offset:4096
ds_read_b128 v[52:55], v5 offset:36864
s_waitcnt vmcnt(13)
ds_write_b128 v12, v[144:147]
ds_read_b64_tr_b16 v[144:145], v13
ds_read_b64_tr_b16 v[146:147], v13 offset:256
s_waitcnt lgkmcnt(10)
v_mfma_f32_32x32x16_bf16 v[16:31], v[64:67], v[136:139], v[16:31]
buffer_load_dwordx4 v[200:203], v11, s[8:11], s34 offen
s_add_u32 s34, s34, 0x20000
v_mfma_f32_32x32x16_bf16 v[32:47], v[68:71], v[136:139], v[32:47]
ds_read_b128 v[56:59], v6 offset:4096
ds_read_b128 v[60:63], v6 offset:36864
s_waitcnt vmcnt(13)
ds_write_b128 v12, v[148:151]
ds_read_b64_tr_b16 v[148:149], v13
ds_read_b64_tr_b16 v[150:151], v13 offset:256
s_waitcnt lgkmcnt(10)
v_mfma_f32_32x32x16_bf16 v[16:31], v[72:75], v[140:143], v[16:31]
buffer_load_dwordx4 v[204:207], v11, s[8:11], s34 offen
s_add_u32 s34, s34, 0x20000
s_and_b32 s34, s34, 0x3fffff
v_mfma_f32_32x32x16_bf16 v[32:47], v[76:79], v[140:143], v[32:47]
ds_read_b128 v[64:67], v7 offset:4096
ds_read_b128 v[68:71], v7 offset:36864
s_waitcnt vmcnt(13)
ds_write_b128 v12, v[152:155]
ds_read_b64_tr_b16 v[152:153], v13
ds_read_b64_tr_b16 v[154:155], v13 offset:256
s_waitcnt lgkmcnt(10)
v_mfma_f32_32x32x16_bf16 v[16:31], v[48:51], v[144:147], v[16:31]
buffer_load_dwordx4 v[208:211], v11, s[8:11], s34 offen
s_add_u32 s34, s34, 0x20000
v_mfma_f32_32x32x16_bf16 v[32:47], v[52:55], v[144:147], v[32:47]
ds_read_b128 v[72:75], v8 offset:4096
ds_read_b128 v[76:79], v8 offset:36864
s_waitcnt vmcnt(13)
ds_write_b128 v12, v[156:159]
ds_read_b64_tr_b16 v[156:157], v13
ds_read_b64_tr_b16 v[158:159], v13 offset:256
s_waitcnt lgkmcnt(10)
v_mfma_f32_32x32x16_bf16 v[16:31], v[56:59], v[148:151], v[16:31]
buffer_load_dwordx4 v[212:215], v11, s[8:11], s34 offen
s_add_u32 s34, s34, 0x20000
v_mfma_f32_32x32x16_bf16 v[32:47], v[60:63], v[148:151], v[32:47]
ds_read_b128 v[48:51], v5 offset:8192
ds_read_b128 v[52:55], v5 offset:40960
s_waitcnt vmcnt(13)
ds_write_b128 v12, v[160:163]
ds_read_b64_tr_b16 v[160:161], v13
ds_read_b64_tr_b16 v[162:163], v13 offset:256
s_waitcnt lgkmcnt(10)
v_mfma_f32_32x32x16_bf16 v[16:31], v[64:67], v[152:155], v[16:31]
buffer_load_dwordx4 v[216:219], v11, s[8:11], s34 offen
s_add_u32 s34, s34, 0x20000
v_mfma_f32_32x32x16_bf16 v[32:47], v[68:71], v[152:155], v[32:47]
ds_read_b128 v[56:59], v6 offset:8192
ds_read_b128 v[60:63], v6 offset:40960
s_waitcnt vmcnt(13)
ds_write_b128 v12, v[164:167]
ds_read_b64_tr_b16 v[164:165], v13
ds_read_b64_tr_b16 v[166:167], v13 offset:256
s_waitcnt lgkmcnt(10)
v_mfma_f32_32x32x16_bf16 v[16:31], v[72:75], v[156:159], v[16:31]
buffer_load_dwordx4 v[220:223], v11, s[8:11], s34 offen
s_add_u32 s34, s34, 0x20000
s_and_b32 s34, s34, 0x3fffff
v_mfma_f32_32x32x16_bf16 v[32:47], v[76:79], v[156:159], v[32:47]
ds_read_b128 v[64:67], v7 offset:8192
ds_read_b128 v[68:71], v7 offset:40960
s_waitcnt vmcnt(13)
ds_write_b128 v12, v[168:171]
ds_read_b64_tr_b16 v[168:169], v13
ds_read_b64_tr_b16 v[170:171], v13 offset:256
s_waitcnt lgkmcnt(10)
v_mfma_f32_32x32x16_bf16 v[16:31], v[48:51], v[160:163], v[16:31]
buffer_load_dwordx4 v[224:227], v11, s[8:11], s34 offen
s_add_u32 s34, s34, 0x20000
v_mfma_f32_32x32x16_bf16 v[32:47], v[52:55], v[160:163], v[32:47]
ds_read_b128 v[72:75], v8 offset:8192
ds_read_b128 v[76:79], v8 offset:40960
s_waitcnt vmcnt(13)
ds_write_b128 v12, v[172:175]
ds_read_b64_tr_b16 v[172:173], v13
ds_read_b64_tr_b16 v[174:175], v13 offset:256
s_waitcnt lgkmcnt(10)
v_mfma_f32_32x32x16_bf16 v[16:31], v[56:59], v[164:167], v[16:31]
buffer_load_dwordx4 v[228:231], v11, s[8:11], s34 offen
s_add_u32 s34, s34, 0x20000
v_mfma_f32_32x32x16_bf16 v[32:47], v[60:63], v[164:167], v[32:47]
ds_read_b128 v[48:51], v5 offset:12288
ds_read_b128 v[52:55], v5 offset:45056
s_waitcnt vmcnt(13)
ds_write_b128 v12, v[176:179]
ds_read_b64_tr_b16 v[176:177], v13
ds_read_b64_tr_b16 v[178:179], v13 offset:256
s_waitcnt lgkmcnt(10)
v_mfma_f32_32x32x16_bf16 v[16:31], v[64:67], v[168:171], v[16:31]
buffer_load_dwordx4 v[232:235], v11, s[8:11], s34 offen
s_add_u32 s34, s34, 0x20000
v_mfma_f32_32x32x16_bf16 v[32:47], v[68:71], v[168:171], v[32:47]
ds_read_b128 v[56:59], v6 offset:12288
ds_read_b128 v[60:63], v6 offset:45056
s_waitcnt vmcnt(13)
ds_write_b128 v12, v[180:183]
ds_read_b64_tr_b16 v[180:181], v13
ds_read_b64_tr_b16 v[182:183], v13 offset:256
s_waitcnt lgkmcnt(10)
v_mfma_f32_32x32x16_bf16 v[16:31], v[72:75], v[172:175], v[16:31]
buffer_load_dwordx4 v[236:239], v11, s[8:11], s34 offen
s_add_u32 s34, s34, 0x20000
s_and_b32 s34, s34, 0x3fffff
v_mfma_f32_32x32x16_bf16 v[32:47], v[76:79], v[172:175], v[32:47]
ds_read_b128 v[64:67], v7 offset:12288
ds_read_b128 v[68:71], v7 offset:45056
s_waitcnt vmcnt(13)
ds_write_b128 v12, v[184:187]
ds_read_b64_tr_b16 v[184:185], v13
ds_read_b64_tr_b16 v[186:187], v13 offset:256
s_waitcnt lgkmcnt(10)
v_mfma_f32_32x32x16_bf16 v[16:31], v[48:51], v[176:179], v[16:31]
buffer_load_dwordx4 v[240:243], v11, s[8:11], s34 offen
s_add_u32 s34, s34, 0x20000
v_mfma_f32_32x32x16_bf16 v[32:47], v[52:55], v[176:179], v[32:47]
ds_read_b128 v[72:75], v8 offset:12288
ds_read_b128 v[76:79], v8 offset:45056
s_waitcnt vmcnt(13)
ds_write_b128 v12, v[188:191]
ds_read_b64_tr_b16 v[188:189], v13
ds_read_b64_tr_b16 v[190:191], v13 offset:256
s_waitcnt lgkmcnt(10)
v_mfma_f32_32x32x16_bf16 v[16:31], v[56:59], v[180:183], v[16:31]
buffer_load_dwordx4 v[244:247], v11, s[8:11], s34 offen
s_add_u32 s34, s34, 0x20000
v_mfma_f32_32x32x16_bf16 v[32:47], v[60:63], v[180:183], v[32:47]
ds_read_b128 v[48:51], v5 offset:16384
ds_read_b128 v[52:55], v5 offset:49152
s_waitcnt vmcnt(13)
ds_write_b128 v12, v[192:195]
ds_read_b64_tr_b16 v[192:193], v13
ds_read_b64_tr_b16 v[194:195], v13 offset:256
s_waitcnt lgkmcnt(10)
v_mfma_f32_32x32x16_bf16 v[16:31], v[64:67], v[184:187], v[16:31]
buffer_load_dwordx4 v[248:251], v11, s[8:11], s34 offen
s_add_u32 s34, s34, 0x20000
v_mfma_f32_32x32x16_bf16 v[32:47], v[68:71], v[184:187], v[32:47]
ds_read_b128 v[56:59], v6 offset:16384
ds_read_b128 v[60:63], v6 offset:49152
s_waitcnt vmcnt(13)
ds_write_b128 v12, v[196:199]
ds_read_b64_tr_b16 v[196:197], v13
ds_read_b64_tr_b16 v[198:199], v13 offset:256
s_waitcnt lgkmcnt(10)
v_mfma_f32_32x32x16_bf16 v[16:31], v[72:75], v[188:191], v[16:31]
buffer_load_dwordx4 v[252:255], v11, s[8:11], s34 offen
s_add_u32 s34, s34, 0x20000
s_and_b32 s34, s34, 0x3fffff
v_mfma_f32_32x32x16_bf16 v[32:47], v[76:79], v[188:191], v[32:47]
ds_read_b128 v[64:67], v7 offset:16384
ds_read_b128 v[68:71], v7 offset:49152
s_waitcnt vmcnt(13)
ds_write_b128 v12, v[200:203]
ds_read_b64_tr_b16 v[200:201], v13
ds_read_b64_tr_b16 v[202:203], v13 offset:256
s_waitcnt lgkmcnt(10)
s_add_u32 m0, s61, 65536
v_mfma_f32_32x32x16_bf16 v[16:31], v[48:51], v[192:195], v[16:31]
v_mfma_f32_32x32x16_bf16 v[32:47], v[52:55], v[192:195], v[32:47]
buffer_load_dwordx4 v2, s[4:7], s66 offen lds
ds_read_b128 v[72:75], v8 offset:16384
ds_read_b128 v[76:79], v8 offset:49152
s_waitcnt vmcnt(13)
ds_write_b128 v12, v[204:207]
ds_read_b64_tr_b16 v[204:205], v13
ds_read_b64_tr_b16 v[206:207], v13 offset:256
s_waitcnt lgkmcnt(10)
s_add_u32 m0, s62, 65536
v_mfma_f32_32x32x16_bf16 v[16:31], v[56:59], v[196:199], v[16:31]
v_mfma_f32_32x32x16_bf16 v[32:47], v[60:63], v[196:199], v[32:47]
buffer_load_dwordx4 v3, s[4:7], s66 offen lds
ds_read_b128 v[48:51], v5 offset:20480
ds_read_b128 v[52:55], v5 offset:53248
s_waitcnt vmcnt(13)
ds_write_b128 v12, v[208:211]
ds_read_b64_tr_b16 v[208:209], v13
ds_read_b64_tr_b16 v[210:211], v13 offset:256
s_waitcnt lgkmcnt(10)
s_add_u32 m0, s63, 65536
v_mfma_f32_32x32x16_bf16 v[16:31], v[64:67], v[200:203], v[16:31]
v_mfma_f32_32x32x16_bf16 v[32:47], v[68:71], v[200:203], v[32:47]
buffer_load_dwordx4 v4, s[4:7], s66 offen lds
ds_read_b128 v[56:59], v6 offset:20480
ds_read_b128 v[60:63], v6 offset:53248
s_waitcnt vmcnt(13)
ds_write_b128 v12, v[212:215]
ds_read_b64_tr_b16 v[212:213], v13
ds_read_b64_tr_b16 v[214:215], v13 offset:256
s_waitcnt lgkmcnt(10)
s_add_u32 m0, s61, 98304
v_mfma_f32_32x32x16_bf16 v[16:31], v[72:75], v[204:207], v[16:31]
v_mfma_f32_32x32x16_bf16 v[32:47], v[76:79], v[204:207], v[32:47]
buffer_load_dwordx4 v2, s[4:7], s67 offen lds
ds_read_b128 v[64:67], v7 offset:20480
ds_read_b128 v[68:71], v7 offset:53248
s_waitcnt vmcnt(13)
ds_write_b128 v12, v[216:219]
ds_read_b64_tr_b16 v[216:217], v13
ds_read_b64_tr_b16 v[218:219], v13 offset:256
s_waitcnt lgkmcnt(10)
s_add_u32 m0, s62, 98304
v_mfma_f32_32x32x16_bf16 v[16:31], v[48:51], v[208:211], v[16:31]
v_mfma_f32_32x32x16_bf16 v[32:47], v[52:55], v[208:211], v[32:47]
buffer_load_dwordx4 v3, s[4:7], s67 offen lds
ds_read_b128 v[72:75], v8 offset:20480
ds_read_b128 v[76:79], v8 offset:53248
s_waitcnt vmcnt(13)
ds_write_b128 v12, v[220:223]
ds_read_b64_tr_b16 v[220:221], v13
ds_read_b64_tr_b16 v[222:223], v13 offset:256
s_waitcnt lgkmcnt(10)
s_add_u32 m0, s63, 98304
v_mfma_f32_32x32x16_bf16 v[16:31], v[56:59], v[212:215], v[16:31]
v_mfma_f32_32x32x16_bf16 v[32:47], v[60:63], v[212:215], v[32:47]
buffer_load_dwordx4 v4, s[4:7], s67 offen lds
ds_read_b128 v[48:51], v5 offset:24576
ds_read_b128 v[52:55], v5 offset:57344
s_waitcnt vmcnt(13)
ds_write_b128 v12, v[224:227]
ds_read_b64_tr_b16 v[224:225], v13
ds_read_b64_tr_b16 v[226:227], v13 offset:256
s_waitcnt lgkmcnt(10)
v_mfma_f32_32x32x16_bf16 v[16:31], v[64:67], v[216:219], v[16:31]
v_mfma_f32_32x32x16_bf16 v[32:47], v[68:71], v[216:219], v[32:47]
buffer_load_dword v107, v107, s[4:7], s31 offen
ds_read_b128 v[56:59], v6 offset:24576
ds_read_b128 v[60:63], v6 offset:57344
s_waitcnt vmcnt(13)
ds_write_b128 v12, v[228:231]
ds_read_b64_tr_b16 v[228:229], v13
ds_read_b64_tr_b16 v[230:231], v13 offset:256
s_waitcnt lgkmcnt(10)
v_mfma_f32_32x32x16_bf16 v[16:31], v[72:75], v[220:223], v[16:31]
v_mad_u32_u24 v100, v104, s52, v105
s_lshl_b32 s17, s52, 3
s_lshl_b32 s18, s17, 1
s_add_u32 s19, s17, s18
v_mfma_f32_32x32x16_bf16 v[32:47], v[76:79], v[220:223], v[32:47]
buffer_load_dwordx4 v[80:83], v100, s[48:51], 0 offen
ds_read_b128 v[64:67], v7 offset:24576
ds_read_b128 v[68:71], v7 offset:57344
s_waitcnt vmcnt(13)
ds_write_b128 v12, v[232:235]
ds_read_b64_tr_b16 v[232:233], v13
ds_read_b64_tr_b16 v[234:235], v13 offset:256
s_waitcnt lgkmcnt(10)
v_mfma_f32_32x32x16_bf16 v[16:31], v[48:51], v[224:227], v[16:31]
buffer_load_dwordx4 v[84:87], v100, s[48:51], s17 offen
v_mfma_f32_32x32x16_bf16 v[32:47], v[52:55], v[224:227], v[32:47]
buffer_load_dwordx4 v[88:91], v100, s[48:51], s18 offen
ds_read_b128 v[72:75], v8 offset:24576
ds_read_b128 v[76:79], v8 offset:57344
s_waitcnt vmcnt(14)
ds_write_b128 v12, v[236:239]
ds_read_b64_tr_b16 v[236:237], v13
ds_read_b64_tr_b16 v[238:239], v13 offset:256
s_waitcnt lgkmcnt(10)
v_mfma_f32_32x32x16_bf16 v[16:31], v[56:59], v[228:231], v[16:31]
buffer_load_dwordx4 v[92:95], v100, s[48:51], s19 offen
v_mfma_f32_32x32x16_bf16 v[32:47], v[60:63], v[228:231], v[32:47]
s_mov_b64 s[22:23], s[54:55]
s_cmp_eq_u32 s53, 0
s_cselect_b32 s17, 9, 11
s_cselect_b32 s18, 5, 9
s_cselect_b32 s19, 64, 32
s_cselect_b32 s30, 0x800, 64
ds_read_b128 v[48:51], v5 offset:28672
ds_read_b128 v[52:55], v5 offset:61440
s_waitcnt vmcnt(14)
ds_write_b128 v12, v[240:243]
ds_read_b64_tr_b16 v[240:241], v13
ds_read_b64_tr_b16 v[242:243], v13 offset:256
s_waitcnt lgkmcnt(10)
v_mfma_f32_32x32x16_bf16 v[16:31], v[64:67], v[232:235], v[16:31]
v_lshlrev_b32 v97, s17, v101
v_lshlrev_b32 v98, s18, v102
v_add3_u32 v96, v97, v98, v103
v_mfma_f32_32x32x16_bf16 v[32:47], v[68:71], v[232:235], v[32:47]
v_add_u32 v97, s19, v96
v_add_u32 v98, s30, v96
v_add_u32 v99, s30, v97
ds_read_b128 v[56:59], v6 offset:28672
ds_read_b128 v[60:63], v6 offset:61440
s_waitcnt vmcnt(13)
ds_write_b128 v12, v[244:247]
ds_read_b64_tr_b16 v[244:245], v13
ds_read_b64_tr_b16 v[246:247], v13 offset:256
s_waitcnt lgkmcnt(10)
v_mfma_f32_32x32x16_bf16 v[16:31], v[72:75], v[236:239], v[16:31]
s_mov_b64 s[48:49], s[86:87]
s_mov_b32 s50, s88
s_mov_b64 s[52:53], s[90:91]
s_mov_b64 s[54:55], s[92:93]
v_mfma_f32_32x32x16_bf16 v[32:47], v[76:79], v[236:239], v[32:47]
s_mov_b64 s[86:87], s[94:95]
s_mov_b32 s88, s96
s_mov_b64 s[90:91], s[98:99]
s_mov_b64 s[92:93], s[100:101]
ds_read_b128 v[64:67], v7 offset:28672
ds_read_b128 v[68:71], v7 offset:61440
s_waitcnt vmcnt(12)
ds_write_b128 v12, v[248:251]
ds_read_b64_tr_b16 v[248:249], v13
ds_read_b64_tr_b16 v[250:251], v13 offset:256
s_waitcnt lgkmcnt(10)
v_mfma_f32_32x32x16_bf16 v[16:31], v[48:51], v[240:243], v[16:31]
s_mov_b64 s[94:95], s[38:39]
s_mov_b32 s96, s40
s_mov_b64 s[98:99], s[42:43]
s_mov_b64 s[100:101], s[44:45]
v_mfma_f32_32x32x16_bf16 v[32:47], v[52:55], v[240:243], v[32:47]
s_mov_b32 s40, 0
s_mov_b32 s44, 1073741824
s_mov_b32 s45, 1073741824
ds_read_b128 v[72:75], v8 offset:28672
ds_read_b128 v[76:79], v8 offset:61440
s_waitcnt vmcnt(11)
ds_write_b128 v12, v[252:255]
ds_read_b64_tr_b16 v[252:253], v13
ds_read_b64_tr_b16 v[254:255], v13 offset:256
s_waitcnt lgkmcnt(10)
v_mfma_f32_32x32x16_bf16 v[16:31], v[56:59], v[244:247], v[16:31]
v_mfma_f32_32x32x16_bf16 v[32:47], v[60:63], v[244:247], v[32:47]
s_waitcnt lgkmcnt(5)
v_mfma_f32_32x32x16_bf16 v[16:31], v[64:67], v[248:251], v[16:31]
v_mfma_f32_32x32x16_bf16 v[32:47], v[68:71], v[248:251], v[32:47]
s_waitcnt lgkmcnt(0)
v_mfma_f32_32x32x16_bf16 v[16:31], v[72:75], v[252:255], v[16:31]
v_mfma_f32_32x32x16_bf16 v[32:47], v[76:79], v[252:255], v[32:47]
v_add_u32 v5, 0x10000, v5
v_add_u32 v6, 0x10000, v6
v_add_u32 v7, 0x10000, v7
v_add_u32 v8, 0x10000, v8
s_waitcnt vmcnt(5)
s_barrier
ds_read_b128 v[48:51], v5 offset:0
ds_read_b128 v[52:55], v6 offset:0
ds_read_b128 v[56:59], v7 offset:0
ds_read_b128 v[60:63], v8 offset:0
ds_read_b128 v[64:67], v5 offset:4096
ds_read_b128 v[68:71], v6 offset:4096
s_mov_b32 m0, s60
v_cvt_pk_bf16_f32 v16, v16, v17
v_cvt_pk_bf16_f32 v17, v18, v19
buffer_load_dwordx4 v1, s[4:7], s31 offen lds
s_mov_b32 m0, s61
v_cvt_pk_bf16_f32 v18, v20, v21
v_cvt_pk_bf16_f32 v19, v22, v23
buffer_load_dwordx4 v2, s[4:7], s31 offen lds
s_mov_b32 m0, s62
v_cvt_pk_bf16_f32 v20, v24, v25
v_cvt_pk_bf16_f32 v21, v26, v27
buffer_load_dwordx4 v3, s[4:7], s31 offen lds
s_mov_b32 m0, s63
v_cvt_pk_bf16_f32 v22, v28, v29
v_cvt_pk_bf16_f32 v23, v30, v31
buffer_load_dwordx4 v4, s[4:7], s31 offen lds
s_add_u32 s31, s31, 0x8000
buffer_store_dwordx4 v[16:19], v9, s[12:15], s35 offen sc1
buffer_store_dwordx4 v[20:23], v10, s[12:15], s35 offen sc1
s_add_u32 s35, s35, 0x2000
.kv_loop_1026:
ds_read_b128 v[72:75], v7 offset:4096
s_waitcnt lgkmcnt(6)
v_mfma_f32_32x32x16_bf16 v[16:31], v[48:51], v[128:131], 0
ds_read_b128 v[76:79], v8 offset:4096
s_waitcnt lgkmcnt(6)
v_mfma_f32_32x32x16_bf16 v[16:31], v[52:55], v[132:135], v[16:31]
ds_read_b128 v[48:51], v5 offset:8192
s_waitcnt lgkmcnt(6)
v_mfma_f32_32x32x16_bf16 v[16:31], v[56:59], v[136:139], v[16:31]
s_sub_u32 s36, s36, 1
ds_read_b128 v[52:55], v6 offset:8192
s_waitcnt lgkmcnt(6)
v_mfma_f32_32x32x16_bf16 v[16:31], v[60:63], v[140:143], v[16:31]
v_cvt_pk_bf16_f32 v32, v32, v33
v_cvt_pk_bf16_f32 v33, v34, v35
ds_read_b128 v[56:59], v7 offset:8192
s_waitcnt lgkmcnt(6)
v_mfma_f32_32x32x16_bf16 v[16:31], v[64:67], v[144:147], v[16:31]
v_cvt_pk_bf16_f32 v34, v36, v37
v_cvt_pk_bf16_f32 v35, v38, v39
ds_read_b128 v[60:63], v8 offset:8192
s_waitcnt lgkmcnt(6)
v_mfma_f32_32x32x16_bf16 v[16:31], v[68:71], v[148:151], v[16:31]
v_cvt_pk_bf16_f32 v36, v40, v41
v_cvt_pk_bf16_f32 v37, v42, v43
ds_read_b128 v[64:67], v5 offset:12288
s_waitcnt lgkmcnt(6)
v_mfma_f32_32x32x16_bf16 v[16:31], v[72:75], v[152:155], v[16:31]
v_cvt_pk_bf16_f32 v38, v44, v45
v_cvt_pk_bf16_f32 v39, v46, v47
ds_read_b128 v[68:71], v6 offset:12288
s_waitcnt lgkmcnt(6)
v_mfma_f32_32x32x16_bf16 v[16:31], v[76:79], v[156:159], v[16:31]
buffer_store_dwordx4 v[32:35], v9, s[12:15], s35 offen sc1
ds_read_b128 v[72:75], v7 offset:12288
s_waitcnt lgkmcnt(6)
v_mfma_f32_32x32x16_bf16 v[16:31], v[48:51], v[160:163], v[16:31]
buffer_store_dwordx4 v[36:39], v10, s[12:15], s35 offen sc1
ds_read_b128 v[76:79], v8 offset:12288
s_waitcnt lgkmcnt(6)
v_mfma_f32_32x32x16_bf16 v[16:31], v[52:55], v[164:167], v[16:31]
s_add_u32 s35, s35, 0x2000
s_waitcnt vmcnt(8)
ds_write_b128 v12, v[80:83] offset:0
ds_write_b128 v12, v[84:87] offset:1024
ds_read_b128 v[48:51], v5 offset:16384
s_waitcnt lgkmcnt(8)
v_mfma_f32_32x32x16_bf16 v[16:31], v[56:59], v[168:171], v[16:31]
ds_write_b128 v12, v[88:91] offset:2048
ds_write_b128 v12, v[92:95] offset:3072
ds_read_b128 v[52:55], v6 offset:16384
s_waitcnt lgkmcnt(10)
v_mfma_f32_32x32x16_bf16 v[16:31], v[60:63], v[172:175], v[16:31]
ds_read_b64_tr_b16 v[80:81], v96
ds_read_b64_tr_b16 v[82:83], v96 offset:1024
ds_read_b128 v[56:59], v7 offset:16384
s_waitcnt lgkmcnt(12)
v_mfma_f32_32x32x16_bf16 v[16:31], v[64:67], v[176:179], v[16:31]
ds_read_b64_tr_b16 v[84:85], v97
ds_read_b64_tr_b16 v[86:87], v97 offset:1024
ds_read_b128 v[60:63], v8 offset:16384
s_waitcnt lgkmcnt(14)
v_mfma_f32_32x32x16_bf16 v[16:31], v[68:71], v[180:183], v[16:31]
ds_read_b64_tr_b16 v[88:89], v98
ds_read_b64_tr_b16 v[90:91], v98 offset:1024
ds_read_b128 v[64:67], v5 offset:20480
s_waitcnt lgkmcnt(15)
v_mfma_f32_32x32x16_bf16 v[16:31], v[72:75], v[184:187], v[16:31]
ds_read_b64_tr_b16 v[92:93], v99
ds_read_b64_tr_b16 v[94:95], v99 offset:1024
ds_read_b128 v[68:71], v6 offset:20480
v_mfma_f32_32x32x16_bf16 v[16:31], v[76:79], v[188:191], v[16:31]
ds_read_b128 v[72:75], v7 offset:20480
s_waitcnt lgkmcnt(15)
v_mfma_f32_32x32x16_bf16 v[16:31], v[48:51], v[192:195], v[16:31]
s_waitcnt lgkmcnt(11)
buffer_store_dwordx4 v[80:83], v106, s[24:27], s22 offen offset:0 sc1
ds_read_b128 v[76:79], v8 offset:20480
v_mfma_f32_32x32x16_bf16 v[16:31], v[52:55], v[196:199], v[16:31]
s_waitcnt lgkmcnt(9)
buffer_store_dwordx4 v[84:87], v106, s[24:27], s22 offen offset:1024 sc1
ds_read_b128 v[48:51], v5 offset:24576
v_mfma_f32_32x32x16_bf16 v[16:31], v[56:59], v[200:203], v[16:31]
s_waitcnt lgkmcnt(7)
buffer_store_dwordx4 v[88:91], v106, s[24:27], s23 offen offset:0 sc1
ds_read_b128 v[52:55], v6 offset:24576
v_mfma_f32_32x32x16_bf16 v[16:31], v[60:63], v[204:207], v[16:31]
s_waitcnt lgkmcnt(5)
buffer_store_dwordx4 v[92:95], v106, s[24:27], s23 offen offset:1024 sc1
ds_read_b128 v[56:59], v7 offset:24576
v_mfma_f32_32x32x16_bf16 v[16:31], v[64:67], v[208:211], v[16:31]
s_cmp_lg_u32 s16, 0
s_cbranch_scc1 .kv_sk_1030
.kv_sk_1030:
s_barrier
s_or_b32 s47, s20, s16
s_cbranch_scc1 .sig_1031
v_lshlrev_b32 v108, 12, v0
v_lshlrev_b32_e64 v109, s2, 1
buffer_atomic_or v109, v108, s[56:59], s46 offen offset:0 sc1
.sig_1031:
s_add_u32 s46, s46, 32
ds_read_b128 v[60:63], v8 offset:24576
s_waitcnt lgkmcnt(6)
s_add_u32 m0, s32, s60
v_mfma_f32_32x32x16_bf16 v[16:31], v[68:71], v[212:215], v[16:31]
buffer_load_dwordx4 v1, s[4:7], s31 offen lds
ds_read_b128 v[64:67], v5 offset:28672
s_waitcnt lgkmcnt(6)
s_add_u32 m0, s32, s61
v_mfma_f32_32x32x16_bf16 v[16:31], v[72:75], v[216:219], v[16:31]
buffer_load_dwordx4 v2, s[4:7], s31 offen lds
ds_read_b128 v[68:71], v6 offset:28672
s_waitcnt lgkmcnt(6)
s_add_u32 m0, s32, s62
v_mfma_f32_32x32x16_bf16 v[16:31], v[76:79], v[220:223], v[16:31]
buffer_load_dwordx4 v3, s[4:7], s31 offen lds
ds_read_b128 v[72:75], v7 offset:28672
s_waitcnt lgkmcnt(6)
s_add_u32 m0, s32, s63
v_mfma_f32_32x32x16_bf16 v[16:31], v[48:51], v[224:227], v[16:31]
buffer_load_dwordx4 v4, s[4:7], s31 offen lds
ds_read_b128 v[76:79], v8 offset:28672
s_waitcnt lgkmcnt(6)
v_mfma_f32_32x32x16_bf16 v[16:31], v[52:55], v[228:231], v[16:31]
s_add_u32 s31, s31, 0x8000
s_add_u32 s32, s32, 0x8000
s_and_b32 s32, s32, 0x1ffff
s_mov_b32 s16, 0
v_mad_u32_u24 v100, v104, s52, v105
s_lshl_b32 s17, s52, 3
s_lshl_b32 s18, s17, 1
s_add_u32 s19, s17, s18
buffer_load_dwordx4 v[80:83], v100, s[48:51], 0 offen
v_add_u32 v5, 0x8000, v5
v_add_u32 v6, 0x8000, v6
v_add_u32 v7, 0x8000, v7
v_add_u32 v8, 0x8000, v8
ds_read_b128 v[48:51], v5 offset:0
s_waitcnt lgkmcnt(6)
v_mfma_f32_32x32x16_bf16 v[16:31], v[56:59], v[232:235], v[16:31]
buffer_load_dwordx4 v[84:87], v100, s[48:51], s17 offen
buffer_load_dwordx4 v[88:91], v100, s[48:51], s18 offen
ds_read_b128 v[52:55], v6 offset:0
s_waitcnt lgkmcnt(6)
v_mfma_f32_32x32x16_bf16 v[16:31], v[60:63], v[236:239], v[16:31]
buffer_load_dwordx4 v[92:95], v100, s[48:51], s19 offen
s_mov_b64 s[22:23], s[54:55]
s_cmp_eq_u32 s53, 0
s_cselect_b32 s17, 9, 11
s_cselect_b32 s18, 5, 9
s_cselect_b32 s19, 64, 32
s_cselect_b32 s30, 0x800, 64
ds_read_b128 v[56:59], v7 offset:0
s_waitcnt lgkmcnt(6)
v_mfma_f32_32x32x16_bf16 v[16:31], v[64:67], v[240:243], v[16:31]
v_lshlrev_b32 v97, s17, v101
v_lshlrev_b32 v98, s18, v102
v_add3_u32 v96, v97, v98, v103
v_add_u32 v97, s19, v96
v_add_u32 v98, s30, v96
v_add_u32 v99, s30, v97
ds_read_b128 v[60:63], v8 offset:0
s_waitcnt lgkmcnt(6)
v_mfma_f32_32x32x16_bf16 v[16:31], v[68:71], v[244:247], v[16:31]
s_mov_b64 s[48:49], s[86:87]
s_mov_b32 s50, s88
s_mov_b64 s[52:53], s[90:91]
s_mov_b64 s[54:55], s[92:93]
s_mov_b64 s[86:87], s[94:95]
s_mov_b32 s88, s96
s_mov_b64 s[90:91], s[98:99]
s_mov_b64 s[92:93], s[100:101]
ds_read_b128 v[64:67], v5 offset:4096
s_waitcnt lgkmcnt(6)
v_mfma_f32_32x32x16_bf16 v[16:31], v[72:75], v[248:251], v[16:31]
s_mov_b64 s[94:95], s[38:39]
s_mov_b32 s96, s40
s_mov_b64 s[98:99], s[42:43]
s_mov_b64 s[100:101], s[44:45]
s_mov_b32 s40, 0
s_mov_b32 s44, 1073741824
s_mov_b32 s45, 1073741824
ds_read_b128 v[68:71], v6 offset:4096
s_waitcnt lgkmcnt(6)
v_mfma_f32_32x32x16_bf16 v[16:31], v[76:79], v[252:255], v[16:31]
s_cmp_eq_u32 s36, 0
s_cbranch_scc1 .kv_ex_1027
ds_read_b128 v[72:75], v7 offset:4096
s_waitcnt lgkmcnt(6)
v_mfma_f32_32x32x16_bf16 v[32:47], v[48:51], v[128:131], 0
ds_read_b128 v[76:79], v8 offset:4096
s_waitcnt lgkmcnt(6)
v_mfma_f32_32x32x16_bf16 v[32:47], v[52:55], v[132:135], v[32:47]
ds_read_b128 v[48:51], v5 offset:8192
s_waitcnt lgkmcnt(6)
v_mfma_f32_32x32x16_bf16 v[32:47], v[56:59], v[136:139], v[32:47]
s_sub_u32 s36, s36, 1
ds_read_b128 v[52:55], v6 offset:8192
s_waitcnt lgkmcnt(6)
v_mfma_f32_32x32x16_bf16 v[32:47], v[60:63], v[140:143], v[32:47]
v_cvt_pk_bf16_f32 v16, v16, v17
v_cvt_pk_bf16_f32 v17, v18, v19
ds_read_b128 v[56:59], v7 offset:8192
s_waitcnt lgkmcnt(6)
v_mfma_f32_32x32x16_bf16 v[32:47], v[64:67], v[144:147], v[32:47]
v_cvt_pk_bf16_f32 v18, v20, v21
v_cvt_pk_bf16_f32 v19, v22, v23
ds_read_b128 v[60:63], v8 offset:8192
s_waitcnt lgkmcnt(6)
v_mfma_f32_32x32x16_bf16 v[32:47], v[68:71], v[148:151], v[32:47]
v_cvt_pk_bf16_f32 v20, v24, v25
v_cvt_pk_bf16_f32 v21, v26, v27
ds_read_b128 v[64:67], v5 offset:12288
s_waitcnt lgkmcnt(6)
v_mfma_f32_32x32x16_bf16 v[32:47], v[72:75], v[152:155], v[32:47]
v_cvt_pk_bf16_f32 v22, v28, v29
v_cvt_pk_bf16_f32 v23, v30, v31
ds_read_b128 v[68:71], v6 offset:12288
s_waitcnt lgkmcnt(6)
v_mfma_f32_32x32x16_bf16 v[32:47], v[76:79], v[156:159], v[32:47]
buffer_store_dwordx4 v[16:19], v9, s[12:15], s35 offen sc1
ds_read_b128 v[72:75], v7 offset:12288
s_waitcnt lgkmcnt(6)
v_mfma_f32_32x32x16_bf16 v[32:47], v[48:51], v[160:163], v[32:47]
buffer_store_dwordx4 v[20:23], v10, s[12:15], s35 offen sc1
ds_read_b128 v[76:79], v8 offset:12288
s_waitcnt lgkmcnt(6)
v_mfma_f32_32x32x16_bf16 v[32:47], v[52:55], v[164:167], v[32:47]
s_add_u32 s35, s35, 0x2000
ds_read_b128 v[48:51], v5 offset:16384
s_waitcnt lgkmcnt(6)
v_mfma_f32_32x32x16_bf16 v[32:47], v[56:59], v[168:171], v[32:47]
ds_read_b128 v[52:55], v6 offset:16384
s_waitcnt lgkmcnt(6)
v_mfma_f32_32x32x16_bf16 v[32:47], v[60:63], v[172:175], v[32:47]
ds_read_b128 v[56:59], v7 offset:16384
s_waitcnt lgkmcnt(6)
v_mfma_f32_32x32x16_bf16 v[32:47], v[64:67], v[176:179], v[32:47]
ds_read_b128 v[60:63], v8 offset:16384
s_waitcnt lgkmcnt(6)
v_mfma_f32_32x32x16_bf16 v[32:47], v[68:71], v[180:183], v[32:47]
ds_read_b128 v[64:67], v5 offset:20480
s_waitcnt lgkmcnt(6)
v_mfma_f32_32x32x16_bf16 v[32:47], v[72:75], v[184:187], v[32:47]
ds_read_b128 v[68:71], v6 offset:20480
s_waitcnt lgkmcnt(6)
v_mfma_f32_32x32x16_bf16 v[32:47], v[76:79], v[188:191], v[32:47]
ds_read_b128 v[72:75], v7 offset:20480
s_waitcnt lgkmcnt(6)
v_mfma_f32_32x32x16_bf16 v[32:47], v[48:51], v[192:195], v[32:47]
ds_read_b128 v[76:79], v8 offset:20480
s_waitcnt lgkmcnt(6)
v_mfma_f32_32x32x16_bf16 v[32:47], v[52:55], v[196:199], v[32:47]
ds_read_b128 v[48:51], v5 offset:24576
s_waitcnt lgkmcnt(6)
v_mfma_f32_32x32x16_bf16 v[32:47], v[56:59], v[200:203], v[32:47]
ds_read_b128 v[52:55], v6 offset:24576
s_waitcnt lgkmcnt(6)
v_mfma_f32_32x32x16_bf16 v[32:47], v[60:63], v[204:207], v[32:47]
ds_read_b128 v[56:59], v7 offset:24576
s_waitcnt lgkmcnt(6)
v_mfma_f32_32x32x16_bf16 v[32:47], v[64:67], v[208:211], v[32:47]
s_waitcnt vmcnt(16)
s_barrier
ds_read_b128 v[60:63], v8 offset:24576
s_waitcnt lgkmcnt(6)
s_add_u32 m0, s32, s60
v_mfma_f32_32x32x16_bf16 v[32:47], v[68:71], v[212:215], v[32:47]
buffer_load_dwordx4 v1, s[4:7], s31 offen lds
ds_read_b128 v[64:67], v5 offset:28672
s_waitcnt lgkmcnt(6)
s_add_u32 m0, s32, s61
v_mfma_f32_32x32x16_bf16 v[32:47], v[72:75], v[216:219], v[32:47]
buffer_load_dwordx4 v2, s[4:7], s31 offen lds
ds_read_b128 v[68:71], v6 offset:28672
s_waitcnt lgkmcnt(6)
s_add_u32 m0, s32, s62
v_mfma_f32_32x32x16_bf16 v[32:47], v[76:79], v[220:223], v[32:47]
buffer_load_dwordx4 v3, s[4:7], s31 offen lds
ds_read_b128 v[72:75], v7 offset:28672
s_waitcnt lgkmcnt(6)
s_add_u32 m0, s32, s63
v_mfma_f32_32x32x16_bf16 v[32:47], v[48:51], v[224:227], v[32:47]
buffer_load_dwordx4 v4, s[4:7], s31 offen lds
ds_read_b128 v[76:79], v8 offset:28672
s_waitcnt lgkmcnt(6)
v_mfma_f32_32x32x16_bf16 v[32:47], v[52:55], v[228:231], v[32:47]
s_add_u32 s31, s31, 0x8000
s_add_u32 s32, s32, 0x8000
s_and_b32 s32, s32, 0x1ffff
s_mov_b32 s16, 0
v_add_u32 v5, s37, v5
v_add_u32 v6, s37, v6
v_add_u32 v7, s37, v7
v_add_u32 v8, s37, v8
s_xor_b32 s37, s37, 0xfffe0000
ds_read_b128 v[48:51], v5 offset:0
s_waitcnt lgkmcnt(6)
v_mfma_f32_32x32x16_bf16 v[32:47], v[56:59], v[232:235], v[32:47]
ds_read_b128 v[52:55], v6 offset:0
s_waitcnt lgkmcnt(6)
v_mfma_f32_32x32x16_bf16 v[32:47], v[60:63], v[236:239], v[32:47]
ds_read_b128 v[56:59], v7 offset:0
s_waitcnt lgkmcnt(6)
v_mfma_f32_32x32x16_bf16 v[32:47], v[64:67], v[240:243], v[32:47]
ds_read_b128 v[60:63], v8 offset:0
s_waitcnt lgkmcnt(6)
v_mfma_f32_32x32x16_bf16 v[32:47], v[68:71], v[244:247], v[32:47]
ds_read_b128 v[64:67], v5 offset:4096
s_waitcnt lgkmcnt(6)
v_mfma_f32_32x32x16_bf16 v[32:47], v[72:75], v[248:251], v[32:47]
ds_read_b128 v[68:71], v6 offset:4096
s_waitcnt lgkmcnt(6)
v_mfma_f32_32x32x16_bf16 v[32:47], v[76:79], v[252:255], v[32:47]
s_cmp_eq_u32 s36, 0
s_cbranch_scc0 .kv_loop_1026
s_cmp_lg_u32 s20, 0
s_cbranch_scc1 .pw_1032
s_mov_b32 s63, 0
s_mov_b32 s60, 0x0
s_mov_b32 s61, 0x7f8000
v_lshlrev_b32 v111, 2, v0
v_mov_b32 v110, 0
s_mov_b64 exec, s[60:61]
buffer_atomic_or v110, v111, s[56:59], 0 offen sc0 sc1
s_mov_b64 exec, -1
.pw_1032:
s_nop 7
v_cvt_pk_bf16_f32 v32, v32, v33
v_cvt_pk_bf16_f32 v33, v34, v35
v_cvt_pk_bf16_f32 v34, v36, v37
v_cvt_pk_bf16_f32 v35, v38, v39
v_cvt_pk_bf16_f32 v36, v40, v41
v_cvt_pk_bf16_f32 v37, v42, v43
v_cvt_pk_bf16_f32 v38, v44, v45
v_cvt_pk_bf16_f32 v39, v46, v47
buffer_store_dwordx4 v[32:35], v9, s[12:15], s35 offen sc1
buffer_store_dwordx4 v[36:39], v10, s[12:15], s35 offen sc1
s_branch .kv_done_1017
.kv_ex_1027:
s_cmp_lg_u32 s20, 0
s_cbranch_scc1 .pw_1033
s_mov_b32 s63, 0
s_mov_b32 s60, 0x0
s_mov_b32 s61, 0x7f8000
v_lshlrev_b32 v111, 2, v0
v_mov_b32 v110, 0
s_mov_b64 exec, s[60:61]
buffer_atomic_or v110, v111, s[56:59], 0 offen sc0 sc1
s_mov_b64 exec, -1
.pw_1033:
s_nop 7
v_cvt_pk_bf16_f32 v16, v16, v17
v_cvt_pk_bf16_f32 v17, v18, v19
v_cvt_pk_bf16_f32 v18, v20, v21
v_cvt_pk_bf16_f32 v19, v22, v23
v_cvt_pk_bf16_f32 v20, v24, v25
v_cvt_pk_bf16_f32 v21, v26, v27
v_cvt_pk_bf16_f32 v22, v28, v29
v_cvt_pk_bf16_f32 v23, v30, v31
buffer_store_dwordx4 v[16:19], v9, s[12:15], s35 offen sc1
buffer_store_dwordx4 v[20:23], v10, s[12:15], s35 offen sc1
.kv_done_1017:
s_waitcnt vmcnt(0) lgkmcnt(0)
s_cmp_lg_u32 s20, 0
s_cbranch_scc1 .pw_1034
v_or_b32 v110, s63, v110
v_cmp_ne_u32 vcc, -1, v110
s_and_b64 vcc, vcc, s[60:61]
s_cbranch_scc1 .pslow_1035
.pret_1036:
.pw_1034:
s_barrier
s_lshr_b32 s46, s2, 5
s_lshl_b32 s46, s46, 2
s_cmp_lg_u32 s20, 0
s_cbranch_scc1 .sig_1038
v_lshlrev_b32 v108, 12, v0
v_lshlrev_b32_e64 v109, s2, 1
buffer_atomic_or v109, v108, s[56:59], s46 offen offset:0 sc1
.sig_1038:
s_load_dwordx2 s[32:33], s[0:1], 104
v_lshlrev_b32 v1, 4, v0
s_and_b32 s21, s2, 7
s_lshl_b32 s21, s21, 2
s_bfe_u32 s23, s2, 0x20003
s_add_u32 s21, s21, s23
s_lshr_b32 s22, s2, 5
s_lshl_b32 s23, s22, 2
s_lshr_b32 s38, 0x4abcdef, s23
s_and_b32 s38, s38, 15
s_lshr_b32 s39, 0x3987652, s23
s_and_b32 s39, s39, 15
s_cmp_eq_u32 s22, 6
s_cselect_b32 s27, 1, 0
s_lshl_b32 s36, s20, 12
s_mov_b32 s65, 1
v_and_b32 v4, 31, v0
v_lshrrev_b32 v10, 5, v0
v_lshlrev_b32 v10, 2, v10
v_sub_u32 v4, v4, v10
s_and_b32 s23, s20, 1
s_lshl_b32 s23, s23, 5
v_add_u32 v4, s23, v4
v_mov_b32 v8, 0xff800000
v_add_u32 v9, 0x20000, v1
s_waitcnt lgkmcnt(0)
s_add_u32 s4, s32, 0
s_addc_u32 s5, s33, 0
s_mov_b32 s6, 2621440
s_mov_b32 s7, 0x00020000
s_add_u32 s8, s32, 72728576
s_addc_u32 s9, s33, 0
s_mov_b32 s10, 5242880
s_mov_b32 s11, 0x00020000
s_add_u32 s16, s32, 48496640
s_addc_u32 s17, s33, 0
s_mov_b32 s18, 16777216
s_mov_b32 s19, 0x00020000
s_bfe_u32 s48, s20, 0x10001
s_mul_i32 s23, s48, 16777216
s_add_u32 s23, s23, 14942208
s_lshl_b32 s24, s21, 19
s_add_u32 s23, s23, s24
s_add_u32 s12, s32, s23
s_addc_u32 s13, s33, 0
s_mov_b32 s15, 0x00020000
.round_1039:
s_cmp_lt_u32 s20, 4
s_cselect_b32 s23, s38, s39
s_and_b32 s26, s20, 3
s_lshl_b32 s24, s23, 2
s_add_u32 s24, s24, s26
s_lshr_b32 s25, s24, 1
s_lshl_b32 s37, s38, 1
s_add_u32 s37, s37, 2
s_lshl_b32 s14, s37, 14
s_sub_u32 s37, s37, s25
s_sub_u32 s37, s37, 1
s_mul_i32 s34, s24, 40960
s_lshl_b32 s35, s20, 17
s_lshl_b32 s23, s21, 12
s_add_u32 s35, s35, s23
v_mov_b32 v2, v1
v_add_u32 v3, 0x10000, v1
s_and_b32 s28, s20, 1
s_lshl_b32 s28, s28, 13
s_lshl_b32 s49, s26, 13
s_mov_b32 s30, s49
s_cmp_ge_u32 s20, 4
s_cbranch_scc1 .att_b_1040
s_add_u32 m0, s36, 0
s_nop 0
buffer_load_dwordx4 v1, s[8:11], s35 offen offset:0 lds
buffer_load_dwordx4 v1, s[8:11], s35 offen offset:1024 lds
buffer_load_dwordx4 v1, s[8:11], s35 offen offset:2048 lds
buffer_load_dwordx4 v1, s[8:11], s35 offen offset:3072 lds
s_add_u32 s35, s35, 0x100000
buffer_load_dwordx4 v[80:83], v1, s[4:7], s34 offen offset:0
buffer_load_dwordx4 v[84:87], v1, s[4:7], s34 offen offset:1024
buffer_load_dwordx4 v[88:91], v1, s[4:7], s34 offen offset:2048
buffer_load_dwordx4 v[92:95], v1, s[4:7], s34 offen offset:3072
s_add_u32 s34, s34, 0x1000
buffer_load_dwordx4 v[96:99], v1, s[4:7], s34 offen offset:0
buffer_load_dwordx4 v[100:103], v1, s[4:7], s34 offen offset:1024
buffer_load_dwordx4 v[104:107], v1, s[4:7], s34 offen offset:2048
buffer_load_dwordx4 v[108:111], v1, s[4:7], s34 offen offset:3072
s_add_u32 s34, s34, 0x1000
s_add_u32 m0, s36, 32768
s_nop 0
buffer_load_dwordx4 v1, s[8:11], s35 offen offset:0 lds
buffer_load_dwordx4 v1, s[8:11], s35 offen offset:1024 lds
buffer_load_dwordx4 v1, s[8:11], s35 offen offset:2048 lds
buffer_load_dwordx4 v1, s[8:11], s35 offen offset:3072 lds
s_add_u32 s35, s35, 0x100000
buffer_load_dwordx4 v[112:115], v1, s[4:7], s34 offen offset:0
buffer_load_dwordx4 v[116:119], v1, s[4:7], s34 offen offset:1024
buffer_load_dwordx4 v[120:123], v1, s[4:7], s34 offen offset:2048
buffer_load_dwordx4 v[124:127], v1, s[4:7], s34 offen offset:3072
s_add_u32 s34, s34, 0x1000
buffer_load_dwordx4 v[128:131], v1, s[4:7], s34 offen offset:0
buffer_load_dwordx4 v[132:135], v1, s[4:7], s34 offen offset:1024
buffer_load_dwordx4 v[136:139], v1, s[4:7], s34 offen offset:2048
buffer_load_dwordx4 v[140:143], v1, s[4:7], s34 offen offset:3072
s_add_u32 s34, s34, 0x1000
s_waitcnt vmcnt(20)
s_barrier
s_cmp_lg_u32 s65, 0
s_cbranch_scc1 .lrel_1042
s_lshl_b32 s63, 1, s2
s_mov_b64 exec, 3
v_or_b32 v12, s63, v12
v_cmp_eq_u32 vcc, -1, v12
s_and_b64 exec, exec, vcc
s_cbranch_scc0 .rel_1043
buffer_store_byte v12, v10, s[56:59], 0 offen offset:128 sc0 sc1
.rel_1043:
s_mov_b64 exec, -1
.lrel_1042:
ds_read_b128 v[176:179], v2 offset:0
ds_read_b128 v[180:183], v2 offset:1024
ds_read_b128 v[184:187], v2 offset:2048
ds_read_b128 v[188:191], v2 offset:3072
ds_read_b128 v[192:195], v2 offset:4096
ds_read_b128 v[196:199], v2 offset:5120
s_waitcnt vmcnt(19)
s_waitcnt lgkmcnt(5)
v_mfma_f32_32x32x16_bf16 v[16:31], v[176:179], v[80:83], 0
ds_read_b128 v[200:203], v2 offset:6144
s_add_u32 m0, s36, 65536
s_nop 0
s_waitcnt lgkmcnt(5)
v_mfma_f32_32x32x16_bf16 v[32:47], v[180:183], v[80:83], 0
ds_read_b128 v[204:207], v2 offset:7168
buffer_load_dwordx4 v1, s[8:11], s35 offen offset:0 lds
s_waitcnt lgkmcnt(5)
v_mfma_f32_32x32x16_bf16 v[48:63], v[184:187], v[80:83], 0
ds_read_b128 v[176:179], v2 offset:8192
buffer_load_dwordx4 v1, s[8:11], s35 offen offset:1024 lds
s_waitcnt lgkmcnt(5)
v_mfma_f32_32x32x16_bf16 v[64:79], v[188:191], v[80:83], 0
ds_read_b128 v[180:183], v2 offset:9216
buffer_load_dwordx4 v1, s[8:11], s35 offen offset:2048 lds
s_waitcnt vmcnt(21)
s_waitcnt lgkmcnt(5)
v_mfma_f32_32x32x16_bf16 v[16:31], v[192:195], v[84:87], v[16:31]
ds_read_b128 v[184:187], v2 offset:10240
buffer_load_dwordx4 v1, s[8:11], s35 offen offset:3072 lds
s_add_u32 s35, s35, 0x100000
s_waitcnt lgkmcnt(5)
v_mfma_f32_32x32x16_bf16 v[32:47], v[196:199], v[84:87], v[32:47]
ds_read_b128 v[188:191], v2 offset:11264
buffer_load_dwordx4 v[208:211], v1, s[4:7], s34 offen offset:0
s_waitcnt lgkmcnt(5)
v_mfma_f32_32x32x16_bf16 v[48:63], v[200:203], v[84:87], v[48:63]
ds_read_b128 v[192:195], v2 offset:12288
buffer_load_dwordx4 v[212:215], v1, s[4:7], s34 offen offset:1024
s_waitcnt lgkmcnt(5)
v_mfma_f32_32x32x16_bf16 v[64:79], v[204:207], v[84:87], v[64:79]
ds_read_b128 v[196:199], v2 offset:13312
buffer_load_dwordx4 v[216:219], v1, s[4:7], s34 offen offset:2048
s_waitcnt vmcnt(24)
s_waitcnt lgkmcnt(5)
v_mfma_f32_32x32x16_bf16 v[16:31], v[176:179], v[88:91], v[16:31]
ds_read_b128 v[200:203], v2 offset:14336
buffer_load_dwordx4 v[220:223], v1, s[4:7], s34 offen offset:3072
s_add_u32 s34, s34, 0x1000
s_waitcnt lgkmcnt(5)
v_mfma_f32_32x32x16_bf16 v[32:47], v[180:183], v[88:91], v[32:47]
ds_read_b128 v[204:207], v2 offset:15360
buffer_load_dwordx4 v[224:227], v1, s[4:7], s34 offen offset:0
s_waitcnt lgkmcnt(5)
v_mfma_f32_32x32x16_bf16 v[48:63], v[184:187], v[88:91], v[48:63]
ds_read_b128 v[176:179], v2 offset:16384
buffer_load_dwordx4 v[228:231], v1, s[4:7], s34 offen offset:1024
s_waitcnt lgkmcnt(5)
v_mfma_f32_32x32x16_bf16 v[64:79], v[188:191], v[88:91], v[64:79]
ds_read_b128 v[180:183], v2 offset:17408
buffer_load_dwordx4 v[232:235], v1, s[4:7], s34 offen offset:2048
s_waitcnt vmcnt(27)
s_waitcnt lgkmcnt(5)
v_mfma_f32_32x32x16_bf16 v[16:31], v[192:195], v[92:95], v[16:31]
ds_read_b128 v[184:187], v2 offset:18432
buffer_load_dwordx4 v[236:239], v1, s[4:7], s34 offen offset:3072
s_add_u32 s34, s34, 0x1000
s_waitcnt lgkmcnt(5)
v_mfma_f32_32x32x16_bf16 v[32:47], v[196:199], v[92:95], v[32:47]
ds_read_b128 v[188:191], v2 offset:19456
s_waitcnt lgkmcnt(5)
v_mfma_f32_32x32x16_bf16 v[48:63], v[200:203], v[92:95], v[48:63]
ds_read_b128 v[192:195], v2 offset:20480
s_waitcnt lgkmcnt(5)
v_mfma_f32_32x32x16_bf16 v[64:79], v[204:207], v[92:95], v[64:79]
ds_read_b128 v[196:199], v2 offset:21504
s_waitcnt vmcnt(20)
s_barrier
s_waitcnt lgkmcnt(5)
v_mfma_f32_32x32x16_bf16 v[16:31], v[176:179], v[96:99], v[16:31]
ds_read_b128 v[200:203], v2 offset:22528
s_waitcnt lgkmcnt(5)
v_mfma_f32_32x32x16_bf16 v[32:47], v[180:183], v[96:99], v[32:47]
ds_read_b128 v[204:207], v2 offset:23552
s_waitcnt lgkmcnt(5)
v_mfma_f32_32x32x16_bf16 v[48:63], v[184:187], v[96:99], v[48:63]
ds_read_b128 v[176:179], v2 offset:24576
s_waitcnt lgkmcnt(5)
v_mfma_f32_32x32x16_bf16 v[64:79], v[188:191], v[96:99], v[64:79]
ds_read_b128 v[180:183], v2 offset:25600
s_waitcnt lgkmcnt(5)
v_mfma_f32_32x32x16_bf16 v[16:31], v[192:195], v[100:103], v[16:31]
ds_read_b128 v[184:187], v2 offset:26624
s_waitcnt lgkmcnt(5)
v_mfma_f32_32x32x16_bf16 v[32:47], v[196:199], v[100:103], v[32:47]
ds_read_b128 v[188:191], v2 offset:27648
s_waitcnt lgkmcnt(5)
v_mfma_f32_32x32x16_bf16 v[48:63], v[200:203], v[100:103], v[48:63]
ds_read_b128 v[192:195], v2 offset:28672
s_waitcnt lgkmcnt(5)
v_mfma_f32_32x32x16_bf16 v[64:79], v[204:207], v[100:103], v[64:79]
ds_read_b128 v[196:199], v2 offset:29696
s_waitcnt lgkmcnt(5)
v_mfma_f32_32x32x16_bf16 v[16:31], v[176:179], v[104:107], v[16:31]
ds_read_b128 v[200:203], v2 offset:30720
s_waitcnt lgkmcnt(5)
v_mfma_f32_32x32x16_bf16 v[32:47], v[180:183], v[104:107], v[32:47]
ds_read_b128 v[204:207], v2 offset:31744
s_waitcnt lgkmcnt(5)
v_mfma_f32_32x32x16_bf16 v[48:63], v[184:187], v[104:107], v[48:63]
ds_read_b128 v[176:179], v2 offset:32768
s_waitcnt lgkmcnt(5)
v_mfma_f32_32x32x16_bf16 v[64:79], v[188:191], v[104:107], v[64:79]
ds_read_b128 v[180:183], v2 offset:33792
s_waitcnt lgkmcnt(5)
v_mfma_f32_32x32x16_bf16 v[16:31], v[192:195], v[108:111], v[16:31]
ds_read_b128 v[184:187], v2 offset:34816
s_waitcnt lgkmcnt(5)
v_mfma_f32_32x32x16_bf16 v[32:47], v[196:199], v[108:111], v[32:47]
ds_read_b128 v[188:191], v2 offset:35840
s_waitcnt lgkmcnt(5)
v_mfma_f32_32x32x16_bf16 v[48:63], v[200:203], v[108:111], v[48:63]
ds_read_b128 v[192:195], v2 offset:36864
s_waitcnt lgkmcnt(5)
v_mfma_f32_32x32x16_bf16 v[64:79], v[204:207], v[108:111], v[64:79]
ds_read_b128 v[196:199], v2 offset:37888
s_waitcnt vmcnt(19)
s_waitcnt lgkmcnt(5)
v_mfma_f32_32x32x16_bf16 v[16:31], v[176:179], v[112:115], v[16:31]
ds_read_b128 v[200:203], v2 offset:38912
s_add_u32 m0, s36, 98304
s_nop 0
s_waitcnt lgkmcnt(5)
v_mfma_f32_32x32x16_bf16 v[32:47], v[180:183], v[112:115], v[32:47]
ds_read_b128 v[204:207], v2 offset:39936
buffer_load_dwordx4 v1, s[8:11], s35 offen offset:0 lds
s_waitcnt lgkmcnt(5)
v_mfma_f32_32x32x16_bf16 v[48:63], v[184:187], v[112:115], v[48:63]
ds_read_b128 v[176:179], v2 offset:40960
buffer_load_dwordx4 v1, s[8:11], s35 offen offset:1024 lds
s_waitcnt lgkmcnt(5)
v_mfma_f32_32x32x16_bf16 v[64:79], v[188:191], v[112:115], v[64:79]
ds_read_b128 v[180:183], v2 offset:41984
buffer_load_dwordx4 v1, s[8:11], s35 offen offset:2048 lds
s_waitcnt vmcnt(21)
s_waitcnt lgkmcnt(5)
v_mfma_f32_32x32x16_bf16 v[16:31], v[192:195], v[116:119], v[16:31]
ds_read_b128 v[184:187], v2 offset:43008
buffer_load_dwordx4 v1, s[8:11], s35 offen offset:3072 lds
s_add_u32 s35, s35, 0x100000
s_waitcnt lgkmcnt(5)
v_mfma_f32_32x32x16_bf16 v[32:47], v[196:199], v[116:119], v[32:47]
ds_read_b128 v[188:191], v2 offset:44032
buffer_load_dwordx4 v[80:83], v1, s[4:7], s34 offen offset:0
s_waitcnt lgkmcnt(5)
v_mfma_f32_32x32x16_bf16 v[48:63], v[200:203], v[116:119], v[48:63]
ds_read_b128 v[192:195], v2 offset:45056
buffer_load_dwordx4 v[84:87], v1, s[4:7], s34 offen offset:1024
s_waitcnt lgkmcnt(5)
v_mfma_f32_32x32x16_bf16 v[64:79], v[204:207], v[116:119], v[64:79]
ds_read_b128 v[196:199], v2 offset:46080
buffer_load_dwordx4 v[88:91], v1, s[4:7], s34 offen offset:2048
s_waitcnt vmcnt(24)
s_waitcnt lgkmcnt(5)
v_mfma_f32_32x32x16_bf16 v[16:31], v[176:179], v[120:123], v[16:31]
ds_read_b128 v[200:203], v2 offset:47104
buffer_load_dwordx4 v[92:95], v1, s[4:7], s34 offen offset:3072
s_add_u32 s34, s34, 0x1000
s_waitcnt lgkmcnt(5)
v_mfma_f32_32x32x16_bf16 v[32:47], v[180:183], v[120:123], v[32:47]
ds_read_b128 v[204:207], v2 offset:48128
buffer_load_dwordx4 v[96:99], v1, s[4:7], s34 offen offset:0
s_waitcnt lgkmcnt(5)
v_mfma_f32_32x32x16_bf16 v[48:63], v[184:187], v[120:123], v[48:63]
ds_read_b128 v[176:179], v2 offset:49152
buffer_load_dwordx4 v[100:103], v1, s[4:7], s34 offen offset:1024
s_waitcnt lgkmcnt(5)
v_mfma_f32_32x32x16_bf16 v[64:79], v[188:191], v[120:123], v[64:79]
ds_read_b128 v[180:183], v2 offset:50176
buffer_load_dwordx4 v[104:107], v1, s[4:7], s34 offen offset:2048
s_waitcnt vmcnt(27)
s_waitcnt lgkmcnt(5)
v_mfma_f32_32x32x16_bf16 v[16:31], v[192:195], v[124:127], v[16:31]
ds_read_b128 v[184:187], v2 offset:51200
buffer_load_dwordx4 v[108:111], v1, s[4:7], s34 offen offset:3072
s_add_u32 s34, s34, 0x1000
s_waitcnt lgkmcnt(5)
v_mfma_f32_32x32x16_bf16 v[32:47], v[196:199], v[124:127], v[32:47]
ds_read_b128 v[188:191], v2 offset:52224
s_waitcnt lgkmcnt(5)
v_mfma_f32_32x32x16_bf16 v[48:63], v[200:203], v[124:127], v[48:63]
ds_read_b128 v[192:195], v2 offset:53248
s_waitcnt lgkmcnt(5)
v_mfma_f32_32x32x16_bf16 v[64:79], v[204:207], v[124:127], v[64:79]
ds_read_b128 v[196:199], v2 offset:54272
s_waitcnt vmcnt(20)
s_barrier
s_waitcnt lgkmcnt(5)
v_mfma_f32_32x32x16_bf16 v[16:31], v[176:179], v[128:131], v[16:31]
ds_read_b128 v[200:203], v2 offset:55296
s_waitcnt lgkmcnt(5)
v_mfma_f32_32x32x16_bf16 v[32:47], v[180:183], v[128:131], v[32:47]
ds_read_b128 v[204:207], v2 offset:56320
s_waitcnt lgkmcnt(5)
v_mfma_f32_32x32x16_bf16 v[48:63], v[184:187], v[128:131], v[48:63]
ds_read_b128 v[176:179], v2 offset:57344
s_waitcnt lgkmcnt(5)
v_mfma_f32_32x32x16_bf16 v[64:79], v[188:191], v[128:131], v[64:79]
ds_read_b128 v[180:183], v2 offset:58368
s_waitcnt lgkmcnt(5)
v_mfma_f32_32x32x16_bf16 v[16:31], v[192:195], v[132:135], v[16:31]
ds_read_b128 v[184:187], v2 offset:59392
s_waitcnt lgkmcnt(5)
v_mfma_f32_32x32x16_bf16 v[32:47], v[196:199], v[132:135], v[32:47]
ds_read_b128 v[188:191], v2 offset:60416
s_waitcnt lgkmcnt(5)
v_mfma_f32_32x32x16_bf16 v[48:63], v[200:203], v[132:135], v[48:63]
ds_read_b128 v[192:195], v2 offset:61440
s_waitcnt lgkmcnt(5)
v_mfma_f32_32x32x16_bf16 v[64:79], v[204:207], v[132:135], v[64:79]
ds_read_b128 v[196:199], v2 offset:62464
s_waitcnt lgkmcnt(5)
v_mfma_f32_32x32x16_bf16 v[16:31], v[176:179], v[136:139], v[16:31]
ds_read_b128 v[200:203], v2 offset:63488
s_waitcnt lgkmcnt(5)
v_mfma_f32_32x32x16_bf16 v[32:47], v[180:183], v[136:139], v[32:47]
ds_read_b128 v[204:207], v2 offset:64512
s_waitcnt lgkmcnt(5)
v_mfma_f32_32x32x16_bf16 v[48:63], v[184:187], v[136:139], v[48:63]
ds_read_b128 v[176:179], v3 offset:0
s_waitcnt lgkmcnt(5)
v_mfma_f32_32x32x16_bf16 v[64:79], v[188:191], v[136:139], v[64:79]
ds_read_b128 v[180:183], v3 offset:1024
s_waitcnt lgkmcnt(5)
v_mfma_f32_32x32x16_bf16 v[16:31], v[192:195], v[140:143], v[16:31]
ds_read_b128 v[184:187], v3 offset:2048
s_waitcnt lgkmcnt(5)
v_mfma_f32_32x32x16_bf16 v[32:47], v[196:199], v[140:143], v[32:47]
ds_read_b128 v[188:191], v3 offset:3072
s_waitcnt lgkmcnt(5)
v_mfma_f32_32x32x16_bf16 v[48:63], v[200:203], v[140:143], v[48:63]
ds_read_b128 v[192:195], v3 offset:4096
s_waitcnt lgkmcnt(5)
v_mfma_f32_32x32x16_bf16 v[64:79], v[204:207], v[140:143], v[64:79]
ds_read_b128 v[196:199], v3 offset:5120
s_waitcnt vmcnt(19)
s_waitcnt lgkmcnt(5)
v_mfma_f32_32x32x16_bf16 v[16:31], v[176:179], v[208:211], v[16:31]
ds_read_b128 v[200:203], v3 offset:6144
s_add_u32 m0, s36, 131072
s_nop 0
s_waitcnt lgkmcnt(5)
v_mfma_f32_32x32x16_bf16 v[32:47], v[180:183], v[208:211], v[32:47]
ds_read_b128 v[204:207], v3 offset:7168
buffer_load_dwordx4 v1, s[8:11], s35 offen offset:0 lds
s_waitcnt lgkmcnt(5)
v_mfma_f32_32x32x16_bf16 v[48:63], v[184:187], v[208:211], v[48:63]
ds_read_b128 v[176:179], v3 offset:8192
buffer_load_dwordx4 v1, s[8:11], s35 offen offset:1024 lds
s_waitcnt lgkmcnt(5)
v_mfma_f32_32x32x16_bf16 v[64:79], v[188:191], v[208:211], v[64:79]
ds_read_b128 v[180:183], v3 offset:9216
buffer_load_dwordx4 v1, s[8:11], s35 offen offset:2048 lds
s_waitcnt vmcnt(21)
s_waitcnt lgkmcnt(5)
v_mfma_f32_32x32x16_bf16 v[16:31], v[192:195], v[212:215], v[16:31]
ds_read_b128 v[184:187], v3 offset:10240
buffer_load_dwordx4 v1, s[8:11], s35 offen offset:3072 lds
s_add_u32 s35, s35, 0x100000
s_waitcnt lgkmcnt(5)
v_mfma_f32_32x32x16_bf16 v[32:47], v[196:199], v[212:215], v[32:47]
ds_read_b128 v[188:191], v3 offset:11264
buffer_load_dwordx4 v[112:115], v1, s[4:7], s34 offen offset:0
s_waitcnt lgkmcnt(5)
v_mfma_f32_32x32x16_bf16 v[48:63], v[200:203], v[212:215], v[48:63]
ds_read_b128 v[192:195], v3 offset:12288
buffer_load_dwordx4 v[116:119], v1, s[4:7], s34 offen offset:1024
s_waitcnt lgkmcnt(5)
v_mfma_f32_32x32x16_bf16 v[64:79], v[204:207], v[212:215], v[64:79]
ds_read_b128 v[196:199], v3 offset:13312
buffer_load_dwordx4 v[120:123], v1, s[4:7], s34 offen offset:2048
s_waitcnt vmcnt(24)
s_waitcnt lgkmcnt(5)
v_mfma_f32_32x32x16_bf16 v[16:31], v[176:179], v[216:219], v[16:31]
ds_read_b128 v[200:203], v3 offset:14336
buffer_load_dwordx4 v[124:127], v1, s[4:7], s34 offen offset:3072
s_add_u32 s34, s34, 0x1000
s_waitcnt lgkmcnt(5)
v_mfma_f32_32x32x16_bf16 v[32:47], v[180:183], v[216:219], v[32:47]
ds_read_b128 v[204:207], v3 offset:15360
buffer_load_dwordx4 v[128:131], v1, s[4:7], s34 offen offset:0
s_waitcnt lgkmcnt(5)
v_mfma_f32_32x32x16_bf16 v[48:63], v[184:187], v[216:219], v[48:63]
ds_read_b128 v[176:179], v3 offset:16384
buffer_load_dwordx4 v[132:135], v1, s[4:7], s34 offen offset:1024
s_waitcnt lgkmcnt(5)
v_mfma_f32_32x32x16_bf16 v[64:79], v[188:191], v[216:219], v[64:79]
ds_read_b128 v[180:183], v3 offset:17408
buffer_load_dwordx4 v[136:139], v1, s[4:7], s34 offen offset:2048
s_waitcnt vmcnt(27)
s_waitcnt lgkmcnt(5)
v_mfma_f32_32x32x16_bf16 v[16:31], v[192:195], v[220:223], v[16:31]
ds_read_b128 v[184:187], v3 offset:18432
buffer_load_dwordx4 v[140:143], v1, s[4:7], s34 offen offset:3072
s_add_u32 s34, s34, 0x1000
s_waitcnt lgkmcnt(5)
v_mfma_f32_32x32x16_bf16 v[32:47], v[196:199], v[220:223], v[32:47]
ds_read_b128 v[188:191], v3 offset:19456
s_waitcnt lgkmcnt(5)
v_mfma_f32_32x32x16_bf16 v[48:63], v[200:203], v[220:223], v[48:63]
ds_read_b128 v[192:195], v3 offset:20480
s_waitcnt lgkmcnt(5)
v_mfma_f32_32x32x16_bf16 v[64:79], v[204:207], v[220:223], v[64:79]
ds_read_b128 v[196:199], v3 offset:21504
s_waitcnt vmcnt(20)
s_barrier
s_waitcnt lgkmcnt(5)
v_mfma_f32_32x32x16_bf16 v[16:31], v[176:179], v[224:227], v[16:31]
ds_read_b128 v[200:203], v3 offset:22528
s_waitcnt lgkmcnt(5)
v_mfma_f32_32x32x16_bf16 v[32:47], v[180:183], v[224:227], v[32:47]
ds_read_b128 v[204:207], v3 offset:23552
s_waitcnt lgkmcnt(5)
v_mfma_f32_32x32x16_bf16 v[48:63], v[184:187], v[224:227], v[48:63]
ds_read_b128 v[176:179], v3 offset:24576
s_waitcnt lgkmcnt(5)
v_mfma_f32_32x32x16_bf16 v[64:79], v[188:191], v[224:227], v[64:79]
ds_read_b128 v[180:183], v3 offset:25600
s_waitcnt lgkmcnt(5)
v_mfma_f32_32x32x16_bf16 v[16:31], v[192:195], v[228:231], v[16:31]
ds_read_b128 v[184:187], v3 offset:26624
s_waitcnt lgkmcnt(5)
v_mfma_f32_32x32x16_bf16 v[32:47], v[196:199], v[228:231], v[32:47]
ds_read_b128 v[188:191], v3 offset:27648
s_waitcnt lgkmcnt(5)
v_mfma_f32_32x32x16_bf16 v[48:63], v[200:203], v[228:231], v[48:63]
ds_read_b128 v[192:195], v3 offset:28672
s_waitcnt lgkmcnt(5)
v_mfma_f32_32x32x16_bf16 v[64:79], v[204:207], v[228:231], v[64:79]
ds_read_b128 v[196:199], v3 offset:29696
s_waitcnt lgkmcnt(5)
v_mfma_f32_32x32x16_bf16 v[16:31], v[176:179], v[232:235], v[16:31]
ds_read_b128 v[200:203], v3 offset:30720
s_waitcnt lgkmcnt(5)
v_mfma_f32_32x32x16_bf16 v[32:47], v[180:183], v[232:235], v[32:47]
ds_read_b128 v[204:207], v3 offset:31744
s_waitcnt lgkmcnt(5)
v_mfma_f32_32x32x16_bf16 v[48:63], v[184:187], v[232:235], v[48:63]
ds_read_b128 v[176:179], v3 offset:32768
s_waitcnt lgkmcnt(5)
v_mfma_f32_32x32x16_bf16 v[64:79], v[188:191], v[232:235], v[64:79]
ds_read_b128 v[180:183], v3 offset:33792
s_waitcnt lgkmcnt(5)
v_mfma_f32_32x32x16_bf16 v[16:31], v[192:195], v[236:239], v[16:31]
ds_read_b128 v[184:187], v3 offset:34816
s_waitcnt lgkmcnt(5)
v_mfma_f32_32x32x16_bf16 v[32:47], v[196:199], v[236:239], v[32:47]
ds_read_b128 v[188:191], v3 offset:35840
s_waitcnt lgkmcnt(5)
v_mfma_f32_32x32x16_bf16 v[48:63], v[200:203], v[236:239], v[48:63]
ds_read_b128 v[192:195], v3 offset:36864
s_waitcnt lgkmcnt(5)
v_mfma_f32_32x32x16_bf16 v[64:79], v[204:207], v[236:239], v[64:79]
ds_read_b128 v[196:199], v3 offset:37888
s_waitcnt vmcnt(19)
s_waitcnt lgkmcnt(5)
v_mfma_f32_32x32x16_bf16 v[16:31], v[176:179], v[80:83], v[16:31]
ds_read_b128 v[200:203], v3 offset:38912
s_waitcnt lgkmcnt(5)
v_mfma_f32_32x32x16_bf16 v[32:47], v[180:183], v[80:83], v[32:47]
ds_read_b128 v[204:207], v3 offset:39936
s_waitcnt lgkmcnt(5)
v_mfma_f32_32x32x16_bf16 v[48:63], v[184:187], v[80:83], v[48:63]
ds_read_b128 v[176:179], v3 offset:40960
s_waitcnt lgkmcnt(5)
v_mfma_f32_32x32x16_bf16 v[64:79], v[188:191], v[80:83], v[64:79]
ds_read_b128 v[180:183], v3 offset:41984
s_waitcnt vmcnt(18)
s_waitcnt lgkmcnt(5)
v_mfma_f32_32x32x16_bf16 v[16:31], v[192:195], v[84:87], v[16:31]
ds_read_b128 v[184:187], v3 offset:43008
s_waitcnt lgkmcnt(5)
v_mfma_f32_32x32x16_bf16 v[32:47], v[196:199], v[84:87], v[32:47]
ds_read_b128 v[188:191], v3 offset:44032
s_waitcnt lgkmcnt(5)
v_mfma_f32_32x32x16_bf16 v[48:63], v[200:203], v[84:87], v[48:63]
ds_read_b128 v[192:195], v3 offset:45056
s_waitcnt lgkmcnt(5)
v_mfma_f32_32x32x16_bf16 v[64:79], v[204:207], v[84:87], v[64:79]
ds_read_b128 v[196:199], v3 offset:46080
s_waitcnt vmcnt(17)
s_waitcnt lgkmcnt(5)
v_mfma_f32_32x32x16_bf16 v[16:31], v[176:179], v[88:91], v[16:31]
ds_read_b128 v[200:203], v3 offset:47104
s_waitcnt lgkmcnt(5)
v_mfma_f32_32x32x16_bf16 v[32:47], v[180:183], v[88:91], v[32:47]
ds_read_b128 v[204:207], v3 offset:48128
s_waitcnt lgkmcnt(5)
v_mfma_f32_32x32x16_bf16 v[48:63], v[184:187], v[88:91], v[48:63]
ds_read_b128 v[176:179], v3 offset:49152
s_waitcnt lgkmcnt(5)
v_mfma_f32_32x32x16_bf16 v[64:79], v[188:191], v[88:91], v[64:79]
ds_read_b128 v[180:183], v3 offset:50176
s_waitcnt vmcnt(16)
s_waitcnt lgkmcnt(5)
v_mfma_f32_32x32x16_bf16 v[16:31], v[192:195], v[92:95], v[16:31]
ds_read_b128 v[184:187], v3 offset:51200
s_waitcnt lgkmcnt(5)
v_mfma_f32_32x32x16_bf16 v[32:47], v[196:199], v[92:95], v[32:47]
ds_read_b128 v[188:191], v3 offset:52224
s_waitcnt lgkmcnt(5)
v_mfma_f32_32x32x16_bf16 v[48:63], v[200:203], v[92:95], v[48:63]
ds_read_b128 v[192:195], v3 offset:53248
s_waitcnt lgkmcnt(5)
v_mfma_f32_32x32x16_bf16 v[64:79], v[204:207], v[92:95], v[64:79]
ds_read_b128 v[196:199], v3 offset:54272
s_waitcnt vmcnt(8)
s_barrier
s_waitcnt lgkmcnt(5)
v_mfma_f32_32x32x16_bf16 v[16:31], v[176:179], v[96:99], v[16:31]
ds_read_b128 v[200:203], v3 offset:55296
s_waitcnt lgkmcnt(5)
v_mfma_f32_32x32x16_bf16 v[32:47], v[180:183], v[96:99], v[32:47]
ds_read_b128 v[204:207], v3 offset:56320
s_waitcnt lgkmcnt(5)
v_mfma_f32_32x32x16_bf16 v[48:63], v[184:187], v[96:99], v[48:63]
ds_read_b128 v[176:179], v3 offset:57344
s_waitcnt lgkmcnt(5)
v_mfma_f32_32x32x16_bf16 v[64:79], v[188:191], v[96:99], v[64:79]
ds_read_b128 v[180:183], v3 offset:58368
s_waitcnt lgkmcnt(5)
v_mfma_f32_32x32x16_bf16 v[16:31], v[192:195], v[100:103], v[16:31]
ds_read_b128 v[184:187], v3 offset:59392
s_waitcnt lgkmcnt(5)
v_mfma_f32_32x32x16_bf16 v[32:47], v[196:199], v[100:103], v[32:47]
ds_read_b128 v[188:191], v3 offset:60416
s_waitcnt lgkmcnt(5)
v_mfma_f32_32x32x16_bf16 v[48:63], v[200:203], v[100:103], v[48:63]
ds_read_b128 v[192:195], v3 offset:61440
s_waitcnt lgkmcnt(5)
v_mfma_f32_32x32x16_bf16 v[64:79], v[204:207], v[100:103], v[64:79]
ds_read_b128 v[196:199], v3 offset:62464
s_waitcnt lgkmcnt(5)
v_mfma_f32_32x32x16_bf16 v[16:31], v[176:179], v[104:107], v[16:31]
ds_read_b128 v[200:203], v3 offset:63488
s_waitcnt lgkmcnt(5)
v_mfma_f32_32x32x16_bf16 v[32:47], v[180:183], v[104:107], v[32:47]
ds_read_b128 v[204:207], v3 offset:64512
s_waitcnt lgkmcnt(5)
v_mfma_f32_32x32x16_bf16 v[48:63], v[184:187], v[104:107], v[48:63]
ds_read_b128 v[176:179], v9 offset:0
s_waitcnt lgkmcnt(5)
v_mfma_f32_32x32x16_bf16 v[64:79], v[188:191], v[104:107], v[64:79]
ds_read_b128 v[180:183], v9 offset:1024
s_waitcnt lgkmcnt(5)
v_mfma_f32_32x32x16_bf16 v[16:31], v[192:195], v[108:111], v[16:31]
ds_read_b128 v[184:187], v9 offset:2048
s_waitcnt lgkmcnt(5)
v_mfma_f32_32x32x16_bf16 v[32:47], v[196:199], v[108:111], v[32:47]
ds_read_b128 v[188:191], v9 offset:3072
s_waitcnt lgkmcnt(5)
v_mfma_f32_32x32x16_bf16 v[48:63], v[200:203], v[108:111], v[48:63]
ds_read_b128 v[192:195], v9 offset:4096
s_waitcnt lgkmcnt(5)
v_mfma_f32_32x32x16_bf16 v[64:79], v[204:207], v[108:111], v[64:79]
ds_read_b128 v[196:199], v9 offset:5120
s_waitcnt vmcnt(7)
s_waitcnt lgkmcnt(5)
v_mfma_f32_32x32x16_bf16 v[16:31], v[176:179], v[112:115], v[16:31]
ds_read_b128 v[200:203], v9 offset:6144
s_waitcnt lgkmcnt(5)
v_mfma_f32_32x32x16_bf16 v[32:47], v[180:183], v[112:115], v[32:47]
ds_read_b128 v[204:207], v9 offset:7168
s_waitcnt lgkmcnt(5)
v_mfma_f32_32x32x16_bf16 v[48:63], v[184:187], v[112:115], v[48:63]
ds_read_b128 v[176:179], v9 offset:8192
s_waitcnt lgkmcnt(5)
v_mfma_f32_32x32x16_bf16 v[64:79], v[188:191], v[112:115], v[64:79]
ds_read_b128 v[180:183], v9 offset:9216
s_waitcnt vmcnt(6)
s_waitcnt lgkmcnt(5)
v_mfma_f32_32x32x16_bf16 v[16:31], v[192:195], v[116:119], v[16:31]
ds_read_b128 v[184:187], v9 offset:10240
s_waitcnt lgkmcnt(5)
v_mfma_f32_32x32x16_bf16 v[32:47], v[196:199], v[116:119], v[32:47]
ds_read_b128 v[188:191], v9 offset:11264
s_waitcnt lgkmcnt(5)
v_mfma_f32_32x32x16_bf16 v[48:63], v[200:203], v[116:119], v[48:63]
ds_read_b128 v[192:195], v9 offset:12288
s_waitcnt lgkmcnt(5)
v_mfma_f32_32x32x16_bf16 v[64:79], v[204:207], v[116:119], v[64:79]
ds_read_b128 v[196:199], v9 offset:13312
s_waitcnt vmcnt(5)
s_waitcnt lgkmcnt(5)
v_mfma_f32_32x32x16_bf16 v[16:31], v[176:179], v[120:123], v[16:31]
ds_read_b128 v[200:203], v9 offset:14336
s_waitcnt lgkmcnt(5)
v_mfma_f32_32x32x16_bf16 v[32:47], v[180:183], v[120:123], v[32:47]
ds_read_b128 v[204:207], v9 offset:15360
s_waitcnt lgkmcnt(5)
v_mfma_f32_32x32x16_bf16 v[48:63], v[184:187], v[120:123], v[48:63]
ds_read_b128 v[176:179], v9 offset:16384
s_waitcnt lgkmcnt(5)
v_mfma_f32_32x32x16_bf16 v[64:79], v[188:191], v[120:123], v[64:79]
ds_read_b128 v[180:183], v9 offset:17408
s_waitcnt vmcnt(4)
s_waitcnt lgkmcnt(5)
v_mfma_f32_32x32x16_bf16 v[16:31], v[192:195], v[124:127], v[16:31]
ds_read_b128 v[184:187], v9 offset:18432
s_waitcnt lgkmcnt(5)
v_mfma_f32_32x32x16_bf16 v[32:47], v[196:199], v[124:127], v[32:47]
ds_read_b128 v[188:191], v9 offset:19456
s_waitcnt lgkmcnt(5)
v_mfma_f32_32x32x16_bf16 v[48:63], v[200:203], v[124:127], v[48:63]
ds_read_b128 v[192:195], v9 offset:20480
s_waitcnt lgkmcnt(5)
v_mfma_f32_32x32x16_bf16 v[64:79], v[204:207], v[124:127], v[64:79]
ds_read_b128 v[196:199], v9 offset:21504
s_barrier
s_waitcnt vmcnt(3)
s_waitcnt lgkmcnt(5)
v_mfma_f32_32x32x16_bf16 v[16:31], v[176:179], v[128:131], v[16:31]
ds_read_b128 v[200:203], v9 offset:22528
s_waitcnt lgkmcnt(5)
v_mfma_f32_32x32x16_bf16 v[32:47], v[180:183], v[128:131], v[32:47]
ds_read_b128 v[204:207], v9 offset:23552
s_waitcnt lgkmcnt(5)
v_mfma_f32_32x32x16_bf16 v[48:63], v[184:187], v[128:131], v[48:63]
ds_read_b128 v[176:179], v9 offset:24576
s_waitcnt lgkmcnt(5)
v_mfma_f32_32x32x16_bf16 v[64:79], v[188:191], v[128:131], v[64:79]
ds_read_b128 v[180:183], v9 offset:25600
s_waitcnt vmcnt(2)
s_waitcnt lgkmcnt(5)
v_mfma_f32_32x32x16_bf16 v[16:31], v[192:195], v[132:135], v[16:31]
ds_read_b128 v[184:187], v9 offset:26624
s_waitcnt lgkmcnt(5)
v_mfma_f32_32x32x16_bf16 v[32:47], v[196:199], v[132:135], v[32:47]
ds_read_b128 v[188:191], v9 offset:27648
s_waitcnt lgkmcnt(5)
v_mfma_f32_32x32x16_bf16 v[48:63], v[200:203], v[132:135], v[48:63]
ds_read_b128 v[192:195], v9 offset:28672
s_waitcnt lgkmcnt(5)
v_mfma_f32_32x32x16_bf16 v[64:79], v[204:207], v[132:135], v[64:79]
ds_read_b128 v[196:199], v9 offset:29696
s_waitcnt vmcnt(1)
s_waitcnt lgkmcnt(5)
v_mfma_f32_32x32x16_bf16 v[16:31], v[176:179], v[136:139], v[16:31]
ds_read_b128 v[200:203], v9 offset:30720
s_waitcnt lgkmcnt(5)
v_mfma_f32_32x32x16_bf16 v[32:47], v[180:183], v[136:139], v[32:47]
ds_read_b128 v[204:207], v9 offset:31744
s_waitcnt lgkmcnt(5)
v_mfma_f32_32x32x16_bf16 v[48:63], v[184:187], v[136:139], v[48:63]
ds_read_b128 v[176:179], v1 offset:0
s_waitcnt lgkmcnt(5)
v_mfma_f32_32x32x16_bf16 v[64:79], v[188:191], v[136:139], v[64:79]
ds_read_b128 v[180:183], v1 offset:8192
s_waitcnt vmcnt(0)
s_waitcnt lgkmcnt(5)
v_mfma_f32_32x32x16_bf16 v[16:31], v[192:195], v[140:143], v[16:31]
ds_read_b128 v[184:187], v1 offset:1024
s_waitcnt lgkmcnt(5)
v_mfma_f32_32x32x16_bf16 v[32:47], v[196:199], v[140:143], v[32:47]
ds_read_b128 v[188:191], v1 offset:9216
s_waitcnt lgkmcnt(5)
v_mfma_f32_32x32x16_bf16 v[48:63], v[200:203], v[140:143], v[48:63]
ds_read_b128 v[192:195], v1 offset:2048
s_waitcnt lgkmcnt(5)
v_mfma_f32_32x32x16_bf16 v[64:79], v[204:207], v[140:143], v[64:79]
ds_read_b128 v[196:199], v1 offset:10240
s_barrier
s_mov_b32 s23, 0x3e0293ee
v_mul_f32 v16, s23, v16
v_mul_f32 v17, s23, v17
v_cvt_pk_bf16_f32 v144, v16, v17
v_mul_f32 v18, s23, v18
v_mul_f32 v19, s23, v19
v_cvt_pk_bf16_f32 v145, v18, v19
v_mul_f32 v20, s23, v20
v_mul_f32 v21, s23, v21
v_cvt_pk_bf16_f32 v146, v20, v21
v_mul_f32 v22, s23, v22
v_mul_f32 v23, s23, v23
v_cvt_pk_bf16_f32 v147, v22, v23
v_mul_f32 v24, s23, v24
v_mul_f32 v25, s23, v25
v_cvt_pk_bf16_f32 v148, v24, v25
v_mul_f32 v26, s23, v26
v_mul_f32 v27, s23, v27
v_cvt_pk_bf16_f32 v149, v26, v27
v_mul_f32 v28, s23, v28
v_mul_f32 v29, s23, v29
v_cvt_pk_bf16_f32 v150, v28, v29
v_mul_f32 v30, s23, v30
v_mul_f32 v31, s23, v31
v_cvt_pk_bf16_f32 v151, v30, v31
v_mul_f32 v32, s23, v32
v_mul_f32 v33, s23, v33
v_cvt_pk_bf16_f32 v152, v32, v33
v_mul_f32 v34, s23, v34
v_mul_f32 v35, s23, v35
v_cvt_pk_bf16_f32 v153, v34, v35
v_mul_f32 v36, s23, v36
v_mul_f32 v37, s23, v37
v_cvt_pk_bf16_f32 v154, v36, v37
v_mul_f32 v38, s23, v38
v_mul_f32 v39, s23, v39
v_cvt_pk_bf16_f32 v155, v38, v39
v_mul_f32 v40, s23, v40
v_mul_f32 v41, s23, v41
v_cvt_pk_bf16_f32 v156, v40, v41
v_mul_f32 v42, s23, v42
v_mul_f32 v43, s23, v43
v_cvt_pk_bf16_f32 v157, v42, v43
v_mul_f32 v44, s23, v44
v_mul_f32 v45, s23, v45
v_cvt_pk_bf16_f32 v158, v44, v45
v_mul_f32 v46, s23, v46
v_mul_f32 v47, s23, v47
v_cvt_pk_bf16_f32 v159, v46, v47
v_mul_f32 v48, s23, v48
v_mul_f32 v49, s23, v49
v_cvt_pk_bf16_f32 v160, v48, v49
v_mul_f32 v50, s23, v50
v_mul_f32 v51, s23, v51
v_cvt_pk_bf16_f32 v161, v50, v51
v_mul_f32 v52, s23, v52
v_mul_f32 v53, s23, v53
v_cvt_pk_bf16_f32 v162, v52, v53
v_mul_f32 v54, s23, v54
v_mul_f32 v55, s23, v55
v_cvt_pk_bf16_f32 v163, v54, v55
v_mul_f32 v56, s23, v56
v_mul_f32 v57, s23, v57
v_cvt_pk_bf16_f32 v164, v56, v57
v_mul_f32 v58, s23, v58
v_mul_f32 v59, s23, v59
v_cvt_pk_bf16_f32 v165, v58, v59
v_mul_f32 v60, s23, v60
v_mul_f32 v61, s23, v61
v_cvt_pk_bf16_f32 v166, v60, v61
v_mul_f32 v62, s23, v62
v_mul_f32 v63, s23, v63
v_cvt_pk_bf16_f32 v167, v62, v63
v_mul_f32 v64, s23, v64
v_mul_f32 v65, s23, v65
v_cvt_pk_bf16_f32 v168, v64, v65
v_mul_f32 v66, s23, v66
v_mul_f32 v67, s23, v67
v_cvt_pk_bf16_f32 v169, v66, v67
v_mul_f32 v68, s23, v68
v_mul_f32 v69, s23, v69
v_cvt_pk_bf16_f32 v170, v68, v69
v_mul_f32 v70, s23, v70
v_mul_f32 v71, s23, v71
v_cvt_pk_bf16_f32 v171, v70, v71
v_mul_f32 v72, s23, v72
v_mul_f32 v73, s23, v73
v_cvt_pk_bf16_f32 v172, v72, v73
v_mul_f32 v74, s23, v74
v_mul_f32 v75, s23, v75
v_cvt_pk_bf16_f32 v173, v74, v75
v_mul_f32 v76, s23, v76
v_mul_f32 v77, s23, v77
v_cvt_pk_bf16_f32 v174, v76, v77
v_mul_f32 v78, s23, v78
v_mul_f32 v79, s23, v79
v_cvt_pk_bf16_f32 v175, v78, v79
s_waitcnt lgkmcnt(5)
v_mfma_f32_32x32x16_bf16 v[80:95], v[176:179], v[144:147], 0
ds_read_b128 v[200:203], v1 offset:3072
v_mov_b32 v16, 0
v_mov_b32 v17, 0
v_mov_b32 v18, 0
v_mov_b32 v19, 0
s_waitcnt lgkmcnt(5)
v_mfma_f32_32x32x16_bf16 v[96:111], v[180:183], v[144:147], 0
ds_read_b128 v[204:207], v1 offset:11264
v_mov_b32 v20, 0
v_mov_b32 v21, 0
v_mov_b32 v22, 0
v_mov_b32 v23, 0
s_waitcnt lgkmcnt(5)
v_mfma_f32_32x32x16_bf16 v[80:95], v[184:187], v[148:151], v[80:95]
ds_read_b128 v[176:179], v1 offset:4096
v_mov_b32 v24, 0
v_mov_b32 v25, 0
v_mov_b32 v26, 0
v_mov_b32 v27, 0
s_waitcnt lgkmcnt(5)
v_mfma_f32_32x32x16_bf16 v[96:111], v[188:191], v[148:151], v[96:111]
ds_read_b128 v[180:183], v1 offset:12288
v_mov_b32 v28, 0
v_mov_b32 v29, 0
v_mov_b32 v30, 0
v_mov_b32 v31, 0
s_waitcnt lgkmcnt(5)
v_mfma_f32_32x32x16_bf16 v[80:95], v[192:195], v[152:155], v[80:95]
ds_read_b128 v[184:187], v1 offset:5120
v_mov_b32 v32, 0
v_mov_b32 v33, 0
v_mov_b32 v34, 0
v_mov_b32 v35, 0
s_waitcnt lgkmcnt(5)
v_mfma_f32_32x32x16_bf16 v[96:111], v[196:199], v[152:155], v[96:111]
ds_read_b128 v[188:191], v1 offset:13312
v_mov_b32 v36, 0
v_mov_b32 v37, 0
v_mov_b32 v38, 0
v_mov_b32 v39, 0
s_waitcnt lgkmcnt(5)
v_mfma_f32_32x32x16_bf16 v[80:95], v[200:203], v[156:159], v[80:95]
ds_read_b128 v[192:195], v1 offset:6144
v_mov_b32 v40, 0
v_mov_b32 v41, 0
v_mov_b32 v42, 0
v_mov_b32 v43, 0
s_waitcnt lgkmcnt(5)
v_mfma_f32_32x32x16_bf16 v[96:111], v[204:207], v[156:159], v[96:111]
ds_read_b128 v[196:199], v1 offset:14336
v_mov_b32 v44, 0
v_mov_b32 v45, 0
v_mov_b32 v46, 0
v_mov_b32 v47, 0
s_waitcnt lgkmcnt(5)
v_mfma_f32_32x32x16_bf16 v[80:95], v[176:179], v[160:163], v[80:95]
ds_read_b128 v[200:203], v1 offset:7168
v_mov_b32 v48, 0
v_mov_b32 v49, 0
v_mov_b32 v50, 0
v_mov_b32 v51, 0
s_waitcnt lgkmcnt(5)
v_mfma_f32_32x32x16_bf16 v[96:111], v[180:183], v[160:163], v[96:111]
ds_read_b128 v[204:207], v1 offset:15360
v_mov_b32 v52, 0
v_mov_b32 v53, 0
v_mov_b32 v54, 0
v_mov_b32 v55, 0
s_waitcnt lgkmcnt(5)
v_mfma_f32_32x32x16_bf16 v[80:95], v[184:187], v[164:167], v[80:95]
ds_read_b128 v[176:179], v1 offset:32768
v_mov_b32 v56, 0
v_mov_b32 v57, 0
v_mov_b32 v58, 0
v_mov_b32 v59, 0
s_waitcnt lgkmcnt(5)
v_mfma_f32_32x32x16_bf16 v[96:111], v[188:191], v[164:167], v[96:111]
ds_read_b128 v[180:183], v1 offset:40960
v_mov_b32 v60, 0
v_mov_b32 v61, 0
v_mov_b32 v62, 0
v_mov_b32 v63, 0
s_waitcnt lgkmcnt(5)
v_mfma_f32_32x32x16_bf16 v[80:95], v[192:195], v[168:171], v[80:95]
ds_read_b128 v[184:187], v1 offset:33792
v_mov_b32 v64, 0
v_mov_b32 v65, 0
v_mov_b32 v66, 0
v_mov_b32 v67, 0
s_waitcnt lgkmcnt(5)
v_mfma_f32_32x32x16_bf16 v[96:111], v[196:199], v[168:171], v[96:111]
ds_read_b128 v[188:191], v1 offset:41984
v_mov_b32 v68, 0
v_mov_b32 v69, 0
v_mov_b32 v70, 0
v_mov_b32 v71, 0
s_waitcnt lgkmcnt(5)
v_mfma_f32_32x32x16_bf16 v[80:95], v[200:203], v[172:175], v[80:95]
ds_read_b128 v[192:195], v1 offset:34816
v_mov_b32 v72, 0
v_mov_b32 v73, 0
v_mov_b32 v74, 0
v_mov_b32 v75, 0
s_waitcnt lgkmcnt(5)
v_mfma_f32_32x32x16_bf16 v[96:111], v[204:207], v[172:175], v[96:111]
ds_read_b128 v[196:199], v1 offset:43008
v_mov_b32 v76, 0
v_mov_b32 v77, 0
v_mov_b32 v78, 0
v_mov_b32 v79, 0
v_add_u32 v2, 0x8000, v1
s_mov_b32 s31, 0x10000
v_mov_b32 v6, 0
v_mov_b32 v7, 0
s_cmp_lg_u32 s25, 0
s_cbranch_scc1 .nomask_1044
v_cmp_gt_i32_e64 s[40:41], 0, v4
v_cmp_gt_i32_e64 s[42:43], 1, v4
v_cmp_gt_i32_e64 s[44:45], 2, v4
v_cmp_gt_i32_e64 s[46:47], 3, v4
v_cndmask_b32_e64 v80, v80, v8, s[40:41]
v_cndmask_b32_e64 v81, v81, v8, s[42:43]
v_cndmask_b32_e64 v82, v82, v8, s[44:45]
v_cndmask_b32_e64 v83, v83, v8, s[46:47]
v_cmp_gt_i32_e64 s[40:41], 8, v4
v_cmp_gt_i32_e64 s[42:43], 9, v4
v_cmp_gt_i32_e64 s[44:45], 10, v4
v_cmp_gt_i32_e64 s[46:47], 11, v4
v_cndmask_b32_e64 v84, v84, v8, s[40:41]
v_cndmask_b32_e64 v85, v85, v8, s[42:43]
v_cndmask_b32_e64 v86, v86, v8, s[44:45]
v_cndmask_b32_e64 v87, v87, v8, s[46:47]
v_cmp_gt_i32_e64 s[40:41], 16, v4
v_cmp_gt_i32_e64 s[42:43], 17, v4
v_cmp_gt_i32_e64 s[44:45], 18, v4
v_cmp_gt_i32_e64 s[46:47], 19, v4
v_cndmask_b32_e64 v88, v88, v8, s[40:41]
v_cndmask_b32_e64 v89, v89, v8, s[42:43]
v_cndmask_b32_e64 v90, v90, v8, s[44:45]
v_cndmask_b32_e64 v91, v91, v8, s[46:47]
v_cmp_gt_i32_e64 s[40:41], 24, v4
v_cmp_gt_i32_e64 s[42:43], 25, v4
v_cmp_gt_i32_e64 s[44:45], 26, v4
v_cmp_gt_i32_e64 s[46:47], 27, v4
v_cndmask_b32_e64 v92, v92, v8, s[40:41]
v_cndmask_b32_e64 v93, v93, v8, s[42:43]
v_cndmask_b32_e64 v94, v94, v8, s[44:45]
v_cndmask_b32_e64 v95, v95, v8, s[46:47]
v_cmp_gt_i32_e64 s[40:41], 32, v4
v_cmp_gt_i32_e64 s[42:43], 33, v4
v_cmp_gt_i32_e64 s[44:45], 34, v4
v_cmp_gt_i32_e64 s[46:47], 35, v4
v_cndmask_b32_e64 v96, v96, v8, s[40:41]
v_cndmask_b32_e64 v97, v97, v8, s[42:43]
v_cndmask_b32_e64 v98, v98, v8, s[44:45]
v_cndmask_b32_e64 v99, v99, v8, s[46:47]
v_cmp_gt_i32_e64 s[40:41], 40, v4
v_cmp_gt_i32_e64 s[42:43], 41, v4
v_cmp_gt_i32_e64 s[44:45], 42, v4
v_cmp_gt_i32_e64 s[46:47], 43, v4
v_cndmask_b32_e64 v100, v100, v8, s[40:41]
v_cndmask_b32_e64 v101, v101, v8, s[42:43]
v_cndmask_b32_e64 v102, v102, v8, s[44:45]
v_cndmask_b32_e64 v103, v103, v8, s[46:47]
v_cmp_gt_i32_e64 s[40:41], 48, v4
v_cmp_gt_i32_e64 s[42:43], 49, v4
v_cmp_gt_i32_e64 s[44:45], 50, v4
v_cmp_gt_i32_e64 s[46:47], 51, v4
v_cndmask_b32_e64 v104, v104, v8, s[40:41]
v_cndmask_b32_e64 v105, v105, v8, s[42:43]
v_cndmask_b32_e64 v106, v106, v8, s[44:45]
v_cndmask_b32_e64 v107, v107, v8, s[46:47]
v_cmp_gt_i32_e64 s[40:41], 56, v4
v_cmp_gt_i32_e64 s[42:43], 57, v4
v_cmp_gt_i32_e64 s[44:45], 58, v4
v_cmp_gt_i32_e64 s[46:47], 59, v4
v_cndmask_b32_e64 v108, v108, v8, s[40:41]
v_cndmask_b32_e64 v109, v109, v8, s[42:43]
v_cndmask_b32_e64 v110, v110, v8, s[44:45]
v_cndmask_b32_e64 v111, v111, v8, s[46:47]
.nomask_1044:
v_max3_f32 v5, v80, v81, v82
v_max3_f32 v5, v5, v83, v84
v_max3_f32 v5, v5, v85, v86
v_max3_f32 v5, v5, v87, v88
v_max3_f32 v5, v5, v89, v90
v_max3_f32 v5, v5, v91, v92
v_max3_f32 v5, v5, v93, v94
v_max3_f32 v5, v5, v95, v96
v_max3_f32 v5, v5, v97, v98
v_max3_f32 v5, v5, v99, v100
v_max3_f32 v5, v5, v101, v102
v_max3_f32 v5, v5, v103, v104
v_max3_f32 v5, v5, v105, v106
v_max3_f32 v5, v5, v107, v108
v_max3_f32 v5, v5, v109, v110
v_max_f32 v5, v5, v111
v_mov_b32 v10, v5
s_nop 1
v_permlane32_swap_b32 v10, v5
v_max_f32 v10, v10, v5
v_sub_f32 v80, v80, v10
v_sub_f32 v81, v81, v10
v_sub_f32 v82, v82, v10
v_sub_f32 v83, v83, v10
v_sub_f32 v84, v84, v10
v_sub_f32 v85, v85, v10
v_sub_f32 v86, v86, v10
v_sub_f32 v87, v87, v10
v_sub_f32 v88, v88, v10
v_sub_f32 v89, v89, v10
v_sub_f32 v90, v90, v10
v_sub_f32 v91, v91, v10
v_sub_f32 v92, v92, v10
v_sub_f32 v93, v93, v10
v_sub_f32 v94, v94, v10
v_sub_f32 v95, v95, v10
v_sub_f32 v96, v96, v10
v_sub_f32 v97, v97, v10
v_sub_f32 v98, v98, v10
v_sub_f32 v99, v99, v10
v_sub_f32 v100, v100, v10
v_sub_f32 v101, v101, v10
v_sub_f32 v102, v102, v10
v_sub_f32 v103, v103, v10
v_sub_f32 v104, v104, v10
v_sub_f32 v105, v105, v10
v_sub_f32 v106, v106, v10
v_sub_f32 v107, v107, v10
v_sub_f32 v108, v108, v10
v_sub_f32 v109, v109, v10
v_sub_f32 v110, v110, v10
v_sub_f32 v111, v111, v10
v_sub_f32 v208, 0, v10
v_sub_f32 v209, 0, v10
v_sub_f32 v210, 0, v10
v_sub_f32 v211, 0, v10
v_sub_f32 v212, 0, v10
v_sub_f32 v213, 0, v10
v_sub_f32 v214, 0, v10
v_sub_f32 v215, 0, v10
v_sub_f32 v216, 0, v10
v_sub_f32 v217, 0, v10
v_sub_f32 v218, 0, v10
v_sub_f32 v219, 0, v10
v_sub_f32 v220, 0, v10
v_sub_f32 v221, 0, v10
v_sub_f32 v222, 0, v10
v_sub_f32 v223, 0, v10
.loop_1045:
s_cmp_eq_u32 s25, 0
s_cbranch_scc1 .final_1047
s_barrier
s_setprio 3
s_waitcnt lgkmcnt(5)
v_mfma_f32_32x32x16_bf16 v[112:127], v[176:179], v[144:147], v[208:223]
ds_read_b128 v[200:203], v2 offset:3072
v_exp_f32 v80, v80
v_exp_f32 v81, v81
s_waitcnt lgkmcnt(5)
v_mfma_f32_32x32x16_bf16 v[128:143], v[180:183], v[144:147], v[208:223]
ds_read_b128 v[204:207], v2 offset:11264
v_exp_f32 v82, v82
v_exp_f32 v83, v83
s_waitcnt lgkmcnt(5)
v_mfma_f32_32x32x16_bf16 v[112:127], v[184:187], v[148:151], v[112:127]
ds_read_b128 v[176:179], v2 offset:4096
v_exp_f32 v84, v84
v_exp_f32 v85, v85
s_waitcnt lgkmcnt(5)
v_mfma_f32_32x32x16_bf16 v[128:143], v[188:191], v[148:151], v[128:143]
ds_read_b128 v[180:183], v2 offset:12288
v_exp_f32 v86, v86
v_exp_f32 v87, v87
s_waitcnt lgkmcnt(5)
v_mfma_f32_32x32x16_bf16 v[112:127], v[192:195], v[152:155], v[112:127]
ds_read_b128 v[184:187], v2 offset:5120
v_exp_f32 v88, v88
v_exp_f32 v89, v89
s_waitcnt lgkmcnt(5)
v_mfma_f32_32x32x16_bf16 v[128:143], v[196:199], v[152:155], v[128:143]
ds_read_b128 v[188:191], v2 offset:13312
v_exp_f32 v90, v90
v_cvt_pk_bf16_f32 v224, v80, v81
v_cvt_pk_bf16_f32 v225, v82, v83
s_waitcnt lgkmcnt(5)
v_mfma_f32_32x32x16_bf16 v[112:127], v[200:203], v[156:159], v[112:127]
ds_read_b128 v[192:195], v2 offset:6144
v_exp_f32 v91, v91
v_cvt_pk_bf16_f32 v226, v84, v85
v_cvt_pk_bf16_f32 v227, v86, v87
s_waitcnt lgkmcnt(5)
v_mfma_f32_32x32x16_bf16 v[128:143], v[204:207], v[156:159], v[128:143]
ds_read_b128 v[196:199], v2 offset:14336
v_exp_f32 v92, v92
v_cvt_pk_bf16_f32 v228, v88, v89
v_cvt_pk_bf16_f32 v229, v90, v91
s_setprio 2
s_waitcnt lgkmcnt(5)
v_mfma_f32_32x32x16_bf16 v[112:127], v[176:179], v[160:163], v[112:127]
ds_read_b128 v[200:203], v2 offset:7168
v_exp_f32 v93, v93
v_add_f32 v6, v6, v80
v_add_f32 v7, v7, v81
s_waitcnt lgkmcnt(5)
v_mfma_f32_32x32x16_bf16 v[128:143], v[180:183], v[160:163], v[128:143]
ds_read_b128 v[204:207], v2 offset:15360
v_exp_f32 v94, v94
v_cvt_pk_bf16_f32 v230, v92, v93
v_add_f32 v6, v6, v82
s_waitcnt lgkmcnt(5)
v_mfma_f32_32x32x16_bf16 v[112:127], v[184:187], v[164:167], v[112:127]
ds_read_b128 v[176:179], v2 offset:16384
v_exp_f32 v95, v95
v_add_f32 v7, v7, v83
v_add_f32 v6, v6, v84
s_waitcnt lgkmcnt(5)
v_mfma_f32_32x32x16_bf16 v[128:143], v[188:191], v[164:167], v[128:143]
ds_read_b128 v[180:183], v2 offset:17408
v_exp_f32 v96, v96
v_cvt_pk_bf16_f32 v231, v94, v95
v_add_f32 v7, v7, v85
s_waitcnt lgkmcnt(5)
v_mfma_f32_32x32x16_bf16 v[112:127], v[192:195], v[168:171], v[112:127]
ds_read_b128 v[184:187], v2 offset:18432
v_add_u32 v3, s31, v1
s_add_u32 s31, s31, 0x8000
s_cmp_ge_u32 s31, 163840
s_cselect_b32 s31, 0, s31
v_exp_f32 v97, v97
v_add_f32 v6, v6, v86
v_add_f32 v7, v7, v87
s_waitcnt lgkmcnt(5)
v_mfma_f32_32x32x16_bf16 v[128:143], v[196:199], v[168:171], v[128:143]
ds_read_b128 v[188:191], v2 offset:19456
v_exp_f32 v98, v98
v_cvt_pk_bf16_f32 v232, v96, v97
v_add_f32 v6, v6, v88
s_waitcnt lgkmcnt(5)
v_mfma_f32_32x32x16_bf16 v[112:127], v[200:203], v[172:175], v[112:127]
ds_read_b128 v[192:195], v2 offset:20480
v_exp_f32 v99, v99
v_add_f32 v7, v7, v89
v_add_f32 v6, v6, v90
s_waitcnt lgkmcnt(5)
v_mfma_f32_32x32x16_bf16 v[128:143], v[204:207], v[172:175], v[128:143]
ds_read_b128 v[196:199], v2 offset:21504
v_exp_f32 v100, v100
v_cvt_pk_bf16_f32 v233, v98, v99
v_add_f32 v7, v7, v91
s_setprio 1
s_waitcnt lgkmcnt(5)
v_mfma_f32_32x32x16_bf16 v[16:31], v[176:179], v[224:227], v[16:31]
ds_read_b128 v[200:203], v2 offset:22528
v_exp_f32 v101, v101
v_add_f32 v6, v6, v92
v_add_f32 v7, v7, v93
s_waitcnt lgkmcnt(5)
v_mfma_f32_32x32x16_bf16 v[32:47], v[180:183], v[224:227], v[32:47]
ds_read_b128 v[204:207], v2 offset:23552
s_cmp_eq_u32 s25, 1
s_cbranch_scc1 .mask_1050
.maskr_1051:
v_exp_f32 v102, v102
v_cvt_pk_bf16_f32 v234, v100, v101
v_add_f32 v6, v6, v94
s_waitcnt lgkmcnt(5)
v_mfma_f32_32x32x16_bf16 v[48:63], v[184:187], v[224:227], v[48:63]
ds_read_b128 v[176:179], v2 offset:24576
v_exp_f32 v103, v103
v_max3_f32 v5, v112, v113, v114
v_max3_f32 v5, v5, v115, v116
s_waitcnt lgkmcnt(5)
v_mfma_f32_32x32x16_bf16 v[64:79], v[188:191], v[224:227], v[64:79]
ds_read_b128 v[180:183], v2 offset:25600
v_exp_f32 v104, v104
v_cvt_pk_bf16_f32 v235, v102, v103
v_max3_f32 v5, v5, v117, v118
s_waitcnt lgkmcnt(5)
v_mfma_f32_32x32x16_bf16 v[16:31], v[192:195], v[228:231], v[16:31]
ds_read_b128 v[184:187], v2 offset:26624
v_exp_f32 v105, v105
v_max3_f32 v5, v5, v119, v120
v_max3_f32 v5, v5, v121, v122
s_waitcnt lgkmcnt(5)
v_mfma_f32_32x32x16_bf16 v[32:47], v[196:199], v[228:231], v[32:47]
ds_read_b128 v[188:191], v2 offset:27648
v_exp_f32 v106, v106
v_cvt_pk_bf16_f32 v236, v104, v105
v_max3_f32 v5, v5, v123, v124
s_waitcnt lgkmcnt(5)
v_mfma_f32_32x32x16_bf16 v[48:63], v[200:203], v[228:231], v[48:63]
ds_read_b128 v[192:195], v2 offset:28672
v_exp_f32 v107, v107
v_max3_f32 v5, v5, v125, v126
v_max3_f32 v5, v5, v127, v128
s_waitcnt lgkmcnt(5)
v_mfma_f32_32x32x16_bf16 v[64:79], v[204:207], v[228:231], v[64:79]
ds_read_b128 v[196:199], v2 offset:29696
v_exp_f32 v108, v108
v_cvt_pk_bf16_f32 v237, v106, v107
v_max3_f32 v5, v5, v129, v130
s_setprio 0
s_waitcnt lgkmcnt(5)
v_mfma_f32_32x32x16_bf16 v[16:31], v[176:179], v[232:235], v[16:31]
ds_read_b128 v[200:203], v2 offset:30720
v_exp_f32 v109, v109
v_max3_f32 v5, v5, v131, v132
v_max3_f32 v5, v5, v133, v134
s_waitcnt lgkmcnt(5)
v_mfma_f32_32x32x16_bf16 v[32:47], v[180:183], v[232:235], v[32:47]
ds_read_b128 v[204:207], v2 offset:31744
v_exp_f32 v110, v110
v_cvt_pk_bf16_f32 v238, v108, v109
v_max3_f32 v5, v5, v135, v136
s_waitcnt lgkmcnt(5)
v_mfma_f32_32x32x16_bf16 v[48:63], v[184:187], v[232:235], v[48:63]
ds_read_b128 v[176:179], v3 offset:0
v_exp_f32 v111, v111
v_max3_f32 v5, v5, v137, v138
v_max3_f32 v5, v5, v139, v140
s_waitcnt lgkmcnt(5)
v_mfma_f32_32x32x16_bf16 v[64:79], v[188:191], v[232:235], v[64:79]
ds_read_b128 v[180:183], v3 offset:8192
v_cvt_pk_bf16_f32 v239, v110, v111
v_max3_f32 v5, v5, v141, v142
v_max_f32 v5, v5, v143
v_cmp_lt_f32 vcc, 0x41000000, v5
s_waitcnt lgkmcnt(5)
v_mfma_f32_32x32x16_bf16 v[16:31], v[192:195], v[236:239], v[16:31]
ds_read_b128 v[184:187], v3 offset:1024
v_add_f32 v7, v7, v95
v_add_f32 v6, v6, v96
v_add_f32 v7, v7, v97
v_add_f32 v6, v6, v98
s_waitcnt lgkmcnt(5)
v_mfma_f32_32x32x16_bf16 v[32:47], v[196:199], v[236:239], v[32:47]
ds_read_b128 v[188:191], v3 offset:9216
v_add_f32 v7, v7, v99
v_add_f32 v6, v6, v100
v_add_f32 v7, v7, v101
v_add_f32 v6, v6, v102
s_waitcnt lgkmcnt(5)
v_mfma_f32_32x32x16_bf16 v[48:63], v[200:203], v[236:239], v[48:63]
ds_read_b128 v[192:195], v3 offset:2048
v_add_f32 v7, v7, v103
v_add_f32 v6, v6, v104
v_add_f32 v7, v7, v105
v_add_f32 v6, v6, v106
s_waitcnt lgkmcnt(5)
v_mfma_f32_32x32x16_bf16 v[64:79], v[204:207], v[236:239], v[64:79]
ds_read_b128 v[196:199], v3 offset:10240
v_add_f32 v7, v7, v107
v_add_f32 v6, v6, v108
v_add_f32 v7, v7, v109
v_add_f32 v6, v6, v110
v_add_f32 v7, v7, v111
s_sub_u32 s25, s25, 1
s_cbranch_vccnz .resc_1052
.rescr_1053:
.loop_1046:
s_cmp_eq_u32 s25, 0
s_cbranch_scc1 .final_1048
s_barrier
s_setprio 3
s_waitcnt lgkmcnt(5)
v_mfma_f32_32x32x16_bf16 v[80:95], v[176:179], v[144:147], v[208:223]
ds_read_b128 v[200:203], v3 offset:3072
v_exp_f32 v112, v112
v_exp_f32 v113, v113
s_waitcnt lgkmcnt(5)
v_mfma_f32_32x32x16_bf16 v[96:111], v[180:183], v[144:147], v[208:223]
ds_read_b128 v[204:207], v3 offset:11264
v_exp_f32 v114, v114
v_exp_f32 v115, v115
s_waitcnt lgkmcnt(5)
v_mfma_f32_32x32x16_bf16 v[80:95], v[184:187], v[148:151], v[80:95]
ds_read_b128 v[176:179], v3 offset:4096
v_exp_f32 v116, v116
v_exp_f32 v117, v117
s_waitcnt lgkmcnt(5)
v_mfma_f32_32x32x16_bf16 v[96:111], v[188:191], v[148:151], v[96:111]
ds_read_b128 v[180:183], v3 offset:12288
v_exp_f32 v118, v118
v_exp_f32 v119, v119
s_waitcnt lgkmcnt(5)
v_mfma_f32_32x32x16_bf16 v[80:95], v[192:195], v[152:155], v[80:95]
ds_read_b128 v[184:187], v3 offset:5120
v_exp_f32 v120, v120
v_exp_f32 v121, v121
s_waitcnt lgkmcnt(5)
v_mfma_f32_32x32x16_bf16 v[96:111], v[196:199], v[152:155], v[96:111]
ds_read_b128 v[188:191], v3 offset:13312
v_exp_f32 v122, v122
v_cvt_pk_bf16_f32 v224, v112, v113
v_cvt_pk_bf16_f32 v225, v114, v115
s_waitcnt lgkmcnt(5)
v_mfma_f32_32x32x16_bf16 v[80:95], v[200:203], v[156:159], v[80:95]
ds_read_b128 v[192:195], v3 offset:6144
v_exp_f32 v123, v123
v_cvt_pk_bf16_f32 v226, v116, v117
v_cvt_pk_bf16_f32 v227, v118, v119
s_waitcnt lgkmcnt(5)
v_mfma_f32_32x32x16_bf16 v[96:111], v[204:207], v[156:159], v[96:111]
ds_read_b128 v[196:199], v3 offset:14336
v_exp_f32 v124, v124
v_cvt_pk_bf16_f32 v228, v120, v121
v_cvt_pk_bf16_f32 v229, v122, v123
s_setprio 2
s_waitcnt lgkmcnt(5)
v_mfma_f32_32x32x16_bf16 v[80:95], v[176:179], v[160:163], v[80:95]
ds_read_b128 v[200:203], v3 offset:7168
v_exp_f32 v125, v125
v_add_f32 v6, v6, v112
v_add_f32 v7, v7, v113
s_waitcnt lgkmcnt(5)
v_mfma_f32_32x32x16_bf16 v[96:111], v[180:183], v[160:163], v[96:111]
ds_read_b128 v[204:207], v3 offset:15360
v_exp_f32 v126, v126
v_cvt_pk_bf16_f32 v230, v124, v125
v_add_f32 v6, v6, v114
s_waitcnt lgkmcnt(5)
v_mfma_f32_32x32x16_bf16 v[80:95], v[184:187], v[164:167], v[80:95]
ds_read_b128 v[176:179], v3 offset:16384
v_exp_f32 v127, v127
v_add_f32 v7, v7, v115
v_add_f32 v6, v6, v116
s_waitcnt lgkmcnt(5)
v_mfma_f32_32x32x16_bf16 v[96:111], v[188:191], v[164:167], v[96:111]
ds_read_b128 v[180:183], v3 offset:17408
v_exp_f32 v128, v128
v_cvt_pk_bf16_f32 v231, v126, v127
v_add_f32 v7, v7, v117
s_waitcnt lgkmcnt(5)
v_mfma_f32_32x32x16_bf16 v[80:95], v[192:195], v[168:171], v[80:95]
ds_read_b128 v[184:187], v3 offset:18432
v_add_u32 v2, s31, v1
s_add_u32 s31, s31, 0x8000
s_cmp_ge_u32 s31, 163840
s_cselect_b32 s31, 0, s31
v_exp_f32 v129, v129
v_add_f32 v6, v6, v118
v_add_f32 v7, v7, v119
s_waitcnt lgkmcnt(5)
v_mfma_f32_32x32x16_bf16 v[96:111], v[196:199], v[168:171], v[96:111]
ds_read_b128 v[188:191], v3 offset:19456
v_exp_f32 v130, v130
v_cvt_pk_bf16_f32 v232, v128, v129
v_add_f32 v6, v6, v120
s_waitcnt lgkmcnt(5)
v_mfma_f32_32x32x16_bf16 v[80:95], v[200:203], v[172:175], v[80:95]
ds_read_b128 v[192:195], v3 offset:20480
v_exp_f32 v131, v131
v_add_f32 v7, v7, v121
v_add_f32 v6, v6, v122
s_waitcnt lgkmcnt(5)
v_mfma_f32_32x32x16_bf16 v[96:111], v[204:207], v[172:175], v[96:111]
ds_read_b128 v[196:199], v3 offset:21504
v_exp_f32 v132, v132
v_cvt_pk_bf16_f32 v233, v130, v131
v_add_f32 v7, v7, v123
s_setprio 1
s_waitcnt lgkmcnt(5)
v_mfma_f32_32x32x16_bf16 v[16:31], v[176:179], v[224:227], v[16:31]
ds_read_b128 v[200:203], v3 offset:22528
v_exp_f32 v133, v133
v_add_f32 v6, v6, v124
v_add_f32 v7, v7, v125
s_waitcnt lgkmcnt(5)
v_mfma_f32_32x32x16_bf16 v[32:47], v[180:183], v[224:227], v[32:47]
ds_read_b128 v[204:207], v3 offset:23552
s_cmp_eq_u32 s25, 1
s_cbranch_scc1 .mask_1054
.maskr_1055:
v_exp_f32 v134, v134
v_cvt_pk_bf16_f32 v234, v132, v133
v_add_f32 v6, v6, v126
s_waitcnt lgkmcnt(5)
v_mfma_f32_32x32x16_bf16 v[48:63], v[184:187], v[224:227], v[48:63]
ds_read_b128 v[176:179], v3 offset:24576
v_exp_f32 v135, v135
v_max3_f32 v5, v80, v81, v82
v_max3_f32 v5, v5, v83, v84
s_waitcnt lgkmcnt(5)
v_mfma_f32_32x32x16_bf16 v[64:79], v[188:191], v[224:227], v[64:79]
ds_read_b128 v[180:183], v3 offset:25600
v_exp_f32 v136, v136
v_cvt_pk_bf16_f32 v235, v134, v135
v_max3_f32 v5, v5, v85, v86
s_waitcnt lgkmcnt(5)
v_mfma_f32_32x32x16_bf16 v[16:31], v[192:195], v[228:231], v[16:31]
ds_read_b128 v[184:187], v3 offset:26624
v_exp_f32 v137, v137
v_max3_f32 v5, v5, v87, v88
v_max3_f32 v5, v5, v89, v90
s_waitcnt lgkmcnt(5)
v_mfma_f32_32x32x16_bf16 v[32:47], v[196:199], v[228:231], v[32:47]
ds_read_b128 v[188:191], v3 offset:27648
v_exp_f32 v138, v138
v_cvt_pk_bf16_f32 v236, v136, v137
v_max3_f32 v5, v5, v91, v92
s_waitcnt lgkmcnt(5)
v_mfma_f32_32x32x16_bf16 v[48:63], v[200:203], v[228:231], v[48:63]
ds_read_b128 v[192:195], v3 offset:28672
v_exp_f32 v139, v139
v_max3_f32 v5, v5, v93, v94
v_max3_f32 v5, v5, v95, v96
s_waitcnt lgkmcnt(5)
v_mfma_f32_32x32x16_bf16 v[64:79], v[204:207], v[228:231], v[64:79]
ds_read_b128 v[196:199], v3 offset:29696
v_exp_f32 v140, v140
v_cvt_pk_bf16_f32 v237, v138, v139
v_max3_f32 v5, v5, v97, v98
s_setprio 0
s_waitcnt lgkmcnt(5)
v_mfma_f32_32x32x16_bf16 v[16:31], v[176:179], v[232:235], v[16:31]
ds_read_b128 v[200:203], v3 offset:30720
v_exp_f32 v141, v141
v_max3_f32 v5, v5, v99, v100
v_max3_f32 v5, v5, v101, v102
s_waitcnt lgkmcnt(5)
v_mfma_f32_32x32x16_bf16 v[32:47], v[180:183], v[232:235], v[32:47]
ds_read_b128 v[204:207], v3 offset:31744
v_exp_f32 v142, v142
v_cvt_pk_bf16_f32 v238, v140, v141
v_max3_f32 v5, v5, v103, v104
s_waitcnt lgkmcnt(5)
v_mfma_f32_32x32x16_bf16 v[48:63], v[184:187], v[232:235], v[48:63]
ds_read_b128 v[176:179], v2 offset:0
v_exp_f32 v143, v143
v_max3_f32 v5, v5, v105, v106
v_max3_f32 v5, v5, v107, v108
s_waitcnt lgkmcnt(5)
v_mfma_f32_32x32x16_bf16 v[64:79], v[188:191], v[232:235], v[64:79]
ds_read_b128 v[180:183], v2 offset:8192
v_cvt_pk_bf16_f32 v239, v142, v143
v_max3_f32 v5, v5, v109, v110
v_max_f32 v5, v5, v111
v_cmp_lt_f32 vcc, 0x41000000, v5
s_waitcnt lgkmcnt(5)
v_mfma_f32_32x32x16_bf16 v[16:31], v[192:195], v[236:239], v[16:31]
ds_read_b128 v[184:187], v2 offset:1024
v_add_f32 v7, v7, v127
v_add_f32 v6, v6, v128
v_add_f32 v7, v7, v129
v_add_f32 v6, v6, v130
s_waitcnt lgkmcnt(5)
v_mfma_f32_32x32x16_bf16 v[32:47], v[196:199], v[236:239], v[32:47]
ds_read_b128 v[188:191], v2 offset:9216
v_add_f32 v7, v7, v131
v_add_f32 v6, v6, v132
v_add_f32 v7, v7, v133
v_add_f32 v6, v6, v134
s_waitcnt lgkmcnt(5)
v_mfma_f32_32x32x16_bf16 v[48:63], v[200:203], v[236:239], v[48:63]
ds_read_b128 v[192:195], v2 offset:2048
v_add_f32 v7, v7, v135
v_add_f32 v6, v6, v136
v_add_f32 v7, v7, v137
v_add_f32 v6, v6, v138
s_waitcnt lgkmcnt(5)
v_mfma_f32_32x32x16_bf16 v[64:79], v[204:207], v[236:239], v[64:79]
ds_read_b128 v[196:199], v2 offset:10240
v_add_f32 v7, v7, v139
v_add_f32 v6, v6, v140
v_add_f32 v7, v7, v141
v_add_f32 v6, v6, v142
v_add_f32 v7, v7, v143
s_sub_u32 s25, s25, 1
s_cbranch_vccnz .resc_1056
.rescr_1057:
s_branch .loop_1045
.mask_1050:
v_cmp_gt_i32_e64 s[40:41], 0, v4
v_cmp_gt_i32_e64 s[42:43], 1, v4
v_cmp_gt_i32_e64 s[44:45], 2, v4
v_cmp_gt_i32_e64 s[46:47], 3, v4
v_cndmask_b32_e64 v112, v112, v8, s[40:41]
v_cndmask_b32_e64 v113, v113, v8, s[42:43]
v_cndmask_b32_e64 v114, v114, v8, s[44:45]
v_cndmask_b32_e64 v115, v115, v8, s[46:47]
v_cmp_gt_i32_e64 s[40:41], 8, v4
v_cmp_gt_i32_e64 s[42:43], 9, v4
v_cmp_gt_i32_e64 s[44:45], 10, v4
v_cmp_gt_i32_e64 s[46:47], 11, v4
v_cndmask_b32_e64 v116, v116, v8, s[40:41]
v_cndmask_b32_e64 v117, v117, v8, s[42:43]
v_cndmask_b32_e64 v118, v118, v8, s[44:45]
v_cndmask_b32_e64 v119, v119, v8, s[46:47]
v_cmp_gt_i32_e64 s[40:41], 16, v4
v_cmp_gt_i32_e64 s[42:43], 17, v4
v_cmp_gt_i32_e64 s[44:45], 18, v4
v_cmp_gt_i32_e64 s[46:47], 19, v4
v_cndmask_b32_e64 v120, v120, v8, s[40:41]
v_cndmask_b32_e64 v121, v121, v8, s[42:43]
v_cndmask_b32_e64 v122, v122, v8, s[44:45]
v_cndmask_b32_e64 v123, v123, v8, s[46:47]
v_cmp_gt_i32_e64 s[40:41], 24, v4
v_cmp_gt_i32_e64 s[42:43], 25, v4
v_cmp_gt_i32_e64 s[44:45], 26, v4
v_cmp_gt_i32_e64 s[46:47], 27, v4
v_cndmask_b32_e64 v124, v124, v8, s[40:41]
v_cndmask_b32_e64 v125, v125, v8, s[42:43]
v_cndmask_b32_e64 v126, v126, v8, s[44:45]
v_cndmask_b32_e64 v127, v127, v8, s[46:47]
v_cmp_gt_i32_e64 s[40:41], 32, v4
v_cmp_gt_i32_e64 s[42:43], 33, v4
v_cmp_gt_i32_e64 s[44:45], 34, v4
v_cmp_gt_i32_e64 s[46:47], 35, v4
v_cndmask_b32_e64 v128, v128, v8, s[40:41]
v_cndmask_b32_e64 v129, v129, v8, s[42:43]
v_cndmask_b32_e64 v130, v130, v8, s[44:45]
v_cndmask_b32_e64 v131, v131, v8, s[46:47]
v_cmp_gt_i32_e64 s[40:41], 40, v4
v_cmp_gt_i32_e64 s[42:43], 41, v4
v_cmp_gt_i32_e64 s[44:45], 42, v4
v_cmp_gt_i32_e64 s[46:47], 43, v4
v_cndmask_b32_e64 v132, v132, v8, s[40:41]
v_cndmask_b32_e64 v133, v133, v8, s[42:43]
v_cndmask_b32_e64 v134, v134, v8, s[44:45]
v_cndmask_b32_e64 v135, v135, v8, s[46:47]
v_cmp_gt_i32_e64 s[40:41], 48, v4
v_cmp_gt_i32_e64 s[42:43], 49, v4
v_cmp_gt_i32_e64 s[44:45], 50, v4
v_cmp_gt_i32_e64 s[46:47], 51, v4
v_cndmask_b32_e64 v136, v136, v8, s[40:41]
v_cndmask_b32_e64 v137, v137, v8, s[42:43]
v_cndmask_b32_e64 v138, v138, v8, s[44:45]
v_cndmask_b32_e64 v139, v139, v8, s[46:47]
v_cmp_gt_i32_e64 s[40:41], 56, v4
v_cmp_gt_i32_e64 s[42:43], 57, v4
v_cmp_gt_i32_e64 s[44:45], 58, v4
v_cmp_gt_i32_e64 s[46:47], 59, v4
v_cndmask_b32_e64 v140, v140, v8, s[40:41]
v_cndmask_b32_e64 v141, v141, v8, s[42:43]
v_cndmask_b32_e64 v142, v142, v8, s[44:45]
v_cndmask_b32_e64 v143, v143, v8, s[46:47]
s_branch .maskr_1051
.resc_1052:
v_mov_b32 v10, v5
s_nop 1
v_permlane32_swap_b32 v10, v5
v_max3_f32 v10, v10, v5, 0
v_exp_f32_e64 v11, -v10
v_sub_f32 v112, v112, v10
v_sub_f32 v113, v113, v10
v_sub_f32 v114, v114, v10
v_sub_f32 v115, v115, v10
v_sub_f32 v116, v116, v10
v_sub_f32 v117, v117, v10
v_sub_f32 v118, v118, v10
v_sub_f32 v119, v119, v10
v_sub_f32 v120, v120, v10
v_sub_f32 v121, v121, v10
v_sub_f32 v122, v122, v10
v_sub_f32 v123, v123, v10
v_sub_f32 v124, v124, v10
v_sub_f32 v125, v125, v10
v_sub_f32 v126, v126, v10
v_sub_f32 v127, v127, v10
v_sub_f32 v128, v128, v10
v_sub_f32 v129, v129, v10
v_sub_f32 v130, v130, v10
v_sub_f32 v131, v131, v10
v_sub_f32 v132, v132, v10
v_sub_f32 v133, v133, v10
v_sub_f32 v134, v134, v10
v_sub_f32 v135, v135, v10
v_sub_f32 v136, v136, v10
v_sub_f32 v137, v137, v10
v_sub_f32 v138, v138, v10
v_sub_f32 v139, v139, v10
v_sub_f32 v140, v140, v10
v_sub_f32 v141, v141, v10
v_sub_f32 v142, v142, v10
v_sub_f32 v143, v143, v10
v_sub_f32 v208, v208, v10
v_sub_f32 v209, v209, v10
v_sub_f32 v210, v210, v10
v_sub_f32 v211, v211, v10
v_sub_f32 v212, v212, v10
v_sub_f32 v213, v213, v10
v_sub_f32 v214, v214, v10
v_sub_f32 v215, v215, v10
v_sub_f32 v216, v216, v10
v_sub_f32 v217, v217, v10
v_sub_f32 v218, v218, v10
v_sub_f32 v219, v219, v10
v_sub_f32 v220, v220, v10
v_sub_f32 v221, v221, v10
v_sub_f32 v222, v222, v10
v_sub_f32 v223, v223, v10
v_mul_f32 v6, v6, v11
v_mul_f32 v7, v7, v11
v_mul_f32 v16, v16, v11
v_mul_f32 v17, v17, v11
v_mul_f32 v18, v18, v11
v_mul_f32 v19, v19, v11
v_mul_f32 v20, v20, v11
v_mul_f32 v21, v21, v11
v_mul_f32 v22, v22, v11
v_mul_f32 v23, v23, v11
v_mul_f32 v24, v24, v11
v_mul_f32 v25, v25, v11
v_mul_f32 v26, v26, v11
v_mul_f32 v27, v27, v11
v_mul_f32 v28, v28, v11
v_mul_f32 v29, v29, v11
v_mul_f32 v30, v30, v11
v_mul_f32 v31, v31, v11
v_mul_f32 v32, v32, v11
v_mul_f32 v33, v33, v11
v_mul_f32 v34, v34, v11
v_mul_f32 v35, v35, v11
v_mul_f32 v36, v36, v11
v_mul_f32 v37, v37, v11
v_mul_f32 v38, v38, v11
v_mul_f32 v39, v39, v11
v_mul_f32 v40, v40, v11
v_mul_f32 v41, v41, v11
v_mul_f32 v42, v42, v11
v_mul_f32 v43, v43, v11
v_mul_f32 v44, v44, v11
v_mul_f32 v45, v45, v11
v_mul_f32 v46, v46, v11
v_mul_f32 v47, v47, v11
v_mul_f32 v48, v48, v11
v_mul_f32 v49, v49, v11
v_mul_f32 v50, v50, v11
v_mul_f32 v51, v51, v11
v_mul_f32 v52, v52, v11
v_mul_f32 v53, v53, v11
v_mul_f32 v54, v54, v11
v_mul_f32 v55, v55, v11
v_mul_f32 v56, v56, v11
v_mul_f32 v57, v57, v11
v_mul_f32 v58, v58, v11
v_mul_f32 v59, v59, v11
v_mul_f32 v60, v60, v11
v_mul_f32 v61, v61, v11
v_mul_f32 v62, v62, v11
v_mul_f32 v63, v63, v11
v_mul_f32 v64, v64, v11
v_mul_f32 v65, v65, v11
v_mul_f32 v66, v66, v11
v_mul_f32 v67, v67, v11
v_mul_f32 v68, v68, v11
v_mul_f32 v69, v69, v11
v_mul_f32 v70, v70, v11
v_mul_f32 v71, v71, v11
v_mul_f32 v72, v72, v11
v_mul_f32 v73, v73, v11
v_mul_f32 v74, v74, v11
v_mul_f32 v75, v75, v11
v_mul_f32 v76, v76, v11
v_mul_f32 v77, v77, v11
v_mul_f32 v78, v78, v11
v_mul_f32 v79, v79, v11
s_branch .rescr_1053
.mask_1054:
v_cmp_gt_i32_e64 s[40:41], 0, v4
v_cmp_gt_i32_e64 s[42:43], 1, v4
v_cmp_gt_i32_e64 s[44:45], 2, v4
v_cmp_gt_i32_e64 s[46:47], 3, v4
v_cndmask_b32_e64 v80, v80, v8, s[40:41]
v_cndmask_b32_e64 v81, v81, v8, s[42:43]
v_cndmask_b32_e64 v82, v82, v8, s[44:45]
v_cndmask_b32_e64 v83, v83, v8, s[46:47]
v_cmp_gt_i32_e64 s[40:41], 8, v4
v_cmp_gt_i32_e64 s[42:43], 9, v4
v_cmp_gt_i32_e64 s[44:45], 10, v4
v_cmp_gt_i32_e64 s[46:47], 11, v4
v_cndmask_b32_e64 v84, v84, v8, s[40:41]
v_cndmask_b32_e64 v85, v85, v8, s[42:43]
v_cndmask_b32_e64 v86, v86, v8, s[44:45]
v_cndmask_b32_e64 v87, v87, v8, s[46:47]
v_cmp_gt_i32_e64 s[40:41], 16, v4
v_cmp_gt_i32_e64 s[42:43], 17, v4
v_cmp_gt_i32_e64 s[44:45], 18, v4
v_cmp_gt_i32_e64 s[46:47], 19, v4
v_cndmask_b32_e64 v88, v88, v8, s[40:41]
v_cndmask_b32_e64 v89, v89, v8, s[42:43]
v_cndmask_b32_e64 v90, v90, v8, s[44:45]
v_cndmask_b32_e64 v91, v91, v8, s[46:47]
v_cmp_gt_i32_e64 s[40:41], 24, v4
v_cmp_gt_i32_e64 s[42:43], 25, v4
v_cmp_gt_i32_e64 s[44:45], 26, v4
v_cmp_gt_i32_e64 s[46:47], 27, v4
v_cndmask_b32_e64 v92, v92, v8, s[40:41]
v_cndmask_b32_e64 v93, v93, v8, s[42:43]
v_cndmask_b32_e64 v94, v94, v8, s[44:45]
v_cndmask_b32_e64 v95, v95, v8, s[46:47]
v_cmp_gt_i32_e64 s[40:41], 32, v4
v_cmp_gt_i32_e64 s[42:43], 33, v4
v_cmp_gt_i32_e64 s[44:45], 34, v4
v_cmp_gt_i32_e64 s[46:47], 35, v4
v_cndmask_b32_e64 v96, v96, v8, s[40:41]
v_cndmask_b32_e64 v97, v97, v8, s[42:43]
v_cndmask_b32_e64 v98, v98, v8, s[44:45]
v_cndmask_b32_e64 v99, v99, v8, s[46:47]
v_cmp_gt_i32_e64 s[40:41], 40, v4
v_cmp_gt_i32_e64 s[42:43], 41, v4
v_cmp_gt_i32_e64 s[44:45], 42, v4
v_cmp_gt_i32_e64 s[46:47], 43, v4
v_cndmask_b32_e64 v100, v100, v8, s[40:41]
v_cndmask_b32_e64 v101, v101, v8, s[42:43]
v_cndmask_b32_e64 v102, v102, v8, s[44:45]
v_cndmask_b32_e64 v103, v103, v8, s[46:47]
v_cmp_gt_i32_e64 s[40:41], 48, v4
v_cmp_gt_i32_e64 s[42:43], 49, v4
v_cmp_gt_i32_e64 s[44:45], 50, v4
v_cmp_gt_i32_e64 s[46:47], 51, v4
v_cndmask_b32_e64 v104, v104, v8, s[40:41]
v_cndmask_b32_e64 v105, v105, v8, s[42:43]
v_cndmask_b32_e64 v106, v106, v8, s[44:45]
v_cndmask_b32_e64 v107, v107, v8, s[46:47]
v_cmp_gt_i32_e64 s[40:41], 56, v4
v_cmp_gt_i32_e64 s[42:43], 57, v4
v_cmp_gt_i32_e64 s[44:45], 58, v4
v_cmp_gt_i32_e64 s[46:47], 59, v4
v_cndmask_b32_e64 v108, v108, v8, s[40:41]
v_cndmask_b32_e64 v109, v109, v8, s[42:43]
v_cndmask_b32_e64 v110, v110, v8, s[44:45]
v_cndmask_b32_e64 v111, v111, v8, s[46:47]
s_branch .maskr_1055
.resc_1056:
v_mov_b32 v10, v5
s_nop 1
v_permlane32_swap_b32 v10, v5
v_max3_f32 v10, v10, v5, 0
v_exp_f32_e64 v11, -v10
v_sub_f32 v80, v80, v10
v_sub_f32 v81, v81, v10
v_sub_f32 v82, v82, v10
v_sub_f32 v83, v83, v10
v_sub_f32 v84, v84, v10
v_sub_f32 v85, v85, v10
v_sub_f32 v86, v86, v10
v_sub_f32 v87, v87, v10
v_sub_f32 v88, v88, v10
v_sub_f32 v89, v89, v10
v_sub_f32 v90, v90, v10
v_sub_f32 v91, v91, v10
v_sub_f32 v92, v92, v10
v_sub_f32 v93, v93, v10
v_sub_f32 v94, v94, v10
v_sub_f32 v95, v95, v10
v_sub_f32 v96, v96, v10
v_sub_f32 v97, v97, v10
v_sub_f32 v98, v98, v10
v_sub_f32 v99, v99, v10
v_sub_f32 v100, v100, v10
v_sub_f32 v101, v101, v10
v_sub_f32 v102, v102, v10
v_sub_f32 v103, v103, v10
v_sub_f32 v104, v104, v10
v_sub_f32 v105, v105, v10
v_sub_f32 v106, v106, v10
v_sub_f32 v107, v107, v10
v_sub_f32 v108, v108, v10
v_sub_f32 v109, v109, v10
v_sub_f32 v110, v110, v10
v_sub_f32 v111, v111, v10
v_sub_f32 v208, v208, v10
v_sub_f32 v209, v209, v10
v_sub_f32 v210, v210, v10
v_sub_f32 v211, v211, v10
v_sub_f32 v212, v212, v10
v_sub_f32 v213, v213, v10
v_sub_f32 v214, v214, v10
v_sub_f32 v215, v215, v10
v_sub_f32 v216, v216, v10
v_sub_f32 v217, v217, v10
v_sub_f32 v218, v218, v10
v_sub_f32 v219, v219, v10
v_sub_f32 v220, v220, v10
v_sub_f32 v221, v221, v10
v_sub_f32 v222, v222, v10
v_sub_f32 v223, v223, v10
v_mul_f32 v6, v6, v11
v_mul_f32 v7, v7, v11
v_mul_f32 v16, v16, v11
v_mul_f32 v17, v17, v11
v_mul_f32 v18, v18, v11
v_mul_f32 v19, v19, v11
v_mul_f32 v20, v20, v11
v_mul_f32 v21, v21, v11
v_mul_f32 v22, v22, v11
v_mul_f32 v23, v23, v11
v_mul_f32 v24, v24, v11
v_mul_f32 v25, v25, v11
v_mul_f32 v26, v26, v11
v_mul_f32 v27, v27, v11
v_mul_f32 v28, v28, v11
v_mul_f32 v29, v29, v11
v_mul_f32 v30, v30, v11
v_mul_f32 v31, v31, v11
v_mul_f32 v32, v32, v11
v_mul_f32 v33, v33, v11
v_mul_f32 v34, v34, v11
v_mul_f32 v35, v35, v11
v_mul_f32 v36, v36, v11
v_mul_f32 v37, v37, v11
v_mul_f32 v38, v38, v11
v_mul_f32 v39, v39, v11
v_mul_f32 v40, v40, v11
v_mul_f32 v41, v41, v11
v_mul_f32 v42, v42, v11
v_mul_f32 v43, v43, v11
v_mul_f32 v44, v44, v11
v_mul_f32 v45, v45, v11
v_mul_f32 v46, v46, v11
v_mul_f32 v47, v47, v11
v_mul_f32 v48, v48, v11
v_mul_f32 v49, v49, v11
v_mul_f32 v50, v50, v11
v_mul_f32 v51, v51, v11
v_mul_f32 v52, v52, v11
v_mul_f32 v53, v53, v11
v_mul_f32 v54, v54, v11
v_mul_f32 v55, v55, v11
v_mul_f32 v56, v56, v11
v_mul_f32 v57, v57, v11
v_mul_f32 v58, v58, v11
v_mul_f32 v59, v59, v11
v_mul_f32 v60, v60, v11
v_mul_f32 v61, v61, v11
v_mul_f32 v62, v62, v11
v_mul_f32 v63, v63, v11
v_mul_f32 v64, v64, v11
v_mul_f32 v65, v65, v11
v_mul_f32 v66, v66, v11
v_mul_f32 v67, v67, v11
v_mul_f32 v68, v68, v11
v_mul_f32 v69, v69, v11
v_mul_f32 v70, v70, v11
v_mul_f32 v71, v71, v11
v_mul_f32 v72, v72, v11
v_mul_f32 v73, v73, v11
v_mul_f32 v74, v74, v11
v_mul_f32 v75, v75, v11
v_mul_f32 v76, v76, v11
v_mul_f32 v77, v77, v11
v_mul_f32 v78, v78, v11
v_mul_f32 v79, v79, v11
s_branch .rescr_1057
.final_1047:
s_cmp_eq_u32 s37, 0
s_cbranch_scc1 .nobar_1058
s_barrier
.nobar_1058:
s_waitcnt lgkmcnt(0)
ds_read_b128 v[176:179], v2 offset:16384
ds_read_b128 v[180:183], v2 offset:17408
ds_read_b128 v[184:187], v2 offset:18432
ds_read_b128 v[188:191], v2 offset:19456
ds_read_b128 v[192:195], v2 offset:20480
ds_read_b128 v[196:199], v2 offset:21504
v_exp_f32 v80, v80
v_exp_f32 v81, v81
v_exp_f32 v82, v82
v_exp_f32 v83, v83
v_exp_f32 v84, v84
v_exp_f32 v85, v85
v_exp_f32 v86, v86
v_exp_f32 v87, v87
v_exp_f32 v88, v88
v_exp_f32 v89, v89
v_cvt_pk_bf16_f32 v224, v80, v81
v_cvt_pk_bf16_f32 v225, v82, v83
v_cvt_pk_bf16_f32 v226, v84, v85
v_cvt_pk_bf16_f32 v227, v86, v87
s_waitcnt lgkmcnt(5)
s_nop 0
v_mfma_f32_32x32x16_bf16 v[16:31], v[176:179], v[224:227], v[16:31]
ds_read_b128 v[200:203], v2 offset:22528
v_exp_f32 v90, v90
v_exp_f32 v91, v91
v_cvt_pk_bf16_f32 v228, v88, v89
v_add_f32 v6, v6, v80
v_add_f32 v7, v7, v81
s_waitcnt lgkmcnt(5)
v_mfma_f32_32x32x16_bf16 v[32:47], v[180:183], v[224:227], v[32:47]
ds_read_b128 v[204:207], v2 offset:23552
v_exp_f32 v92, v92
v_exp_f32 v93, v93
v_cvt_pk_bf16_f32 v229, v90, v91
v_add_f32 v6, v6, v82
v_add_f32 v7, v7, v83
s_waitcnt lgkmcnt(5)
v_mfma_f32_32x32x16_bf16 v[48:63], v[184:187], v[224:227], v[48:63]
ds_read_b128 v[176:179], v2 offset:24576
v_exp_f32 v94, v94
v_exp_f32 v95, v95
v_cvt_pk_bf16_f32 v230, v92, v93
v_add_f32 v6, v6, v84
v_add_f32 v7, v7, v85
s_waitcnt lgkmcnt(5)
v_mfma_f32_32x32x16_bf16 v[64:79], v[188:191], v[224:227], v[64:79]
ds_read_b128 v[180:183], v2 offset:25600
v_exp_f32 v96, v96
v_exp_f32 v97, v97
v_cvt_pk_bf16_f32 v231, v94, v95
v_add_f32 v6, v6, v86
v_add_f32 v7, v7, v87
s_waitcnt lgkmcnt(5)
v_mfma_f32_32x32x16_bf16 v[16:31], v[192:195], v[228:231], v[16:31]
ds_read_b128 v[184:187], v2 offset:26624
v_exp_f32 v98, v98
v_exp_f32 v99, v99
v_cvt_pk_bf16_f32 v232, v96, v97
v_add_f32 v6, v6, v88
v_add_f32 v7, v7, v89
s_waitcnt lgkmcnt(5)
v_mfma_f32_32x32x16_bf16 v[32:47], v[196:199], v[228:231], v[32:47]
ds_read_b128 v[188:191], v2 offset:27648
v_exp_f32 v100, v100
v_exp_f32 v101, v101
v_cvt_pk_bf16_f32 v233, v98, v99
v_add_f32 v6, v6, v90
v_add_f32 v7, v7, v91
s_waitcnt lgkmcnt(5)
v_mfma_f32_32x32x16_bf16 v[48:63], v[200:203], v[228:231], v[48:63]
ds_read_b128 v[192:195], v2 offset:28672
v_exp_f32 v102, v102
v_exp_f32 v103, v103
v_cvt_pk_bf16_f32 v234, v100, v101
v_add_f32 v6, v6, v92
v_add_f32 v7, v7, v93
s_waitcnt lgkmcnt(5)
v_mfma_f32_32x32x16_bf16 v[64:79], v[204:207], v[228:231], v[64:79]
ds_read_b128 v[196:199], v2 offset:29696
v_exp_f32 v104, v104
v_exp_f32 v105, v105
v_cvt_pk_bf16_f32 v235, v102, v103
v_add_f32 v6, v6, v94
v_add_f32 v7, v7, v95
s_waitcnt lgkmcnt(5)
v_mfma_f32_32x32x16_bf16 v[16:31], v[176:179], v[232:235], v[16:31]
ds_read_b128 v[200:203], v2 offset:30720
v_exp_f32 v106, v106
v_exp_f32 v107, v107
v_cvt_pk_bf16_f32 v236, v104, v105
v_add_f32 v6, v6, v96
v_add_f32 v7, v7, v97
s_waitcnt lgkmcnt(5)
v_mfma_f32_32x32x16_bf16 v[32:47], v[180:183], v[232:235], v[32:47]
ds_read_b128 v[204:207], v2 offset:31744
v_exp_f32 v108, v108
v_exp_f32 v109, v109
v_cvt_pk_bf16_f32 v237, v106, v107
v_add_f32 v6, v6, v98
v_add_f32 v7, v7, v99
s_waitcnt lgkmcnt(5)
v_mfma_f32_32x32x16_bf16 v[48:63], v[184:187], v[232:235], v[48:63]
v_exp_f32 v110, v110
v_exp_f32 v111, v111
v_cvt_pk_bf16_f32 v238, v108, v109
v_add_f32 v6, v6, v100
v_add_f32 v7, v7, v101
s_waitcnt lgkmcnt(4)
v_mfma_f32_32x32x16_bf16 v[64:79], v[188:191], v[232:235], v[64:79]
v_cvt_pk_bf16_f32 v239, v110, v111
v_add_f32 v6, v6, v102
v_add_f32 v7, v7, v103
v_add_f32 v6, v6, v104
v_add_f32 v7, v7, v105
s_waitcnt lgkmcnt(3)
v_mfma_f32_32x32x16_bf16 v[16:31], v[192:195], v[236:239], v[16:31]
v_add_f32 v6, v6, v106
v_add_f32 v7, v7, v107
v_add_f32 v6, v6, v108
v_add_f32 v7, v7, v109
s_waitcnt lgkmcnt(2)
v_mfma_f32_32x32x16_bf16 v[32:47], v[196:199], v[236:239], v[32:47]
v_add_f32 v6, v6, v110
v_add_f32 v7, v7, v111
s_waitcnt lgkmcnt(1)
v_mfma_f32_32x32x16_bf16 v[48:63], v[200:203], v[236:239], v[48:63]
s_waitcnt lgkmcnt(0)
v_mfma_f32_32x32x16_bf16 v[64:79], v[204:207], v[236:239], v[64:79]
s_branch .epi_1049
.final_1048:
s_cmp_eq_u32 s37, 0
s_cbranch_scc1 .nobar_1059
s_barrier
.nobar_1059:
s_waitcnt lgkmcnt(0)
ds_read_b128 v[176:179], v3 offset:16384
ds_read_b128 v[180:183], v3 offset:17408
ds_read_b128 v[184:187], v3 offset:18432
ds_read_b128 v[188:191], v3 offset:19456
ds_read_b128 v[192:195], v3 offset:20480
ds_read_b128 v[196:199], v3 offset:21504
v_exp_f32 v112, v112
v_exp_f32 v113, v113
v_exp_f32 v114, v114
v_exp_f32 v115, v115
v_exp_f32 v116, v116
v_exp_f32 v117, v117
v_exp_f32 v118, v118
v_exp_f32 v119, v119
v_exp_f32 v120, v120
v_exp_f32 v121, v121
v_cvt_pk_bf16_f32 v224, v112, v113
v_cvt_pk_bf16_f32 v225, v114, v115
v_cvt_pk_bf16_f32 v226, v116, v117
v_cvt_pk_bf16_f32 v227, v118, v119
s_waitcnt lgkmcnt(5)
s_nop 0
v_mfma_f32_32x32x16_bf16 v[16:31], v[176:179], v[224:227], v[16:31]
ds_read_b128 v[200:203], v3 offset:22528
v_exp_f32 v122, v122
v_exp_f32 v123, v123
v_cvt_pk_bf16_f32 v228, v120, v121
v_add_f32 v6, v6, v112
v_add_f32 v7, v7, v113
s_waitcnt lgkmcnt(5)
v_mfma_f32_32x32x16_bf16 v[32:47], v[180:183], v[224:227], v[32:47]
ds_read_b128 v[204:207], v3 offset:23552
v_exp_f32 v124, v124
v_exp_f32 v125, v125
v_cvt_pk_bf16_f32 v229, v122, v123
v_add_f32 v6, v6, v114
v_add_f32 v7, v7, v115
s_waitcnt lgkmcnt(5)
v_mfma_f32_32x32x16_bf16 v[48:63], v[184:187], v[224:227], v[48:63]
ds_read_b128 v[176:179], v3 offset:24576
v_exp_f32 v126, v126
v_exp_f32 v127, v127
v_cvt_pk_bf16_f32 v230, v124, v125
v_add_f32 v6, v6, v116
v_add_f32 v7, v7, v117
s_waitcnt lgkmcnt(5)
v_mfma_f32_32x32x16_bf16 v[64:79], v[188:191], v[224:227], v[64:79]
ds_read_b128 v[180:183], v3 offset:25600
v_exp_f32 v128, v128
v_exp_f32 v129, v129
v_cvt_pk_bf16_f32 v231, v126, v127
v_add_f32 v6, v6, v118
v_add_f32 v7, v7, v119
s_waitcnt lgkmcnt(5)
v_mfma_f32_32x32x16_bf16 v[16:31], v[192:195], v[228:231], v[16:31]
ds_read_b128 v[184:187], v3 offset:26624
v_exp_f32 v130, v130
v_exp_f32 v131, v131
v_cvt_pk_bf16_f32 v232, v128, v129
v_add_f32 v6, v6, v120
v_add_f32 v7, v7, v121
s_waitcnt lgkmcnt(5)
v_mfma_f32_32x32x16_bf16 v[32:47], v[196:199], v[228:231], v[32:47]
ds_read_b128 v[188:191], v3 offset:27648
v_exp_f32 v132, v132
v_exp_f32 v133, v133
v_cvt_pk_bf16_f32 v233, v130, v131
v_add_f32 v6, v6, v122
v_add_f32 v7, v7, v123
s_waitcnt lgkmcnt(5)
v_mfma_f32_32x32x16_bf16 v[48:63], v[200:203], v[228:231], v[48:63]
ds_read_b128 v[192:195], v3 offset:28672
v_exp_f32 v134, v134
v_exp_f32 v135, v135
v_cvt_pk_bf16_f32 v234, v132, v133
v_add_f32 v6, v6, v124
v_add_f32 v7, v7, v125
s_waitcnt lgkmcnt(5)
v_mfma_f32_32x32x16_bf16 v[64:79], v[204:207], v[228:231], v[64:79]
ds_read_b128 v[196:199], v3 offset:29696
v_exp_f32 v136, v136
v_exp_f32 v137, v137
v_cvt_pk_bf16_f32 v235, v134, v135
v_add_f32 v6, v6, v126
v_add_f32 v7, v7, v127
s_waitcnt lgkmcnt(5)
v_mfma_f32_32x32x16_bf16 v[16:31], v[176:179], v[232:235], v[16:31]
ds_read_b128 v[200:203], v3 offset:30720
v_exp_f32 v138, v138
v_exp_f32 v139, v139
v_cvt_pk_bf16_f32 v236, v136, v137
v_add_f32 v6, v6, v128
v_add_f32 v7, v7, v129
s_waitcnt lgkmcnt(5)
v_mfma_f32_32x32x16_bf16 v[32:47], v[180:183], v[232:235], v[32:47]
ds_read_b128 v[204:207], v3 offset:31744
v_exp_f32 v140, v140
v_exp_f32 v141, v141
v_cvt_pk_bf16_f32 v237, v138, v139
v_add_f32 v6, v6, v130
v_add_f32 v7, v7, v131
s_waitcnt lgkmcnt(5)
v_mfma_f32_32x32x16_bf16 v[48:63], v[184:187], v[232:235], v[48:63]
v_exp_f32 v142, v142
v_exp_f32 v143, v143
v_cvt_pk_bf16_f32 v238, v140, v141
v_add_f32 v6, v6, v132
v_add_f32 v7, v7, v133
s_waitcnt lgkmcnt(4)
v_mfma_f32_32x32x16_bf16 v[64:79], v[188:191], v[232:235], v[64:79]
v_cvt_pk_bf16_f32 v239, v142, v143
v_add_f32 v6, v6, v134
v_add_f32 v7, v7, v135
v_add_f32 v6, v6, v136
v_add_f32 v7, v7, v137
s_waitcnt lgkmcnt(3)
v_mfma_f32_32x32x16_bf16 v[16:31], v[192:195], v[236:239], v[16:31]
v_add_f32 v6, v6, v138
v_add_f32 v7, v7, v139
v_add_f32 v6, v6, v140
v_add_f32 v7, v7, v141
s_waitcnt lgkmcnt(2)
v_mfma_f32_32x32x16_bf16 v[32:47], v[196:199], v[236:239], v[32:47]
v_add_f32 v6, v6, v142
v_add_f32 v7, v7, v143
s_waitcnt lgkmcnt(1)
v_mfma_f32_32x32x16_bf16 v[48:63], v[200:203], v[236:239], v[48:63]
s_waitcnt lgkmcnt(0)
v_mfma_f32_32x32x16_bf16 v[64:79], v[204:207], v[236:239], v[64:79]
.epi_1049:
v_add_f32 v6, v6, v7
v_mov_b32 v10, v6
s_nop 1
v_permlane32_swap_b32 v10, v6
v_add_f32 v10, v10, v6
v_rcp_f32 v10, v10
s_lshl_b32 s23, s24, 18
s_lshl_b32 s26, s21, 13
s_add_u32 s23, s23, s26
s_add_u32 s26, s23, 0x1000
v_mul_f32 v16, v16, v10
v_mul_f32 v17, v17, v10
v_cvt_pk_bf16_f32 v80, v16, v17
v_mul_f32 v18, v18, v10
v_mul_f32 v19, v19, v10
v_cvt_pk_bf16_f32 v81, v18, v19
v_mul_f32 v20, v20, v10
v_mul_f32 v21, v21, v10
v_cvt_pk_bf16_f32 v82, v20, v21
v_mul_f32 v22, v22, v10
v_mul_f32 v23, v23, v10
v_cvt_pk_bf16_f32 v83, v22, v23
buffer_store_dwordx4 v[80:83], v1, s[16:19], s23 offen offset:0 sc1
v_mul_f32 v24, v24, v10
v_mul_f32 v25, v25, v10
v_cvt_pk_bf16_f32 v84, v24, v25
v_mul_f32 v26, v26, v10
v_mul_f32 v27, v27, v10
v_cvt_pk_bf16_f32 v85, v26, v27
v_mul_f32 v28, v28, v10
v_mul_f32 v29, v29, v10
v_cvt_pk_bf16_f32 v86, v28, v29
v_mul_f32 v30, v30, v10
v_mul_f32 v31, v31, v10
v_cvt_pk_bf16_f32 v87, v30, v31
buffer_store_dwordx4 v[84:87], v1, s[16:19], s23 offen offset:1024 sc1
v_mul_f32 v32, v32, v10
v_mul_f32 v33, v33, v10
v_cvt_pk_bf16_f32 v88, v32, v33
v_mul_f32 v34, v34, v10
v_mul_f32 v35, v35, v10
v_cvt_pk_bf16_f32 v89, v34, v35
v_mul_f32 v36, v36, v10
v_mul_f32 v37, v37, v10
v_cvt_pk_bf16_f32 v90, v36, v37
v_mul_f32 v38, v38, v10
v_mul_f32 v39, v39, v10
v_cvt_pk_bf16_f32 v91, v38, v39
buffer_store_dwordx4 v[88:91], v1, s[16:19], s23 offen offset:2048 sc1
v_mul_f32 v40, v40, v10
v_mul_f32 v41, v41, v10
v_cvt_pk_bf16_f32 v92, v40, v41
v_mul_f32 v42, v42, v10
v_mul_f32 v43, v43, v10
v_cvt_pk_bf16_f32 v93, v42, v43
v_mul_f32 v44, v44, v10
v_mul_f32 v45, v45, v10
v_cvt_pk_bf16_f32 v94, v44, v45
v_mul_f32 v46, v46, v10
v_mul_f32 v47, v47, v10
v_cvt_pk_bf16_f32 v95, v46, v47
buffer_store_dwordx4 v[92:95], v1, s[16:19], s23 offen offset:3072 sc1
v_mul_f32 v48, v48, v10
v_mul_f32 v49, v49, v10
v_cvt_pk_bf16_f32 v96, v48, v49
v_mul_f32 v50, v50, v10
v_mul_f32 v51, v51, v10
v_cvt_pk_bf16_f32 v97, v50, v51
v_mul_f32 v52, v52, v10
v_mul_f32 v53, v53, v10
v_cvt_pk_bf16_f32 v98, v52, v53
v_mul_f32 v54, v54, v10
v_mul_f32 v55, v55, v10
v_cvt_pk_bf16_f32 v99, v54, v55
buffer_store_dwordx4 v[96:99], v1, s[16:19], s26 offen offset:0 sc1
v_mul_f32 v56, v56, v10
v_mul_f32 v57, v57, v10
v_cvt_pk_bf16_f32 v100, v56, v57
v_mul_f32 v58, v58, v10
v_mul_f32 v59, v59, v10
v_cvt_pk_bf16_f32 v101, v58, v59
v_mul_f32 v60, v60, v10
v_mul_f32 v61, v61, v10
v_cvt_pk_bf16_f32 v102, v60, v61
v_mul_f32 v62, v62, v10
v_mul_f32 v63, v63, v10
v_cvt_pk_bf16_f32 v103, v62, v63
buffer_store_dwordx4 v[100:103], v1, s[16:19], s26 offen offset:1024 sc1
v_mul_f32 v64, v64, v10
v_mul_f32 v65, v65, v10
v_cvt_pk_bf16_f32 v104, v64, v65
v_mul_f32 v66, v66, v10
v_mul_f32 v67, v67, v10
v_cvt_pk_bf16_f32 v105, v66, v67
v_mul_f32 v68, v68, v10
v_mul_f32 v69, v69, v10
v_cvt_pk_bf16_f32 v106, v68, v69
v_mul_f32 v70, v70, v10
v_mul_f32 v71, v71, v10
v_cvt_pk_bf16_f32 v107, v70, v71
buffer_store_dwordx4 v[104:107], v1, s[16:19], s26 offen offset:2048 sc1
v_mul_f32 v72, v72, v10
v_mul_f32 v73, v73, v10
v_cvt_pk_bf16_f32 v108, v72, v73
v_mul_f32 v74, v74, v10
v_mul_f32 v75, v75, v10
v_cvt_pk_bf16_f32 v109, v74, v75
v_mul_f32 v76, v76, v10
v_mul_f32 v77, v77, v10
v_cvt_pk_bf16_f32 v110, v76, v77
v_mul_f32 v78, v78, v10
v_mul_f32 v79, v79, v10
v_cvt_pk_bf16_f32 v111, v78, v79
buffer_store_dwordx4 v[108:111], v1, s[16:19], s26 offen offset:3072 sc1
s_branch .endr_1041
.att_b_1040:
s_add_u32 m0, s36, 0
s_nop 0
buffer_load_dwordx4 v1, s[8:11], s35 offen offset:0 lds
buffer_load_dwordx4 v1, s[8:11], s35 offen offset:1024 lds
buffer_load_dwordx4 v1, s[8:11], s35 offen offset:2048 lds
buffer_load_dwordx4 v1, s[8:11], s35 offen offset:3072 lds
s_add_u32 s35, s35, 0x100000
buffer_load_dwordx4 v[80:83], v1, s[4:7], s34 offen offset:0
buffer_load_dwordx4 v[84:87], v1, s[4:7], s34 offen offset:1024
buffer_load_dwordx4 v[88:91], v1, s[4:7], s34 offen offset:2048
buffer_load_dwordx4 v[92:95], v1, s[4:7], s34 offen offset:3072
s_add_u32 s34, s34, 0x1000
buffer_load_dwordx4 v[96:99], v1, s[4:7], s34 offen offset:0
buffer_load_dwordx4 v[100:103], v1, s[4:7], s34 offen offset:1024
buffer_load_dwordx4 v[104:107], v1, s[4:7], s34 offen offset:2048
buffer_load_dwordx4 v[108:111], v1, s[4:7], s34 offen offset:3072
s_add_u32 s34, s34, 0x1000
s_add_u32 m0, s36, 32768
s_nop 0
buffer_load_dwordx4 v1, s[8:11], s35 offen offset:0 lds
buffer_load_dwordx4 v1, s[8:11], s35 offen offset:1024 lds
buffer_load_dwordx4 v1, s[8:11], s35 offen offset:2048 lds
buffer_load_dwordx4 v1, s[8:11], s35 offen offset:3072 lds
s_add_u32 s35, s35, 0x100000
buffer_load_dwordx4 v[112:115], v1, s[4:7], s34 offen offset:0
buffer_load_dwordx4 v[116:119], v1, s[4:7], s34 offen offset:1024
buffer_load_dwordx4 v[120:123], v1, s[4:7], s34 offen offset:2048
buffer_load_dwordx4 v[124:127], v1, s[4:7], s34 offen offset:3072
s_add_u32 s34, s34, 0x1000
buffer_load_dwordx4 v[128:131], v1, s[4:7], s34 offen offset:0
buffer_load_dwordx4 v[132:135], v1, s[4:7], s34 offen offset:1024
buffer_load_dwordx4 v[136:139], v1, s[4:7], s34 offen offset:2048
buffer_load_dwordx4 v[140:143], v1, s[4:7], s34 offen offset:3072
s_add_u32 s34, s34, 0x1000
s_waitcnt vmcnt(20)
s_barrier
ds_read_b128 v[176:179], v2 offset:0
ds_read_b128 v[180:183], v2 offset:1024
ds_read_b128 v[184:187], v2 offset:2048
ds_read_b128 v[188:191], v2 offset:3072
ds_read_b128 v[192:195], v2 offset:4096
ds_read_b128 v[196:199], v2 offset:5120
s_waitcnt vmcnt(19)
s_waitcnt lgkmcnt(5)
v_mfma_f32_32x32x16_bf16 v[16:31], v[176:179], v[80:83], 0
ds_read_b128 v[200:203], v2 offset:6144
s_add_u32 m0, s36, 65536
s_nop 0
s_waitcnt lgkmcnt(5)
v_mfma_f32_32x32x16_bf16 v[32:47], v[180:183], v[80:83], 0
ds_read_b128 v[204:207], v2 offset:7168
buffer_load_dwordx4 v1, s[8:11], s35 offen offset:0 lds
s_waitcnt lgkmcnt(5)
v_mfma_f32_32x32x16_bf16 v[48:63], v[184:187], v[80:83], 0
ds_read_b128 v[176:179], v2 offset:8192
buffer_load_dwordx4 v1, s[8:11], s35 offen offset:1024 lds
s_waitcnt lgkmcnt(5)
v_mfma_f32_32x32x16_bf16 v[64:79], v[188:191], v[80:83], 0
ds_read_b128 v[180:183], v2 offset:9216
buffer_load_dwordx4 v1, s[8:11], s35 offen offset:2048 lds
s_waitcnt vmcnt(21)
s_waitcnt lgkmcnt(5)
v_mfma_f32_32x32x16_bf16 v[16:31], v[192:195], v[84:87], v[16:31]
ds_read_b128 v[184:187], v2 offset:10240
buffer_load_dwordx4 v1, s[8:11], s35 offen offset:3072 lds
s_add_u32 s35, s35, 0x100000
s_waitcnt lgkmcnt(5)
v_mfma_f32_32x32x16_bf16 v[32:47], v[196:199], v[84:87], v[32:47]
ds_read_b128 v[188:191], v2 offset:11264
buffer_load_dwordx4 v[208:211], v1, s[4:7], s34 offen offset:0
s_waitcnt lgkmcnt(5)
v_mfma_f32_32x32x16_bf16 v[48:63], v[200:203], v[84:87], v[48:63]
ds_read_b128 v[192:195], v2 offset:12288
buffer_load_dwordx4 v[212:215], v1, s[4:7], s34 offen offset:1024
s_waitcnt lgkmcnt(5)
v_mfma_f32_32x32x16_bf16 v[64:79], v[204:207], v[84:87], v[64:79]
ds_read_b128 v[196:199], v2 offset:13312
buffer_load_dwordx4 v[216:219], v1, s[4:7], s34 offen offset:2048
s_waitcnt vmcnt(24)
s_waitcnt lgkmcnt(5)
v_mfma_f32_32x32x16_bf16 v[16:31], v[176:179], v[88:91], v[16:31]
ds_read_b128 v[200:203], v2 offset:14336
buffer_load_dwordx4 v[220:223], v1, s[4:7], s34 offen offset:3072
s_add_u32 s34, s34, 0x1000
s_waitcnt lgkmcnt(5)
v_mfma_f32_32x32x16_bf16 v[32:47], v[180:183], v[88:91], v[32:47]
ds_read_b128 v[204:207], v2 offset:15360
buffer_load_dwordx4 v[224:227], v1, s[4:7], s34 offen offset:0
s_waitcnt lgkmcnt(5)
v_mfma_f32_32x32x16_bf16 v[48:63], v[184:187], v[88:91], v[48:63]
ds_read_b128 v[176:179], v2 offset:16384
buffer_load_dwordx4 v[228:231], v1, s[4:7], s34 offen offset:1024
s_waitcnt lgkmcnt(5)
v_mfma_f32_32x32x16_bf16 v[64:79], v[188:191], v[88:91], v[64:79]
ds_read_b128 v[180:183], v2 offset:17408
buffer_load_dwordx4 v[232:235], v1, s[4:7], s34 offen offset:2048
s_waitcnt vmcnt(27)
s_waitcnt lgkmcnt(5)
v_mfma_f32_32x32x16_bf16 v[16:31], v[192:195], v[92:95], v[16:31]
ds_read_b128 v[184:187], v2 offset:18432
buffer_load_dwordx4 v[236:239], v1, s[4:7], s34 offen offset:3072
s_add_u32 s34, s34, 0x1000
s_waitcnt lgkmcnt(5)
v_mfma_f32_32x32x16_bf16 v[32:47], v[196:199], v[92:95], v[32:47]
ds_read_b128 v[188:191], v2 offset:19456
s_waitcnt lgkmcnt(5)
v_mfma_f32_32x32x16_bf16 v[48:63], v[200:203], v[92:95], v[48:63]
ds_read_b128 v[192:195], v2 offset:20480
s_waitcnt lgkmcnt(5)
v_mfma_f32_32x32x16_bf16 v[64:79], v[204:207], v[92:95], v[64:79]
ds_read_b128 v[196:199], v2 offset:21504
s_waitcnt vmcnt(20)
s_barrier
s_waitcnt lgkmcnt(5)
v_mfma_f32_32x32x16_bf16 v[16:31], v[176:179], v[96:99], v[16:31]
ds_read_b128 v[200:203], v2 offset:22528
s_waitcnt lgkmcnt(5)
v_mfma_f32_32x32x16_bf16 v[32:47], v[180:183], v[96:99], v[32:47]
ds_read_b128 v[204:207], v2 offset:23552
s_waitcnt lgkmcnt(5)
v_mfma_f32_32x32x16_bf16 v[48:63], v[184:187], v[96:99], v[48:63]
ds_read_b128 v[176:179], v2 offset:24576
s_waitcnt lgkmcnt(5)
v_mfma_f32_32x32x16_bf16 v[64:79], v[188:191], v[96:99], v[64:79]
ds_read_b128 v[180:183], v2 offset:25600
s_waitcnt lgkmcnt(5)
v_mfma_f32_32x32x16_bf16 v[16:31], v[192:195], v[100:103], v[16:31]
ds_read_b128 v[184:187], v2 offset:26624
s_waitcnt lgkmcnt(5)
v_mfma_f32_32x32x16_bf16 v[32:47], v[196:199], v[100:103], v[32:47]
ds_read_b128 v[188:191], v2 offset:27648
s_waitcnt lgkmcnt(5)
v_mfma_f32_32x32x16_bf16 v[48:63], v[200:203], v[100:103], v[48:63]
ds_read_b128 v[192:195], v2 offset:28672
s_waitcnt lgkmcnt(5)
v_mfma_f32_32x32x16_bf16 v[64:79], v[204:207], v[100:103], v[64:79]
ds_read_b128 v[196:199], v2 offset:29696
s_waitcnt lgkmcnt(5)
v_mfma_f32_32x32x16_bf16 v[16:31], v[176:179], v[104:107], v[16:31]
ds_read_b128 v[200:203], v2 offset:30720
s_waitcnt lgkmcnt(5)
v_mfma_f32_32x32x16_bf16 v[32:47], v[180:183], v[104:107], v[32:47]
ds_read_b128 v[204:207], v2 offset:31744
s_waitcnt lgkmcnt(5)
v_mfma_f32_32x32x16_bf16 v[48:63], v[184:187], v[104:107], v[48:63]
ds_read_b128 v[176:179], v2 offset:32768
s_waitcnt lgkmcnt(5)
v_mfma_f32_32x32x16_bf16 v[64:79], v[188:191], v[104:107], v[64:79]
ds_read_b128 v[180:183], v2 offset:33792
s_waitcnt lgkmcnt(5)
v_mfma_f32_32x32x16_bf16 v[16:31], v[192:195], v[108:111], v[16:31]
ds_read_b128 v[184:187], v2 offset:34816
s_waitcnt lgkmcnt(5)
v_mfma_f32_32x32x16_bf16 v[32:47], v[196:199], v[108:111], v[32:47]
ds_read_b128 v[188:191], v2 offset:35840
s_waitcnt lgkmcnt(5)
v_mfma_f32_32x32x16_bf16 v[48:63], v[200:203], v[108:111], v[48:63]
ds_read_b128 v[192:195], v2 offset:36864
s_waitcnt lgkmcnt(5)
v_mfma_f32_32x32x16_bf16 v[64:79], v[204:207], v[108:111], v[64:79]
ds_read_b128 v[196:199], v2 offset:37888
s_waitcnt vmcnt(19)
s_waitcnt lgkmcnt(5)
v_mfma_f32_32x32x16_bf16 v[16:31], v[176:179], v[112:115], v[16:31]
ds_read_b128 v[200:203], v2 offset:38912
s_add_u32 m0, s36, 98304
s_nop 0
s_waitcnt lgkmcnt(5)
v_mfma_f32_32x32x16_bf16 v[32:47], v[180:183], v[112:115], v[32:47]
ds_read_b128 v[204:207], v2 offset:39936
buffer_load_dwordx4 v1, s[8:11], s35 offen offset:0 lds
s_waitcnt lgkmcnt(5)
v_mfma_f32_32x32x16_bf16 v[48:63], v[184:187], v[112:115], v[48:63]
ds_read_b128 v[176:179], v2 offset:40960
buffer_load_dwordx4 v1, s[8:11], s35 offen offset:1024 lds
s_waitcnt lgkmcnt(5)
v_mfma_f32_32x32x16_bf16 v[64:79], v[188:191], v[112:115], v[64:79]
ds_read_b128 v[180:183], v2 offset:41984
buffer_load_dwordx4 v1, s[8:11], s35 offen offset:2048 lds
s_waitcnt vmcnt(21)
s_waitcnt lgkmcnt(5)
v_mfma_f32_32x32x16_bf16 v[16:31], v[192:195], v[116:119], v[16:31]
ds_read_b128 v[184:187], v2 offset:43008
buffer_load_dwordx4 v1, s[8:11], s35 offen offset:3072 lds
s_add_u32 s35, s35, 0x100000
s_waitcnt lgkmcnt(5)
v_mfma_f32_32x32x16_bf16 v[32:47], v[196:199], v[116:119], v[32:47]
ds_read_b128 v[188:191], v2 offset:44032
buffer_load_dwordx4 v[80:83], v1, s[4:7], s34 offen offset:0
s_waitcnt lgkmcnt(5)
v_mfma_f32_32x32x16_bf16 v[48:63], v[200:203], v[116:119], v[48:63]
ds_read_b128 v[192:195], v2 offset:45056
buffer_load_dwordx4 v[84:87], v1, s[4:7], s34 offen offset:1024
s_waitcnt lgkmcnt(5)
v_mfma_f32_32x32x16_bf16 v[64:79], v[204:207], v[116:119], v[64:79]
ds_read_b128 v[196:199], v2 offset:46080
buffer_load_dwordx4 v[88:91], v1, s[4:7], s34 offen offset:2048
s_waitcnt vmcnt(24)
s_waitcnt lgkmcnt(5)
v_mfma_f32_32x32x16_bf16 v[16:31], v[176:179], v[120:123], v[16:31]
ds_read_b128 v[200:203], v2 offset:47104
buffer_load_dwordx4 v[92:95], v1, s[4:7], s34 offen offset:3072
s_add_u32 s34, s34, 0x1000
s_waitcnt lgkmcnt(5)
v_mfma_f32_32x32x16_bf16 v[32:47], v[180:183], v[120:123], v[32:47]
ds_read_b128 v[204:207], v2 offset:48128
buffer_load_dwordx4 v[96:99], v1, s[4:7], s34 offen offset:0
s_waitcnt lgkmcnt(5)
v_mfma_f32_32x32x16_bf16 v[48:63], v[184:187], v[120:123], v[48:63]
ds_read_b128 v[176:179], v2 offset:49152
buffer_load_dwordx4 v[100:103], v1, s[4:7], s34 offen offset:1024
s_waitcnt lgkmcnt(5)
v_mfma_f32_32x32x16_bf16 v[64:79], v[188:191], v[120:123], v[64:79]
ds_read_b128 v[180:183], v2 offset:50176
buffer_load_dwordx4 v[104:107], v1, s[4:7], s34 offen offset:2048
s_waitcnt vmcnt(27)
s_waitcnt lgkmcnt(5)
v_mfma_f32_32x32x16_bf16 v[16:31], v[192:195], v[124:127], v[16:31]
ds_read_b128 v[184:187], v2 offset:51200
buffer_load_dwordx4 v[108:111], v1, s[4:7], s34 offen offset:3072
s_add_u32 s34, s34, 0x1000
s_waitcnt lgkmcnt(5)
v_mfma_f32_32x32x16_bf16 v[32:47], v[196:199], v[124:127], v[32:47]
ds_read_b128 v[188:191], v2 offset:52224
s_waitcnt lgkmcnt(5)
v_mfma_f32_32x32x16_bf16 v[48:63], v[200:203], v[124:127], v[48:63]
ds_read_b128 v[192:195], v2 offset:53248
s_waitcnt lgkmcnt(5)
v_mfma_f32_32x32x16_bf16 v[64:79], v[204:207], v[124:127], v[64:79]
ds_read_b128 v[196:199], v2 offset:54272
s_waitcnt vmcnt(20)
s_barrier
s_waitcnt lgkmcnt(5)
v_mfma_f32_32x32x16_bf16 v[16:31], v[176:179], v[128:131], v[16:31]
ds_read_b128 v[200:203], v2 offset:55296
s_waitcnt lgkmcnt(5)
v_mfma_f32_32x32x16_bf16 v[32:47], v[180:183], v[128:131], v[32:47]
ds_read_b128 v[204:207], v2 offset:56320
s_waitcnt lgkmcnt(5)
v_mfma_f32_32x32x16_bf16 v[48:63], v[184:187], v[128:131], v[48:63]
ds_read_b128 v[176:179], v2 offset:57344
s_waitcnt lgkmcnt(5)
v_mfma_f32_32x32x16_bf16 v[64:79], v[188:191], v[128:131], v[64:79]
ds_read_b128 v[180:183], v2 offset:58368
s_waitcnt lgkmcnt(5)
v_mfma_f32_32x32x16_bf16 v[16:31], v[192:195], v[132:135], v[16:31]
ds_read_b128 v[184:187], v2 offset:59392
s_waitcnt lgkmcnt(5)
v_mfma_f32_32x32x16_bf16 v[32:47], v[196:199], v[132:135], v[32:47]
ds_read_b128 v[188:191], v2 offset:60416
s_waitcnt lgkmcnt(5)
v_mfma_f32_32x32x16_bf16 v[48:63], v[200:203], v[132:135], v[48:63]
ds_read_b128 v[192:195], v2 offset:61440
s_waitcnt lgkmcnt(5)
v_mfma_f32_32x32x16_bf16 v[64:79], v[204:207], v[132:135], v[64:79]
ds_read_b128 v[196:199], v2 offset:62464
s_waitcnt lgkmcnt(5)
v_mfma_f32_32x32x16_bf16 v[16:31], v[176:179], v[136:139], v[16:31]
ds_read_b128 v[200:203], v2 offset:63488
s_waitcnt lgkmcnt(5)
v_mfma_f32_32x32x16_bf16 v[32:47], v[180:183], v[136:139], v[32:47]
ds_read_b128 v[204:207], v2 offset:64512
s_waitcnt lgkmcnt(5)
v_mfma_f32_32x32x16_bf16 v[48:63], v[184:187], v[136:139], v[48:63]
ds_read_b128 v[176:179], v3 offset:0
s_waitcnt lgkmcnt(5)
v_mfma_f32_32x32x16_bf16 v[64:79], v[188:191], v[136:139], v[64:79]
ds_read_b128 v[180:183], v3 offset:1024
s_waitcnt lgkmcnt(5)
v_mfma_f32_32x32x16_bf16 v[16:31], v[192:195], v[140:143], v[16:31]
ds_read_b128 v[184:187], v3 offset:2048
s_waitcnt lgkmcnt(5)
v_mfma_f32_32x32x16_bf16 v[32:47], v[196:199], v[140:143], v[32:47]
ds_read_b128 v[188:191], v3 offset:3072
s_waitcnt lgkmcnt(5)
v_mfma_f32_32x32x16_bf16 v[48:63], v[200:203], v[140:143], v[48:63]
ds_read_b128 v[192:195], v3 offset:4096
s_waitcnt lgkmcnt(5)
v_mfma_f32_32x32x16_bf16 v[64:79], v[204:207], v[140:143], v[64:79]
ds_read_b128 v[196:199], v3 offset:5120
s_waitcnt vmcnt(19)
s_waitcnt lgkmcnt(5)
v_mfma_f32_32x32x16_bf16 v[16:31], v[176:179], v[208:211], v[16:31]
ds_read_b128 v[200:203], v3 offset:6144
s_add_u32 m0, s36, 131072
s_nop 0
s_waitcnt lgkmcnt(5)
v_mfma_f32_32x32x16_bf16 v[32:47], v[180:183], v[208:211], v[32:47]
ds_read_b128 v[204:207], v3 offset:7168
buffer_load_dwordx4 v1, s[8:11], s35 offen offset:0 lds
s_waitcnt lgkmcnt(5)
v_mfma_f32_32x32x16_bf16 v[48:63], v[184:187], v[208:211], v[48:63]
ds_read_b128 v[176:179], v3 offset:8192
buffer_load_dwordx4 v1, s[8:11], s35 offen offset:1024 lds
s_waitcnt lgkmcnt(5)
v_mfma_f32_32x32x16_bf16 v[64:79], v[188:191], v[208:211], v[64:79]
ds_read_b128 v[180:183], v3 offset:9216
buffer_load_dwordx4 v1, s[8:11], s35 offen offset:2048 lds
s_waitcnt vmcnt(21)
s_waitcnt lgkmcnt(5)
v_mfma_f32_32x32x16_bf16 v[16:31], v[192:195], v[212:215], v[16:31]
ds_read_b128 v[184:187], v3 offset:10240
buffer_load_dwordx4 v1, s[8:11], s35 offen offset:3072 lds
s_add_u32 s35, s35, 0x100000
s_waitcnt lgkmcnt(5)
v_mfma_f32_32x32x16_bf16 v[32:47], v[196:199], v[212:215], v[32:47]
ds_read_b128 v[188:191], v3 offset:11264
buffer_load_dwordx4 v[112:115], v1, s[4:7], s34 offen offset:0
s_waitcnt lgkmcnt(5)
v_mfma_f32_32x32x16_bf16 v[48:63], v[200:203], v[212:215], v[48:63]
ds_read_b128 v[192:195], v3 offset:12288
buffer_load_dwordx4 v[116:119], v1, s[4:7], s34 offen offset:1024
s_waitcnt lgkmcnt(5)
v_mfma_f32_32x32x16_bf16 v[64:79], v[204:207], v[212:215], v[64:79]
ds_read_b128 v[196:199], v3 offset:13312
buffer_load_dwordx4 v[120:123], v1, s[4:7], s34 offen offset:2048
s_waitcnt vmcnt(24)
s_waitcnt lgkmcnt(5)
v_mfma_f32_32x32x16_bf16 v[16:31], v[176:179], v[216:219], v[16:31]
ds_read_b128 v[200:203], v3 offset:14336
buffer_load_dwordx4 v[124:127], v1, s[4:7], s34 offen offset:3072
s_add_u32 s34, s34, 0x1000
s_waitcnt lgkmcnt(5)
v_mfma_f32_32x32x16_bf16 v[32:47], v[180:183], v[216:219], v[32:47]
ds_read_b128 v[204:207], v3 offset:15360
buffer_load_dwordx4 v[128:131], v1, s[4:7], s34 offen offset:0
s_waitcnt lgkmcnt(5)
v_mfma_f32_32x32x16_bf16 v[48:63], v[184:187], v[216:219], v[48:63]
ds_read_b128 v[176:179], v3 offset:16384
buffer_load_dwordx4 v[132:135], v1, s[4:7], s34 offen offset:1024
s_waitcnt lgkmcnt(5)
v_mfma_f32_32x32x16_bf16 v[64:79], v[188:191], v[216:219], v[64:79]
ds_read_b128 v[180:183], v3 offset:17408
buffer_load_dwordx4 v[136:139], v1, s[4:7], s34 offen offset:2048
s_waitcnt vmcnt(27)
s_waitcnt lgkmcnt(5)
v_mfma_f32_32x32x16_bf16 v[16:31], v[192:195], v[220:223], v[16:31]
ds_read_b128 v[184:187], v3 offset:18432
buffer_load_dwordx4 v[140:143], v1, s[4:7], s34 offen offset:3072
s_add_u32 s34, s34, 0x1000
s_waitcnt lgkmcnt(5)
v_mfma_f32_32x32x16_bf16 v[32:47], v[196:199], v[220:223], v[32:47]
ds_read_b128 v[188:191], v3 offset:19456
s_waitcnt lgkmcnt(5)
v_mfma_f32_32x32x16_bf16 v[48:63], v[200:203], v[220:223], v[48:63]
ds_read_b128 v[192:195], v3 offset:20480
s_waitcnt lgkmcnt(5)
v_mfma_f32_32x32x16_bf16 v[64:79], v[204:207], v[220:223], v[64:79]
ds_read_b128 v[196:199], v3 offset:21504
s_waitcnt vmcnt(20)
s_barrier
s_waitcnt lgkmcnt(5)
v_mfma_f32_32x32x16_bf16 v[16:31], v[176:179], v[224:227], v[16:31]
ds_read_b128 v[200:203], v3 offset:22528
s_waitcnt lgkmcnt(5)
v_mfma_f32_32x32x16_bf16 v[32:47], v[180:183], v[224:227], v[32:47]
ds_read_b128 v[204:207], v3 offset:23552
s_waitcnt lgkmcnt(5)
v_mfma_f32_32x32x16_bf16 v[48:63], v[184:187], v[224:227], v[48:63]
ds_read_b128 v[176:179], v3 offset:24576
s_waitcnt lgkmcnt(5)
v_mfma_f32_32x32x16_bf16 v[64:79], v[188:191], v[224:227], v[64:79]
ds_read_b128 v[180:183], v3 offset:25600
s_waitcnt lgkmcnt(5)
v_mfma_f32_32x32x16_bf16 v[16:31], v[192:195], v[228:231], v[16:31]
ds_read_b128 v[184:187], v3 offset:26624
s_waitcnt lgkmcnt(5)
v_mfma_f32_32x32x16_bf16 v[32:47], v[196:199], v[228:231], v[32:47]
ds_read_b128 v[188:191], v3 offset:27648
s_waitcnt lgkmcnt(5)
v_mfma_f32_32x32x16_bf16 v[48:63], v[200:203], v[228:231], v[48:63]
ds_read_b128 v[192:195], v3 offset:28672
s_waitcnt lgkmcnt(5)
v_mfma_f32_32x32x16_bf16 v[64:79], v[204:207], v[228:231], v[64:79]
ds_read_b128 v[196:199], v3 offset:29696
s_waitcnt lgkmcnt(5)
v_mfma_f32_32x32x16_bf16 v[16:31], v[176:179], v[232:235], v[16:31]
ds_read_b128 v[200:203], v3 offset:30720
s_waitcnt lgkmcnt(5)
v_mfma_f32_32x32x16_bf16 v[32:47], v[180:183], v[232:235], v[32:47]
ds_read_b128 v[204:207], v3 offset:31744
s_waitcnt lgkmcnt(5)
v_mfma_f32_32x32x16_bf16 v[48:63], v[184:187], v[232:235], v[48:63]
ds_read_b128 v[176:179], v3 offset:32768
s_waitcnt lgkmcnt(5)
v_mfma_f32_32x32x16_bf16 v[64:79], v[188:191], v[232:235], v[64:79]
ds_read_b128 v[180:183], v3 offset:33792
s_waitcnt lgkmcnt(5)
v_mfma_f32_32x32x16_bf16 v[16:31], v[192:195], v[236:239], v[16:31]
ds_read_b128 v[184:187], v3 offset:34816
s_waitcnt lgkmcnt(5)
v_mfma_f32_32x32x16_bf16 v[32:47], v[196:199], v[236:239], v[32:47]
ds_read_b128 v[188:191], v3 offset:35840
s_waitcnt lgkmcnt(5)
v_mfma_f32_32x32x16_bf16 v[48:63], v[200:203], v[236:239], v[48:63]
ds_read_b128 v[192:195], v3 offset:36864
s_waitcnt lgkmcnt(5)
v_mfma_f32_32x32x16_bf16 v[64:79], v[204:207], v[236:239], v[64:79]
ds_read_b128 v[196:199], v3 offset:37888
s_cmp_lg_u32 s20, 4
s_cbranch_scc1 .pw_1060
s_lshl_b32 s63, 1, s2
s_not_b32 s63, s63
s_mov_b32 s60, 0x7f
s_mov_b32 s61, 0x0
v_lshlrev_b32 v11, 2, v0
v_mov_b32 v10, 0
s_mov_b64 exec, s[60:61]
buffer_atomic_or v10, v11, s[56:59], 0 offen sc0 sc1
s_mov_b64 exec, -1
.pw_1060:
s_waitcnt vmcnt(19)
s_waitcnt lgkmcnt(5)
v_mfma_f32_32x32x16_bf16 v[16:31], v[176:179], v[80:83], v[16:31]
ds_read_b128 v[200:203], v3 offset:38912
s_waitcnt lgkmcnt(5)
v_mfma_f32_32x32x16_bf16 v[32:47], v[180:183], v[80:83], v[32:47]
ds_read_b128 v[204:207], v3 offset:39936
s_waitcnt lgkmcnt(5)
v_mfma_f32_32x32x16_bf16 v[48:63], v[184:187], v[80:83], v[48:63]
ds_read_b128 v[176:179], v3 offset:40960
s_waitcnt lgkmcnt(5)
v_mfma_f32_32x32x16_bf16 v[64:79], v[188:191], v[80:83], v[64:79]
ds_read_b128 v[180:183], v3 offset:41984
s_waitcnt vmcnt(18)
s_waitcnt lgkmcnt(5)
v_mfma_f32_32x32x16_bf16 v[16:31], v[192:195], v[84:87], v[16:31]
ds_read_b128 v[184:187], v3 offset:43008
s_waitcnt lgkmcnt(5)
v_mfma_f32_32x32x16_bf16 v[32:47], v[196:199], v[84:87], v[32:47]
ds_read_b128 v[188:191], v3 offset:44032
s_waitcnt lgkmcnt(5)
v_mfma_f32_32x32x16_bf16 v[48:63], v[200:203], v[84:87], v[48:63]
ds_read_b128 v[192:195], v3 offset:45056
s_waitcnt lgkmcnt(5)
v_mfma_f32_32x32x16_bf16 v[64:79], v[204:207], v[84:87], v[64:79]
ds_read_b128 v[196:199], v3 offset:46080
s_waitcnt vmcnt(17)
s_waitcnt lgkmcnt(5)
v_mfma_f32_32x32x16_bf16 v[16:31], v[176:179], v[88:91], v[16:31]
ds_read_b128 v[200:203], v3 offset:47104
s_waitcnt lgkmcnt(5)
v_mfma_f32_32x32x16_bf16 v[32:47], v[180:183], v[88:91], v[32:47]
ds_read_b128 v[204:207], v3 offset:48128
s_waitcnt lgkmcnt(5)
v_mfma_f32_32x32x16_bf16 v[48:63], v[184:187], v[88:91], v[48:63]
ds_read_b128 v[176:179], v3 offset:49152
s_waitcnt lgkmcnt(5)
v_mfma_f32_32x32x16_bf16 v[64:79], v[188:191], v[88:91], v[64:79]
ds_read_b128 v[180:183], v3 offset:50176
s_waitcnt vmcnt(16)
s_waitcnt lgkmcnt(5)
v_mfma_f32_32x32x16_bf16 v[16:31], v[192:195], v[92:95], v[16:31]
ds_read_b128 v[184:187], v3 offset:51200
s_waitcnt lgkmcnt(5)
v_mfma_f32_32x32x16_bf16 v[32:47], v[196:199], v[92:95], v[32:47]
ds_read_b128 v[188:191], v3 offset:52224
s_waitcnt lgkmcnt(5)
v_mfma_f32_32x32x16_bf16 v[48:63], v[200:203], v[92:95], v[48:63]
ds_read_b128 v[192:195], v3 offset:53248
s_waitcnt lgkmcnt(5)
v_mfma_f32_32x32x16_bf16 v[64:79], v[204:207], v[92:95], v[64:79]
ds_read_b128 v[196:199], v3 offset:54272
s_waitcnt vmcnt(8)
s_cmp_lg_u32 s20, 4
s_cbranch_scc1 .pw_1061
s_waitcnt vmcnt(0)
v_or_b32 v10, s63, v10
v_cmp_ne_u32 vcc, -1, v10
s_and_b64 vcc, vcc, s[60:61]
s_cbranch_scc1 .pslow_1062
.pret_1063:
.pw_1061:
s_barrier
s_cmp_eq_u32 s48, 0
s_cselect_b32 s50, s28, 1073741824
s_mov_b32 m0, s30
s_add_u32 s29, s50, 0x1000
s_waitcnt lgkmcnt(5)
v_mfma_f32_32x32x16_bf16 v[16:31], v[176:179], v[96:99], v[16:31]
ds_read_b128 v[200:203], v3 offset:55296
buffer_load_dwordx4 v1, s[12:15], s50 offen offset:0 lds
s_waitcnt lgkmcnt(5)
v_mfma_f32_32x32x16_bf16 v[32:47], v[180:183], v[96:99], v[32:47]
ds_read_b128 v[204:207], v3 offset:56320
buffer_load_dwordx4 v1, s[12:15], s50 offen offset:1024 lds
s_waitcnt lgkmcnt(5)
v_mfma_f32_32x32x16_bf16 v[48:63], v[184:187], v[96:99], v[48:63]
ds_read_b128 v[176:179], v3 offset:57344
buffer_load_dwordx4 v1, s[12:15], s50 offen offset:2048 lds
s_waitcnt lgkmcnt(5)
v_mfma_f32_32x32x16_bf16 v[64:79], v[188:191], v[96:99], v[64:79]
ds_read_b128 v[180:183], v3 offset:58368
buffer_load_dwordx4 v1, s[12:15], s50 offen offset:3072 lds
s_waitcnt lgkmcnt(5)
v_mfma_f32_32x32x16_bf16 v[16:31], v[192:195], v[100:103], v[16:31]
ds_read_b128 v[184:187], v3 offset:59392
s_add_u32 m0, s30, 0x1000
s_add_u32 s30, s30, 0x8000
s_waitcnt lgkmcnt(5)
v_mfma_f32_32x32x16_bf16 v[32:47], v[196:199], v[100:103], v[32:47]
ds_read_b128 v[188:191], v3 offset:60416
buffer_load_dwordx4 v1, s[12:15], s29 offen offset:0 lds
s_waitcnt lgkmcnt(5)
v_mfma_f32_32x32x16_bf16 v[48:63], v[200:203], v[100:103], v[48:63]
ds_read_b128 v[192:195], v3 offset:61440
buffer_load_dwordx4 v1, s[12:15], s29 offen offset:1024 lds
s_waitcnt lgkmcnt(5)
v_mfma_f32_32x32x16_bf16 v[64:79], v[204:207], v[100:103], v[64:79]
ds_read_b128 v[196:199], v3 offset:62464
buffer_load_dwordx4 v1, s[12:15], s29 offen offset:2048 lds
s_waitcnt lgkmcnt(5)
v_mfma_f32_32x32x16_bf16 v[16:31], v[176:179], v[104:107], v[16:31]
ds_read_b128 v[200:203], v3 offset:63488
buffer_load_dwordx4 v1, s[12:15], s29 offen offset:3072 lds
s_waitcnt lgkmcnt(5)
v_mfma_f32_32x32x16_bf16 v[32:47], v[180:183], v[104:107], v[32:47]
ds_read_b128 v[204:207], v3 offset:64512
s_cmp_eq_u32 s48, 0
s_cselect_b32 s29, 0x4000, 0
s_add_u32 s28, s28, s29
s_waitcnt lgkmcnt(5)
v_mfma_f32_32x32x16_bf16 v[48:63], v[184:187], v[104:107], v[48:63]
ds_read_b128 v[176:179], v9 offset:0
s_mov_b32 m0, s30
s_add_u32 s29, s28, 0x1000
s_waitcnt lgkmcnt(5)
v_mfma_f32_32x32x16_bf16 v[64:79], v[188:191], v[104:107], v[64:79]
ds_read_b128 v[180:183], v9 offset:1024
buffer_load_dwordx4 v1, s[12:15], s28 offen offset:0 lds
s_waitcnt lgkmcnt(5)
v_mfma_f32_32x32x16_bf16 v[16:31], v[192:195], v[108:111], v[16:31]
ds_read_b128 v[184:187], v9 offset:2048
buffer_load_dwordx4 v1, s[12:15], s28 offen offset:1024 lds
s_waitcnt lgkmcnt(5)
v_mfma_f32_32x32x16_bf16 v[32:47], v[196:199], v[108:111], v[32:47]
ds_read_b128 v[188:191], v9 offset:3072
buffer_load_dwordx4 v1, s[12:15], s28 offen offset:2048 lds
s_waitcnt lgkmcnt(5)
v_mfma_f32_32x32x16_bf16 v[48:63], v[200:203], v[108:111], v[48:63]
ds_read_b128 v[192:195], v9 offset:4096
buffer_load_dwordx4 v1, s[12:15], s28 offen offset:3072 lds
s_waitcnt lgkmcnt(5)
v_mfma_f32_32x32x16_bf16 v[64:79], v[204:207], v[108:111], v[64:79]
ds_read_b128 v[196:199], v9 offset:5120
s_add_u32 m0, s30, 0x1000
s_add_u32 s30, s30, 0x8000
s_waitcnt vmcnt(19)
s_waitcnt lgkmcnt(5)
v_mfma_f32_32x32x16_bf16 v[16:31], v[176:179], v[112:115], v[16:31]
ds_read_b128 v[200:203], v9 offset:6144
buffer_load_dwordx4 v1, s[12:15], s29 offen offset:0 lds
s_waitcnt lgkmcnt(5)
v_mfma_f32_32x32x16_bf16 v[32:47], v[180:183], v[112:115], v[32:47]
ds_read_b128 v[204:207], v9 offset:7168
buffer_load_dwordx4 v1, s[12:15], s29 offen offset:1024 lds
s_waitcnt lgkmcnt(5)
v_mfma_f32_32x32x16_bf16 v[48:63], v[184:187], v[112:115], v[48:63]
ds_read_b128 v[176:179], v9 offset:8192
buffer_load_dwordx4 v1, s[12:15], s29 offen offset:2048 lds
s_waitcnt lgkmcnt(5)
v_mfma_f32_32x32x16_bf16 v[64:79], v[188:191], v[112:115], v[64:79]
ds_read_b128 v[180:183], v9 offset:9216
buffer_load_dwordx4 v1, s[12:15], s29 offen offset:3072 lds
s_waitcnt vmcnt(22)
s_waitcnt lgkmcnt(5)
v_mfma_f32_32x32x16_bf16 v[16:31], v[192:195], v[116:119], v[16:31]
ds_read_b128 v[184:187], v9 offset:10240
s_add_u32 s28, s28, 0x4000
s_cmp_ge_u32 s30, 163840
s_cselect_b32 s30, s49, s30
s_waitcnt lgkmcnt(5)
v_mfma_f32_32x32x16_bf16 v[32:47], v[196:199], v[116:119], v[32:47]
ds_read_b128 v[188:191], v9 offset:11264
s_mov_b32 m0, s30
s_add_u32 s29, s28, 0x1000
s_waitcnt lgkmcnt(5)
v_mfma_f32_32x32x16_bf16 v[48:63], v[200:203], v[116:119], v[48:63]
ds_read_b128 v[192:195], v9 offset:12288
buffer_load_dwordx4 v1, s[12:15], s28 offen offset:0 lds
s_waitcnt lgkmcnt(5)
v_mfma_f32_32x32x16_bf16 v[64:79], v[204:207], v[116:119], v[64:79]
ds_read_b128 v[196:199], v9 offset:13312
buffer_load_dwordx4 v1, s[12:15], s28 offen offset:1024 lds
s_waitcnt vmcnt(23)
s_waitcnt lgkmcnt(5)
v_mfma_f32_32x32x16_bf16 v[16:31], v[176:179], v[120:123], v[16:31]
ds_read_b128 v[200:203], v9 offset:14336
buffer_load_dwordx4 v1, s[12:15], s28 offen offset:2048 lds
s_waitcnt lgkmcnt(5)
v_mfma_f32_32x32x16_bf16 v[32:47], v[180:183], v[120:123], v[32:47]
ds_read_b128 v[204:207], v9 offset:15360
buffer_load_dwordx4 v1, s[12:15], s28 offen offset:3072 lds
s_waitcnt lgkmcnt(5)
v_mfma_f32_32x32x16_bf16 v[48:63], v[184:187], v[120:123], v[48:63]
ds_read_b128 v[176:179], v9 offset:16384
s_add_u32 m0, s30, 0x1000
s_add_u32 s30, s30, 0x8000
s_waitcnt lgkmcnt(5)
v_mfma_f32_32x32x16_bf16 v[64:79], v[188:191], v[120:123], v[64:79]
ds_read_b128 v[180:183], v9 offset:17408
buffer_load_dwordx4 v1, s[12:15], s29 offen offset:0 lds
s_waitcnt vmcnt(25)
s_waitcnt lgkmcnt(5)
v_mfma_f32_32x32x16_bf16 v[16:31], v[192:195], v[124:127], v[16:31]
ds_read_b128 v[184:187], v9 offset:18432
buffer_load_dwordx4 v1, s[12:15], s29 offen offset:1024 lds
s_waitcnt lgkmcnt(5)
v_mfma_f32_32x32x16_bf16 v[32:47], v[196:199], v[124:127], v[32:47]
ds_read_b128 v[188:191], v9 offset:19456
buffer_load_dwordx4 v1, s[12:15], s29 offen offset:2048 lds
s_waitcnt lgkmcnt(5)
v_mfma_f32_32x32x16_bf16 v[48:63], v[200:203], v[124:127], v[48:63]
ds_read_b128 v[192:195], v9 offset:20480
buffer_load_dwordx4 v1, s[12:15], s29 offen offset:3072 lds
s_waitcnt lgkmcnt(5)
v_mfma_f32_32x32x16_bf16 v[64:79], v[204:207], v[124:127], v[64:79]
ds_read_b128 v[196:199], v9 offset:21504
s_add_u32 s28, s28, 0x4000
s_cmp_ge_u32 s30, 163840
s_cselect_b32 s30, s49, s30
s_waitcnt vmcnt(16)
s_barrier
s_waitcnt lgkmcnt(5)
v_mfma_f32_32x32x16_bf16 v[16:31], v[176:179], v[128:131], v[16:31]
ds_read_b128 v[200:203], v9 offset:22528
s_mov_b32 m0, s30
s_add_u32 s29, s28, 0x1000
s_waitcnt lgkmcnt(5)
v_mfma_f32_32x32x16_bf16 v[32:47], v[180:183], v[128:131], v[32:47]
ds_read_b128 v[204:207], v9 offset:23552
buffer_load_dwordx4 v1, s[12:15], s28 offen offset:0 lds
s_waitcnt lgkmcnt(5)
v_mfma_f32_32x32x16_bf16 v[48:63], v[184:187], v[128:131], v[48:63]
ds_read_b128 v[176:179], v9 offset:24576
buffer_load_dwordx4 v1, s[12:15], s28 offen offset:1024 lds
s_waitcnt lgkmcnt(5)
v_mfma_f32_32x32x16_bf16 v[64:79], v[188:191], v[128:131], v[64:79]
ds_read_b128 v[180:183], v9 offset:25600
buffer_load_dwordx4 v1, s[12:15], s28 offen offset:2048 lds
s_waitcnt lgkmcnt(5)
v_mfma_f32_32x32x16_bf16 v[16:31], v[192:195], v[132:135], v[16:31]
ds_read_b128 v[184:187], v9 offset:26624
buffer_load_dwordx4 v1, s[12:15], s28 offen offset:3072 lds
s_waitcnt lgkmcnt(5)
v_mfma_f32_32x32x16_bf16 v[32:47], v[196:199], v[132:135], v[32:47]
ds_read_b128 v[188:191], v9 offset:27648
s_add_u32 m0, s30, 0x1000
s_add_u32 s30, s30, 0x8000
s_waitcnt lgkmcnt(5)
v_mfma_f32_32x32x16_bf16 v[48:63], v[200:203], v[132:135], v[48:63]
ds_read_b128 v[192:195], v9 offset:28672
buffer_load_dwordx4 v1, s[12:15], s29 offen offset:0 lds
s_waitcnt lgkmcnt(5)
v_mfma_f32_32x32x16_bf16 v[64:79], v[204:207], v[132:135], v[64:79]
ds_read_b128 v[196:199], v9 offset:29696
buffer_load_dwordx4 v1, s[12:15], s29 offen offset:1024 lds
s_waitcnt lgkmcnt(5)
v_mfma_f32_32x32x16_bf16 v[16:31], v[176:179], v[136:139], v[16:31]
ds_read_b128 v[200:203], v9 offset:30720
buffer_load_dwordx4 v1, s[12:15], s29 offen offset:2048 lds
s_waitcnt lgkmcnt(5)
v_mfma_f32_32x32x16_bf16 v[32:47], v[180:183], v[136:139], v[32:47]
ds_read_b128 v[204:207], v9 offset:31744
buffer_load_dwordx4 v1, s[12:15], s29 offen offset:3072 lds
s_waitcnt lgkmcnt(5)
v_mfma_f32_32x32x16_bf16 v[48:63], v[184:187], v[136:139], v[48:63]
ds_read_b128 v[176:179], v1 offset:0
s_add_u32 s28, s28, 0x4000
s_cmp_ge_u32 s30, 163840
s_cselect_b32 s30, s49, s30
s_waitcnt lgkmcnt(5)
v_mfma_f32_32x32x16_bf16 v[64:79], v[188:191], v[136:139], v[64:79]
ds_read_b128 v[180:183], v1 offset:8192
s_waitcnt lgkmcnt(5)
v_mfma_f32_32x32x16_bf16 v[16:31], v[192:195], v[140:143], v[16:31]
ds_read_b128 v[184:187], v1 offset:1024
s_waitcnt lgkmcnt(5)
v_mfma_f32_32x32x16_bf16 v[32:47], v[196:199], v[140:143], v[32:47]
ds_read_b128 v[188:191], v1 offset:9216
s_waitcnt lgkmcnt(5)
v_mfma_f32_32x32x16_bf16 v[48:63], v[200:203], v[140:143], v[48:63]
ds_read_b128 v[192:195], v1 offset:2048
s_waitcnt lgkmcnt(5)
v_mfma_f32_32x32x16_bf16 v[64:79], v[204:207], v[140:143], v[64:79]
ds_read_b128 v[196:199], v1 offset:10240
s_waitcnt vmcnt(16)
s_barrier
s_mov_b32 s23, 0x3e0293ee
v_mul_f32 v16, s23, v16
v_mul_f32 v17, s23, v17
v_cvt_pk_bf16_f32 v144, v16, v17
v_mul_f32 v18, s23, v18
v_mul_f32 v19, s23, v19
v_cvt_pk_bf16_f32 v145, v18, v19
s_mov_b32 m0, s30
s_add_u32 s29, s28, 0x1000
v_mul_f32 v20, s23, v20
v_mul_f32 v21, s23, v21
v_cvt_pk_bf16_f32 v146, v20, v21
v_mul_f32 v22, s23, v22
v_mul_f32 v23, s23, v23
v_cvt_pk_bf16_f32 v147, v22, v23
buffer_load_dwordx4 v1, s[12:15], s28 offen offset:0 lds
v_mul_f32 v24, s23, v24
v_mul_f32 v25, s23, v25
v_cvt_pk_bf16_f32 v148, v24, v25
v_mul_f32 v26, s23, v26
v_mul_f32 v27, s23, v27
v_cvt_pk_bf16_f32 v149, v26, v27
buffer_load_dwordx4 v1, s[12:15], s28 offen offset:1024 lds
v_mul_f32 v28, s23, v28
v_mul_f32 v29, s23, v29
v_cvt_pk_bf16_f32 v150, v28, v29
v_mul_f32 v30, s23, v30
v_mul_f32 v31, s23, v31
v_cvt_pk_bf16_f32 v151, v30, v31
buffer_load_dwordx4 v1, s[12:15], s28 offen offset:2048 lds
v_mul_f32 v32, s23, v32
v_mul_f32 v33, s23, v33
v_cvt_pk_bf16_f32 v152, v32, v33
v_mul_f32 v34, s23, v34
v_mul_f32 v35, s23, v35
v_cvt_pk_bf16_f32 v153, v34, v35
buffer_load_dwordx4 v1, s[12:15], s28 offen offset:3072 lds
v_mul_f32 v36, s23, v36
v_mul_f32 v37, s23, v37
v_cvt_pk_bf16_f32 v154, v36, v37
v_mul_f32 v38, s23, v38
v_mul_f32 v39, s23, v39
v_cvt_pk_bf16_f32 v155, v38, v39
s_add_u32 m0, s30, 0x1000
s_add_u32 s30, s30, 0x8000
v_mul_f32 v40, s23, v40
v_mul_f32 v41, s23, v41
v_cvt_pk_bf16_f32 v156, v40, v41
v_mul_f32 v42, s23, v42
v_mul_f32 v43, s23, v43
v_cvt_pk_bf16_f32 v157, v42, v43
buffer_load_dwordx4 v1, s[12:15], s29 offen offset:0 lds
v_mul_f32 v44, s23, v44
v_mul_f32 v45, s23, v45
v_cvt_pk_bf16_f32 v158, v44, v45
v_mul_f32 v46, s23, v46
v_mul_f32 v47, s23, v47
v_cvt_pk_bf16_f32 v159, v46, v47
buffer_load_dwordx4 v1, s[12:15], s29 offen offset:1024 lds
v_mul_f32 v48, s23, v48
v_mul_f32 v49, s23, v49
v_cvt_pk_bf16_f32 v160, v48, v49
v_mul_f32 v50, s23, v50
v_mul_f32 v51, s23, v51
v_cvt_pk_bf16_f32 v161, v50, v51
buffer_load_dwordx4 v1, s[12:15], s29 offen offset:2048 lds
v_mul_f32 v52, s23, v52
v_mul_f32 v53, s23, v53
v_cvt_pk_bf16_f32 v162, v52, v53
v_mul_f32 v54, s23, v54
v_mul_f32 v55, s23, v55
v_cvt_pk_bf16_f32 v163, v54, v55
buffer_load_dwordx4 v1, s[12:15], s29 offen offset:3072 lds
v_mul_f32 v56, s23, v56
v_mul_f32 v57, s23, v57
v_cvt_pk_bf16_f32 v164, v56, v57
v_mul_f32 v58, s23, v58
v_mul_f32 v59, s23, v59
v_cvt_pk_bf16_f32 v165, v58, v59
s_add_u32 s28, s28, 0x4000
s_cmp_ge_u32 s30, 163840
s_cselect_b32 s30, s49, s30
v_mul_f32 v60, s23, v60
v_mul_f32 v61, s23, v61
v_cvt_pk_bf16_f32 v166, v60, v61
v_mul_f32 v62, s23, v62
v_mul_f32 v63, s23, v63
v_cvt_pk_bf16_f32 v167, v62, v63
v_mul_f32 v64, s23, v64
v_mul_f32 v65, s23, v65
v_cvt_pk_bf16_f32 v168, v64, v65
v_mul_f32 v66, s23, v66
v_mul_f32 v67, s23, v67
v_cvt_pk_bf16_f32 v169, v66, v67
v_mul_f32 v68, s23, v68
v_mul_f32 v69, s23, v69
v_cvt_pk_bf16_f32 v170, v68, v69
v_mul_f32 v70, s23, v70
v_mul_f32 v71, s23, v71
v_cvt_pk_bf16_f32 v171, v70, v71
v_mul_f32 v72, s23, v72
v_mul_f32 v73, s23, v73
v_cvt_pk_bf16_f32 v172, v72, v73
v_mul_f32 v74, s23, v74
v_mul_f32 v75, s23, v75
v_cvt_pk_bf16_f32 v173, v74, v75
v_mul_f32 v76, s23, v76
v_mul_f32 v77, s23, v77
v_cvt_pk_bf16_f32 v174, v76, v77
v_mul_f32 v78, s23, v78
v_mul_f32 v79, s23, v79
v_cvt_pk_bf16_f32 v175, v78, v79
s_waitcnt lgkmcnt(5)
v_mfma_f32_32x32x16_bf16 v[80:95], v[176:179], v[144:147], 0
ds_read_b128 v[200:203], v1 offset:3072
v_mov_b32 v16, 0
v_mov_b32 v17, 0
v_mov_b32 v18, 0
v_mov_b32 v19, 0
s_waitcnt lgkmcnt(5)
v_mfma_f32_32x32x16_bf16 v[96:111], v[180:183], v[144:147], 0
ds_read_b128 v[204:207], v1 offset:11264
v_mov_b32 v20, 0
v_mov_b32 v21, 0
v_mov_b32 v22, 0
v_mov_b32 v23, 0
s_waitcnt lgkmcnt(5)
v_mfma_f32_32x32x16_bf16 v[80:95], v[184:187], v[148:151], v[80:95]
ds_read_b128 v[176:179], v1 offset:4096
v_mov_b32 v24, 0
v_mov_b32 v25, 0
v_mov_b32 v26, 0
v_mov_b32 v27, 0
s_waitcnt lgkmcnt(5)
v_mfma_f32_32x32x16_bf16 v[96:111], v[188:191], v[148:151], v[96:111]
ds_read_b128 v[180:183], v1 offset:12288
v_mov_b32 v28, 0
v_mov_b32 v29, 0
v_mov_b32 v30, 0
v_mov_b32 v31, 0
s_waitcnt lgkmcnt(5)
v_mfma_f32_32x32x16_bf16 v[80:95], v[192:195], v[152:155], v[80:95]
ds_read_b128 v[184:187], v1 offset:5120
v_mov_b32 v32, 0
v_mov_b32 v33, 0
v_mov_b32 v34, 0
v_mov_b32 v35, 0
s_waitcnt lgkmcnt(5)
v_mfma_f32_32x32x16_bf16 v[96:111], v[196:199], v[152:155], v[96:111]
ds_read_b128 v[188:191], v1 offset:13312
v_mov_b32 v36, 0
v_mov_b32 v37, 0
v_mov_b32 v38, 0
v_mov_b32 v39, 0
s_waitcnt lgkmcnt(5)
v_mfma_f32_32x32x16_bf16 v[80:95], v[200:203], v[156:159], v[80:95]
ds_read_b128 v[192:195], v1 offset:6144
v_mov_b32 v40, 0
v_mov_b32 v41, 0
v_mov_b32 v42, 0
v_mov_b32 v43, 0
s_waitcnt lgkmcnt(5)
v_mfma_f32_32x32x16_bf16 v[96:111], v[204:207], v[156:159], v[96:111]
ds_read_b128 v[196:199], v1 offset:14336
v_mov_b32 v44, 0
v_mov_b32 v45, 0
v_mov_b32 v46, 0
v_mov_b32 v47, 0
s_waitcnt lgkmcnt(5)
v_mfma_f32_32x32x16_bf16 v[80:95], v[176:179], v[160:163], v[80:95]
ds_read_b128 v[200:203], v1 offset:7168
v_mov_b32 v48, 0
v_mov_b32 v49, 0
v_mov_b32 v50, 0
v_mov_b32 v51, 0
s_waitcnt lgkmcnt(5)
v_mfma_f32_32x32x16_bf16 v[96:111], v[180:183], v[160:163], v[96:111]
ds_read_b128 v[204:207], v1 offset:15360
v_mov_b32 v52, 0
v_mov_b32 v53, 0
v_mov_b32 v54, 0
v_mov_b32 v55, 0
s_waitcnt lgkmcnt(5)
v_mfma_f32_32x32x16_bf16 v[80:95], v[184:187], v[164:167], v[80:95]
ds_read_b128 v[176:179], v1 offset:32768
v_mov_b32 v56, 0
v_mov_b32 v57, 0
v_mov_b32 v58, 0
v_mov_b32 v59, 0
s_waitcnt lgkmcnt(5)
v_mfma_f32_32x32x16_bf16 v[96:111], v[188:191], v[164:167], v[96:111]
ds_read_b128 v[180:183], v1 offset:40960
v_mov_b32 v60, 0
v_mov_b32 v61, 0
v_mov_b32 v62, 0
v_mov_b32 v63, 0
s_waitcnt lgkmcnt(5)
v_mfma_f32_32x32x16_bf16 v[80:95], v[192:195], v[168:171], v[80:95]
ds_read_b128 v[184:187], v1 offset:33792
v_mov_b32 v64, 0
v_mov_b32 v65, 0
v_mov_b32 v66, 0
v_mov_b32 v67, 0
s_waitcnt lgkmcnt(5)
v_mfma_f32_32x32x16_bf16 v[96:111], v[196:199], v[168:171], v[96:111]
ds_read_b128 v[188:191], v1 offset:41984
v_mov_b32 v68, 0
v_mov_b32 v69, 0
v_mov_b32 v70, 0
v_mov_b32 v71, 0
s_waitcnt lgkmcnt(5)
v_mfma_f32_32x32x16_bf16 v[80:95], v[200:203], v[172:175], v[80:95]
ds_read_b128 v[192:195], v1 offset:34816
v_mov_b32 v72, 0
v_mov_b32 v73, 0
v_mov_b32 v74, 0
v_mov_b32 v75, 0
s_waitcnt lgkmcnt(5)
v_mfma_f32_32x32x16_bf16 v[96:111], v[204:207], v[172:175], v[96:111]
ds_read_b128 v[196:199], v1 offset:43008
v_mov_b32 v76, 0
v_mov_b32 v77, 0
v_mov_b32 v78, 0
v_mov_b32 v79, 0
v_add_u32 v2, 0x8000, v1
s_mov_b32 s31, 0x10000
v_mov_b32 v6, 0
v_mov_b32 v7, 0
s_cmp_lg_u32 s25, 0
s_cbranch_scc1 .nomask_1065
v_cmp_gt_i32_e64 s[40:41], 0, v4
v_cmp_gt_i32_e64 s[42:43], 1, v4
v_cmp_gt_i32_e64 s[44:45], 2, v4
v_cmp_gt_i32_e64 s[46:47], 3, v4
v_cndmask_b32_e64 v80, v80, v8, s[40:41]
v_cndmask_b32_e64 v81, v81, v8, s[42:43]
v_cndmask_b32_e64 v82, v82, v8, s[44:45]
v_cndmask_b32_e64 v83, v83, v8, s[46:47]
v_cmp_gt_i32_e64 s[40:41], 8, v4
v_cmp_gt_i32_e64 s[42:43], 9, v4
v_cmp_gt_i32_e64 s[44:45], 10, v4
v_cmp_gt_i32_e64 s[46:47], 11, v4
v_cndmask_b32_e64 v84, v84, v8, s[40:41]
v_cndmask_b32_e64 v85, v85, v8, s[42:43]
v_cndmask_b32_e64 v86, v86, v8, s[44:45]
v_cndmask_b32_e64 v87, v87, v8, s[46:47]
v_cmp_gt_i32_e64 s[40:41], 16, v4
v_cmp_gt_i32_e64 s[42:43], 17, v4
v_cmp_gt_i32_e64 s[44:45], 18, v4
v_cmp_gt_i32_e64 s[46:47], 19, v4
v_cndmask_b32_e64 v88, v88, v8, s[40:41]
v_cndmask_b32_e64 v89, v89, v8, s[42:43]
v_cndmask_b32_e64 v90, v90, v8, s[44:45]
v_cndmask_b32_e64 v91, v91, v8, s[46:47]
v_cmp_gt_i32_e64 s[40:41], 24, v4
v_cmp_gt_i32_e64 s[42:43], 25, v4
v_cmp_gt_i32_e64 s[44:45], 26, v4
v_cmp_gt_i32_e64 s[46:47], 27, v4
v_cndmask_b32_e64 v92, v92, v8, s[40:41]
v_cndmask_b32_e64 v93, v93, v8, s[42:43]
v_cndmask_b32_e64 v94, v94, v8, s[44:45]
v_cndmask_b32_e64 v95, v95, v8, s[46:47]
v_cmp_gt_i32_e64 s[40:41], 32, v4
v_cmp_gt_i32_e64 s[42:43], 33, v4
v_cmp_gt_i32_e64 s[44:45], 34, v4
v_cmp_gt_i32_e64 s[46:47], 35, v4
v_cndmask_b32_e64 v96, v96, v8, s[40:41]
v_cndmask_b32_e64 v97, v97, v8, s[42:43]
v_cndmask_b32_e64 v98, v98, v8, s[44:45]
v_cndmask_b32_e64 v99, v99, v8, s[46:47]
v_cmp_gt_i32_e64 s[40:41], 40, v4
v_cmp_gt_i32_e64 s[42:43], 41, v4
v_cmp_gt_i32_e64 s[44:45], 42, v4
v_cmp_gt_i32_e64 s[46:47], 43, v4
v_cndmask_b32_e64 v100, v100, v8, s[40:41]
v_cndmask_b32_e64 v101, v101, v8, s[42:43]
v_cndmask_b32_e64 v102, v102, v8, s[44:45]
v_cndmask_b32_e64 v103, v103, v8, s[46:47]
v_cmp_gt_i32_e64 s[40:41], 48, v4
v_cmp_gt_i32_e64 s[42:43], 49, v4
v_cmp_gt_i32_e64 s[44:45], 50, v4
v_cmp_gt_i32_e64 s[46:47], 51, v4
v_cndmask_b32_e64 v104, v104, v8, s[40:41]
v_cndmask_b32_e64 v105, v105, v8, s[42:43]
v_cndmask_b32_e64 v106, v106, v8, s[44:45]
v_cndmask_b32_e64 v107, v107, v8, s[46:47]
v_cmp_gt_i32_e64 s[40:41], 56, v4
v_cmp_gt_i32_e64 s[42:43], 57, v4
v_cmp_gt_i32_e64 s[44:45], 58, v4
v_cmp_gt_i32_e64 s[46:47], 59, v4
v_cndmask_b32_e64 v108, v108, v8, s[40:41]
v_cndmask_b32_e64 v109, v109, v8, s[42:43]
v_cndmask_b32_e64 v110, v110, v8, s[44:45]
v_cndmask_b32_e64 v111, v111, v8, s[46:47]
.nomask_1065:
v_max3_f32 v5, v80, v81, v82
v_max3_f32 v5, v5, v83, v84
v_max3_f32 v5, v5, v85, v86
v_max3_f32 v5, v5, v87, v88
v_max3_f32 v5, v5, v89, v90
v_max3_f32 v5, v5, v91, v92
v_max3_f32 v5, v5, v93, v94
v_max3_f32 v5, v5, v95, v96
v_max3_f32 v5, v5, v97, v98
v_max3_f32 v5, v5, v99, v100
v_max3_f32 v5, v5, v101, v102
v_max3_f32 v5, v5, v103, v104
v_max3_f32 v5, v5, v105, v106
v_max3_f32 v5, v5, v107, v108
v_max3_f32 v5, v5, v109, v110
v_max_f32 v5, v5, v111
v_mov_b32 v10, v5
s_nop 1
v_permlane32_swap_b32 v10, v5
v_max_f32 v10, v10, v5
v_sub_f32 v80, v80, v10
v_sub_f32 v81, v81, v10
v_sub_f32 v82, v82, v10
v_sub_f32 v83, v83, v10
v_sub_f32 v84, v84, v10
v_sub_f32 v85, v85, v10
v_sub_f32 v86, v86, v10
v_sub_f32 v87, v87, v10
v_sub_f32 v88, v88, v10
v_sub_f32 v89, v89, v10
v_sub_f32 v90, v90, v10
v_sub_f32 v91, v91, v10
v_sub_f32 v92, v92, v10
v_sub_f32 v93, v93, v10
v_sub_f32 v94, v94, v10
v_sub_f32 v95, v95, v10
v_sub_f32 v96, v96, v10
v_sub_f32 v97, v97, v10
v_sub_f32 v98, v98, v10
v_sub_f32 v99, v99, v10
v_sub_f32 v100, v100, v10
v_sub_f32 v101, v101, v10
v_sub_f32 v102, v102, v10
v_sub_f32 v103, v103, v10
v_sub_f32 v104, v104, v10
v_sub_f32 v105, v105, v10
v_sub_f32 v106, v106, v10
v_sub_f32 v107, v107, v10
v_sub_f32 v108, v108, v10
v_sub_f32 v109, v109, v10
v_sub_f32 v110, v110, v10
v_sub_f32 v111, v111, v10
v_sub_f32 v208, 0, v10
v_sub_f32 v209, 0, v10
v_sub_f32 v210, 0, v10
v_sub_f32 v211, 0, v10
v_sub_f32 v212, 0, v10
v_sub_f32 v213, 0, v10
v_sub_f32 v214, 0, v10
v_sub_f32 v215, 0, v10
v_sub_f32 v216, 0, v10
v_sub_f32 v217, 0, v10
v_sub_f32 v218, 0, v10
v_sub_f32 v219, 0, v10
v_sub_f32 v220, 0, v10
v_sub_f32 v221, 0, v10
v_sub_f32 v222, 0, v10
v_sub_f32 v223, 0, v10
.loop_1066:
s_cmp_eq_u32 s25, 0
s_cbranch_scc1 .final_1068
s_waitcnt vmcnt(16)
s_barrier
s_setprio 3
s_waitcnt lgkmcnt(5)
v_mfma_f32_32x32x16_bf16 v[112:127], v[176:179], v[144:147], v[208:223]
ds_read_b128 v[200:203], v2 offset:3072
v_exp_f32 v80, v80
v_exp_f32 v81, v81
s_mov_b32 m0, s30
s_add_u32 s29, s28, 0x1000
s_waitcnt lgkmcnt(5)
v_mfma_f32_32x32x16_bf16 v[128:143], v[180:183], v[144:147], v[208:223]
ds_read_b128 v[204:207], v2 offset:11264
v_exp_f32 v82, v82
v_exp_f32 v83, v83
buffer_load_dwordx4 v1, s[12:15], s28 offen offset:0 lds
s_waitcnt lgkmcnt(5)
v_mfma_f32_32x32x16_bf16 v[112:127], v[184:187], v[148:151], v[112:127]
ds_read_b128 v[176:179], v2 offset:4096
v_exp_f32 v84, v84
v_exp_f32 v85, v85
buffer_load_dwordx4 v1, s[12:15], s28 offen offset:1024 lds
s_waitcnt lgkmcnt(5)
v_mfma_f32_32x32x16_bf16 v[128:143], v[188:191], v[148:151], v[128:143]
ds_read_b128 v[180:183], v2 offset:12288
v_exp_f32 v86, v86
v_exp_f32 v87, v87
buffer_load_dwordx4 v1, s[12:15], s28 offen offset:2048 lds
s_waitcnt lgkmcnt(5)
v_mfma_f32_32x32x16_bf16 v[112:127], v[192:195], v[152:155], v[112:127]
ds_read_b128 v[184:187], v2 offset:5120
v_exp_f32 v88, v88
v_exp_f32 v89, v89
buffer_load_dwordx4 v1, s[12:15], s28 offen offset:3072 lds
s_waitcnt lgkmcnt(5)
v_mfma_f32_32x32x16_bf16 v[128:143], v[196:199], v[152:155], v[128:143]
ds_read_b128 v[188:191], v2 offset:13312
v_exp_f32 v90, v90
s_add_u32 m0, s30, 0x1000
s_add_u32 s30, s30, 0x8000
v_cvt_pk_bf16_f32 v224, v80, v81
v_cvt_pk_bf16_f32 v225, v82, v83
s_waitcnt lgkmcnt(5)
v_mfma_f32_32x32x16_bf16 v[112:127], v[200:203], v[156:159], v[112:127]
ds_read_b128 v[192:195], v2 offset:6144
v_exp_f32 v91, v91
buffer_load_dwordx4 v1, s[12:15], s29 offen offset:0 lds
v_cvt_pk_bf16_f32 v226, v84, v85
v_cvt_pk_bf16_f32 v227, v86, v87
s_waitcnt lgkmcnt(5)
v_mfma_f32_32x32x16_bf16 v[128:143], v[204:207], v[156:159], v[128:143]
ds_read_b128 v[196:199], v2 offset:14336
v_exp_f32 v92, v92
buffer_load_dwordx4 v1, s[12:15], s29 offen offset:1024 lds
v_cvt_pk_bf16_f32 v228, v88, v89
v_cvt_pk_bf16_f32 v229, v90, v91
s_setprio 2
s_waitcnt lgkmcnt(5)
v_mfma_f32_32x32x16_bf16 v[112:127], v[176:179], v[160:163], v[112:127]
ds_read_b128 v[200:203], v2 offset:7168
v_exp_f32 v93, v93
buffer_load_dwordx4 v1, s[12:15], s29 offen offset:2048 lds
v_add_f32 v6, v6, v80
v_add_f32 v7, v7, v81
s_waitcnt lgkmcnt(5)
v_mfma_f32_32x32x16_bf16 v[128:143], v[180:183], v[160:163], v[128:143]
ds_read_b128 v[204:207], v2 offset:15360
v_exp_f32 v94, v94
buffer_load_dwordx4 v1, s[12:15], s29 offen offset:3072 lds
v_cvt_pk_bf16_f32 v230, v92, v93
v_add_f32 v6, v6, v82
s_waitcnt lgkmcnt(5)
v_mfma_f32_32x32x16_bf16 v[112:127], v[184:187], v[164:167], v[112:127]
ds_read_b128 v[176:179], v2 offset:16384
v_exp_f32 v95, v95
s_add_u32 s28, s28, 0x4000
s_cmp_ge_u32 s30, 163840
s_cselect_b32 s30, s49, s30
v_add_f32 v7, v7, v83
v_add_f32 v6, v6, v84
s_waitcnt lgkmcnt(5)
v_mfma_f32_32x32x16_bf16 v[128:143], v[188:191], v[164:167], v[128:143]
ds_read_b128 v[180:183], v2 offset:17408
v_exp_f32 v96, v96
v_cvt_pk_bf16_f32 v231, v94, v95
v_add_f32 v7, v7, v85
s_waitcnt lgkmcnt(5)
v_mfma_f32_32x32x16_bf16 v[112:127], v[192:195], v[168:171], v[112:127]
ds_read_b128 v[184:187], v2 offset:18432
v_add_u32 v3, s31, v1
s_add_u32 s31, s31, 0x8000
s_cmp_ge_u32 s31, 163840
s_cselect_b32 s31, 0, s31
v_exp_f32 v97, v97
v_add_f32 v6, v6, v86
v_add_f32 v7, v7, v87
s_waitcnt lgkmcnt(5)
v_mfma_f32_32x32x16_bf16 v[128:143], v[196:199], v[168:171], v[128:143]
ds_read_b128 v[188:191], v2 offset:19456
v_exp_f32 v98, v98
v_cvt_pk_bf16_f32 v232, v96, v97
v_add_f32 v6, v6, v88
s_waitcnt lgkmcnt(5)
v_mfma_f32_32x32x16_bf16 v[112:127], v[200:203], v[172:175], v[112:127]
ds_read_b128 v[192:195], v2 offset:20480
v_exp_f32 v99, v99
v_add_f32 v7, v7, v89
v_add_f32 v6, v6, v90
s_waitcnt lgkmcnt(5)
v_mfma_f32_32x32x16_bf16 v[128:143], v[204:207], v[172:175], v[128:143]
ds_read_b128 v[196:199], v2 offset:21504
v_exp_f32 v100, v100
v_cvt_pk_bf16_f32 v233, v98, v99
v_add_f32 v7, v7, v91
s_setprio 1
s_waitcnt lgkmcnt(5)
v_mfma_f32_32x32x16_bf16 v[16:31], v[176:179], v[224:227], v[16:31]
ds_read_b128 v[200:203], v2 offset:22528
v_exp_f32 v101, v101
v_add_f32 v6, v6, v92
v_add_f32 v7, v7, v93
s_waitcnt lgkmcnt(5)
v_mfma_f32_32x32x16_bf16 v[32:47], v[180:183], v[224:227], v[32:47]
ds_read_b128 v[204:207], v2 offset:23552
s_cmp_eq_u32 s25, 1
s_cbranch_scc1 .mask_1071
.maskr_1072:
v_exp_f32 v102, v102
v_cvt_pk_bf16_f32 v234, v100, v101
v_add_f32 v6, v6, v94
s_waitcnt lgkmcnt(5)
v_mfma_f32_32x32x16_bf16 v[48:63], v[184:187], v[224:227], v[48:63]
ds_read_b128 v[176:179], v2 offset:24576
v_exp_f32 v103, v103
v_max3_f32 v5, v112, v113, v114
v_max3_f32 v5, v5, v115, v116
s_waitcnt lgkmcnt(5)
v_mfma_f32_32x32x16_bf16 v[64:79], v[188:191], v[224:227], v[64:79]
ds_read_b128 v[180:183], v2 offset:25600
v_exp_f32 v104, v104
v_cvt_pk_bf16_f32 v235, v102, v103
v_max3_f32 v5, v5, v117, v118
s_waitcnt lgkmcnt(5)
v_mfma_f32_32x32x16_bf16 v[16:31], v[192:195], v[228:231], v[16:31]
ds_read_b128 v[184:187], v2 offset:26624
v_exp_f32 v105, v105
v_max3_f32 v5, v5, v119, v120
v_max3_f32 v5, v5, v121, v122
s_waitcnt lgkmcnt(5)
v_mfma_f32_32x32x16_bf16 v[32:47], v[196:199], v[228:231], v[32:47]
ds_read_b128 v[188:191], v2 offset:27648
v_exp_f32 v106, v106
v_cvt_pk_bf16_f32 v236, v104, v105
v_max3_f32 v5, v5, v123, v124
s_waitcnt lgkmcnt(5)
v_mfma_f32_32x32x16_bf16 v[48:63], v[200:203], v[228:231], v[48:63]
ds_read_b128 v[192:195], v2 offset:28672
v_exp_f32 v107, v107
v_max3_f32 v5, v5, v125, v126
v_max3_f32 v5, v5, v127, v128
s_waitcnt lgkmcnt(5)
v_mfma_f32_32x32x16_bf16 v[64:79], v[204:207], v[228:231], v[64:79]
ds_read_b128 v[196:199], v2 offset:29696
v_exp_f32 v108, v108
v_cvt_pk_bf16_f32 v237, v106, v107
v_max3_f32 v5, v5, v129, v130
s_setprio 0
s_waitcnt lgkmcnt(5)
v_mfma_f32_32x32x16_bf16 v[16:31], v[176:179], v[232:235], v[16:31]
ds_read_b128 v[200:203], v2 offset:30720
v_exp_f32 v109, v109
v_max3_f32 v5, v5, v131, v132
v_max3_f32 v5, v5, v133, v134
s_waitcnt lgkmcnt(5)
v_mfma_f32_32x32x16_bf16 v[32:47], v[180:183], v[232:235], v[32:47]
ds_read_b128 v[204:207], v2 offset:31744
v_exp_f32 v110, v110
v_cvt_pk_bf16_f32 v238, v108, v109
v_max3_f32 v5, v5, v135, v136
s_waitcnt lgkmcnt(5)
v_mfma_f32_32x32x16_bf16 v[48:63], v[184:187], v[232:235], v[48:63]
ds_read_b128 v[176:179], v3 offset:0
v_exp_f32 v111, v111
v_max3_f32 v5, v5, v137, v138
v_max3_f32 v5, v5, v139, v140
s_waitcnt lgkmcnt(5)
v_mfma_f32_32x32x16_bf16 v[64:79], v[188:191], v[232:235], v[64:79]
ds_read_b128 v[180:183], v3 offset:8192
v_cvt_pk_bf16_f32 v239, v110, v111
v_max3_f32 v5, v5, v141, v142
v_max_f32 v5, v5, v143
v_cmp_lt_f32 vcc, 0x41000000, v5
s_waitcnt lgkmcnt(5)
v_mfma_f32_32x32x16_bf16 v[16:31], v[192:195], v[236:239], v[16:31]
ds_read_b128 v[184:187], v3 offset:1024
v_add_f32 v7, v7, v95
v_add_f32 v6, v6, v96
v_add_f32 v7, v7, v97
v_add_f32 v6, v6, v98
s_waitcnt lgkmcnt(5)
v_mfma_f32_32x32x16_bf16 v[32:47], v[196:199], v[236:239], v[32:47]
ds_read_b128 v[188:191], v3 offset:9216
v_add_f32 v7, v7, v99
v_add_f32 v6, v6, v100
v_add_f32 v7, v7, v101
v_add_f32 v6, v6, v102
s_waitcnt lgkmcnt(5)
v_mfma_f32_32x32x16_bf16 v[48:63], v[200:203], v[236:239], v[48:63]
ds_read_b128 v[192:195], v3 offset:2048
v_add_f32 v7, v7, v103
v_add_f32 v6, v6, v104
v_add_f32 v7, v7, v105
v_add_f32 v6, v6, v106
s_waitcnt lgkmcnt(5)
v_mfma_f32_32x32x16_bf16 v[64:79], v[204:207], v[236:239], v[64:79]
ds_read_b128 v[196:199], v3 offset:10240
v_add_f32 v7, v7, v107
v_add_f32 v6, v6, v108
v_add_f32 v7, v7, v109
v_add_f32 v6, v6, v110
v_add_f32 v7, v7, v111
s_sub_u32 s25, s25, 1
s_cbranch_vccnz .resc_1073
.rescr_1074:
.loop_1067:
s_cmp_eq_u32 s25, 0
s_cbranch_scc1 .final_1069
s_waitcnt vmcnt(16)
s_barrier
s_setprio 3
s_waitcnt lgkmcnt(5)
v_mfma_f32_32x32x16_bf16 v[80:95], v[176:179], v[144:147], v[208:223]
ds_read_b128 v[200:203], v3 offset:3072
v_exp_f32 v112, v112
v_exp_f32 v113, v113
s_mov_b32 m0, s30
s_add_u32 s29, s28, 0x1000
s_waitcnt lgkmcnt(5)
v_mfma_f32_32x32x16_bf16 v[96:111], v[180:183], v[144:147], v[208:223]
ds_read_b128 v[204:207], v3 offset:11264
v_exp_f32 v114, v114
v_exp_f32 v115, v115
buffer_load_dwordx4 v1, s[12:15], s28 offen offset:0 lds
s_waitcnt lgkmcnt(5)
v_mfma_f32_32x32x16_bf16 v[80:95], v[184:187], v[148:151], v[80:95]
ds_read_b128 v[176:179], v3 offset:4096
v_exp_f32 v116, v116
v_exp_f32 v117, v117
buffer_load_dwordx4 v1, s[12:15], s28 offen offset:1024 lds
s_waitcnt lgkmcnt(5)
v_mfma_f32_32x32x16_bf16 v[96:111], v[188:191], v[148:151], v[96:111]
ds_read_b128 v[180:183], v3 offset:12288
v_exp_f32 v118, v118
v_exp_f32 v119, v119
buffer_load_dwordx4 v1, s[12:15], s28 offen offset:2048 lds
s_waitcnt lgkmcnt(5)
v_mfma_f32_32x32x16_bf16 v[80:95], v[192:195], v[152:155], v[80:95]
ds_read_b128 v[184:187], v3 offset:5120
v_exp_f32 v120, v120
v_exp_f32 v121, v121
buffer_load_dwordx4 v1, s[12:15], s28 offen offset:3072 lds
s_waitcnt lgkmcnt(5)
v_mfma_f32_32x32x16_bf16 v[96:111], v[196:199], v[152:155], v[96:111]
ds_read_b128 v[188:191], v3 offset:13312
v_exp_f32 v122, v122
s_add_u32 m0, s30, 0x1000
s_add_u32 s30, s30, 0x8000
v_cvt_pk_bf16_f32 v224, v112, v113
v_cvt_pk_bf16_f32 v225, v114, v115
s_waitcnt lgkmcnt(5)
v_mfma_f32_32x32x16_bf16 v[80:95], v[200:203], v[156:159], v[80:95]
ds_read_b128 v[192:195], v3 offset:6144
v_exp_f32 v123, v123
buffer_load_dwordx4 v1, s[12:15], s29 offen offset:0 lds
v_cvt_pk_bf16_f32 v226, v116, v117
v_cvt_pk_bf16_f32 v227, v118, v119
s_waitcnt lgkmcnt(5)
v_mfma_f32_32x32x16_bf16 v[96:111], v[204:207], v[156:159], v[96:111]
ds_read_b128 v[196:199], v3 offset:14336
v_exp_f32 v124, v124
buffer_load_dwordx4 v1, s[12:15], s29 offen offset:1024 lds
v_cvt_pk_bf16_f32 v228, v120, v121
v_cvt_pk_bf16_f32 v229, v122, v123
s_setprio 2
s_waitcnt lgkmcnt(5)
v_mfma_f32_32x32x16_bf16 v[80:95], v[176:179], v[160:163], v[80:95]
ds_read_b128 v[200:203], v3 offset:7168
v_exp_f32 v125, v125
buffer_load_dwordx4 v1, s[12:15], s29 offen offset:2048 lds
v_add_f32 v6, v6, v112
v_add_f32 v7, v7, v113
s_waitcnt lgkmcnt(5)
v_mfma_f32_32x32x16_bf16 v[96:111], v[180:183], v[160:163], v[96:111]
ds_read_b128 v[204:207], v3 offset:15360
v_exp_f32 v126, v126
buffer_load_dwordx4 v1, s[12:15], s29 offen offset:3072 lds
v_cvt_pk_bf16_f32 v230, v124, v125
v_add_f32 v6, v6, v114
s_waitcnt lgkmcnt(5)
v_mfma_f32_32x32x16_bf16 v[80:95], v[184:187], v[164:167], v[80:95]
ds_read_b128 v[176:179], v3 offset:16384
v_exp_f32 v127, v127
s_add_u32 s28, s28, 0x4000
s_cmp_ge_u32 s30, 163840
s_cselect_b32 s30, s49, s30
v_add_f32 v7, v7, v115
v_add_f32 v6, v6, v116
s_waitcnt lgkmcnt(5)
v_mfma_f32_32x32x16_bf16 v[96:111], v[188:191], v[164:167], v[96:111]
ds_read_b128 v[180:183], v3 offset:17408
v_exp_f32 v128, v128
v_cvt_pk_bf16_f32 v231, v126, v127
v_add_f32 v7, v7, v117
s_waitcnt lgkmcnt(5)
v_mfma_f32_32x32x16_bf16 v[80:95], v[192:195], v[168:171], v[80:95]
ds_read_b128 v[184:187], v3 offset:18432
v_add_u32 v2, s31, v1
s_add_u32 s31, s31, 0x8000
s_cmp_ge_u32 s31, 163840
s_cselect_b32 s31, 0, s31
v_exp_f32 v129, v129
v_add_f32 v6, v6, v118
v_add_f32 v7, v7, v119
s_waitcnt lgkmcnt(5)
v_mfma_f32_32x32x16_bf16 v[96:111], v[196:199], v[168:171], v[96:111]
ds_read_b128 v[188:191], v3 offset:19456
v_exp_f32 v130, v130
v_cvt_pk_bf16_f32 v232, v128, v129
v_add_f32 v6, v6, v120
s_waitcnt lgkmcnt(5)
v_mfma_f32_32x32x16_bf16 v[80:95], v[200:203], v[172:175], v[80:95]
ds_read_b128 v[192:195], v3 offset:20480
v_exp_f32 v131, v131
v_add_f32 v7, v7, v121
v_add_f32 v6, v6, v122
s_waitcnt lgkmcnt(5)
v_mfma_f32_32x32x16_bf16 v[96:111], v[204:207], v[172:175], v[96:111]
ds_read_b128 v[196:199], v3 offset:21504
v_exp_f32 v132, v132
v_cvt_pk_bf16_f32 v233, v130, v131
v_add_f32 v7, v7, v123
s_setprio 1
s_waitcnt lgkmcnt(5)
v_mfma_f32_32x32x16_bf16 v[16:31], v[176:179], v[224:227], v[16:31]
ds_read_b128 v[200:203], v3 offset:22528
v_exp_f32 v133, v133
v_add_f32 v6, v6, v124
v_add_f32 v7, v7, v125
s_waitcnt lgkmcnt(5)
v_mfma_f32_32x32x16_bf16 v[32:47], v[180:183], v[224:227], v[32:47]
ds_read_b128 v[204:207], v3 offset:23552
s_cmp_eq_u32 s25, 1
s_cbranch_scc1 .mask_1075
.maskr_1076:
v_exp_f32 v134, v134
v_cvt_pk_bf16_f32 v234, v132, v133
v_add_f32 v6, v6, v126
s_waitcnt lgkmcnt(5)
v_mfma_f32_32x32x16_bf16 v[48:63], v[184:187], v[224:227], v[48:63]
ds_read_b128 v[176:179], v3 offset:24576
v_exp_f32 v135, v135
v_max3_f32 v5, v80, v81, v82
v_max3_f32 v5, v5, v83, v84
s_waitcnt lgkmcnt(5)
v_mfma_f32_32x32x16_bf16 v[64:79], v[188:191], v[224:227], v[64:79]
ds_read_b128 v[180:183], v3 offset:25600
v_exp_f32 v136, v136
v_cvt_pk_bf16_f32 v235, v134, v135
v_max3_f32 v5, v5, v85, v86
s_waitcnt lgkmcnt(5)
v_mfma_f32_32x32x16_bf16 v[16:31], v[192:195], v[228:231], v[16:31]
ds_read_b128 v[184:187], v3 offset:26624
v_exp_f32 v137, v137
v_max3_f32 v5, v5, v87, v88
v_max3_f32 v5, v5, v89, v90
s_waitcnt lgkmcnt(5)
v_mfma_f32_32x32x16_bf16 v[32:47], v[196:199], v[228:231], v[32:47]
ds_read_b128 v[188:191], v3 offset:27648
v_exp_f32 v138, v138
v_cvt_pk_bf16_f32 v236, v136, v137
v_max3_f32 v5, v5, v91, v92
s_waitcnt lgkmcnt(5)
v_mfma_f32_32x32x16_bf16 v[48:63], v[200:203], v[228:231], v[48:63]
ds_read_b128 v[192:195], v3 offset:28672
v_exp_f32 v139, v139
v_max3_f32 v5, v5, v93, v94
v_max3_f32 v5, v5, v95, v96
s_waitcnt lgkmcnt(5)
v_mfma_f32_32x32x16_bf16 v[64:79], v[204:207], v[228:231], v[64:79]
ds_read_b128 v[196:199], v3 offset:29696
v_exp_f32 v140, v140
v_cvt_pk_bf16_f32 v237, v138, v139
v_max3_f32 v5, v5, v97, v98
s_setprio 0
s_waitcnt lgkmcnt(5)
v_mfma_f32_32x32x16_bf16 v[16:31], v[176:179], v[232:235], v[16:31]
ds_read_b128 v[200:203], v3 offset:30720
v_exp_f32 v141, v141
v_max3_f32 v5, v5, v99, v100
v_max3_f32 v5, v5, v101, v102
s_waitcnt lgkmcnt(5)
v_mfma_f32_32x32x16_bf16 v[32:47], v[180:183], v[232:235], v[32:47]
ds_read_b128 v[204:207], v3 offset:31744
v_exp_f32 v142, v142
v_cvt_pk_bf16_f32 v238, v140, v141
v_max3_f32 v5, v5, v103, v104
s_waitcnt lgkmcnt(5)
v_mfma_f32_32x32x16_bf16 v[48:63], v[184:187], v[232:235], v[48:63]
ds_read_b128 v[176:179], v2 offset:0
v_exp_f32 v143, v143
v_max3_f32 v5, v5, v105, v106
v_max3_f32 v5, v5, v107, v108
s_waitcnt lgkmcnt(5)
v_mfma_f32_32x32x16_bf16 v[64:79], v[188:191], v[232:235], v[64:79]
ds_read_b128 v[180:183], v2 offset:8192
v_cvt_pk_bf16_f32 v239, v142, v143
v_max3_f32 v5, v5, v109, v110
v_max_f32 v5, v5, v111
v_cmp_lt_f32 vcc, 0x41000000, v5
s_waitcnt lgkmcnt(5)
v_mfma_f32_32x32x16_bf16 v[16:31], v[192:195], v[236:239], v[16:31]
ds_read_b128 v[184:187], v2 offset:1024
v_add_f32 v7, v7, v127
v_add_f32 v6, v6, v128
v_add_f32 v7, v7, v129
v_add_f32 v6, v6, v130
s_waitcnt lgkmcnt(5)
v_mfma_f32_32x32x16_bf16 v[32:47], v[196:199], v[236:239], v[32:47]
ds_read_b128 v[188:191], v2 offset:9216
v_add_f32 v7, v7, v131
v_add_f32 v6, v6, v132
v_add_f32 v7, v7, v133
v_add_f32 v6, v6, v134
s_waitcnt lgkmcnt(5)
v_mfma_f32_32x32x16_bf16 v[48:63], v[200:203], v[236:239], v[48:63]
ds_read_b128 v[192:195], v2 offset:2048
v_add_f32 v7, v7, v135
v_add_f32 v6, v6, v136
v_add_f32 v7, v7, v137
v_add_f32 v6, v6, v138
s_waitcnt lgkmcnt(5)
v_mfma_f32_32x32x16_bf16 v[64:79], v[204:207], v[236:239], v[64:79]
ds_read_b128 v[196:199], v2 offset:10240
v_add_f32 v7, v7, v139
v_add_f32 v6, v6, v140
v_add_f32 v7, v7, v141
v_add_f32 v6, v6, v142
v_add_f32 v7, v7, v143
s_sub_u32 s25, s25, 1
s_cbranch_vccnz .resc_1077
.rescr_1078:
s_branch .loop_1066
.mask_1071:
v_cmp_gt_i32_e64 s[40:41], 0, v4
v_cmp_gt_i32_e64 s[42:43], 1, v4
v_cmp_gt_i32_e64 s[44:45], 2, v4
v_cmp_gt_i32_e64 s[46:47], 3, v4
v_cndmask_b32_e64 v112, v112, v8, s[40:41]
v_cndmask_b32_e64 v113, v113, v8, s[42:43]
v_cndmask_b32_e64 v114, v114, v8, s[44:45]
v_cndmask_b32_e64 v115, v115, v8, s[46:47]
v_cmp_gt_i32_e64 s[40:41], 8, v4
v_cmp_gt_i32_e64 s[42:43], 9, v4
v_cmp_gt_i32_e64 s[44:45], 10, v4
v_cmp_gt_i32_e64 s[46:47], 11, v4
v_cndmask_b32_e64 v116, v116, v8, s[40:41]
v_cndmask_b32_e64 v117, v117, v8, s[42:43]
v_cndmask_b32_e64 v118, v118, v8, s[44:45]
v_cndmask_b32_e64 v119, v119, v8, s[46:47]
v_cmp_gt_i32_e64 s[40:41], 16, v4
v_cmp_gt_i32_e64 s[42:43], 17, v4
v_cmp_gt_i32_e64 s[44:45], 18, v4
v_cmp_gt_i32_e64 s[46:47], 19, v4
v_cndmask_b32_e64 v120, v120, v8, s[40:41]
v_cndmask_b32_e64 v121, v121, v8, s[42:43]
v_cndmask_b32_e64 v122, v122, v8, s[44:45]
v_cndmask_b32_e64 v123, v123, v8, s[46:47]
v_cmp_gt_i32_e64 s[40:41], 24, v4
v_cmp_gt_i32_e64 s[42:43], 25, v4
v_cmp_gt_i32_e64 s[44:45], 26, v4
v_cmp_gt_i32_e64 s[46:47], 27, v4
v_cndmask_b32_e64 v124, v124, v8, s[40:41]
v_cndmask_b32_e64 v125, v125, v8, s[42:43]
v_cndmask_b32_e64 v126, v126, v8, s[44:45]
v_cndmask_b32_e64 v127, v127, v8, s[46:47]
v_cmp_gt_i32_e64 s[40:41], 32, v4
v_cmp_gt_i32_e64 s[42:43], 33, v4
v_cmp_gt_i32_e64 s[44:45], 34, v4
v_cmp_gt_i32_e64 s[46:47], 35, v4
v_cndmask_b32_e64 v128, v128, v8, s[40:41]
v_cndmask_b32_e64 v129, v129, v8, s[42:43]
v_cndmask_b32_e64 v130, v130, v8, s[44:45]
v_cndmask_b32_e64 v131, v131, v8, s[46:47]
v_cmp_gt_i32_e64 s[40:41], 40, v4
v_cmp_gt_i32_e64 s[42:43], 41, v4
v_cmp_gt_i32_e64 s[44:45], 42, v4
v_cmp_gt_i32_e64 s[46:47], 43, v4
v_cndmask_b32_e64 v132, v132, v8, s[40:41]
v_cndmask_b32_e64 v133, v133, v8, s[42:43]
v_cndmask_b32_e64 v134, v134, v8, s[44:45]
v_cndmask_b32_e64 v135, v135, v8, s[46:47]
v_cmp_gt_i32_e64 s[40:41], 48, v4
v_cmp_gt_i32_e64 s[42:43], 49, v4
v_cmp_gt_i32_e64 s[44:45], 50, v4
v_cmp_gt_i32_e64 s[46:47], 51, v4
v_cndmask_b32_e64 v136, v136, v8, s[40:41]
v_cndmask_b32_e64 v137, v137, v8, s[42:43]
v_cndmask_b32_e64 v138, v138, v8, s[44:45]
v_cndmask_b32_e64 v139, v139, v8, s[46:47]
v_cmp_gt_i32_e64 s[40:41], 56, v4
v_cmp_gt_i32_e64 s[42:43], 57, v4
v_cmp_gt_i32_e64 s[44:45], 58, v4
v_cmp_gt_i32_e64 s[46:47], 59, v4
v_cndmask_b32_e64 v140, v140, v8, s[40:41]
v_cndmask_b32_e64 v141, v141, v8, s[42:43]
v_cndmask_b32_e64 v142, v142, v8, s[44:45]
v_cndmask_b32_e64 v143, v143, v8, s[46:47]
s_branch .maskr_1072
.resc_1073:
v_mov_b32 v10, v5
s_nop 1
v_permlane32_swap_b32 v10, v5
v_max3_f32 v10, v10, v5, 0
v_exp_f32_e64 v11, -v10
v_sub_f32 v112, v112, v10
v_sub_f32 v113, v113, v10
v_sub_f32 v114, v114, v10
v_sub_f32 v115, v115, v10
v_sub_f32 v116, v116, v10
v_sub_f32 v117, v117, v10
v_sub_f32 v118, v118, v10
v_sub_f32 v119, v119, v10
v_sub_f32 v120, v120, v10
v_sub_f32 v121, v121, v10
v_sub_f32 v122, v122, v10
v_sub_f32 v123, v123, v10
v_sub_f32 v124, v124, v10
v_sub_f32 v125, v125, v10
v_sub_f32 v126, v126, v10
v_sub_f32 v127, v127, v10
v_sub_f32 v128, v128, v10
v_sub_f32 v129, v129, v10
v_sub_f32 v130, v130, v10
v_sub_f32 v131, v131, v10
v_sub_f32 v132, v132, v10
v_sub_f32 v133, v133, v10
v_sub_f32 v134, v134, v10
v_sub_f32 v135, v135, v10
v_sub_f32 v136, v136, v10
v_sub_f32 v137, v137, v10
v_sub_f32 v138, v138, v10
v_sub_f32 v139, v139, v10
v_sub_f32 v140, v140, v10
v_sub_f32 v141, v141, v10
v_sub_f32 v142, v142, v10
v_sub_f32 v143, v143, v10
v_sub_f32 v208, v208, v10
v_sub_f32 v209, v209, v10
v_sub_f32 v210, v210, v10
v_sub_f32 v211, v211, v10
v_sub_f32 v212, v212, v10
v_sub_f32 v213, v213, v10
v_sub_f32 v214, v214, v10
v_sub_f32 v215, v215, v10
v_sub_f32 v216, v216, v10
v_sub_f32 v217, v217, v10
v_sub_f32 v218, v218, v10
v_sub_f32 v219, v219, v10
v_sub_f32 v220, v220, v10
v_sub_f32 v221, v221, v10
v_sub_f32 v222, v222, v10
v_sub_f32 v223, v223, v10
v_mul_f32 v6, v6, v11
v_mul_f32 v7, v7, v11
v_mul_f32 v16, v16, v11
v_mul_f32 v17, v17, v11
v_mul_f32 v18, v18, v11
v_mul_f32 v19, v19, v11
v_mul_f32 v20, v20, v11
v_mul_f32 v21, v21, v11
v_mul_f32 v22, v22, v11
v_mul_f32 v23, v23, v11
v_mul_f32 v24, v24, v11
v_mul_f32 v25, v25, v11
v_mul_f32 v26, v26, v11
v_mul_f32 v27, v27, v11
v_mul_f32 v28, v28, v11
v_mul_f32 v29, v29, v11
v_mul_f32 v30, v30, v11
v_mul_f32 v31, v31, v11
v_mul_f32 v32, v32, v11
v_mul_f32 v33, v33, v11
v_mul_f32 v34, v34, v11
v_mul_f32 v35, v35, v11
v_mul_f32 v36, v36, v11
v_mul_f32 v37, v37, v11
v_mul_f32 v38, v38, v11
v_mul_f32 v39, v39, v11
v_mul_f32 v40, v40, v11
v_mul_f32 v41, v41, v11
v_mul_f32 v42, v42, v11
v_mul_f32 v43, v43, v11
v_mul_f32 v44, v44, v11
v_mul_f32 v45, v45, v11
v_mul_f32 v46, v46, v11
v_mul_f32 v47, v47, v11
v_mul_f32 v48, v48, v11
v_mul_f32 v49, v49, v11
v_mul_f32 v50, v50, v11
v_mul_f32 v51, v51, v11
v_mul_f32 v52, v52, v11
v_mul_f32 v53, v53, v11
v_mul_f32 v54, v54, v11
v_mul_f32 v55, v55, v11
v_mul_f32 v56, v56, v11
v_mul_f32 v57, v57, v11
v_mul_f32 v58, v58, v11
v_mul_f32 v59, v59, v11
v_mul_f32 v60, v60, v11
v_mul_f32 v61, v61, v11
v_mul_f32 v62, v62, v11
v_mul_f32 v63, v63, v11
v_mul_f32 v64, v64, v11
v_mul_f32 v65, v65, v11
v_mul_f32 v66, v66, v11
v_mul_f32 v67, v67, v11
v_mul_f32 v68, v68, v11
v_mul_f32 v69, v69, v11
v_mul_f32 v70, v70, v11
v_mul_f32 v71, v71, v11
v_mul_f32 v72, v72, v11
v_mul_f32 v73, v73, v11
v_mul_f32 v74, v74, v11
v_mul_f32 v75, v75, v11
v_mul_f32 v76, v76, v11
v_mul_f32 v77, v77, v11
v_mul_f32 v78, v78, v11
v_mul_f32 v79, v79, v11
s_branch .rescr_1074
.mask_1075:
v_cmp_gt_i32_e64 s[40:41], 0, v4
v_cmp_gt_i32_e64 s[42:43], 1, v4
v_cmp_gt_i32_e64 s[44:45], 2, v4
v_cmp_gt_i32_e64 s[46:47], 3, v4
v_cndmask_b32_e64 v80, v80, v8, s[40:41]
v_cndmask_b32_e64 v81, v81, v8, s[42:43]
v_cndmask_b32_e64 v82, v82, v8, s[44:45]
v_cndmask_b32_e64 v83, v83, v8, s[46:47]
v_cmp_gt_i32_e64 s[40:41], 8, v4
v_cmp_gt_i32_e64 s[42:43], 9, v4
v_cmp_gt_i32_e64 s[44:45], 10, v4
v_cmp_gt_i32_e64 s[46:47], 11, v4
v_cndmask_b32_e64 v84, v84, v8, s[40:41]
v_cndmask_b32_e64 v85, v85, v8, s[42:43]
v_cndmask_b32_e64 v86, v86, v8, s[44:45]
v_cndmask_b32_e64 v87, v87, v8, s[46:47]
v_cmp_gt_i32_e64 s[40:41], 16, v4
v_cmp_gt_i32_e64 s[42:43], 17, v4
v_cmp_gt_i32_e64 s[44:45], 18, v4
v_cmp_gt_i32_e64 s[46:47], 19, v4
v_cndmask_b32_e64 v88, v88, v8, s[40:41]
v_cndmask_b32_e64 v89, v89, v8, s[42:43]
v_cndmask_b32_e64 v90, v90, v8, s[44:45]
v_cndmask_b32_e64 v91, v91, v8, s[46:47]
v_cmp_gt_i32_e64 s[40:41], 24, v4
v_cmp_gt_i32_e64 s[42:43], 25, v4
v_cmp_gt_i32_e64 s[44:45], 26, v4
v_cmp_gt_i32_e64 s[46:47], 27, v4
v_cndmask_b32_e64 v92, v92, v8, s[40:41]
v_cndmask_b32_e64 v93, v93, v8, s[42:43]
v_cndmask_b32_e64 v94, v94, v8, s[44:45]
v_cndmask_b32_e64 v95, v95, v8, s[46:47]
v_cmp_gt_i32_e64 s[40:41], 32, v4
v_cmp_gt_i32_e64 s[42:43], 33, v4
v_cmp_gt_i32_e64 s[44:45], 34, v4
v_cmp_gt_i32_e64 s[46:47], 35, v4
v_cndmask_b32_e64 v96, v96, v8, s[40:41]
v_cndmask_b32_e64 v97, v97, v8, s[42:43]
v_cndmask_b32_e64 v98, v98, v8, s[44:45]
v_cndmask_b32_e64 v99, v99, v8, s[46:47]
v_cmp_gt_i32_e64 s[40:41], 40, v4
v_cmp_gt_i32_e64 s[42:43], 41, v4
v_cmp_gt_i32_e64 s[44:45], 42, v4
v_cmp_gt_i32_e64 s[46:47], 43, v4
v_cndmask_b32_e64 v100, v100, v8, s[40:41]
v_cndmask_b32_e64 v101, v101, v8, s[42:43]
v_cndmask_b32_e64 v102, v102, v8, s[44:45]
v_cndmask_b32_e64 v103, v103, v8, s[46:47]
v_cmp_gt_i32_e64 s[40:41], 48, v4
v_cmp_gt_i32_e64 s[42:43], 49, v4
v_cmp_gt_i32_e64 s[44:45], 50, v4
v_cmp_gt_i32_e64 s[46:47], 51, v4
v_cndmask_b32_e64 v104, v104, v8, s[40:41]
v_cndmask_b32_e64 v105, v105, v8, s[42:43]
v_cndmask_b32_e64 v106, v106, v8, s[44:45]
v_cndmask_b32_e64 v107, v107, v8, s[46:47]
v_cmp_gt_i32_e64 s[40:41], 56, v4
v_cmp_gt_i32_e64 s[42:43], 57, v4
v_cmp_gt_i32_e64 s[44:45], 58, v4
v_cmp_gt_i32_e64 s[46:47], 59, v4
v_cndmask_b32_e64 v108, v108, v8, s[40:41]
v_cndmask_b32_e64 v109, v109, v8, s[42:43]
v_cndmask_b32_e64 v110, v110, v8, s[44:45]
v_cndmask_b32_e64 v111, v111, v8, s[46:47]
s_branch .maskr_1076
.resc_1077:
v_mov_b32 v10, v5
s_nop 1
v_permlane32_swap_b32 v10, v5
v_max3_f32 v10, v10, v5, 0
v_exp_f32_e64 v11, -v10
v_sub_f32 v80, v80, v10
v_sub_f32 v81, v81, v10
v_sub_f32 v82, v82, v10
v_sub_f32 v83, v83, v10
v_sub_f32 v84, v84, v10
v_sub_f32 v85, v85, v10
v_sub_f32 v86, v86, v10
v_sub_f32 v87, v87, v10
v_sub_f32 v88, v88, v10
v_sub_f32 v89, v89, v10
v_sub_f32 v90, v90, v10
v_sub_f32 v91, v91, v10
v_sub_f32 v92, v92, v10
v_sub_f32 v93, v93, v10
v_sub_f32 v94, v94, v10
v_sub_f32 v95, v95, v10
v_sub_f32 v96, v96, v10
v_sub_f32 v97, v97, v10
v_sub_f32 v98, v98, v10
v_sub_f32 v99, v99, v10
v_sub_f32 v100, v100, v10
v_sub_f32 v101, v101, v10
v_sub_f32 v102, v102, v10
v_sub_f32 v103, v103, v10
v_sub_f32 v104, v104, v10
v_sub_f32 v105, v105, v10
v_sub_f32 v106, v106, v10
v_sub_f32 v107, v107, v10
v_sub_f32 v108, v108, v10
v_sub_f32 v109, v109, v10
v_sub_f32 v110, v110, v10
v_sub_f32 v111, v111, v10
v_sub_f32 v208, v208, v10
v_sub_f32 v209, v209, v10
v_sub_f32 v210, v210, v10
v_sub_f32 v211, v211, v10
v_sub_f32 v212, v212, v10
v_sub_f32 v213, v213, v10
v_sub_f32 v214, v214, v10
v_sub_f32 v215, v215, v10
v_sub_f32 v216, v216, v10
v_sub_f32 v217, v217, v10
v_sub_f32 v218, v218, v10
v_sub_f32 v219, v219, v10
v_sub_f32 v220, v220, v10
v_sub_f32 v221, v221, v10
v_sub_f32 v222, v222, v10
v_sub_f32 v223, v223, v10
v_mul_f32 v6, v6, v11
v_mul_f32 v7, v7, v11
v_mul_f32 v16, v16, v11
v_mul_f32 v17, v17, v11
v_mul_f32 v18, v18, v11
v_mul_f32 v19, v19, v11
v_mul_f32 v20, v20, v11
v_mul_f32 v21, v21, v11
v_mul_f32 v22, v22, v11
v_mul_f32 v23, v23, v11
v_mul_f32 v24, v24, v11
v_mul_f32 v25, v25, v11
v_mul_f32 v26, v26, v11
v_mul_f32 v27, v27, v11
v_mul_f32 v28, v28, v11
v_mul_f32 v29, v29, v11
v_mul_f32 v30, v30, v11
v_mul_f32 v31, v31, v11
v_mul_f32 v32, v32, v11
v_mul_f32 v33, v33, v11
v_mul_f32 v34, v34, v11
v_mul_f32 v35, v35, v11
v_mul_f32 v36, v36, v11
v_mul_f32 v37, v37, v11
v_mul_f32 v38, v38, v11
v_mul_f32 v39, v39, v11
v_mul_f32 v40, v40, v11
v_mul_f32 v41, v41, v11
v_mul_f32 v42, v42, v11
v_mul_f32 v43, v43, v11
v_mul_f32 v44, v44, v11
v_mul_f32 v45, v45, v11
v_mul_f32 v46, v46, v11
v_mul_f32 v47, v47, v11
v_mul_f32 v48, v48, v11
v_mul_f32 v49, v49, v11
v_mul_f32 v50, v50, v11
v_mul_f32 v51, v51, v11
v_mul_f32 v52, v52, v11
v_mul_f32 v53, v53, v11
v_mul_f32 v54, v54, v11
v_mul_f32 v55, v55, v11
v_mul_f32 v56, v56, v11
v_mul_f32 v57, v57, v11
v_mul_f32 v58, v58, v11
v_mul_f32 v59, v59, v11
v_mul_f32 v60, v60, v11
v_mul_f32 v61, v61, v11
v_mul_f32 v62, v62, v11
v_mul_f32 v63, v63, v11
v_mul_f32 v64, v64, v11
v_mul_f32 v65, v65, v11
v_mul_f32 v66, v66, v11
v_mul_f32 v67, v67, v11
v_mul_f32 v68, v68, v11
v_mul_f32 v69, v69, v11
v_mul_f32 v70, v70, v11
v_mul_f32 v71, v71, v11
v_mul_f32 v72, v72, v11
v_mul_f32 v73, v73, v11
v_mul_f32 v74, v74, v11
v_mul_f32 v75, v75, v11
v_mul_f32 v76, v76, v11
v_mul_f32 v77, v77, v11
v_mul_f32 v78, v78, v11
v_mul_f32 v79, v79, v11
s_branch .rescr_1078
.final_1068:
s_waitcnt vmcnt(16)
s_barrier
.nobar_1079:
s_waitcnt lgkmcnt(0)
ds_read_b128 v[176:179], v2 offset:16384
ds_read_b128 v[180:183], v2 offset:17408
ds_read_b128 v[184:187], v2 offset:18432
ds_read_b128 v[188:191], v2 offset:19456
ds_read_b128 v[192:195], v2 offset:20480
ds_read_b128 v[196:199], v2 offset:21504
v_exp_f32 v80, v80
s_mov_b32 m0, s30
s_add_u32 s29, s28, 0x1000
v_exp_f32 v81, v81
buffer_load_dwordx4 v1, s[12:15], s28 offen offset:0 lds
v_exp_f32 v82, v82
buffer_load_dwordx4 v1, s[12:15], s28 offen offset:1024 lds
v_exp_f32 v83, v83
buffer_load_dwordx4 v1, s[12:15], s28 offen offset:2048 lds
v_exp_f32 v84, v84
buffer_load_dwordx4 v1, s[12:15], s28 offen offset:3072 lds
v_exp_f32 v85, v85
s_add_u32 m0, s30, 0x1000
s_add_u32 s30, s30, 0x8000
v_exp_f32 v86, v86
buffer_load_dwordx4 v1, s[12:15], s29 offen offset:0 lds
v_exp_f32 v87, v87
buffer_load_dwordx4 v1, s[12:15], s29 offen offset:1024 lds
v_exp_f32 v88, v88
buffer_load_dwordx4 v1, s[12:15], s29 offen offset:2048 lds
v_exp_f32 v89, v89
buffer_load_dwordx4 v1, s[12:15], s29 offen offset:3072 lds
v_cvt_pk_bf16_f32 v224, v80, v81
v_cvt_pk_bf16_f32 v225, v82, v83
v_cvt_pk_bf16_f32 v226, v84, v85
v_cvt_pk_bf16_f32 v227, v86, v87
s_add_u32 s28, s28, 0x4000
s_cmp_ge_u32 s30, 163840
s_cselect_b32 s30, s49, s30
s_waitcnt lgkmcnt(5)
v_mfma_f32_32x32x16_bf16 v[16:31], v[176:179], v[224:227], v[16:31]
ds_read_b128 v[200:203], v2 offset:22528
v_exp_f32 v90, v90
v_exp_f32 v91, v91
v_cvt_pk_bf16_f32 v228, v88, v89
v_add_f32 v6, v6, v80
v_add_f32 v7, v7, v81
s_waitcnt lgkmcnt(5)
v_mfma_f32_32x32x16_bf16 v[32:47], v[180:183], v[224:227], v[32:47]
ds_read_b128 v[204:207], v2 offset:23552
v_exp_f32 v92, v92
v_exp_f32 v93, v93
v_cvt_pk_bf16_f32 v229, v90, v91
v_add_f32 v6, v6, v82
v_add_f32 v7, v7, v83
s_waitcnt lgkmcnt(5)
v_mfma_f32_32x32x16_bf16 v[48:63], v[184:187], v[224:227], v[48:63]
ds_read_b128 v[176:179], v2 offset:24576
v_exp_f32 v94, v94
v_exp_f32 v95, v95
v_cvt_pk_bf16_f32 v230, v92, v93
v_add_f32 v6, v6, v84
v_add_f32 v7, v7, v85
s_waitcnt lgkmcnt(5)
v_mfma_f32_32x32x16_bf16 v[64:79], v[188:191], v[224:227], v[64:79]
ds_read_b128 v[180:183], v2 offset:25600
v_exp_f32 v96, v96
v_exp_f32 v97, v97
v_cvt_pk_bf16_f32 v231, v94, v95
v_add_f32 v6, v6, v86
v_add_f32 v7, v7, v87
s_waitcnt lgkmcnt(5)
v_mfma_f32_32x32x16_bf16 v[16:31], v[192:195], v[228:231], v[16:31]
ds_read_b128 v[184:187], v2 offset:26624
v_exp_f32 v98, v98
v_exp_f32 v99, v99
v_cvt_pk_bf16_f32 v232, v96, v97
v_add_f32 v6, v6, v88
v_add_f32 v7, v7, v89
s_waitcnt lgkmcnt(5)
v_mfma_f32_32x32x16_bf16 v[32:47], v[196:199], v[228:231], v[32:47]
ds_read_b128 v[188:191], v2 offset:27648
v_exp_f32 v100, v100
v_exp_f32 v101, v101
v_cvt_pk_bf16_f32 v233, v98, v99
v_add_f32 v6, v6, v90
v_add_f32 v7, v7, v91
s_waitcnt lgkmcnt(5)
v_mfma_f32_32x32x16_bf16 v[48:63], v[200:203], v[228:231], v[48:63]
ds_read_b128 v[192:195], v2 offset:28672
v_exp_f32 v102, v102
v_exp_f32 v103, v103
v_cvt_pk_bf16_f32 v234, v100, v101
v_add_f32 v6, v6, v92
v_add_f32 v7, v7, v93
s_waitcnt lgkmcnt(5)
v_mfma_f32_32x32x16_bf16 v[64:79], v[204:207], v[228:231], v[64:79]
ds_read_b128 v[196:199], v2 offset:29696
v_exp_f32 v104, v104
v_exp_f32 v105, v105
v_cvt_pk_bf16_f32 v235, v102, v103
v_add_f32 v6, v6, v94
v_add_f32 v7, v7, v95
s_waitcnt lgkmcnt(5)
v_mfma_f32_32x32x16_bf16 v[16:31], v[176:179], v[232:235], v[16:31]
ds_read_b128 v[200:203], v2 offset:30720
v_exp_f32 v106, v106
v_exp_f32 v107, v107
v_cvt_pk_bf16_f32 v236, v104, v105
v_add_f32 v6, v6, v96
v_add_f32 v7, v7, v97
s_waitcnt lgkmcnt(5)
v_mfma_f32_32x32x16_bf16 v[32:47], v[180:183], v[232:235], v[32:47]
ds_read_b128 v[204:207], v2 offset:31744
v_exp_f32 v108, v108
v_exp_f32 v109, v109
v_cvt_pk_bf16_f32 v237, v106, v107
v_add_f32 v6, v6, v98
v_add_f32 v7, v7, v99
s_waitcnt lgkmcnt(5)
v_mfma_f32_32x32x16_bf16 v[48:63], v[184:187], v[232:235], v[48:63]
v_exp_f32 v110, v110
v_exp_f32 v111, v111
v_cvt_pk_bf16_f32 v238, v108, v109
v_add_f32 v6, v6, v100
v_add_f32 v7, v7, v101
s_waitcnt lgkmcnt(4)
v_mfma_f32_32x32x16_bf16 v[64:79], v[188:191], v[232:235], v[64:79]
v_cvt_pk_bf16_f32 v239, v110, v111
v_add_f32 v6, v6, v102
v_add_f32 v7, v7, v103
v_add_f32 v6, v6, v104
v_add_f32 v7, v7, v105
s_waitcnt lgkmcnt(3)
v_mfma_f32_32x32x16_bf16 v[16:31], v[192:195], v[236:239], v[16:31]
v_add_f32 v6, v6, v106
v_add_f32 v7, v7, v107
v_add_f32 v6, v6, v108
v_add_f32 v7, v7, v109
s_waitcnt lgkmcnt(2)
v_mfma_f32_32x32x16_bf16 v[32:47], v[196:199], v[236:239], v[32:47]
v_add_f32 v6, v6, v110
v_add_f32 v7, v7, v111
s_waitcnt lgkmcnt(1)
v_mfma_f32_32x32x16_bf16 v[48:63], v[200:203], v[236:239], v[48:63]
s_waitcnt lgkmcnt(0)
v_mfma_f32_32x32x16_bf16 v[64:79], v[204:207], v[236:239], v[64:79]
s_branch .epi_1070
.final_1069:
s_waitcnt vmcnt(16)
s_barrier
.nobar_1080:
s_waitcnt lgkmcnt(0)
ds_read_b128 v[176:179], v3 offset:16384
ds_read_b128 v[180:183], v3 offset:17408
ds_read_b128 v[184:187], v3 offset:18432
ds_read_b128 v[188:191], v3 offset:19456
ds_read_b128 v[192:195], v3 offset:20480
ds_read_b128 v[196:199], v3 offset:21504
v_exp_f32 v112, v112
s_mov_b32 m0, s30
s_add_u32 s29, s28, 0x1000
v_exp_f32 v113, v113
buffer_load_dwordx4 v1, s[12:15], s28 offen offset:0 lds
v_exp_f32 v114, v114
buffer_load_dwordx4 v1, s[12:15], s28 offen offset:1024 lds
v_exp_f32 v115, v115
buffer_load_dwordx4 v1, s[12:15], s28 offen offset:2048 lds
v_exp_f32 v116, v116
buffer_load_dwordx4 v1, s[12:15], s28 offen offset:3072 lds
v_exp_f32 v117, v117
s_add_u32 m0, s30, 0x1000
s_add_u32 s30, s30, 0x8000
v_exp_f32 v118, v118
buffer_load_dwordx4 v1, s[12:15], s29 offen offset:0 lds
v_exp_f32 v119, v119
buffer_load_dwordx4 v1, s[12:15], s29 offen offset:1024 lds
v_exp_f32 v120, v120
buffer_load_dwordx4 v1, s[12:15], s29 offen offset:2048 lds
v_exp_f32 v121, v121
buffer_load_dwordx4 v1, s[12:15], s29 offen offset:3072 lds
v_cvt_pk_bf16_f32 v224, v112, v113
v_cvt_pk_bf16_f32 v225, v114, v115
v_cvt_pk_bf16_f32 v226, v116, v117
v_cvt_pk_bf16_f32 v227, v118, v119
s_add_u32 s28, s28, 0x4000
s_cmp_ge_u32 s30, 163840
s_cselect_b32 s30, s49, s30
s_waitcnt lgkmcnt(5)
v_mfma_f32_32x32x16_bf16 v[16:31], v[176:179], v[224:227], v[16:31]
ds_read_b128 v[200:203], v3 offset:22528
v_exp_f32 v122, v122
v_exp_f32 v123, v123
v_cvt_pk_bf16_f32 v228, v120, v121
v_add_f32 v6, v6, v112
v_add_f32 v7, v7, v113
s_waitcnt lgkmcnt(5)
v_mfma_f32_32x32x16_bf16 v[32:47], v[180:183], v[224:227], v[32:47]
ds_read_b128 v[204:207], v3 offset:23552
v_exp_f32 v124, v124
v_exp_f32 v125, v125
v_cvt_pk_bf16_f32 v229, v122, v123
v_add_f32 v6, v6, v114
v_add_f32 v7, v7, v115
s_waitcnt lgkmcnt(5)
v_mfma_f32_32x32x16_bf16 v[48:63], v[184:187], v[224:227], v[48:63]
ds_read_b128 v[176:179], v3 offset:24576
v_exp_f32 v126, v126
v_exp_f32 v127, v127
v_cvt_pk_bf16_f32 v230, v124, v125
v_add_f32 v6, v6, v116
v_add_f32 v7, v7, v117
s_waitcnt lgkmcnt(5)
v_mfma_f32_32x32x16_bf16 v[64:79], v[188:191], v[224:227], v[64:79]
ds_read_b128 v[180:183], v3 offset:25600
v_exp_f32 v128, v128
v_exp_f32 v129, v129
v_cvt_pk_bf16_f32 v231, v126, v127
v_add_f32 v6, v6, v118
v_add_f32 v7, v7, v119
s_waitcnt lgkmcnt(5)
v_mfma_f32_32x32x16_bf16 v[16:31], v[192:195], v[228:231], v[16:31]
ds_read_b128 v[184:187], v3 offset:26624
v_exp_f32 v130, v130
v_exp_f32 v131, v131
v_cvt_pk_bf16_f32 v232, v128, v129
v_add_f32 v6, v6, v120
v_add_f32 v7, v7, v121
s_waitcnt lgkmcnt(5)
v_mfma_f32_32x32x16_bf16 v[32:47], v[196:199], v[228:231], v[32:47]
ds_read_b128 v[188:191], v3 offset:27648
v_exp_f32 v132, v132
v_exp_f32 v133, v133
v_cvt_pk_bf16_f32 v233, v130, v131
v_add_f32 v6, v6, v122
v_add_f32 v7, v7, v123
s_waitcnt lgkmcnt(5)
v_mfma_f32_32x32x16_bf16 v[48:63], v[200:203], v[228:231], v[48:63]
ds_read_b128 v[192:195], v3 offset:28672
v_exp_f32 v134, v134
v_exp_f32 v135, v135
v_cvt_pk_bf16_f32 v234, v132, v133
v_add_f32 v6, v6, v124
v_add_f32 v7, v7, v125
s_waitcnt lgkmcnt(5)
v_mfma_f32_32x32x16_bf16 v[64:79], v[204:207], v[228:231], v[64:79]
ds_read_b128 v[196:199], v3 offset:29696
v_exp_f32 v136, v136
v_exp_f32 v137, v137
v_cvt_pk_bf16_f32 v235, v134, v135
v_add_f32 v6, v6, v126
v_add_f32 v7, v7, v127
s_waitcnt lgkmcnt(5)
v_mfma_f32_32x32x16_bf16 v[16:31], v[176:179], v[232:235], v[16:31]
ds_read_b128 v[200:203], v3 offset:30720
v_exp_f32 v138, v138
v_exp_f32 v139, v139
v_cvt_pk_bf16_f32 v236, v136, v137
v_add_f32 v6, v6, v128
v_add_f32 v7, v7, v129
s_waitcnt lgkmcnt(5)
v_mfma_f32_32x32x16_bf16 v[32:47], v[180:183], v[232:235], v[32:47]
ds_read_b128 v[204:207], v3 offset:31744
v_exp_f32 v140, v140
v_exp_f32 v141, v141
v_cvt_pk_bf16_f32 v237, v138, v139
v_add_f32 v6, v6, v130
v_add_f32 v7, v7, v131
s_waitcnt lgkmcnt(5)
v_mfma_f32_32x32x16_bf16 v[48:63], v[184:187], v[232:235], v[48:63]
v_exp_f32 v142, v142
v_exp_f32 v143, v143
v_cvt_pk_bf16_f32 v238, v140, v141
v_add_f32 v6, v6, v132
v_add_f32 v7, v7, v133
s_waitcnt lgkmcnt(4)
v_mfma_f32_32x32x16_bf16 v[64:79], v[188:191], v[232:235], v[64:79]
v_cvt_pk_bf16_f32 v239, v142, v143
v_add_f32 v6, v6, v134
v_add_f32 v7, v7, v135
v_add_f32 v6, v6, v136
v_add_f32 v7, v7, v137
s_waitcnt lgkmcnt(3)
v_mfma_f32_32x32x16_bf16 v[16:31], v[192:195], v[236:239], v[16:31]
v_add_f32 v6, v6, v138
v_add_f32 v7, v7, v139
v_add_f32 v6, v6, v140
v_add_f32 v7, v7, v141
s_waitcnt lgkmcnt(2)
v_mfma_f32_32x32x16_bf16 v[32:47], v[196:199], v[236:239], v[32:47]
v_add_f32 v6, v6, v142
v_add_f32 v7, v7, v143
s_waitcnt lgkmcnt(1)
v_mfma_f32_32x32x16_bf16 v[48:63], v[200:203], v[236:239], v[48:63]
s_waitcnt lgkmcnt(0)
v_mfma_f32_32x32x16_bf16 v[64:79], v[204:207], v[236:239], v[64:79]
.epi_1070:
v_add_f32 v6, v6, v7
v_mov_b32 v10, v6
s_nop 1
v_permlane32_swap_b32 v10, v6
v_add_f32 v10, v10, v6
v_rcp_f32 v10, v10
s_lshl_b32 s23, s24, 18
s_lshl_b32 s26, s21, 13
s_add_u32 s23, s23, s26
s_add_u32 s26, s23, 0x1000
v_mul_f32 v16, v16, v10
v_mul_f32 v17, v17, v10
v_cvt_pk_bf16_f32 v80, v16, v17
v_mul_f32 v18, v18, v10
v_mul_f32 v19, v19, v10
v_cvt_pk_bf16_f32 v81, v18, v19
v_mul_f32 v20, v20, v10
v_mul_f32 v21, v21, v10
v_cvt_pk_bf16_f32 v82, v20, v21
v_mul_f32 v22, v22, v10
v_mul_f32 v23, v23, v10
v_cvt_pk_bf16_f32 v83, v22, v23
buffer_store_dwordx4 v[80:83], v1, s[16:19], s23 offen offset:0 sc1
v_mul_f32 v24, v24, v10
v_mul_f32 v25, v25, v10
v_cvt_pk_bf16_f32 v84, v24, v25
v_mul_f32 v26, v26, v10
v_mul_f32 v27, v27, v10
v_cvt_pk_bf16_f32 v85, v26, v27
v_mul_f32 v28, v28, v10
v_mul_f32 v29, v29, v10
v_cvt_pk_bf16_f32 v86, v28, v29
v_mul_f32 v30, v30, v10
v_mul_f32 v31, v31, v10
v_cvt_pk_bf16_f32 v87, v30, v31
buffer_store_dwordx4 v[84:87], v1, s[16:19], s23 offen offset:1024 sc1
v_mul_f32 v32, v32, v10
v_mul_f32 v33, v33, v10
v_cvt_pk_bf16_f32 v88, v32, v33
v_mul_f32 v34, v34, v10
v_mul_f32 v35, v35, v10
v_cvt_pk_bf16_f32 v89, v34, v35
v_mul_f32 v36, v36, v10
v_mul_f32 v37, v37, v10
v_cvt_pk_bf16_f32 v90, v36, v37
v_mul_f32 v38, v38, v10
v_mul_f32 v39, v39, v10
v_cvt_pk_bf16_f32 v91, v38, v39
buffer_store_dwordx4 v[88:91], v1, s[16:19], s23 offen offset:2048 sc1
v_mul_f32 v40, v40, v10
v_mul_f32 v41, v41, v10
v_cvt_pk_bf16_f32 v92, v40, v41
v_mul_f32 v42, v42, v10
v_mul_f32 v43, v43, v10
v_cvt_pk_bf16_f32 v93, v42, v43
v_mul_f32 v44, v44, v10
v_mul_f32 v45, v45, v10
v_cvt_pk_bf16_f32 v94, v44, v45
v_mul_f32 v46, v46, v10
v_mul_f32 v47, v47, v10
v_cvt_pk_bf16_f32 v95, v46, v47
buffer_store_dwordx4 v[92:95], v1, s[16:19], s23 offen offset:3072 sc1
v_mul_f32 v48, v48, v10
v_mul_f32 v49, v49, v10
v_cvt_pk_bf16_f32 v96, v48, v49
v_mul_f32 v50, v50, v10
v_mul_f32 v51, v51, v10
v_cvt_pk_bf16_f32 v97, v50, v51
v_mul_f32 v52, v52, v10
v_mul_f32 v53, v53, v10
v_cvt_pk_bf16_f32 v98, v52, v53
v_mul_f32 v54, v54, v10
v_mul_f32 v55, v55, v10
v_cvt_pk_bf16_f32 v99, v54, v55
buffer_store_dwordx4 v[96:99], v1, s[16:19], s26 offen offset:0 sc1
v_mul_f32 v56, v56, v10
v_mul_f32 v57, v57, v10
v_cvt_pk_bf16_f32 v100, v56, v57
v_mul_f32 v58, v58, v10
v_mul_f32 v59, v59, v10
v_cvt_pk_bf16_f32 v101, v58, v59
v_mul_f32 v60, v60, v10
v_mul_f32 v61, v61, v10
v_cvt_pk_bf16_f32 v102, v60, v61
v_mul_f32 v62, v62, v10
v_mul_f32 v63, v63, v10
v_cvt_pk_bf16_f32 v103, v62, v63
buffer_store_dwordx4 v[100:103], v1, s[16:19], s26 offen offset:1024 sc1
v_mul_f32 v64, v64, v10
v_mul_f32 v65, v65, v10
v_cvt_pk_bf16_f32 v104, v64, v65
v_mul_f32 v66, v66, v10
v_mul_f32 v67, v67, v10
v_cvt_pk_bf16_f32 v105, v66, v67
v_mul_f32 v68, v68, v10
v_mul_f32 v69, v69, v10
v_cvt_pk_bf16_f32 v106, v68, v69
v_mul_f32 v70, v70, v10
v_mul_f32 v71, v71, v10
v_cvt_pk_bf16_f32 v107, v70, v71
buffer_store_dwordx4 v[104:107], v1, s[16:19], s26 offen offset:2048 sc1
v_mul_f32 v72, v72, v10
v_mul_f32 v73, v73, v10
v_cvt_pk_bf16_f32 v108, v72, v73
v_mul_f32 v74, v74, v10
v_mul_f32 v75, v75, v10
v_cvt_pk_bf16_f32 v109, v74, v75
v_mul_f32 v76, v76, v10
v_mul_f32 v77, v77, v10
v_cvt_pk_bf16_f32 v110, v76, v77
v_mul_f32 v78, v78, v10
v_mul_f32 v79, v79, v10
v_cvt_pk_bf16_f32 v111, v78, v79
buffer_store_dwordx4 v[108:111], v1, s[16:19], s26 offen offset:3072 sc1
.idle_1081:
s_sub_u32 s37, s37, 1
s_cmp_eq_u32 s37, 0
s_cbranch_scc1 .idle_end_1082
s_waitcnt vmcnt(16)
s_barrier
s_mov_b32 m0, s30
s_add_u32 s29, s28, 0x1000
buffer_load_dwordx4 v1, s[12:15], s28 offen offset:0 lds
buffer_load_dwordx4 v1, s[12:15], s28 offen offset:1024 lds
buffer_load_dwordx4 v1, s[12:15], s28 offen offset:2048 lds
buffer_load_dwordx4 v1, s[12:15], s28 offen offset:3072 lds
s_add_u32 m0, s30, 0x1000
s_add_u32 s30, s30, 0x8000
buffer_load_dwordx4 v1, s[12:15], s29 offen offset:0 lds
buffer_load_dwordx4 v1, s[12:15], s29 offen offset:1024 lds
buffer_load_dwordx4 v1, s[12:15], s29 offen offset:2048 lds
buffer_load_dwordx4 v1, s[12:15], s29 offen offset:3072 lds
s_add_u32 s28, s28, 0x4000
s_cmp_ge_u32 s30, 163840
s_cselect_b32 s30, s49, s30
s_branch .idle_1081
.idle_end_1082:
.endr_1041:
s_cmp_lg_u32 s20, 4
s_cbranch_scc1 .pw_1083
s_mov_b32 s63, 0
s_mov_b32 s60, 0x200007f
s_mov_b32 s61, 0x0
v_lshlrev_b32 v11, 2, v0
v_mov_b32 v10, 0
s_mov_b64 exec, s[60:61]
buffer_atomic_or v10, v11, s[56:59], 0 offen sc0 sc1
s_mov_b64 exec, -1
.pw_1083:
s_waitcnt vmcnt(0) lgkmcnt(0)
s_cmp_lg_u32 s20, 4
s_cbranch_scc1 .pw_1084
v_or_b32 v10, s63, v10
v_cmp_ne_u32 vcc, -1, v10
s_and_b64 vcc, vcc, s[60:61]
s_cbranch_scc1 .pslow_1085
.pret_1086:
.pw_1084:
s_barrier
s_cmp_lg_u32 s20, 0
s_cbranch_scc1 .pw_1088
v_mov_b32 v10, s38
v_writelane_b32 v10, s39, 1
v_lshlrev_b32_e64 v12, s2, 1
v_lshlrev_b32 v11, 2, v10
s_mov_b64 exec, 3
buffer_atomic_or v12, v11, s[56:59], 0 offen offset:32 sc0 sc1
s_mov_b64 exec, -1
.pw_1088:
s_cmp_lg_u32 s27, 0
s_cbranch_scc1 .nxt_1089
s_cmp_lg_u32 s20, 0
s_cbranch_scc1 .pw_1090
s_lshl_b32 s63, 1, s2
s_mov_b64 exec, 3
s_waitcnt vmcnt(0)
v_or_b32 v12, s63, v12
v_cmp_eq_u32 vcc, -1, v12
s_and_b64 exec, exec, vcc
s_cbranch_scc0 .rel_1091
buffer_store_byte v12, v10, s[56:59], 0 offen offset:128 sc0 sc1
.rel_1091:
s_mov_b64 exec, -1
.pw_1090:
s_branch .kf3_1003
.nxt_1089:
s_mov_b32 s65, s20
s_mov_b32 s27, 0
s_mov_b32 s38, 1
s_mov_b32 s39, 0
s_branch .round_1039
.pslow_1035:
s_mov_b32 s62, 30000
.ploop_1037:
s_sleep 6
v_lshlrev_b32 v111, 2, v0
v_mov_b32 v110, 0
s_mov_b64 exec, s[60:61]
buffer_atomic_or v110, v111, s[56:59], 0 offen sc0 sc1
s_mov_b64 exec, -1
s_sub_u32 s62, s62, 1
s_waitcnt vmcnt(0)
s_cbranch_scc1 .pret_1036
v_or_b32 v110, s63, v110
v_cmp_ne_u32 vcc, -1, v110
s_and_b64 vcc, vcc, s[60:61]
s_cbranch_scc1 .ploop_1037
s_branch .pret_1036
.pslow_1062:
s_mov_b32 s62, 30000
.ploop_1064:
s_sleep 6
v_lshlrev_b32 v11, 2, v0
v_mov_b32 v10, 0
s_mov_b64 exec, s[60:61]
buffer_atomic_or v10, v11, s[56:59], 0 offen sc0 sc1
s_mov_b64 exec, -1
s_sub_u32 s62, s62, 1
s_waitcnt vmcnt(0)
s_cbranch_scc1 .pret_1063
v_or_b32 v10, s63, v10
v_cmp_ne_u32 vcc, -1, v10
s_and_b64 vcc, vcc, s[60:61]
s_cbranch_scc1 .ploop_1064
s_branch .pret_1063
.pslow_1085:
s_mov_b32 s62, 30000
.ploop_1087:
s_sleep 6
v_lshlrev_b32 v11, 2, v0
v_mov_b32 v10, 0
s_mov_b64 exec, s[60:61]
buffer_atomic_or v10, v11, s[56:59], 0 offen sc0 sc1
s_mov_b64 exec, -1
s_sub_u32 s62, s62, 1
s_waitcnt vmcnt(0)
s_cbranch_scc1 .pret_1086
v_or_b32 v10, s63, v10
v_cmp_ne_u32 vcc, -1, v10
s_and_b64 vcc, vcc, s[60:61]
s_cbranch_scc1 .ploop_1087
s_branch .pret_1086
.kfb_1002:
s_load_dwordx2 s[4:5], s[0:1], 0
s_load_dwordx2 s[8:9], s[0:1], 56
s_load_dwordx2 s[28:29], s[0:1], 104
s_load_dwordx2 s[56:57], s[0:1], 96
s_mov_b32 s58, 256
s_mov_b32 s59, 0x00020000
s_sub_u32 s16, s2, 224
s_and_b32 s17, s20, 1
s_lshr_b32 s18, s20, 1
s_lshr_b32 s40, s16, 3
s_lshl_b32 s19, s16, 1
s_add_u32 s19, s19, s17
s_mul_i32 s21, s19, 40960
s_mul_i32 s22, s18, 320
s_add_u32 s21, s21, s22
v_and_b32 v10, 31, v0
v_mul_u32_u24 v10, 0x500, v10
v_lshrrev_b32 v11, 5, v0
v_lshl_add_u32 v7, v11, 4, v10
v_lshrrev_b32 v10, 3, v0
v_mul_u32_u24 v10, 0x500, v10
v_lshrrev_b32 v11, 2, v0
v_and_b32 v11, 4, v11
v_xor_b32 v11, v11, v0
v_and_b32 v11, 7, v11
v_lshl_add_u32 v10, v11, 4, v10
s_lshl_b32 s22, s20, 1
s_mul_i32 s23, s20, 3
s_sub_u32 s24, s23, 4
s_add_u32 s25, s22, 4
s_cmp_lt_u32 s20, 4
s_cselect_b32 s24, s22, s24
s_cselect_b32 s25, s23, s25
s_lshl_b32 s41, s24, 10
s_add_u32 s41, s41, 81920
s_add_u32 s22, s24, 0
s_and_b32 s23, s22, 1
s_mul_i32 s23, s23, 10240
s_lshr_b32 s22, s22, 1
s_lshl_b32 s22, s22, 7
s_add_u32 s22, s22, s23
v_add_u32 v1, s22, v10
s_add_u32 s22, s24, 1
s_and_b32 s23, s22, 1
s_mul_i32 s23, s23, 10240
s_lshr_b32 s22, s22, 1
s_lshl_b32 s22, s22, 7
s_add_u32 s22, s22, s23
v_add_u32 v2, s22, v10
s_add_u32 s22, s24, 2
s_and_b32 s23, s22, 1
s_mul_i32 s23, s23, 10240
s_lshr_b32 s22, s22, 1
s_lshl_b32 s22, s22, 7
s_add_u32 s22, s22, s23
v_add_u32 v3, s22, v10
s_mul_i32 s26, s40, 204800
s_lshl_b32 s22, s20, 14
s_add_u32 s22, s22, 61440
v_lshl_add_u32 v166, v0, 7, s22
v_add_u32 v167, 0x2000, v166
s_mov_b32 s6, 2621440
s_mov_b32 s7, 0x00020000
s_mov_b32 s10, 819200
s_mov_b32 s11, 0x00020000
s_waitcnt lgkmcnt(0)
buffer_load_dwordx4 v[208:211], v7, s[4:7], s21 offen offset:0
buffer_load_dwordx4 v[212:215], v7, s[4:7], s21 offen offset:32
buffer_load_dwordx4 v[216:219], v7, s[4:7], s21 offen offset:64
buffer_load_dwordx4 v[220:223], v7, s[4:7], s21 offen offset:96
buffer_load_dwordx4 v[224:227], v7, s[4:7], s21 offen offset:128
buffer_load_dwordx4 v[228:231], v7, s[4:7], s21 offen offset:160
buffer_load_dwordx4 v[232:235], v7, s[4:7], s21 offen offset:192
buffer_load_dwordx4 v[236:239], v7, s[4:7], s21 offen offset:224
buffer_load_dwordx4 v[240:243], v7, s[4:7], s21 offen offset:256
buffer_load_dwordx4 v[244:247], v7, s[4:7], s21 offen offset:288
s_barrier
s_mov_b32 s27, s26
s_add_u32 m0, s41, 0
s_nop 0
buffer_load_dwordx4 v1, s[8:11], s26 offen lds
s_add_u32 m0, s41, 1024
s_nop 0
buffer_load_dwordx4 v2, s[8:11], s26 offen lds
s_cmp_lt_u32 s20, 4
s_cbranch_scc1 .b_sk_1092
s_add_u32 m0, s41, 2048
s_nop 0
buffer_load_dwordx4 v3, s[8:11], s26 offen lds
.b_sk_1092:
s_add_u32 s26, s26, 20480
s_add_u32 m0, s41, 20480
s_nop 0
buffer_load_dwordx4 v1, s[8:11], s26 offen lds
s_add_u32 m0, s41, 21504
s_nop 0
buffer_load_dwordx4 v2, s[8:11], s26 offen lds
s_cmp_lt_u32 s20, 4
s_cbranch_scc1 .b_sk_1093
s_add_u32 m0, s41, 22528
s_nop 0
buffer_load_dwordx4 v3, s[8:11], s26 offen lds
.b_sk_1093:
s_add_u32 s26, s26, 20480
s_add_u32 m0, s41, 40960
s_nop 0
buffer_load_dwordx4 v1, s[8:11], s26 offen lds
s_add_u32 m0, s41, 41984
s_nop 0
buffer_load_dwordx4 v2, s[8:11], s26 offen lds
s_cmp_lt_u32 s20, 4
s_cbranch_scc1 .b_sk_1094
s_add_u32 m0, s41, 43008
s_nop 0
buffer_load_dwordx4 v3, s[8:11], s26 offen lds
.b_sk_1094:
s_add_u32 s26, s26, 20480
buffer_load_dword v166, v166, s[8:11], s27 offen
buffer_load_dword v167, v167, s[8:11], s27 offen
s_add_u32 s12, s28, 0
s_addc_u32 s13, s29, 0
s_mov_b32 s14, 2621440
s_mov_b32 s15, 0x00020000
s_add_u32 s32, s28, 2621440
s_addc_u32 s33, s29, 0
s_mov_b32 s34, 2621440
s_mov_b32 s35, 0x00020000
v_lshlrev_b32 v4, 4, v0
v_add_u32 v5, 40960, v4
v_mov_b32 v168, v4
v_mov_b32 v169, v5
v_and_b32 v10, 31, v0
s_lshl_b32 s22, s17, 11
s_add_u32 s22, s22, 143360
v_lshlrev_b32 v9, 6, v10
v_add_u32 v9, s22, v9
v_lshrrev_b32 v11, 5, v0
v_lshl_add_u32 v8, v11, 3, v9
s_lshl_b32 s22, s18, 4
v_add_u32 v8, s22, v8
v_lshrrev_b32 v10, 5, v0
v_lshlrev_b32 v10, 9, v10
v_bfe_u32 v11, v0, 2, 2
v_lshl_add_u32 v10, v11, 7, v10
v_bfe_u32 v11, v0, 3, 1
v_lshl_add_u32 v10, v11, 6, v10
v_bfe_u32 v11, v0, 4, 1
v_lshl_add_u32 v10, v11, 5, v10
v_and_b32 v11, 3, v0
v_lshl_add_u32 v10, v11, 3, v10
s_add_u32 s22, s25, 0
s_and_b32 s23, s22, 1
s_lshl_b32 s23, s23, 6
s_lshr_b32 s22, s22, 1
s_lshl_b32 s22, s22, 11
s_add_u32 s22, s22, 81920
v_xor_b32 v160, s23, v10
v_add_u32 v160, s22, v160
s_add_u32 s22, s25, 1
s_and_b32 s23, s22, 1
s_lshl_b32 s23, s23, 6
s_lshr_b32 s22, s22, 1
s_lshl_b32 s22, s22, 11
s_add_u32 s22, s22, 81920
v_xor_b32 v161, s23, v10
v_add_u32 v161, s22, v161
s_add_u32 s22, s25, 2
s_and_b32 s23, s22, 1
s_lshl_b32 s23, s23, 6
s_lshr_b32 s22, s22, 1
s_lshl_b32 s22, s22, 11
s_add_u32 s22, s22, 81920
v_xor_b32 v162, s23, v10
v_add_u32 v162, s22, v162
v_mov_b32 v164, 0xc0135761
v_mov_b32 v165, 0xbdd2d3e8
s_mov_b32 s45, 0x3f803f80
v_mov_b32 v14, 0
v_mov_b32 v15, 0
v_mov_b32 v16, 0
v_mov_b32 v17, 0
s_waitcnt vmcnt(17)
v_dot2c_f32_bf16 v14, s45, v208
v_dot2c_f32_bf16 v15, v208, v208
v_dot2c_f32_bf16 v16, s45, v209
v_dot2c_f32_bf16 v17, v209, v209
v_dot2c_f32_bf16 v14, s45, v210
v_dot2c_f32_bf16 v15, v210, v210
v_dot2c_f32_bf16 v16, s45, v211
v_dot2c_f32_bf16 v17, v211, v211
s_waitcnt vmcnt(16)
v_dot2c_f32_bf16 v14, s45, v212
v_dot2c_f32_bf16 v15, v212, v212
v_dot2c_f32_bf16 v16, s45, v213
v_dot2c_f32_bf16 v17, v213, v213
v_dot2c_f32_bf16 v14, s45, v214
v_dot2c_f32_bf16 v15, v214, v214
v_dot2c_f32_bf16 v16, s45, v215
v_dot2c_f32_bf16 v17, v215, v215
s_waitcnt vmcnt(15)
v_dot2c_f32_bf16 v14, s45, v216
v_dot2c_f32_bf16 v15, v216, v216
v_dot2c_f32_bf16 v16, s45, v217
v_dot2c_f32_bf16 v17, v217, v217
v_dot2c_f32_bf16 v14, s45, v218
v_dot2c_f32_bf16 v15, v218, v218
v_dot2c_f32_bf16 v16, s45, v219
v_dot2c_f32_bf16 v17, v219, v219
s_waitcnt vmcnt(14)
v_dot2c_f32_bf16 v14, s45, v220
v_dot2c_f32_bf16 v15, v220, v220
v_dot2c_f32_bf16 v16, s45, v221
v_dot2c_f32_bf16 v17, v221, v221
v_dot2c_f32_bf16 v14, s45, v222
v_dot2c_f32_bf16 v15, v222, v222
v_dot2c_f32_bf16 v16, s45, v223
v_dot2c_f32_bf16 v17, v223, v223
s_waitcnt vmcnt(13)
v_dot2c_f32_bf16 v14, s45, v224
v_dot2c_f32_bf16 v15, v224, v224
v_dot2c_f32_bf16 v16, s45, v225
v_dot2c_f32_bf16 v17, v225, v225
v_dot2c_f32_bf16 v14, s45, v226
v_dot2c_f32_bf16 v15, v226, v226
v_dot2c_f32_bf16 v16, s45, v227
v_dot2c_f32_bf16 v17, v227, v227
s_waitcnt vmcnt(12)
v_dot2c_f32_bf16 v14, s45, v228
v_dot2c_f32_bf16 v15, v228, v228
v_dot2c_f32_bf16 v16, s45, v229
v_dot2c_f32_bf16 v17, v229, v229
v_dot2c_f32_bf16 v14, s45, v230
v_dot2c_f32_bf16 v15, v230, v230
v_dot2c_f32_bf16 v16, s45, v231
v_dot2c_f32_bf16 v17, v231, v231
s_waitcnt vmcnt(11)
v_dot2c_f32_bf16 v14, s45, v232
v_dot2c_f32_bf16 v15, v232, v232
v_dot2c_f32_bf16 v16, s45, v233
v_dot2c_f32_bf16 v17, v233, v233
v_dot2c_f32_bf16 v14, s45, v234
v_dot2c_f32_bf16 v15, v234, v234
v_dot2c_f32_bf16 v16, s45, v235
v_dot2c_f32_bf16 v17, v235, v235
s_waitcnt vmcnt(10)
v_dot2c_f32_bf16 v14, s45, v236
v_dot2c_f32_bf16 v15, v236, v236
v_dot2c_f32_bf16 v16, s45, v237
v_dot2c_f32_bf16 v17, v237, v237
v_dot2c_f32_bf16 v14, s45, v238
v_dot2c_f32_bf16 v15, v238, v238
v_dot2c_f32_bf16 v16, s45, v239
v_dot2c_f32_bf16 v17, v239, v239
s_waitcnt vmcnt(9)
v_dot2c_f32_bf16 v14, s45, v240
v_dot2c_f32_bf16 v15, v240, v240
v_dot2c_f32_bf16 v16, s45, v241
v_dot2c_f32_bf16 v17, v241, v241
v_dot2c_f32_bf16 v14, s45, v242
v_dot2c_f32_bf16 v15, v242, v242
v_dot2c_f32_bf16 v16, s45, v243
v_dot2c_f32_bf16 v17, v243, v243
s_waitcnt vmcnt(8)
v_dot2c_f32_bf16 v14, s45, v244
v_dot2c_f32_bf16 v15, v244, v244
v_dot2c_f32_bf16 v16, s45, v245
v_dot2c_f32_bf16 v17, v245, v245
v_dot2c_f32_bf16 v14, s45, v246
v_dot2c_f32_bf16 v15, v246, v246
v_dot2c_f32_bf16 v16, s45, v247
v_dot2c_f32_bf16 v17, v247, v247
s_nop 1
v_add_f32 v14, v14, v16
v_add_f32 v15, v15, v17
ds_write_b64 v8, v[14:15] offset:0
v_permlane32_swap_b32 v208, v210
v_permlane32_swap_b32 v209, v211
v_permlane32_swap_b32 v212, v214
v_permlane32_swap_b32 v213, v215
v_permlane32_swap_b32 v216, v218
v_permlane32_swap_b32 v217, v219
v_permlane32_swap_b32 v220, v222
v_permlane32_swap_b32 v221, v223
v_permlane32_swap_b32 v224, v226
v_permlane32_swap_b32 v225, v227
v_permlane32_swap_b32 v228, v230
v_permlane32_swap_b32 v229, v231
v_permlane32_swap_b32 v232, v234
v_permlane32_swap_b32 v233, v235
v_permlane32_swap_b32 v236, v238
v_permlane32_swap_b32 v237, v239
v_permlane32_swap_b32 v240, v242
v_permlane32_swap_b32 v241, v243
v_permlane32_swap_b32 v244, v246
v_permlane32_swap_b32 v245, v247
s_waitcnt lgkmcnt(0)
s_barrier
ds_read_b128 v[32:35], v9 offset:0
ds_read_b128 v[36:39], v9 offset:16
ds_read_b128 v[40:43], v9 offset:32
ds_read_b128 v[44:47], v9 offset:48
s_waitcnt lgkmcnt(0)
v_pk_add_f32 v[32:33], v[32:33], v[40:41]
v_pk_add_f32 v[34:35], v[34:35], v[42:43]
v_pk_add_f32 v[36:37], v[36:37], v[44:45]
v_pk_add_f32 v[38:39], v[38:39], v[46:47]
v_pk_add_f32 v[32:33], v[32:33], v[36:37]
v_pk_add_f32 v[34:35], v[34:35], v[38:39]
v_pk_add_f32 v[14:15], v[32:33], v[34:35]
v_mul_f32 v14, 0x3acccccd, v14
v_mul_f32 v15, 0x3acccccd, v15
v_fma_f32 v15, -v14, v14, v15
v_max_f32 v15, 0, v15
v_cvt_pk_bf16_f32 v10, v14, v15
v_lshlrev_b32 v13, 16, v10
v_and_b32 v15, 0xffff0000, v10
v_add_f32 v15, 0x3727c5ac, v15
v_cvt_pk_bf16_f32 v10, v15, v15
v_lshlrev_b32 v10, 16, v10
v_sqrt_f32 v10, v10
s_nop 0
v_cvt_pk_bf16_f32 v10, v10, v10
v_lshlrev_b32 v10, 16, v10
v_rcp_f32 v12, v10
s_nop 0
v_mul_f32_e64 v13, -v13, v12
v_mov_b32 v14, 0
v_mov_b32 v15, 0
v_mov_b32 v16, 0
v_mov_b32 v17, 0
s_mul_i32 s22, s19, 40
s_mul_i32 s23, s18, 10
s_add_u32 s22, s22, s23
s_lshl_b32 s22, s22, 10
v_lshlrev_b32 v18, 16, v208
v_and_b32 v19, 0xffff0000, v208
v_lshlrev_b32 v20, 16, v209
v_and_b32 v21, 0xffff0000, v209
v_lshlrev_b32 v22, 16, v210
v_and_b32 v23, 0xffff0000, v210
v_lshlrev_b32 v24, 16, v211
v_and_b32 v25, 0xffff0000, v211
v_pk_fma_f32 v[18:19], v[18:19], v[12:13], v[12:13] op_sel:[0,0,1] op_sel_hi:[1,0,1]
v_pk_fma_f32 v[20:21], v[20:21], v[12:13], v[12:13] op_sel:[0,0,1] op_sel_hi:[1,0,1]
v_pk_fma_f32 v[22:23], v[22:23], v[12:13], v[12:13] op_sel:[0,0,1] op_sel_hi:[1,0,1]
v_pk_fma_f32 v[24:25], v[24:25], v[12:13], v[12:13] op_sel:[0,0,1] op_sel_hi:[1,0,1]
v_cvt_pk_bf16_f32 v208, v18, v19
v_cvt_pk_bf16_f32 v209, v20, v21
v_cvt_pk_bf16_f32 v210, v22, v23
v_cvt_pk_bf16_f32 v211, v24, v25
v_dot2c_f32_bf16 v14, s45, v208
v_dot2c_f32_bf16 v15, v208, v208
v_dot2c_f32_bf16 v16, s45, v209
v_dot2c_f32_bf16 v17, v209, v209
v_dot2c_f32_bf16 v14, s45, v210
v_dot2c_f32_bf16 v15, v210, v210
v_dot2c_f32_bf16 v16, s45, v211
v_dot2c_f32_bf16 v17, v211, v211
buffer_store_dwordx4 v[208:211], v4, s[12:15], s22 offen offset:0 sc1
v_lshlrev_b32 v18, 16, v212
v_and_b32 v19, 0xffff0000, v212
v_lshlrev_b32 v20, 16, v213
v_and_b32 v21, 0xffff0000, v213
v_lshlrev_b32 v22, 16, v214
v_and_b32 v23, 0xffff0000, v214
v_lshlrev_b32 v24, 16, v215
v_and_b32 v25, 0xffff0000, v215
v_pk_fma_f32 v[18:19], v[18:19], v[12:13], v[12:13] op_sel:[0,0,1] op_sel_hi:[1,0,1]
v_pk_fma_f32 v[20:21], v[20:21], v[12:13], v[12:13] op_sel:[0,0,1] op_sel_hi:[1,0,1]
v_pk_fma_f32 v[22:23], v[22:23], v[12:13], v[12:13] op_sel:[0,0,1] op_sel_hi:[1,0,1]
v_pk_fma_f32 v[24:25], v[24:25], v[12:13], v[12:13] op_sel:[0,0,1] op_sel_hi:[1,0,1]
v_cvt_pk_bf16_f32 v212, v18, v19
v_cvt_pk_bf16_f32 v213, v20, v21
v_cvt_pk_bf16_f32 v214, v22, v23
v_cvt_pk_bf16_f32 v215, v24, v25
v_dot2c_f32_bf16 v14, s45, v212
v_dot2c_f32_bf16 v15, v212, v212
v_dot2c_f32_bf16 v16, s45, v213
v_dot2c_f32_bf16 v17, v213, v213
v_dot2c_f32_bf16 v14, s45, v214
v_dot2c_f32_bf16 v15, v214, v214
v_dot2c_f32_bf16 v16, s45, v215
v_dot2c_f32_bf16 v17, v215, v215
buffer_store_dwordx4 v[212:215], v4, s[12:15], s22 offen offset:1024 sc1
v_lshlrev_b32 v18, 16, v216
v_and_b32 v19, 0xffff0000, v216
v_lshlrev_b32 v20, 16, v217
v_and_b32 v21, 0xffff0000, v217
v_lshlrev_b32 v22, 16, v218
v_and_b32 v23, 0xffff0000, v218
v_lshlrev_b32 v24, 16, v219
v_and_b32 v25, 0xffff0000, v219
v_pk_fma_f32 v[18:19], v[18:19], v[12:13], v[12:13] op_sel:[0,0,1] op_sel_hi:[1,0,1]
v_pk_fma_f32 v[20:21], v[20:21], v[12:13], v[12:13] op_sel:[0,0,1] op_sel_hi:[1,0,1]
v_pk_fma_f32 v[22:23], v[22:23], v[12:13], v[12:13] op_sel:[0,0,1] op_sel_hi:[1,0,1]
v_pk_fma_f32 v[24:25], v[24:25], v[12:13], v[12:13] op_sel:[0,0,1] op_sel_hi:[1,0,1]
v_cvt_pk_bf16_f32 v216, v18, v19
v_cvt_pk_bf16_f32 v217, v20, v21
v_cvt_pk_bf16_f32 v218, v22, v23
v_cvt_pk_bf16_f32 v219, v24, v25
v_dot2c_f32_bf16 v14, s45, v216
v_dot2c_f32_bf16 v15, v216, v216
v_dot2c_f32_bf16 v16, s45, v217
v_dot2c_f32_bf16 v17, v217, v217
v_dot2c_f32_bf16 v14, s45, v218
v_dot2c_f32_bf16 v15, v218, v218
v_dot2c_f32_bf16 v16, s45, v219
v_dot2c_f32_bf16 v17, v219, v219
buffer_store_dwordx4 v[216:219], v4, s[12:15], s22 offen offset:2048 sc1
v_lshlrev_b32 v18, 16, v220
v_and_b32 v19, 0xffff0000, v220
v_lshlrev_b32 v20, 16, v221
v_and_b32 v21, 0xffff0000, v221
v_lshlrev_b32 v22, 16, v222
v_and_b32 v23, 0xffff0000, v222
v_lshlrev_b32 v24, 16, v223
v_and_b32 v25, 0xffff0000, v223
v_pk_fma_f32 v[18:19], v[18:19], v[12:13], v[12:13] op_sel:[0,0,1] op_sel_hi:[1,0,1]
v_pk_fma_f32 v[20:21], v[20:21], v[12:13], v[12:13] op_sel:[0,0,1] op_sel_hi:[1,0,1]
v_pk_fma_f32 v[22:23], v[22:23], v[12:13], v[12:13] op_sel:[0,0,1] op_sel_hi:[1,0,1]
v_pk_fma_f32 v[24:25], v[24:25], v[12:13], v[12:13] op_sel:[0,0,1] op_sel_hi:[1,0,1]
v_cvt_pk_bf16_f32 v220, v18, v19
v_cvt_pk_bf16_f32 v221, v20, v21
v_cvt_pk_bf16_f32 v222, v22, v23
v_cvt_pk_bf16_f32 v223, v24, v25
v_dot2c_f32_bf16 v14, s45, v220
v_dot2c_f32_bf16 v15, v220, v220
v_dot2c_f32_bf16 v16, s45, v221
v_dot2c_f32_bf16 v17, v221, v221
v_dot2c_f32_bf16 v14, s45, v222
v_dot2c_f32_bf16 v15, v222, v222
v_dot2c_f32_bf16 v16, s45, v223
v_dot2c_f32_bf16 v17, v223, v223
buffer_store_dwordx4 v[220:223], v4, s[12:15], s22 offen offset:3072 sc1
s_add_u32 s22, s22, 0x1000
v_lshlrev_b32 v18, 16, v224
v_and_b32 v19, 0xffff0000, v224
v_lshlrev_b32 v20, 16, v225
v_and_b32 v21, 0xffff0000, v225
v_lshlrev_b32 v22, 16, v226
v_and_b32 v23, 0xffff0000, v226
v_lshlrev_b32 v24, 16, v227
v_and_b32 v25, 0xffff0000, v227
v_pk_fma_f32 v[18:19], v[18:19], v[12:13], v[12:13] op_sel:[0,0,1] op_sel_hi:[1,0,1]
v_pk_fma_f32 v[20:21], v[20:21], v[12:13], v[12:13] op_sel:[0,0,1] op_sel_hi:[1,0,1]
v_pk_fma_f32 v[22:23], v[22:23], v[12:13], v[12:13] op_sel:[0,0,1] op_sel_hi:[1,0,1]
v_pk_fma_f32 v[24:25], v[24:25], v[12:13], v[12:13] op_sel:[0,0,1] op_sel_hi:[1,0,1]
v_cvt_pk_bf16_f32 v224, v18, v19
v_cvt_pk_bf16_f32 v225, v20, v21
v_cvt_pk_bf16_f32 v226, v22, v23
v_cvt_pk_bf16_f32 v227, v24, v25
v_dot2c_f32_bf16 v14, s45, v224
v_dot2c_f32_bf16 v15, v224, v224
v_dot2c_f32_bf16 v16, s45, v225
v_dot2c_f32_bf16 v17, v225, v225
v_dot2c_f32_bf16 v14, s45, v226
v_dot2c_f32_bf16 v15, v226, v226
v_dot2c_f32_bf16 v16, s45, v227
v_dot2c_f32_bf16 v17, v227, v227
buffer_store_dwordx4 v[224:227], v4, s[12:15], s22 offen offset:0 sc1
v_lshlrev_b32 v18, 16, v228
v_and_b32 v19, 0xffff0000, v228
v_lshlrev_b32 v20, 16, v229
v_and_b32 v21, 0xffff0000, v229
v_lshlrev_b32 v22, 16, v230
v_and_b32 v23, 0xffff0000, v230
v_lshlrev_b32 v24, 16, v231
v_and_b32 v25, 0xffff0000, v231
v_pk_fma_f32 v[18:19], v[18:19], v[12:13], v[12:13] op_sel:[0,0,1] op_sel_hi:[1,0,1]
v_pk_fma_f32 v[20:21], v[20:21], v[12:13], v[12:13] op_sel:[0,0,1] op_sel_hi:[1,0,1]
v_pk_fma_f32 v[22:23], v[22:23], v[12:13], v[12:13] op_sel:[0,0,1] op_sel_hi:[1,0,1]
v_pk_fma_f32 v[24:25], v[24:25], v[12:13], v[12:13] op_sel:[0,0,1] op_sel_hi:[1,0,1]
v_cvt_pk_bf16_f32 v228, v18, v19
v_cvt_pk_bf16_f32 v229, v20, v21
v_cvt_pk_bf16_f32 v230, v22, v23
v_cvt_pk_bf16_f32 v231, v24, v25
v_dot2c_f32_bf16 v14, s45, v228
v_dot2c_f32_bf16 v15, v228, v228
v_dot2c_f32_bf16 v16, s45, v229
v_dot2c_f32_bf16 v17, v229, v229
v_dot2c_f32_bf16 v14, s45, v230
v_dot2c_f32_bf16 v15, v230, v230
v_dot2c_f32_bf16 v16, s45, v231
v_dot2c_f32_bf16 v17, v231, v231
buffer_store_dwordx4 v[228:231], v4, s[12:15], s22 offen offset:1024 sc1
v_lshlrev_b32 v18, 16, v232
v_and_b32 v19, 0xffff0000, v232
v_lshlrev_b32 v20, 16, v233
v_and_b32 v21, 0xffff0000, v233
v_lshlrev_b32 v22, 16, v234
v_and_b32 v23, 0xffff0000, v234
v_lshlrev_b32 v24, 16, v235
v_and_b32 v25, 0xffff0000, v235
v_pk_fma_f32 v[18:19], v[18:19], v[12:13], v[12:13] op_sel:[0,0,1] op_sel_hi:[1,0,1]
v_pk_fma_f32 v[20:21], v[20:21], v[12:13], v[12:13] op_sel:[0,0,1] op_sel_hi:[1,0,1]
v_pk_fma_f32 v[22:23], v[22:23], v[12:13], v[12:13] op_sel:[0,0,1] op_sel_hi:[1,0,1]
v_pk_fma_f32 v[24:25], v[24:25], v[12:13], v[12:13] op_sel:[0,0,1] op_sel_hi:[1,0,1]
v_cvt_pk_bf16_f32 v232, v18, v19
v_cvt_pk_bf16_f32 v233, v20, v21
v_cvt_pk_bf16_f32 v234, v22, v23
v_cvt_pk_bf16_f32 v235, v24, v25
v_dot2c_f32_bf16 v14, s45, v232
v_dot2c_f32_bf16 v15, v232, v232
v_dot2c_f32_bf16 v16, s45, v233
v_dot2c_f32_bf16 v17, v233, v233
v_dot2c_f32_bf16 v14, s45, v234
v_dot2c_f32_bf16 v15, v234, v234
v_dot2c_f32_bf16 v16, s45, v235
v_dot2c_f32_bf16 v17, v235, v235
buffer_store_dwordx4 v[232:235], v4, s[12:15], s22 offen offset:2048 sc1
v_lshlrev_b32 v18, 16, v236
v_and_b32 v19, 0xffff0000, v236
v_lshlrev_b32 v20, 16, v237
v_and_b32 v21, 0xffff0000, v237
v_lshlrev_b32 v22, 16, v238
v_and_b32 v23, 0xffff0000, v238
v_lshlrev_b32 v24, 16, v239
v_and_b32 v25, 0xffff0000, v239
v_pk_fma_f32 v[18:19], v[18:19], v[12:13], v[12:13] op_sel:[0,0,1] op_sel_hi:[1,0,1]
v_pk_fma_f32 v[20:21], v[20:21], v[12:13], v[12:13] op_sel:[0,0,1] op_sel_hi:[1,0,1]
v_pk_fma_f32 v[22:23], v[22:23], v[12:13], v[12:13] op_sel:[0,0,1] op_sel_hi:[1,0,1]
v_pk_fma_f32 v[24:25], v[24:25], v[12:13], v[12:13] op_sel:[0,0,1] op_sel_hi:[1,0,1]
v_cvt_pk_bf16_f32 v236, v18, v19
v_cvt_pk_bf16_f32 v237, v20, v21
v_cvt_pk_bf16_f32 v238, v22, v23
v_cvt_pk_bf16_f32 v239, v24, v25
v_dot2c_f32_bf16 v14, s45, v236
v_dot2c_f32_bf16 v15, v236, v236
v_dot2c_f32_bf16 v16, s45, v237
v_dot2c_f32_bf16 v17, v237, v237
v_dot2c_f32_bf16 v14, s45, v238
v_dot2c_f32_bf16 v15, v238, v238
v_dot2c_f32_bf16 v16, s45, v239
v_dot2c_f32_bf16 v17, v239, v239
buffer_store_dwordx4 v[236:239], v4, s[12:15], s22 offen offset:3072 sc1
s_add_u32 s22, s22, 0x1000
v_lshlrev_b32 v18, 16, v240
v_and_b32 v19, 0xffff0000, v240
v_lshlrev_b32 v20, 16, v241
v_and_b32 v21, 0xffff0000, v241
v_lshlrev_b32 v22, 16, v242
v_and_b32 v23, 0xffff0000, v242
v_lshlrev_b32 v24, 16, v243
v_and_b32 v25, 0xffff0000, v243
v_pk_fma_f32 v[18:19], v[18:19], v[12:13], v[12:13] op_sel:[0,0,1] op_sel_hi:[1,0,1]
v_pk_fma_f32 v[20:21], v[20:21], v[12:13], v[12:13] op_sel:[0,0,1] op_sel_hi:[1,0,1]
v_pk_fma_f32 v[22:23], v[22:23], v[12:13], v[12:13] op_sel:[0,0,1] op_sel_hi:[1,0,1]
v_pk_fma_f32 v[24:25], v[24:25], v[12:13], v[12:13] op_sel:[0,0,1] op_sel_hi:[1,0,1]
v_cvt_pk_bf16_f32 v240, v18, v19
v_cvt_pk_bf16_f32 v241, v20, v21
v_cvt_pk_bf16_f32 v242, v22, v23
v_cvt_pk_bf16_f32 v243, v24, v25
v_dot2c_f32_bf16 v14, s45, v240
v_dot2c_f32_bf16 v15, v240, v240
v_dot2c_f32_bf16 v16, s45, v241
v_dot2c_f32_bf16 v17, v241, v241
v_dot2c_f32_bf16 v14, s45, v242
v_dot2c_f32_bf16 v15, v242, v242
v_dot2c_f32_bf16 v16, s45, v243
v_dot2c_f32_bf16 v17, v243, v243
buffer_store_dwordx4 v[240:243], v4, s[12:15], s22 offen offset:0 sc1
v_lshlrev_b32 v18, 16, v244
v_and_b32 v19, 0xffff0000, v244
v_lshlrev_b32 v20, 16, v245
v_and_b32 v21, 0xffff0000, v245
v_lshlrev_b32 v22, 16, v246
v_and_b32 v23, 0xffff0000, v246
v_lshlrev_b32 v24, 16, v247
v_and_b32 v25, 0xffff0000, v247
v_pk_fma_f32 v[18:19], v[18:19], v[12:13], v[12:13] op_sel:[0,0,1] op_sel_hi:[1,0,1]
v_pk_fma_f32 v[20:21], v[20:21], v[12:13], v[12:13] op_sel:[0,0,1] op_sel_hi:[1,0,1]
v_pk_fma_f32 v[22:23], v[22:23], v[12:13], v[12:13] op_sel:[0,0,1] op_sel_hi:[1,0,1]
v_pk_fma_f32 v[24:25], v[24:25], v[12:13], v[12:13] op_sel:[0,0,1] op_sel_hi:[1,0,1]
v_cvt_pk_bf16_f32 v244, v18, v19
v_cvt_pk_bf16_f32 v245, v20, v21
v_cvt_pk_bf16_f32 v246, v22, v23
v_cvt_pk_bf16_f32 v247, v24, v25
v_dot2c_f32_bf16 v14, s45, v244
v_dot2c_f32_bf16 v15, v244, v244
v_dot2c_f32_bf16 v16, s45, v245
v_dot2c_f32_bf16 v17, v245, v245
v_dot2c_f32_bf16 v14, s45, v246
v_dot2c_f32_bf16 v15, v246, v246
v_dot2c_f32_bf16 v16, s45, v247
v_dot2c_f32_bf16 v17, v247, v247
buffer_store_dwordx4 v[244:247], v4, s[12:15], s22 offen offset:1024 sc1
s_nop 0
v_add_f32 v14, v14, v16
v_add_f32 v15, v15, v17
ds_write_b64 v8, v[14:15] offset:4096
s_waitcnt lgkmcnt(0)
s_barrier
ds_read_b128 v[32:35], v9 offset:4096
ds_read_b128 v[36:39], v9 offset:4112
ds_read_b128 v[40:43], v9 offset:4128
ds_read_b128 v[44:47], v9 offset:4144
s_waitcnt lgkmcnt(0)
v_pk_add_f32 v[32:33], v[32:33], v[40:41]
v_pk_add_f32 v[34:35], v[34:35], v[42:43]
v_pk_add_f32 v[36:37], v[36:37], v[44:45]
v_pk_add_f32 v[38:39], v[38:39], v[46:47]
v_pk_add_f32 v[32:33], v[32:33], v[36:37]
v_pk_add_f32 v[34:35], v[34:35], v[38:39]
v_pk_add_f32 v[14:15], v[32:33], v[34:35]
v_mul_f32 v14, 0x3acccccd, v14
v_mul_f32 v15, 0x3acccccd, v15
v_fma_f32 v15, -v14, v14, v15
v_max_f32 v15, 0, v15
v_cvt_pk_bf16_f32 v10, v14, v15
v_lshlrev_b32 v13, 16, v10
v_and_b32 v15, 0xffff0000, v10
v_add_f32 v15, 0x3727c5ac, v15
v_cvt_pk_bf16_f32 v10, v15, v15
v_lshlrev_b32 v10, 16, v10
v_sqrt_f32 v10, v10
s_nop 0
v_cvt_pk_bf16_f32 v10, v10, v10
v_lshlrev_b32 v10, 16, v10
v_rcp_f32 v12, v10
s_nop 0
v_mul_f32_e64 v13, -v13, v12
s_sub_u32 s23, s18, s40
s_and_b32 s23, s23, 3
s_mul_i32 s23, s23, 10
s_mul_i32 s22, s17, 40
s_add_u32 s22, s22, s23
s_lshl_b32 s22, s22, 10
v_add_u32 v11, s22, v4
v_lshlrev_b32 v18, 16, v208
v_and_b32 v19, 0xffff0000, v208
v_lshlrev_b32 v20, 16, v209
v_and_b32 v21, 0xffff0000, v209
v_lshlrev_b32 v22, 16, v210
v_and_b32 v23, 0xffff0000, v210
v_lshlrev_b32 v24, 16, v211
v_and_b32 v25, 0xffff0000, v211
v_pk_fma_f32 v[18:19], v[18:19], v[12:13], v[12:13] op_sel:[0,0,1] op_sel_hi:[1,0,1]
v_pk_fma_f32 v[20:21], v[20:21], v[12:13], v[12:13] op_sel:[0,0,1] op_sel_hi:[1,0,1]
v_pk_fma_f32 v[22:23], v[22:23], v[12:13], v[12:13] op_sel:[0,0,1] op_sel_hi:[1,0,1]
v_pk_fma_f32 v[24:25], v[24:25], v[12:13], v[12:13] op_sel:[0,0,1] op_sel_hi:[1,0,1]
v_cvt_pk_bf16_f32 v64, v18, v19
v_cvt_pk_bf16_f32 v65, v20, v21
v_cvt_pk_bf16_f32 v66, v22, v23
v_cvt_pk_bf16_f32 v67, v24, v25
ds_write_b128 v11, v[64:67] offset:0
v_lshlrev_b32 v18, 16, v212
v_and_b32 v19, 0xffff0000, v212
v_lshlrev_b32 v20, 16, v213
v_and_b32 v21, 0xffff0000, v213
v_lshlrev_b32 v22, 16, v214
v_and_b32 v23, 0xffff0000, v214
v_lshlrev_b32 v24, 16, v215
v_and_b32 v25, 0xffff0000, v215
v_pk_fma_f32 v[18:19], v[18:19], v[12:13], v[12:13] op_sel:[0,0,1] op_sel_hi:[1,0,1]
v_pk_fma_f32 v[20:21], v[20:21], v[12:13], v[12:13] op_sel:[0,0,1] op_sel_hi:[1,0,1]
v_pk_fma_f32 v[22:23], v[22:23], v[12:13], v[12:13] op_sel:[0,0,1] op_sel_hi:[1,0,1]
v_pk_fma_f32 v[24:25], v[24:25], v[12:13], v[12:13] op_sel:[0,0,1] op_sel_hi:[1,0,1]
v_cvt_pk_bf16_f32 v68, v18, v19
v_cvt_pk_bf16_f32 v69, v20, v21
v_cvt_pk_bf16_f32 v70, v22, v23
v_cvt_pk_bf16_f32 v71, v24, v25
ds_write_b128 v11, v[68:71] offset:1024
v_lshlrev_b32 v18, 16, v216
v_and_b32 v19, 0xffff0000, v216
v_lshlrev_b32 v20, 16, v217
v_and_b32 v21, 0xffff0000, v217
v_lshlrev_b32 v22, 16, v218
v_and_b32 v23, 0xffff0000, v218
v_lshlrev_b32 v24, 16, v219
v_and_b32 v25, 0xffff0000, v219
v_pk_fma_f32 v[18:19], v[18:19], v[12:13], v[12:13] op_sel:[0,0,1] op_sel_hi:[1,0,1]
v_pk_fma_f32 v[20:21], v[20:21], v[12:13], v[12:13] op_sel:[0,0,1] op_sel_hi:[1,0,1]
v_pk_fma_f32 v[22:23], v[22:23], v[12:13], v[12:13] op_sel:[0,0,1] op_sel_hi:[1,0,1]
v_pk_fma_f32 v[24:25], v[24:25], v[12:13], v[12:13] op_sel:[0,0,1] op_sel_hi:[1,0,1]
v_cvt_pk_bf16_f32 v72, v18, v19
v_cvt_pk_bf16_f32 v73, v20, v21
v_cvt_pk_bf16_f32 v74, v22, v23
v_cvt_pk_bf16_f32 v75, v24, v25
ds_write_b128 v11, v[72:75] offset:2048
v_lshlrev_b32 v18, 16, v220
v_and_b32 v19, 0xffff0000, v220
v_lshlrev_b32 v20, 16, v221
v_and_b32 v21, 0xffff0000, v221
v_lshlrev_b32 v22, 16, v222
v_and_b32 v23, 0xffff0000, v222
v_lshlrev_b32 v24, 16, v223
v_and_b32 v25, 0xffff0000, v223
v_pk_fma_f32 v[18:19], v[18:19], v[12:13], v[12:13] op_sel:[0,0,1] op_sel_hi:[1,0,1]
v_pk_fma_f32 v[20:21], v[20:21], v[12:13], v[12:13] op_sel:[0,0,1] op_sel_hi:[1,0,1]
v_pk_fma_f32 v[22:23], v[22:23], v[12:13], v[12:13] op_sel:[0,0,1] op_sel_hi:[1,0,1]
v_pk_fma_f32 v[24:25], v[24:25], v[12:13], v[12:13] op_sel:[0,0,1] op_sel_hi:[1,0,1]
v_cvt_pk_bf16_f32 v76, v18, v19
v_cvt_pk_bf16_f32 v77, v20, v21
v_cvt_pk_bf16_f32 v78, v22, v23
v_cvt_pk_bf16_f32 v79, v24, v25
ds_write_b128 v11, v[76:79] offset:3072
v_lshlrev_b32 v18, 16, v224
v_and_b32 v19, 0xffff0000, v224
v_lshlrev_b32 v20, 16, v225
v_and_b32 v21, 0xffff0000, v225
v_lshlrev_b32 v22, 16, v226
v_and_b32 v23, 0xffff0000, v226
v_lshlrev_b32 v24, 16, v227
v_and_b32 v25, 0xffff0000, v227
v_pk_fma_f32 v[18:19], v[18:19], v[12:13], v[12:13] op_sel:[0,0,1] op_sel_hi:[1,0,1]
v_pk_fma_f32 v[20:21], v[20:21], v[12:13], v[12:13] op_sel:[0,0,1] op_sel_hi:[1,0,1]
v_pk_fma_f32 v[22:23], v[22:23], v[12:13], v[12:13] op_sel:[0,0,1] op_sel_hi:[1,0,1]
v_pk_fma_f32 v[24:25], v[24:25], v[12:13], v[12:13] op_sel:[0,0,1] op_sel_hi:[1,0,1]
v_cvt_pk_bf16_f32 v80, v18, v19
v_cvt_pk_bf16_f32 v81, v20, v21
v_cvt_pk_bf16_f32 v82, v22, v23
v_cvt_pk_bf16_f32 v83, v24, v25
ds_write_b128 v11, v[80:83] offset:4096
v_lshlrev_b32 v18, 16, v228
v_and_b32 v19, 0xffff0000, v228
v_lshlrev_b32 v20, 16, v229
v_and_b32 v21, 0xffff0000, v229
v_lshlrev_b32 v22, 16, v230
v_and_b32 v23, 0xffff0000, v230
v_lshlrev_b32 v24, 16, v231
v_and_b32 v25, 0xffff0000, v231
v_pk_fma_f32 v[18:19], v[18:19], v[12:13], v[12:13] op_sel:[0,0,1] op_sel_hi:[1,0,1]
v_pk_fma_f32 v[20:21], v[20:21], v[12:13], v[12:13] op_sel:[0,0,1] op_sel_hi:[1,0,1]
v_pk_fma_f32 v[22:23], v[22:23], v[12:13], v[12:13] op_sel:[0,0,1] op_sel_hi:[1,0,1]
v_pk_fma_f32 v[24:25], v[24:25], v[12:13], v[12:13] op_sel:[0,0,1] op_sel_hi:[1,0,1]
v_cvt_pk_bf16_f32 v84, v18, v19
v_cvt_pk_bf16_f32 v85, v20, v21
v_cvt_pk_bf16_f32 v86, v22, v23
v_cvt_pk_bf16_f32 v87, v24, v25
ds_write_b128 v11, v[84:87] offset:5120
v_lshlrev_b32 v18, 16, v232
v_and_b32 v19, 0xffff0000, v232
v_lshlrev_b32 v20, 16, v233
v_and_b32 v21, 0xffff0000, v233
v_lshlrev_b32 v22, 16, v234
v_and_b32 v23, 0xffff0000, v234
v_lshlrev_b32 v24, 16, v235
v_and_b32 v25, 0xffff0000, v235
v_pk_fma_f32 v[18:19], v[18:19], v[12:13], v[12:13] op_sel:[0,0,1] op_sel_hi:[1,0,1]
v_pk_fma_f32 v[20:21], v[20:21], v[12:13], v[12:13] op_sel:[0,0,1] op_sel_hi:[1,0,1]
v_pk_fma_f32 v[22:23], v[22:23], v[12:13], v[12:13] op_sel:[0,0,1] op_sel_hi:[1,0,1]
v_pk_fma_f32 v[24:25], v[24:25], v[12:13], v[12:13] op_sel:[0,0,1] op_sel_hi:[1,0,1]
v_cvt_pk_bf16_f32 v88, v18, v19
v_cvt_pk_bf16_f32 v89, v20, v21
v_cvt_pk_bf16_f32 v90, v22, v23
v_cvt_pk_bf16_f32 v91, v24, v25
ds_write_b128 v11, v[88:91] offset:6144
v_lshlrev_b32 v18, 16, v236
v_and_b32 v19, 0xffff0000, v236
v_lshlrev_b32 v20, 16, v237
v_and_b32 v21, 0xffff0000, v237
v_lshlrev_b32 v22, 16, v238
v_and_b32 v23, 0xffff0000, v238
v_lshlrev_b32 v24, 16, v239
v_and_b32 v25, 0xffff0000, v239
v_pk_fma_f32 v[18:19], v[18:19], v[12:13], v[12:13] op_sel:[0,0,1] op_sel_hi:[1,0,1]
v_pk_fma_f32 v[20:21], v[20:21], v[12:13], v[12:13] op_sel:[0,0,1] op_sel_hi:[1,0,1]
v_pk_fma_f32 v[22:23], v[22:23], v[12:13], v[12:13] op_sel:[0,0,1] op_sel_hi:[1,0,1]
v_pk_fma_f32 v[24:25], v[24:25], v[12:13], v[12:13] op_sel:[0,0,1] op_sel_hi:[1,0,1]
v_cvt_pk_bf16_f32 v92, v18, v19
v_cvt_pk_bf16_f32 v93, v20, v21
v_cvt_pk_bf16_f32 v94, v22, v23
v_cvt_pk_bf16_f32 v95, v24, v25
ds_write_b128 v11, v[92:95] offset:7168
v_lshlrev_b32 v18, 16, v240
v_and_b32 v19, 0xffff0000, v240
v_lshlrev_b32 v20, 16, v241
v_and_b32 v21, 0xffff0000, v241
v_lshlrev_b32 v22, 16, v242
v_and_b32 v23, 0xffff0000, v242
v_lshlrev_b32 v24, 16, v243
v_and_b32 v25, 0xffff0000, v243
v_pk_fma_f32 v[18:19], v[18:19], v[12:13], v[12:13] op_sel:[0,0,1] op_sel_hi:[1,0,1]
v_pk_fma_f32 v[20:21], v[20:21], v[12:13], v[12:13] op_sel:[0,0,1] op_sel_hi:[1,0,1]
v_pk_fma_f32 v[22:23], v[22:23], v[12:13], v[12:13] op_sel:[0,0,1] op_sel_hi:[1,0,1]
v_pk_fma_f32 v[24:25], v[24:25], v[12:13], v[12:13] op_sel:[0,0,1] op_sel_hi:[1,0,1]
v_cvt_pk_bf16_f32 v96, v18, v19
v_cvt_pk_bf16_f32 v97, v20, v21
v_cvt_pk_bf16_f32 v98, v22, v23
v_cvt_pk_bf16_f32 v99, v24, v25
ds_write_b128 v11, v[96:99] offset:8192
v_lshlrev_b32 v18, 16, v244
v_and_b32 v19, 0xffff0000, v244
v_lshlrev_b32 v20, 16, v245
v_and_b32 v21, 0xffff0000, v245
v_lshlrev_b32 v22, 16, v246
v_and_b32 v23, 0xffff0000, v246
v_lshlrev_b32 v24, 16, v247
v_and_b32 v25, 0xffff0000, v247
v_pk_fma_f32 v[18:19], v[18:19], v[12:13], v[12:13] op_sel:[0,0,1] op_sel_hi:[1,0,1]
v_pk_fma_f32 v[20:21], v[20:21], v[12:13], v[12:13] op_sel:[0,0,1] op_sel_hi:[1,0,1]
v_pk_fma_f32 v[22:23], v[22:23], v[12:13], v[12:13] op_sel:[0,0,1] op_sel_hi:[1,0,1]
v_pk_fma_f32 v[24:25], v[24:25], v[12:13], v[12:13] op_sel:[0,0,1] op_sel_hi:[1,0,1]
v_cvt_pk_bf16_f32 v100, v18, v19
v_cvt_pk_bf16_f32 v101, v20, v21
v_cvt_pk_bf16_f32 v102, v22, v23
v_cvt_pk_bf16_f32 v103, v24, v25
ds_write_b128 v11, v[100:103] offset:9216
s_mul_i32 s31, s16, 81920
s_lshl_b32 s22, s25, 11
s_add_u32 s31, s31, s22
s_mov_b32 s42, 10
s_waitcnt lgkmcnt(0)
v_mov_b32 v64, 0
v_mov_b32 v65, 0
v_mov_b32 v66, 0
v_mov_b32 v67, 0
v_mov_b32 v68, 0
v_mov_b32 v69, 0
v_mov_b32 v70, 0
v_mov_b32 v71, 0
v_mov_b32 v72, 0
v_mov_b32 v73, 0
v_mov_b32 v74, 0
v_mov_b32 v75, 0
v_mov_b32 v76, 0
v_mov_b32 v77, 0
v_mov_b32 v78, 0
v_mov_b32 v79, 0
v_mov_b32 v80, 0
v_mov_b32 v81, 0
v_mov_b32 v82, 0
v_mov_b32 v83, 0
v_mov_b32 v84, 0
v_mov_b32 v85, 0
v_mov_b32 v86, 0
v_mov_b32 v87, 0
v_mov_b32 v88, 0
v_mov_b32 v89, 0
v_mov_b32 v90, 0
v_mov_b32 v91, 0
v_mov_b32 v92, 0
v_mov_b32 v93, 0
v_mov_b32 v94, 0
v_mov_b32 v95, 0
v_mov_b32 v96, 0
v_mov_b32 v97, 0
v_mov_b32 v98, 0
v_mov_b32 v99, 0
v_mov_b32 v100, 0
v_mov_b32 v101, 0
v_mov_b32 v102, 0
v_mov_b32 v103, 0
v_mov_b32 v104, 0
v_mov_b32 v105, 0
v_mov_b32 v106, 0
v_mov_b32 v107, 0
v_mov_b32 v108, 0
v_mov_b32 v109, 0
v_mov_b32 v110, 0
v_mov_b32 v111, 0
v_mov_b32 v112, 0
v_mov_b32 v113, 0
v_mov_b32 v114, 0
v_mov_b32 v115, 0
v_mov_b32 v116, 0
v_mov_b32 v117, 0
v_mov_b32 v118, 0
v_mov_b32 v119, 0
v_mov_b32 v120, 0
v_mov_b32 v121, 0
v_mov_b32 v122, 0
v_mov_b32 v123, 0
v_mov_b32 v124, 0
v_mov_b32 v125, 0
v_mov_b32 v126, 0
v_mov_b32 v127, 0
v_mov_b32 v128, 0
v_mov_b32 v129, 0
v_mov_b32 v130, 0
v_mov_b32 v131, 0
v_mov_b32 v132, 0
v_mov_b32 v133, 0
v_mov_b32 v134, 0
v_mov_b32 v135, 0
v_mov_b32 v136, 0
v_mov_b32 v137, 0
v_mov_b32 v138, 0
v_mov_b32 v139, 0
v_mov_b32 v140, 0
v_mov_b32 v141, 0
v_mov_b32 v142, 0
v_mov_b32 v143, 0
v_mov_b32 v144, 0
v_mov_b32 v145, 0
v_mov_b32 v146, 0
v_mov_b32 v147, 0
v_mov_b32 v148, 0
v_mov_b32 v149, 0
v_mov_b32 v150, 0
v_mov_b32 v151, 0
v_mov_b32 v152, 0
v_mov_b32 v153, 0
v_mov_b32 v154, 0
v_mov_b32 v155, 0
v_mov_b32 v156, 0
v_mov_b32 v157, 0
v_mov_b32 v158, 0
v_mov_b32 v159, 0
s_waitcnt vmcnt(0)
s_barrier
s_cmp_lg_u32 s20, 0
s_cbranch_scc1 .sig_1095
v_lshlrev_b32 v170, 12, v0
v_lshlrev_b32_e64 v171, s2, 1
buffer_atomic_or v171, v170, s[56:59], 0 offen offset:188 sc1
.sig_1095:
s_cmp_ge_u32 s20, 4
s_cbranch_scc1 .b_two_1096
s_add_u32 m0, s41, 61440
s_nop 0
buffer_load_dwordx4 v1, s[8:11], s26 offen lds
s_add_u32 m0, s41, 62464
s_nop 0
buffer_load_dwordx4 v2, s[8:11], s26 offen lds
s_add_u32 s26, s26, 20480
s_cmp_eq_u32 s26, 819200
s_cselect_b32 s26, 0, s26
ds_read_b128 v[32:35], v168 offset:0
ds_read_b64_tr_b16 v[176:177], v160 offset:0
ds_read_b64_tr_b16 v[178:179], v160 offset:1024
ds_read_b128 v[36:39], v169 offset:0
ds_read_b64_tr_b16 v[180:181], v161 offset:0
ds_read_b64_tr_b16 v[182:183], v161 offset:1024
ds_read_b64_tr_b16 v[184:185], v162 offset:0
ds_read_b64_tr_b16 v[186:187], v162 offset:1024
.b_loop_1098:
s_sub_u32 s42, s42, 1
s_cmp_eq_u32 s42, 0
s_cselect_b32 s26, 1073741824, s26
s_waitcnt lgkmcnt(0)
s_waitcnt vmcnt(4)
s_barrier
ds_read_b128 v[40:43], v168 offset:1024
ds_read_b64_tr_b16 v[188:189], v160 offset:20480
ds_read_b64_tr_b16 v[190:191], v160 offset:21504
ds_read_b128 v[44:47], v169 offset:1024
s_add_u32 m0, s41, 0
v_mfma_f32_32x32x16_bf16 v[64:79], v[176:179], v[32:35], v[64:79]
ds_read_b64_tr_b16 v[192:193], v161 offset:20480
ds_read_b64_tr_b16 v[194:195], v161 offset:21504
ds_read_b64_tr_b16 v[196:197], v162 offset:20480
ds_read_b64_tr_b16 v[198:199], v162 offset:21504
buffer_load_dwordx4 v1, s[8:11], s26 offen lds
s_add_u32 m0, s41, 1024
v_mfma_f32_32x32x16_bf16 v[80:95], v[176:179], v[36:39], v[80:95]
buffer_load_dwordx4 v2, s[8:11], s26 offen lds
v_mfma_f32_32x32x16_bf16 v[96:111], v[180:183], v[32:35], v[96:111]
v_mfma_f32_32x32x16_bf16 v[112:127], v[180:183], v[36:39], v[112:127]
v_mfma_f32_32x32x16_bf16 v[128:143], v[184:187], v[32:35], v[128:143]
v_mfma_f32_32x32x16_bf16 v[144:159], v[184:187], v[36:39], v[144:159]
s_add_u32 s26, s26, 20480
s_cmp_eq_u32 s26, 819200
s_cselect_b32 s26, 0, s26
s_waitcnt lgkmcnt(0)
s_waitcnt vmcnt(4)
s_barrier
ds_read_b128 v[32:35], v168 offset:2048
ds_read_b64_tr_b16 v[176:177], v160 offset:40960
ds_read_b64_tr_b16 v[178:179], v160 offset:41984
ds_read_b128 v[36:39], v169 offset:2048
s_add_u32 m0, s41, 20480
v_mfma_f32_32x32x16_bf16 v[64:79], v[188:191], v[40:43], v[64:79]
ds_read_b64_tr_b16 v[180:181], v161 offset:40960
ds_read_b64_tr_b16 v[182:183], v161 offset:41984
ds_read_b64_tr_b16 v[184:185], v162 offset:40960
ds_read_b64_tr_b16 v[186:187], v162 offset:41984
buffer_load_dwordx4 v1, s[8:11], s26 offen lds
s_add_u32 m0, s41, 21504
v_mfma_f32_32x32x16_bf16 v[80:95], v[188:191], v[44:47], v[80:95]
buffer_load_dwordx4 v2, s[8:11], s26 offen lds
v_mfma_f32_32x32x16_bf16 v[96:111], v[192:195], v[40:43], v[96:111]
v_mfma_f32_32x32x16_bf16 v[112:127], v[192:195], v[44:47], v[112:127]
v_mfma_f32_32x32x16_bf16 v[128:143], v[196:199], v[40:43], v[128:143]
v_mfma_f32_32x32x16_bf16 v[144:159], v[196:199], v[44:47], v[144:159]
s_add_u32 s26, s26, 20480
s_cmp_eq_u32 s26, 819200
s_cselect_b32 s26, 0, s26
s_waitcnt lgkmcnt(0)
s_waitcnt vmcnt(4)
s_barrier
ds_read_b128 v[40:43], v168 offset:3072
ds_read_b64_tr_b16 v[188:189], v160 offset:61440
ds_read_b64_tr_b16 v[190:191], v160 offset:62464
ds_read_b128 v[44:47], v169 offset:3072
s_add_u32 m0, s41, 40960
v_mfma_f32_32x32x16_bf16 v[64:79], v[176:179], v[32:35], v[64:79]
ds_read_b64_tr_b16 v[192:193], v161 offset:61440
ds_read_b64_tr_b16 v[194:195], v161 offset:62464
ds_read_b64_tr_b16 v[196:197], v162 offset:61440
ds_read_b64_tr_b16 v[198:199], v162 offset:62464
buffer_load_dwordx4 v1, s[8:11], s26 offen lds
s_add_u32 m0, s41, 41984
v_mfma_f32_32x32x16_bf16 v[80:95], v[176:179], v[36:39], v[80:95]
buffer_load_dwordx4 v2, s[8:11], s26 offen lds
v_mfma_f32_32x32x16_bf16 v[96:111], v[180:183], v[32:35], v[96:111]
v_mfma_f32_32x32x16_bf16 v[112:127], v[180:183], v[36:39], v[112:127]
v_mfma_f32_32x32x16_bf16 v[128:143], v[184:187], v[32:35], v[128:143]
v_mfma_f32_32x32x16_bf16 v[144:159], v[184:187], v[36:39], v[144:159]
s_add_u32 s26, s26, 20480
s_cmp_eq_u32 s26, 819200
s_cselect_b32 s26, 0, s26
s_waitcnt lgkmcnt(0)
s_waitcnt vmcnt(4)
s_barrier
ds_read_b128 v[32:35], v168 offset:4096
ds_read_b64_tr_b16 v[176:177], v160 offset:0
ds_read_b64_tr_b16 v[178:179], v160 offset:1024
ds_read_b128 v[36:39], v169 offset:4096
s_add_u32 m0, s41, 61440
v_mfma_f32_32x32x16_bf16 v[64:79], v[188:191], v[40:43], v[64:79]
ds_read_b64_tr_b16 v[180:181], v161 offset:0
ds_read_b64_tr_b16 v[182:183], v161 offset:1024
ds_read_b64_tr_b16 v[184:185], v162 offset:0
ds_read_b64_tr_b16 v[186:187], v162 offset:1024
buffer_load_dwordx4 v1, s[8:11], s26 offen lds
s_add_u32 m0, s41, 62464
v_mfma_f32_32x32x16_bf16 v[80:95], v[188:191], v[44:47], v[80:95]
buffer_load_dwordx4 v2, s[8:11], s26 offen lds
v_mfma_f32_32x32x16_bf16 v[96:111], v[192:195], v[40:43], v[96:111]
v_mfma_f32_32x32x16_bf16 v[112:127], v[192:195], v[44:47], v[112:127]
v_mfma_f32_32x32x16_bf16 v[128:143], v[196:199], v[40:43], v[128:143]
v_mfma_f32_32x32x16_bf16 v[144:159], v[196:199], v[44:47], v[144:159]
s_add_u32 s26, s26, 20480
s_cmp_eq_u32 s26, 819200
s_cselect_b32 s26, 0, s26
v_add_u32 v168, 0x1000, v168
v_add_u32 v169, 0x1000, v169
s_cmp_lg_u32 s42, 0
s_cbranch_scc1 .b_loop_1098
v_pk_mul_f32 v[48:49], v[64:65], v[64:65]
v_pk_mul_f32 v[50:51], v[66:67], v[66:67]
v_pk_mul_f32 v[52:53], v[68:69], v[68:69]
v_pk_mul_f32 v[54:55], v[70:71], v[70:71]
v_pk_mul_f32 v[56:57], v[72:73], v[72:73]
v_pk_mul_f32 v[58:59], v[74:75], v[74:75]
v_pk_mul_f32 v[60:61], v[76:77], v[76:77]
v_pk_mul_f32 v[62:63], v[78:79], v[78:79]
v_pk_fma_f32 v[48:49], v[48:49], v[164:165], v[164:165] op_sel:[0,1,0] op_sel_hi:[1,1,0]
v_pk_fma_f32 v[50:51], v[50:51], v[164:165], v[164:165] op_sel:[0,1,0] op_sel_hi:[1,1,0]
v_pk_fma_f32 v[52:53], v[52:53], v[164:165], v[164:165] op_sel:[0,1,0] op_sel_hi:[1,1,0]
v_pk_fma_f32 v[54:55], v[54:55], v[164:165], v[164:165] op_sel:[0,1,0] op_sel_hi:[1,1,0]
v_pk_fma_f32 v[56:57], v[56:57], v[164:165], v[164:165] op_sel:[0,1,0] op_sel_hi:[1,1,0]
v_pk_fma_f32 v[58:59], v[58:59], v[164:165], v[164:165] op_sel:[0,1,0] op_sel_hi:[1,1,0]
v_pk_fma_f32 v[60:61], v[60:61], v[164:165], v[164:165] op_sel:[0,1,0] op_sel_hi:[1,1,0]
v_pk_fma_f32 v[62:63], v[62:63], v[164:165], v[164:165] op_sel:[0,1,0] op_sel_hi:[1,1,0]
v_pk_mul_f32 v[48:49], v[48:49], v[64:65]
v_pk_mul_f32 v[50:51], v[50:51], v[66:67]
v_pk_mul_f32 v[52:53], v[52:53], v[68:69]
v_pk_mul_f32 v[54:55], v[54:55], v[70:71]
v_pk_mul_f32 v[56:57], v[56:57], v[72:73]
v_pk_mul_f32 v[58:59], v[58:59], v[74:75]
v_pk_mul_f32 v[60:61], v[60:61], v[76:77]
v_pk_mul_f32 v[62:63], v[62:63], v[78:79]
v_exp_f32 v48, v48
v_exp_f32 v49, v49
v_exp_f32 v50, v50
v_exp_f32 v51, v51
v_exp_f32 v52, v52
v_exp_f32 v53, v53
v_exp_f32 v54, v54
v_exp_f32 v55, v55
v_exp_f32 v56, v56
v_exp_f32 v57, v57
v_exp_f32 v58, v58
v_exp_f32 v59, v59
v_exp_f32 v60, v60
v_exp_f32 v61, v61
v_exp_f32 v62, v62
v_exp_f32 v63, v63
v_pk_add_f32 v[48:49], v[48:49], 1.0 op_sel_hi:[1,0]
v_pk_add_f32 v[50:51], v[50:51], 1.0 op_sel_hi:[1,0]
v_pk_add_f32 v[52:53], v[52:53], 1.0 op_sel_hi:[1,0]
v_pk_add_f32 v[54:55], v[54:55], 1.0 op_sel_hi:[1,0]
v_pk_add_f32 v[56:57], v[56:57], 1.0 op_sel_hi:[1,0]
v_pk_add_f32 v[58:59], v[58:59], 1.0 op_sel_hi:[1,0]
v_pk_add_f32 v[60:61], v[60:61], 1.0 op_sel_hi:[1,0]
v_pk_add_f32 v[62:63], v[62:63], 1.0 op_sel_hi:[1,0]
v_rcp_f32 v48, v48
v_rcp_f32 v49, v49
v_rcp_f32 v50, v50
v_rcp_f32 v51, v51
v_rcp_f32 v52, v52
v_rcp_f32 v53, v53
v_rcp_f32 v54, v54
v_rcp_f32 v55, v55
v_rcp_f32 v56, v56
v_rcp_f32 v57, v57
v_rcp_f32 v58, v58
v_rcp_f32 v59, v59
v_rcp_f32 v60, v60
v_rcp_f32 v61, v61
v_rcp_f32 v62, v62
v_rcp_f32 v63, v63
v_pk_mul_f32 v[48:49], v[48:49], v[64:65]
v_pk_mul_f32 v[50:51], v[50:51], v[66:67]
v_pk_mul_f32 v[52:53], v[52:53], v[68:69]
v_pk_mul_f32 v[54:55], v[54:55], v[70:71]
v_pk_mul_f32 v[56:57], v[56:57], v[72:73]
v_pk_mul_f32 v[58:59], v[58:59], v[74:75]
v_pk_mul_f32 v[60:61], v[60:61], v[76:77]
v_pk_mul_f32 v[62:63], v[62:63], v[78:79]
v_cvt_pk_bf16_f32 v64, v48, v49
v_cvt_pk_bf16_f32 v65, v50, v51
v_cvt_pk_bf16_f32 v66, v52, v53
v_cvt_pk_bf16_f32 v67, v54, v55
v_cvt_pk_bf16_f32 v68, v56, v57
v_cvt_pk_bf16_f32 v69, v58, v59
v_cvt_pk_bf16_f32 v70, v60, v61
v_cvt_pk_bf16_f32 v71, v62, v63
buffer_store_dwordx4 v[64:67], v4, s[32:35], s31 offen offset:0 sc1
buffer_store_dwordx4 v[68:71], v4, s[32:35], s31 offen offset:1024 sc1
v_pk_mul_f32 v[48:49], v[80:81], v[80:81]
v_pk_mul_f32 v[50:51], v[82:83], v[82:83]
v_pk_mul_f32 v[52:53], v[84:85], v[84:85]
v_pk_mul_f32 v[54:55], v[86:87], v[86:87]
v_pk_mul_f32 v[56:57], v[88:89], v[88:89]
v_pk_mul_f32 v[58:59], v[90:91], v[90:91]
v_pk_mul_f32 v[60:61], v[92:93], v[92:93]
v_pk_mul_f32 v[62:63], v[94:95], v[94:95]
v_pk_fma_f32 v[48:49], v[48:49], v[164:165], v[164:165] op_sel:[0,1,0] op_sel_hi:[1,1,0]
v_pk_fma_f32 v[50:51], v[50:51], v[164:165], v[164:165] op_sel:[0,1,0] op_sel_hi:[1,1,0]
v_pk_fma_f32 v[52:53], v[52:53], v[164:165], v[164:165] op_sel:[0,1,0] op_sel_hi:[1,1,0]
v_pk_fma_f32 v[54:55], v[54:55], v[164:165], v[164:165] op_sel:[0,1,0] op_sel_hi:[1,1,0]
v_pk_fma_f32 v[56:57], v[56:57], v[164:165], v[164:165] op_sel:[0,1,0] op_sel_hi:[1,1,0]
v_pk_fma_f32 v[58:59], v[58:59], v[164:165], v[164:165] op_sel:[0,1,0] op_sel_hi:[1,1,0]
v_pk_fma_f32 v[60:61], v[60:61], v[164:165], v[164:165] op_sel:[0,1,0] op_sel_hi:[1,1,0]
v_pk_fma_f32 v[62:63], v[62:63], v[164:165], v[164:165] op_sel:[0,1,0] op_sel_hi:[1,1,0]
v_pk_mul_f32 v[48:49], v[48:49], v[80:81]
v_pk_mul_f32 v[50:51], v[50:51], v[82:83]
v_pk_mul_f32 v[52:53], v[52:53], v[84:85]
v_pk_mul_f32 v[54:55], v[54:55], v[86:87]
v_pk_mul_f32 v[56:57], v[56:57], v[88:89]
v_pk_mul_f32 v[58:59], v[58:59], v[90:91]
v_pk_mul_f32 v[60:61], v[60:61], v[92:93]
v_pk_mul_f32 v[62:63], v[62:63], v[94:95]
v_exp_f32 v48, v48
v_exp_f32 v49, v49
v_exp_f32 v50, v50
v_exp_f32 v51, v51
v_exp_f32 v52, v52
v_exp_f32 v53, v53
v_exp_f32 v54, v54
v_exp_f32 v55, v55
v_exp_f32 v56, v56
v_exp_f32 v57, v57
v_exp_f32 v58, v58
v_exp_f32 v59, v59
v_exp_f32 v60, v60
v_exp_f32 v61, v61
v_exp_f32 v62, v62
v_exp_f32 v63, v63
v_pk_add_f32 v[48:49], v[48:49], 1.0 op_sel_hi:[1,0]
v_pk_add_f32 v[50:51], v[50:51], 1.0 op_sel_hi:[1,0]
v_pk_add_f32 v[52:53], v[52:53], 1.0 op_sel_hi:[1,0]
v_pk_add_f32 v[54:55], v[54:55], 1.0 op_sel_hi:[1,0]
v_pk_add_f32 v[56:57], v[56:57], 1.0 op_sel_hi:[1,0]
v_pk_add_f32 v[58:59], v[58:59], 1.0 op_sel_hi:[1,0]
v_pk_add_f32 v[60:61], v[60:61], 1.0 op_sel_hi:[1,0]
v_pk_add_f32 v[62:63], v[62:63], 1.0 op_sel_hi:[1,0]
v_rcp_f32 v48, v48
v_rcp_f32 v49, v49
v_rcp_f32 v50, v50
v_rcp_f32 v51, v51
v_rcp_f32 v52, v52
v_rcp_f32 v53, v53
v_rcp_f32 v54, v54
v_rcp_f32 v55, v55
v_rcp_f32 v56, v56
v_rcp_f32 v57, v57
v_rcp_f32 v58, v58
v_rcp_f32 v59, v59
v_rcp_f32 v60, v60
v_rcp_f32 v61, v61
v_rcp_f32 v62, v62
v_rcp_f32 v63, v63
v_pk_mul_f32 v[48:49], v[48:49], v[80:81]
v_pk_mul_f32 v[50:51], v[50:51], v[82:83]
v_pk_mul_f32 v[52:53], v[52:53], v[84:85]
v_pk_mul_f32 v[54:55], v[54:55], v[86:87]
v_pk_mul_f32 v[56:57], v[56:57], v[88:89]
v_pk_mul_f32 v[58:59], v[58:59], v[90:91]
v_pk_mul_f32 v[60:61], v[60:61], v[92:93]
v_pk_mul_f32 v[62:63], v[62:63], v[94:95]
v_cvt_pk_bf16_f32 v80, v48, v49
v_cvt_pk_bf16_f32 v81, v50, v51
v_cvt_pk_bf16_f32 v82, v52, v53
v_cvt_pk_bf16_f32 v83, v54, v55
v_cvt_pk_bf16_f32 v84, v56, v57
v_cvt_pk_bf16_f32 v85, v58, v59
v_cvt_pk_bf16_f32 v86, v60, v61
v_cvt_pk_bf16_f32 v87, v62, v63
buffer_store_dwordx4 v[80:83], v5, s[32:35], s31 offen offset:0 sc1
buffer_store_dwordx4 v[84:87], v5, s[32:35], s31 offen offset:1024 sc1
s_add_u32 s31, s31, 0x800
v_pk_mul_f32 v[48:49], v[96:97], v[96:97]
v_pk_mul_f32 v[50:51], v[98:99], v[98:99]
v_pk_mul_f32 v[52:53], v[100:101], v[100:101]
v_pk_mul_f32 v[54:55], v[102:103], v[102:103]
v_pk_mul_f32 v[56:57], v[104:105], v[104:105]
v_pk_mul_f32 v[58:59], v[106:107], v[106:107]
v_pk_mul_f32 v[60:61], v[108:109], v[108:109]
v_pk_mul_f32 v[62:63], v[110:111], v[110:111]
v_pk_fma_f32 v[48:49], v[48:49], v[164:165], v[164:165] op_sel:[0,1,0] op_sel_hi:[1,1,0]
v_pk_fma_f32 v[50:51], v[50:51], v[164:165], v[164:165] op_sel:[0,1,0] op_sel_hi:[1,1,0]
v_pk_fma_f32 v[52:53], v[52:53], v[164:165], v[164:165] op_sel:[0,1,0] op_sel_hi:[1,1,0]
v_pk_fma_f32 v[54:55], v[54:55], v[164:165], v[164:165] op_sel:[0,1,0] op_sel_hi:[1,1,0]
v_pk_fma_f32 v[56:57], v[56:57], v[164:165], v[164:165] op_sel:[0,1,0] op_sel_hi:[1,1,0]
v_pk_fma_f32 v[58:59], v[58:59], v[164:165], v[164:165] op_sel:[0,1,0] op_sel_hi:[1,1,0]
v_pk_fma_f32 v[60:61], v[60:61], v[164:165], v[164:165] op_sel:[0,1,0] op_sel_hi:[1,1,0]
v_pk_fma_f32 v[62:63], v[62:63], v[164:165], v[164:165] op_sel:[0,1,0] op_sel_hi:[1,1,0]
v_pk_mul_f32 v[48:49], v[48:49], v[96:97]
v_pk_mul_f32 v[50:51], v[50:51], v[98:99]
v_pk_mul_f32 v[52:53], v[52:53], v[100:101]
v_pk_mul_f32 v[54:55], v[54:55], v[102:103]
v_pk_mul_f32 v[56:57], v[56:57], v[104:105]
v_pk_mul_f32 v[58:59], v[58:59], v[106:107]
v_pk_mul_f32 v[60:61], v[60:61], v[108:109]
v_pk_mul_f32 v[62:63], v[62:63], v[110:111]
v_exp_f32 v48, v48
v_exp_f32 v49, v49
v_exp_f32 v50, v50
v_exp_f32 v51, v51
v_exp_f32 v52, v52
v_exp_f32 v53, v53
v_exp_f32 v54, v54
v_exp_f32 v55, v55
v_exp_f32 v56, v56
v_exp_f32 v57, v57
v_exp_f32 v58, v58
v_exp_f32 v59, v59
v_exp_f32 v60, v60
v_exp_f32 v61, v61
v_exp_f32 v62, v62
v_exp_f32 v63, v63
v_pk_add_f32 v[48:49], v[48:49], 1.0 op_sel_hi:[1,0]
v_pk_add_f32 v[50:51], v[50:51], 1.0 op_sel_hi:[1,0]
v_pk_add_f32 v[52:53], v[52:53], 1.0 op_sel_hi:[1,0]
v_pk_add_f32 v[54:55], v[54:55], 1.0 op_sel_hi:[1,0]
v_pk_add_f32 v[56:57], v[56:57], 1.0 op_sel_hi:[1,0]
v_pk_add_f32 v[58:59], v[58:59], 1.0 op_sel_hi:[1,0]
v_pk_add_f32 v[60:61], v[60:61], 1.0 op_sel_hi:[1,0]
v_pk_add_f32 v[62:63], v[62:63], 1.0 op_sel_hi:[1,0]
v_rcp_f32 v48, v48
v_rcp_f32 v49, v49
v_rcp_f32 v50, v50
v_rcp_f32 v51, v51
v_rcp_f32 v52, v52
v_rcp_f32 v53, v53
v_rcp_f32 v54, v54
v_rcp_f32 v55, v55
v_rcp_f32 v56, v56
v_rcp_f32 v57, v57
v_rcp_f32 v58, v58
v_rcp_f32 v59, v59
v_rcp_f32 v60, v60
v_rcp_f32 v61, v61
v_rcp_f32 v62, v62
v_rcp_f32 v63, v63
v_pk_mul_f32 v[48:49], v[48:49], v[96:97]
v_pk_mul_f32 v[50:51], v[50:51], v[98:99]
v_pk_mul_f32 v[52:53], v[52:53], v[100:101]
v_pk_mul_f32 v[54:55], v[54:55], v[102:103]
v_pk_mul_f32 v[56:57], v[56:57], v[104:105]
v_pk_mul_f32 v[58:59], v[58:59], v[106:107]
v_pk_mul_f32 v[60:61], v[60:61], v[108:109]
v_pk_mul_f32 v[62:63], v[62:63], v[110:111]
v_cvt_pk_bf16_f32 v96, v48, v49
v_cvt_pk_bf16_f32 v97, v50, v51
v_cvt_pk_bf16_f32 v98, v52, v53
v_cvt_pk_bf16_f32 v99, v54, v55
v_cvt_pk_bf16_f32 v100, v56, v57
v_cvt_pk_bf16_f32 v101, v58, v59
v_cvt_pk_bf16_f32 v102, v60, v61
v_cvt_pk_bf16_f32 v103, v62, v63
buffer_store_dwordx4 v[96:99], v4, s[32:35], s31 offen offset:0 sc1
buffer_store_dwordx4 v[100:103], v4, s[32:35], s31 offen offset:1024 sc1
v_pk_mul_f32 v[48:49], v[112:113], v[112:113]
v_pk_mul_f32 v[50:51], v[114:115], v[114:115]
v_pk_mul_f32 v[52:53], v[116:117], v[116:117]
v_pk_mul_f32 v[54:55], v[118:119], v[118:119]
v_pk_mul_f32 v[56:57], v[120:121], v[120:121]
v_pk_mul_f32 v[58:59], v[122:123], v[122:123]
v_pk_mul_f32 v[60:61], v[124:125], v[124:125]
v_pk_mul_f32 v[62:63], v[126:127], v[126:127]
v_pk_fma_f32 v[48:49], v[48:49], v[164:165], v[164:165] op_sel:[0,1,0] op_sel_hi:[1,1,0]
v_pk_fma_f32 v[50:51], v[50:51], v[164:165], v[164:165] op_sel:[0,1,0] op_sel_hi:[1,1,0]
v_pk_fma_f32 v[52:53], v[52:53], v[164:165], v[164:165] op_sel:[0,1,0] op_sel_hi:[1,1,0]
v_pk_fma_f32 v[54:55], v[54:55], v[164:165], v[164:165] op_sel:[0,1,0] op_sel_hi:[1,1,0]
v_pk_fma_f32 v[56:57], v[56:57], v[164:165], v[164:165] op_sel:[0,1,0] op_sel_hi:[1,1,0]
v_pk_fma_f32 v[58:59], v[58:59], v[164:165], v[164:165] op_sel:[0,1,0] op_sel_hi:[1,1,0]
v_pk_fma_f32 v[60:61], v[60:61], v[164:165], v[164:165] op_sel:[0,1,0] op_sel_hi:[1,1,0]
v_pk_fma_f32 v[62:63], v[62:63], v[164:165], v[164:165] op_sel:[0,1,0] op_sel_hi:[1,1,0]
v_pk_mul_f32 v[48:49], v[48:49], v[112:113]
v_pk_mul_f32 v[50:51], v[50:51], v[114:115]
v_pk_mul_f32 v[52:53], v[52:53], v[116:117]
v_pk_mul_f32 v[54:55], v[54:55], v[118:119]
v_pk_mul_f32 v[56:57], v[56:57], v[120:121]
v_pk_mul_f32 v[58:59], v[58:59], v[122:123]
v_pk_mul_f32 v[60:61], v[60:61], v[124:125]
v_pk_mul_f32 v[62:63], v[62:63], v[126:127]
v_exp_f32 v48, v48
v_exp_f32 v49, v49
v_exp_f32 v50, v50
v_exp_f32 v51, v51
v_exp_f32 v52, v52
v_exp_f32 v53, v53
v_exp_f32 v54, v54
v_exp_f32 v55, v55
v_exp_f32 v56, v56
v_exp_f32 v57, v57
v_exp_f32 v58, v58
v_exp_f32 v59, v59
v_exp_f32 v60, v60
v_exp_f32 v61, v61
v_exp_f32 v62, v62
v_exp_f32 v63, v63
v_pk_add_f32 v[48:49], v[48:49], 1.0 op_sel_hi:[1,0]
v_pk_add_f32 v[50:51], v[50:51], 1.0 op_sel_hi:[1,0]
v_pk_add_f32 v[52:53], v[52:53], 1.0 op_sel_hi:[1,0]
v_pk_add_f32 v[54:55], v[54:55], 1.0 op_sel_hi:[1,0]
v_pk_add_f32 v[56:57], v[56:57], 1.0 op_sel_hi:[1,0]
v_pk_add_f32 v[58:59], v[58:59], 1.0 op_sel_hi:[1,0]
v_pk_add_f32 v[60:61], v[60:61], 1.0 op_sel_hi:[1,0]
v_pk_add_f32 v[62:63], v[62:63], 1.0 op_sel_hi:[1,0]
v_rcp_f32 v48, v48
v_rcp_f32 v49, v49
v_rcp_f32 v50, v50
v_rcp_f32 v51, v51
v_rcp_f32 v52, v52
v_rcp_f32 v53, v53
v_rcp_f32 v54, v54
v_rcp_f32 v55, v55
v_rcp_f32 v56, v56
v_rcp_f32 v57, v57
v_rcp_f32 v58, v58
v_rcp_f32 v59, v59
v_rcp_f32 v60, v60
v_rcp_f32 v61, v61
v_rcp_f32 v62, v62
v_rcp_f32 v63, v63
v_pk_mul_f32 v[48:49], v[48:49], v[112:113]
v_pk_mul_f32 v[50:51], v[50:51], v[114:115]
v_pk_mul_f32 v[52:53], v[52:53], v[116:117]
v_pk_mul_f32 v[54:55], v[54:55], v[118:119]
v_pk_mul_f32 v[56:57], v[56:57], v[120:121]
v_pk_mul_f32 v[58:59], v[58:59], v[122:123]
v_pk_mul_f32 v[60:61], v[60:61], v[124:125]
v_pk_mul_f32 v[62:63], v[62:63], v[126:127]
v_cvt_pk_bf16_f32 v112, v48, v49
v_cvt_pk_bf16_f32 v113, v50, v51
v_cvt_pk_bf16_f32 v114, v52, v53
v_cvt_pk_bf16_f32 v115, v54, v55
v_cvt_pk_bf16_f32 v116, v56, v57
v_cvt_pk_bf16_f32 v117, v58, v59
v_cvt_pk_bf16_f32 v118, v60, v61
v_cvt_pk_bf16_f32 v119, v62, v63
buffer_store_dwordx4 v[112:115], v5, s[32:35], s31 offen offset:0 sc1
buffer_store_dwordx4 v[116:119], v5, s[32:35], s31 offen offset:1024 sc1
s_add_u32 s31, s31, 0x800
v_pk_mul_f32 v[48:49], v[128:129], v[128:129]
v_pk_mul_f32 v[50:51], v[130:131], v[130:131]
v_pk_mul_f32 v[52:53], v[132:133], v[132:133]
v_pk_mul_f32 v[54:55], v[134:135], v[134:135]
v_pk_mul_f32 v[56:57], v[136:137], v[136:137]
v_pk_mul_f32 v[58:59], v[138:139], v[138:139]
v_pk_mul_f32 v[60:61], v[140:141], v[140:141]
v_pk_mul_f32 v[62:63], v[142:143], v[142:143]
v_pk_fma_f32 v[48:49], v[48:49], v[164:165], v[164:165] op_sel:[0,1,0] op_sel_hi:[1,1,0]
v_pk_fma_f32 v[50:51], v[50:51], v[164:165], v[164:165] op_sel:[0,1,0] op_sel_hi:[1,1,0]
v_pk_fma_f32 v[52:53], v[52:53], v[164:165], v[164:165] op_sel:[0,1,0] op_sel_hi:[1,1,0]
v_pk_fma_f32 v[54:55], v[54:55], v[164:165], v[164:165] op_sel:[0,1,0] op_sel_hi:[1,1,0]
v_pk_fma_f32 v[56:57], v[56:57], v[164:165], v[164:165] op_sel:[0,1,0] op_sel_hi:[1,1,0]
v_pk_fma_f32 v[58:59], v[58:59], v[164:165], v[164:165] op_sel:[0,1,0] op_sel_hi:[1,1,0]
v_pk_fma_f32 v[60:61], v[60:61], v[164:165], v[164:165] op_sel:[0,1,0] op_sel_hi:[1,1,0]
v_pk_fma_f32 v[62:63], v[62:63], v[164:165], v[164:165] op_sel:[0,1,0] op_sel_hi:[1,1,0]
v_pk_mul_f32 v[48:49], v[48:49], v[128:129]
v_pk_mul_f32 v[50:51], v[50:51], v[130:131]
v_pk_mul_f32 v[52:53], v[52:53], v[132:133]
v_pk_mul_f32 v[54:55], v[54:55], v[134:135]
v_pk_mul_f32 v[56:57], v[56:57], v[136:137]
v_pk_mul_f32 v[58:59], v[58:59], v[138:139]
v_pk_mul_f32 v[60:61], v[60:61], v[140:141]
v_pk_mul_f32 v[62:63], v[62:63], v[142:143]
v_exp_f32 v48, v48
v_exp_f32 v49, v49
v_exp_f32 v50, v50
v_exp_f32 v51, v51
v_exp_f32 v52, v52
v_exp_f32 v53, v53
v_exp_f32 v54, v54
v_exp_f32 v55, v55
v_exp_f32 v56, v56
v_exp_f32 v57, v57
v_exp_f32 v58, v58
v_exp_f32 v59, v59
v_exp_f32 v60, v60
v_exp_f32 v61, v61
v_exp_f32 v62, v62
v_exp_f32 v63, v63
v_pk_add_f32 v[48:49], v[48:49], 1.0 op_sel_hi:[1,0]
v_pk_add_f32 v[50:51], v[50:51], 1.0 op_sel_hi:[1,0]
v_pk_add_f32 v[52:53], v[52:53], 1.0 op_sel_hi:[1,0]
v_pk_add_f32 v[54:55], v[54:55], 1.0 op_sel_hi:[1,0]
v_pk_add_f32 v[56:57], v[56:57], 1.0 op_sel_hi:[1,0]
v_pk_add_f32 v[58:59], v[58:59], 1.0 op_sel_hi:[1,0]
v_pk_add_f32 v[60:61], v[60:61], 1.0 op_sel_hi:[1,0]
v_pk_add_f32 v[62:63], v[62:63], 1.0 op_sel_hi:[1,0]
v_rcp_f32 v48, v48
v_rcp_f32 v49, v49
v_rcp_f32 v50, v50
v_rcp_f32 v51, v51
v_rcp_f32 v52, v52
v_rcp_f32 v53, v53
v_rcp_f32 v54, v54
v_rcp_f32 v55, v55
v_rcp_f32 v56, v56
v_rcp_f32 v57, v57
v_rcp_f32 v58, v58
v_rcp_f32 v59, v59
v_rcp_f32 v60, v60
v_rcp_f32 v61, v61
v_rcp_f32 v62, v62
v_rcp_f32 v63, v63
v_pk_mul_f32 v[48:49], v[48:49], v[128:129]
v_pk_mul_f32 v[50:51], v[50:51], v[130:131]
v_pk_mul_f32 v[52:53], v[52:53], v[132:133]
v_pk_mul_f32 v[54:55], v[54:55], v[134:135]
v_pk_mul_f32 v[56:57], v[56:57], v[136:137]
v_pk_mul_f32 v[58:59], v[58:59], v[138:139]
v_pk_mul_f32 v[60:61], v[60:61], v[140:141]
v_pk_mul_f32 v[62:63], v[62:63], v[142:143]
v_cvt_pk_bf16_f32 v128, v48, v49
v_cvt_pk_bf16_f32 v129, v50, v51
v_cvt_pk_bf16_f32 v130, v52, v53
v_cvt_pk_bf16_f32 v131, v54, v55
v_cvt_pk_bf16_f32 v132, v56, v57
v_cvt_pk_bf16_f32 v133, v58, v59
v_cvt_pk_bf16_f32 v134, v60, v61
v_cvt_pk_bf16_f32 v135, v62, v63
buffer_store_dwordx4 v[128:131], v4, s[32:35], s31 offen offset:0 sc1
buffer_store_dwordx4 v[132:135], v4, s[32:35], s31 offen offset:1024 sc1
v_pk_mul_f32 v[48:49], v[144:145], v[144:145]
v_pk_mul_f32 v[50:51], v[146:147], v[146:147]
v_pk_mul_f32 v[52:53], v[148:149], v[148:149]
v_pk_mul_f32 v[54:55], v[150:151], v[150:151]
v_pk_mul_f32 v[56:57], v[152:153], v[152:153]
v_pk_mul_f32 v[58:59], v[154:155], v[154:155]
v_pk_mul_f32 v[60:61], v[156:157], v[156:157]
v_pk_mul_f32 v[62:63], v[158:159], v[158:159]
v_pk_fma_f32 v[48:49], v[48:49], v[164:165], v[164:165] op_sel:[0,1,0] op_sel_hi:[1,1,0]
v_pk_fma_f32 v[50:51], v[50:51], v[164:165], v[164:165] op_sel:[0,1,0] op_sel_hi:[1,1,0]
v_pk_fma_f32 v[52:53], v[52:53], v[164:165], v[164:165] op_sel:[0,1,0] op_sel_hi:[1,1,0]
v_pk_fma_f32 v[54:55], v[54:55], v[164:165], v[164:165] op_sel:[0,1,0] op_sel_hi:[1,1,0]
v_pk_fma_f32 v[56:57], v[56:57], v[164:165], v[164:165] op_sel:[0,1,0] op_sel_hi:[1,1,0]
v_pk_fma_f32 v[58:59], v[58:59], v[164:165], v[164:165] op_sel:[0,1,0] op_sel_hi:[1,1,0]
v_pk_fma_f32 v[60:61], v[60:61], v[164:165], v[164:165] op_sel:[0,1,0] op_sel_hi:[1,1,0]
v_pk_fma_f32 v[62:63], v[62:63], v[164:165], v[164:165] op_sel:[0,1,0] op_sel_hi:[1,1,0]
v_pk_mul_f32 v[48:49], v[48:49], v[144:145]
v_pk_mul_f32 v[50:51], v[50:51], v[146:147]
v_pk_mul_f32 v[52:53], v[52:53], v[148:149]
v_pk_mul_f32 v[54:55], v[54:55], v[150:151]
v_pk_mul_f32 v[56:57], v[56:57], v[152:153]
v_pk_mul_f32 v[58:59], v[58:59], v[154:155]
v_pk_mul_f32 v[60:61], v[60:61], v[156:157]
v_pk_mul_f32 v[62:63], v[62:63], v[158:159]
v_exp_f32 v48, v48
v_exp_f32 v49, v49
v_exp_f32 v50, v50
v_exp_f32 v51, v51
v_exp_f32 v52, v52
v_exp_f32 v53, v53
v_exp_f32 v54, v54
v_exp_f32 v55, v55
v_exp_f32 v56, v56
v_exp_f32 v57, v57
v_exp_f32 v58, v58
v_exp_f32 v59, v59
v_exp_f32 v60, v60
v_exp_f32 v61, v61
v_exp_f32 v62, v62
v_exp_f32 v63, v63
v_pk_add_f32 v[48:49], v[48:49], 1.0 op_sel_hi:[1,0]
v_pk_add_f32 v[50:51], v[50:51], 1.0 op_sel_hi:[1,0]
v_pk_add_f32 v[52:53], v[52:53], 1.0 op_sel_hi:[1,0]
v_pk_add_f32 v[54:55], v[54:55], 1.0 op_sel_hi:[1,0]
v_pk_add_f32 v[56:57], v[56:57], 1.0 op_sel_hi:[1,0]
v_pk_add_f32 v[58:59], v[58:59], 1.0 op_sel_hi:[1,0]
v_pk_add_f32 v[60:61], v[60:61], 1.0 op_sel_hi:[1,0]
v_pk_add_f32 v[62:63], v[62:63], 1.0 op_sel_hi:[1,0]
v_rcp_f32 v48, v48
v_rcp_f32 v49, v49
v_rcp_f32 v50, v50
v_rcp_f32 v51, v51
v_rcp_f32 v52, v52
v_rcp_f32 v53, v53
v_rcp_f32 v54, v54
v_rcp_f32 v55, v55
v_rcp_f32 v56, v56
v_rcp_f32 v57, v57
v_rcp_f32 v58, v58
v_rcp_f32 v59, v59
v_rcp_f32 v60, v60
v_rcp_f32 v61, v61
v_rcp_f32 v62, v62
v_rcp_f32 v63, v63
v_pk_mul_f32 v[48:49], v[48:49], v[144:145]
v_pk_mul_f32 v[50:51], v[50:51], v[146:147]
v_pk_mul_f32 v[52:53], v[52:53], v[148:149]
v_pk_mul_f32 v[54:55], v[54:55], v[150:151]
v_pk_mul_f32 v[56:57], v[56:57], v[152:153]
v_pk_mul_f32 v[58:59], v[58:59], v[154:155]
v_pk_mul_f32 v[60:61], v[60:61], v[156:157]
v_pk_mul_f32 v[62:63], v[62:63], v[158:159]
v_cvt_pk_bf16_f32 v144, v48, v49
v_cvt_pk_bf16_f32 v145, v50, v51
v_cvt_pk_bf16_f32 v146, v52, v53
v_cvt_pk_bf16_f32 v147, v54, v55
v_cvt_pk_bf16_f32 v148, v56, v57
v_cvt_pk_bf16_f32 v149, v58, v59
v_cvt_pk_bf16_f32 v150, v60, v61
v_cvt_pk_bf16_f32 v151, v62, v63
buffer_store_dwordx4 v[144:147], v5, s[32:35], s31 offen offset:0 sc1
buffer_store_dwordx4 v[148:151], v5, s[32:35], s31 offen offset:1024 sc1
s_add_u32 s31, s31, 0x800
s_branch .b_end_1097
.b_two_1096:
s_add_u32 m0, s41, 61440
s_nop 0
buffer_load_dwordx4 v1, s[8:11], s26 offen lds
s_add_u32 m0, s41, 62464
s_nop 0
buffer_load_dwordx4 v2, s[8:11], s26 offen lds
s_add_u32 m0, s41, 63488
s_nop 0
buffer_load_dwordx4 v3, s[8:11], s26 offen lds
s_add_u32 s26, s26, 20480
s_cmp_eq_u32 s26, 819200
s_cselect_b32 s26, 0, s26
ds_read_b128 v[32:35], v168 offset:0
ds_read_b64_tr_b16 v[176:177], v160 offset:0
ds_read_b64_tr_b16 v[178:179], v160 offset:1024
ds_read_b128 v[36:39], v169 offset:0
ds_read_b64_tr_b16 v[180:181], v161 offset:0
ds_read_b64_tr_b16 v[182:183], v161 offset:1024
.b_loop_1099:
s_sub_u32 s42, s42, 1
s_cmp_eq_u32 s42, 0
s_cselect_b32 s26, 1073741824, s26
s_waitcnt lgkmcnt(0)
s_waitcnt vmcnt(6)
s_barrier
ds_read_b128 v[40:43], v168 offset:1024
ds_read_b64_tr_b16 v[188:189], v160 offset:20480
ds_read_b64_tr_b16 v[190:191], v160 offset:21504
ds_read_b128 v[44:47], v169 offset:1024
s_add_u32 m0, s41, 0
v_mfma_f32_32x32x16_bf16 v[64:79], v[176:179], v[32:35], v[64:79]
ds_read_b64_tr_b16 v[192:193], v161 offset:20480
ds_read_b64_tr_b16 v[194:195], v161 offset:21504
buffer_load_dwordx4 v1, s[8:11], s26 offen lds
s_add_u32 m0, s41, 1024
v_mfma_f32_32x32x16_bf16 v[80:95], v[176:179], v[36:39], v[80:95]
buffer_load_dwordx4 v2, s[8:11], s26 offen lds
s_add_u32 m0, s41, 2048
v_mfma_f32_32x32x16_bf16 v[96:111], v[180:183], v[32:35], v[96:111]
buffer_load_dwordx4 v3, s[8:11], s26 offen lds
v_mfma_f32_32x32x16_bf16 v[112:127], v[180:183], v[36:39], v[112:127]
s_add_u32 s26, s26, 20480
s_cmp_eq_u32 s26, 819200
s_cselect_b32 s26, 0, s26
s_waitcnt lgkmcnt(0)
s_waitcnt vmcnt(6)
s_barrier
ds_read_b128 v[32:35], v168 offset:2048
ds_read_b64_tr_b16 v[176:177], v160 offset:40960
ds_read_b64_tr_b16 v[178:179], v160 offset:41984
ds_read_b128 v[36:39], v169 offset:2048
s_add_u32 m0, s41, 20480
v_mfma_f32_32x32x16_bf16 v[64:79], v[188:191], v[40:43], v[64:79]
ds_read_b64_tr_b16 v[180:181], v161 offset:40960
ds_read_b64_tr_b16 v[182:183], v161 offset:41984
buffer_load_dwordx4 v1, s[8:11], s26 offen lds
s_add_u32 m0, s41, 21504
v_mfma_f32_32x32x16_bf16 v[80:95], v[188:191], v[44:47], v[80:95]
buffer_load_dwordx4 v2, s[8:11], s26 offen lds
s_add_u32 m0, s41, 22528
v_mfma_f32_32x32x16_bf16 v[96:111], v[192:195], v[40:43], v[96:111]
buffer_load_dwordx4 v3, s[8:11], s26 offen lds
v_mfma_f32_32x32x16_bf16 v[112:127], v[192:195], v[44:47], v[112:127]
s_add_u32 s26, s26, 20480
s_cmp_eq_u32 s26, 819200
s_cselect_b32 s26, 0, s26
s_waitcnt lgkmcnt(0)
s_waitcnt vmcnt(6)
s_barrier
ds_read_b128 v[40:43], v168 offset:3072
ds_read_b64_tr_b16 v[188:189], v160 offset:61440
ds_read_b64_tr_b16 v[190:191], v160 offset:62464
ds_read_b128 v[44:47], v169 offset:3072
s_add_u32 m0, s41, 40960
v_mfma_f32_32x32x16_bf16 v[64:79], v[176:179], v[32:35], v[64:79]
ds_read_b64_tr_b16 v[192:193], v161 offset:61440
ds_read_b64_tr_b16 v[194:195], v161 offset:62464
buffer_load_dwordx4 v1, s[8:11], s26 offen lds
s_add_u32 m0, s41, 41984
v_mfma_f32_32x32x16_bf16 v[80:95], v[176:179], v[36:39], v[80:95]
buffer_load_dwordx4 v2, s[8:11], s26 offen lds
s_add_u32 m0, s41, 43008
v_mfma_f32_32x32x16_bf16 v[96:111], v[180:183], v[32:35], v[96:111]
buffer_load_dwordx4 v3, s[8:11], s26 offen lds
v_mfma_f32_32x32x16_bf16 v[112:127], v[180:183], v[36:39], v[112:127]
s_add_u32 s26, s26, 20480
s_cmp_eq_u32 s26, 819200
s_cselect_b32 s26, 0, s26
s_waitcnt lgkmcnt(0)
s_waitcnt vmcnt(6)
s_barrier
ds_read_b128 v[32:35], v168 offset:4096
ds_read_b64_tr_b16 v[176:177], v160 offset:0
ds_read_b64_tr_b16 v[178:179], v160 offset:1024
ds_read_b128 v[36:39], v169 offset:4096
s_add_u32 m0, s41, 61440
v_mfma_f32_32x32x16_bf16 v[64:79], v[188:191], v[40:43], v[64:79]
ds_read_b64_tr_b16 v[180:181], v161 offset:0
ds_read_b64_tr_b16 v[182:183], v161 offset:1024
buffer_load_dwordx4 v1, s[8:11], s26 offen lds
s_add_u32 m0, s41, 62464
v_mfma_f32_32x32x16_bf16 v[80:95], v[188:191], v[44:47], v[80:95]
buffer_load_dwordx4 v2, s[8:11], s26 offen lds
s_add_u32 m0, s41, 63488
v_mfma_f32_32x32x16_bf16 v[96:111], v[192:195], v[40:43], v[96:111]
buffer_load_dwordx4 v3, s[8:11], s26 offen lds
v_mfma_f32_32x32x16_bf16 v[112:127], v[192:195], v[44:47], v[112:127]
s_add_u32 s26, s26, 20480
s_cmp_eq_u32 s26, 819200
s_cselect_b32 s26, 0, s26
v_add_u32 v168, 0x1000, v168
v_add_u32 v169, 0x1000, v169
s_cmp_lg_u32 s42, 0
s_cbranch_scc1 .b_loop_1099
s_cmp_lg_u32 s20, 7
s_cbranch_scc1 .pw_1100
s_mov_b32 s63, 0
s_mov_b32 s60, 0x0
s_mov_b32 s61, 0x7f000000
v_lshlrev_b32 v173, 2, v0
v_mov_b32 v172, 0
s_mov_b64 exec, s[60:61]
buffer_atomic_or v172, v173, s[56:59], 0 offen sc0 sc1
s_mov_b64 exec, -1
.pw_1100:
v_pk_mul_f32 v[48:49], v[64:65], v[64:65]
v_pk_mul_f32 v[50:51], v[66:67], v[66:67]
v_pk_mul_f32 v[52:53], v[68:69], v[68:69]
v_pk_mul_f32 v[54:55], v[70:71], v[70:71]
v_pk_mul_f32 v[56:57], v[72:73], v[72:73]
v_pk_mul_f32 v[58:59], v[74:75], v[74:75]
v_pk_mul_f32 v[60:61], v[76:77], v[76:77]
v_pk_mul_f32 v[62:63], v[78:79], v[78:79]
v_pk_fma_f32 v[48:49], v[48:49], v[164:165], v[164:165] op_sel:[0,1,0] op_sel_hi:[1,1,0]
v_pk_fma_f32 v[50:51], v[50:51], v[164:165], v[164:165] op_sel:[0,1,0] op_sel_hi:[1,1,0]
v_pk_fma_f32 v[52:53], v[52:53], v[164:165], v[164:165] op_sel:[0,1,0] op_sel_hi:[1,1,0]
v_pk_fma_f32 v[54:55], v[54:55], v[164:165], v[164:165] op_sel:[0,1,0] op_sel_hi:[1,1,0]
v_pk_fma_f32 v[56:57], v[56:57], v[164:165], v[164:165] op_sel:[0,1,0] op_sel_hi:[1,1,0]
v_pk_fma_f32 v[58:59], v[58:59], v[164:165], v[164:165] op_sel:[0,1,0] op_sel_hi:[1,1,0]
v_pk_fma_f32 v[60:61], v[60:61], v[164:165], v[164:165] op_sel:[0,1,0] op_sel_hi:[1,1,0]
v_pk_fma_f32 v[62:63], v[62:63], v[164:165], v[164:165] op_sel:[0,1,0] op_sel_hi:[1,1,0]
v_pk_mul_f32 v[48:49], v[48:49], v[64:65]
v_pk_mul_f32 v[50:51], v[50:51], v[66:67]
v_pk_mul_f32 v[52:53], v[52:53], v[68:69]
v_pk_mul_f32 v[54:55], v[54:55], v[70:71]
v_pk_mul_f32 v[56:57], v[56:57], v[72:73]
v_pk_mul_f32 v[58:59], v[58:59], v[74:75]
v_pk_mul_f32 v[60:61], v[60:61], v[76:77]
v_pk_mul_f32 v[62:63], v[62:63], v[78:79]
v_exp_f32 v48, v48
v_exp_f32 v49, v49
v_exp_f32 v50, v50
v_exp_f32 v51, v51
v_exp_f32 v52, v52
v_exp_f32 v53, v53
v_exp_f32 v54, v54
v_exp_f32 v55, v55
v_exp_f32 v56, v56
v_exp_f32 v57, v57
v_exp_f32 v58, v58
v_exp_f32 v59, v59
v_exp_f32 v60, v60
v_exp_f32 v61, v61
v_exp_f32 v62, v62
v_exp_f32 v63, v63
v_pk_add_f32 v[48:49], v[48:49], 1.0 op_sel_hi:[1,0]
v_pk_add_f32 v[50:51], v[50:51], 1.0 op_sel_hi:[1,0]
v_pk_add_f32 v[52:53], v[52:53], 1.0 op_sel_hi:[1,0]
v_pk_add_f32 v[54:55], v[54:55], 1.0 op_sel_hi:[1,0]
v_pk_add_f32 v[56:57], v[56:57], 1.0 op_sel_hi:[1,0]
v_pk_add_f32 v[58:59], v[58:59], 1.0 op_sel_hi:[1,0]
v_pk_add_f32 v[60:61], v[60:61], 1.0 op_sel_hi:[1,0]
v_pk_add_f32 v[62:63], v[62:63], 1.0 op_sel_hi:[1,0]
v_rcp_f32 v48, v48
v_rcp_f32 v49, v49
v_rcp_f32 v50, v50
v_rcp_f32 v51, v51
v_rcp_f32 v52, v52
v_rcp_f32 v53, v53
v_rcp_f32 v54, v54
v_rcp_f32 v55, v55
v_rcp_f32 v56, v56
v_rcp_f32 v57, v57
v_rcp_f32 v58, v58
v_rcp_f32 v59, v59
v_rcp_f32 v60, v60
v_rcp_f32 v61, v61
v_rcp_f32 v62, v62
v_rcp_f32 v63, v63
v_pk_mul_f32 v[48:49], v[48:49], v[64:65]
v_pk_mul_f32 v[50:51], v[50:51], v[66:67]
v_pk_mul_f32 v[52:53], v[52:53], v[68:69]
v_pk_mul_f32 v[54:55], v[54:55], v[70:71]
v_pk_mul_f32 v[56:57], v[56:57], v[72:73]
v_pk_mul_f32 v[58:59], v[58:59], v[74:75]
v_pk_mul_f32 v[60:61], v[60:61], v[76:77]
v_pk_mul_f32 v[62:63], v[62:63], v[78:79]
v_cvt_pk_bf16_f32 v64, v48, v49
v_cvt_pk_bf16_f32 v65, v50, v51
v_cvt_pk_bf16_f32 v66, v52, v53
v_cvt_pk_bf16_f32 v67, v54, v55
v_cvt_pk_bf16_f32 v68, v56, v57
v_cvt_pk_bf16_f32 v69, v58, v59
v_cvt_pk_bf16_f32 v70, v60, v61
v_cvt_pk_bf16_f32 v71, v62, v63
buffer_store_dwordx4 v[64:67], v4, s[32:35], s31 offen offset:0 sc1
buffer_store_dwordx4 v[68:71], v4, s[32:35], s31 offen offset:1024 sc1
v_pk_mul_f32 v[48:49], v[80:81], v[80:81]
v_pk_mul_f32 v[50:51], v[82:83], v[82:83]
v_pk_mul_f32 v[52:53], v[84:85], v[84:85]
v_pk_mul_f32 v[54:55], v[86:87], v[86:87]
v_pk_mul_f32 v[56:57], v[88:89], v[88:89]
v_pk_mul_f32 v[58:59], v[90:91], v[90:91]
v_pk_mul_f32 v[60:61], v[92:93], v[92:93]
v_pk_mul_f32 v[62:63], v[94:95], v[94:95]
v_pk_fma_f32 v[48:49], v[48:49], v[164:165], v[164:165] op_sel:[0,1,0] op_sel_hi:[1,1,0]
v_pk_fma_f32 v[50:51], v[50:51], v[164:165], v[164:165] op_sel:[0,1,0] op_sel_hi:[1,1,0]
v_pk_fma_f32 v[52:53], v[52:53], v[164:165], v[164:165] op_sel:[0,1,0] op_sel_hi:[1,1,0]
v_pk_fma_f32 v[54:55], v[54:55], v[164:165], v[164:165] op_sel:[0,1,0] op_sel_hi:[1,1,0]
v_pk_fma_f32 v[56:57], v[56:57], v[164:165], v[164:165] op_sel:[0,1,0] op_sel_hi:[1,1,0]
v_pk_fma_f32 v[58:59], v[58:59], v[164:165], v[164:165] op_sel:[0,1,0] op_sel_hi:[1,1,0]
v_pk_fma_f32 v[60:61], v[60:61], v[164:165], v[164:165] op_sel:[0,1,0] op_sel_hi:[1,1,0]
v_pk_fma_f32 v[62:63], v[62:63], v[164:165], v[164:165] op_sel:[0,1,0] op_sel_hi:[1,1,0]
v_pk_mul_f32 v[48:49], v[48:49], v[80:81]
v_pk_mul_f32 v[50:51], v[50:51], v[82:83]
v_pk_mul_f32 v[52:53], v[52:53], v[84:85]
v_pk_mul_f32 v[54:55], v[54:55], v[86:87]
v_pk_mul_f32 v[56:57], v[56:57], v[88:89]
v_pk_mul_f32 v[58:59], v[58:59], v[90:91]
v_pk_mul_f32 v[60:61], v[60:61], v[92:93]
v_pk_mul_f32 v[62:63], v[62:63], v[94:95]
v_exp_f32 v48, v48
v_exp_f32 v49, v49
v_exp_f32 v50, v50
v_exp_f32 v51, v51
v_exp_f32 v52, v52
v_exp_f32 v53, v53
v_exp_f32 v54, v54
v_exp_f32 v55, v55
v_exp_f32 v56, v56
v_exp_f32 v57, v57
v_exp_f32 v58, v58
v_exp_f32 v59, v59
v_exp_f32 v60, v60
v_exp_f32 v61, v61
v_exp_f32 v62, v62
v_exp_f32 v63, v63
v_pk_add_f32 v[48:49], v[48:49], 1.0 op_sel_hi:[1,0]
v_pk_add_f32 v[50:51], v[50:51], 1.0 op_sel_hi:[1,0]
v_pk_add_f32 v[52:53], v[52:53], 1.0 op_sel_hi:[1,0]
v_pk_add_f32 v[54:55], v[54:55], 1.0 op_sel_hi:[1,0]
v_pk_add_f32 v[56:57], v[56:57], 1.0 op_sel_hi:[1,0]
v_pk_add_f32 v[58:59], v[58:59], 1.0 op_sel_hi:[1,0]
v_pk_add_f32 v[60:61], v[60:61], 1.0 op_sel_hi:[1,0]
v_pk_add_f32 v[62:63], v[62:63], 1.0 op_sel_hi:[1,0]
v_rcp_f32 v48, v48
v_rcp_f32 v49, v49
v_rcp_f32 v50, v50
v_rcp_f32 v51, v51
v_rcp_f32 v52, v52
v_rcp_f32 v53, v53
v_rcp_f32 v54, v54
v_rcp_f32 v55, v55
v_rcp_f32 v56, v56
v_rcp_f32 v57, v57
v_rcp_f32 v58, v58
v_rcp_f32 v59, v59
v_rcp_f32 v60, v60
v_rcp_f32 v61, v61
v_rcp_f32 v62, v62
v_rcp_f32 v63, v63
v_pk_mul_f32 v[48:49], v[48:49], v[80:81]
v_pk_mul_f32 v[50:51], v[50:51], v[82:83]
v_pk_mul_f32 v[52:53], v[52:53], v[84:85]
v_pk_mul_f32 v[54:55], v[54:55], v[86:87]
v_pk_mul_f32 v[56:57], v[56:57], v[88:89]
v_pk_mul_f32 v[58:59], v[58:59], v[90:91]
v_pk_mul_f32 v[60:61], v[60:61], v[92:93]
v_pk_mul_f32 v[62:63], v[62:63], v[94:95]
v_cvt_pk_bf16_f32 v80, v48, v49
v_cvt_pk_bf16_f32 v81, v50, v51
v_cvt_pk_bf16_f32 v82, v52, v53
v_cvt_pk_bf16_f32 v83, v54, v55
v_cvt_pk_bf16_f32 v84, v56, v57
v_cvt_pk_bf16_f32 v85, v58, v59
v_cvt_pk_bf16_f32 v86, v60, v61
v_cvt_pk_bf16_f32 v87, v62, v63
buffer_store_dwordx4 v[80:83], v5, s[32:35], s31 offen offset:0 sc1
buffer_store_dwordx4 v[84:87], v5, s[32:35], s31 offen offset:1024 sc1
s_add_u32 s31, s31, 0x800
v_pk_mul_f32 v[48:49], v[96:97], v[96:97]
v_pk_mul_f32 v[50:51], v[98:99], v[98:99]
v_pk_mul_f32 v[52:53], v[100:101], v[100:101]
v_pk_mul_f32 v[54:55], v[102:103], v[102:103]
v_pk_mul_f32 v[56:57], v[104:105], v[104:105]
v_pk_mul_f32 v[58:59], v[106:107], v[106:107]
v_pk_mul_f32 v[60:61], v[108:109], v[108:109]
v_pk_mul_f32 v[62:63], v[110:111], v[110:111]
v_pk_fma_f32 v[48:49], v[48:49], v[164:165], v[164:165] op_sel:[0,1,0] op_sel_hi:[1,1,0]
v_pk_fma_f32 v[50:51], v[50:51], v[164:165], v[164:165] op_sel:[0,1,0] op_sel_hi:[1,1,0]
v_pk_fma_f32 v[52:53], v[52:53], v[164:165], v[164:165] op_sel:[0,1,0] op_sel_hi:[1,1,0]
v_pk_fma_f32 v[54:55], v[54:55], v[164:165], v[164:165] op_sel:[0,1,0] op_sel_hi:[1,1,0]
v_pk_fma_f32 v[56:57], v[56:57], v[164:165], v[164:165] op_sel:[0,1,0] op_sel_hi:[1,1,0]
v_pk_fma_f32 v[58:59], v[58:59], v[164:165], v[164:165] op_sel:[0,1,0] op_sel_hi:[1,1,0]
v_pk_fma_f32 v[60:61], v[60:61], v[164:165], v[164:165] op_sel:[0,1,0] op_sel_hi:[1,1,0]
v_pk_fma_f32 v[62:63], v[62:63], v[164:165], v[164:165] op_sel:[0,1,0] op_sel_hi:[1,1,0]
v_pk_mul_f32 v[48:49], v[48:49], v[96:97]
v_pk_mul_f32 v[50:51], v[50:51], v[98:99]
v_pk_mul_f32 v[52:53], v[52:53], v[100:101]
v_pk_mul_f32 v[54:55], v[54:55], v[102:103]
v_pk_mul_f32 v[56:57], v[56:57], v[104:105]
v_pk_mul_f32 v[58:59], v[58:59], v[106:107]
v_pk_mul_f32 v[60:61], v[60:61], v[108:109]
v_pk_mul_f32 v[62:63], v[62:63], v[110:111]
v_exp_f32 v48, v48
v_exp_f32 v49, v49
v_exp_f32 v50, v50
v_exp_f32 v51, v51
v_exp_f32 v52, v52
v_exp_f32 v53, v53
v_exp_f32 v54, v54
v_exp_f32 v55, v55
v_exp_f32 v56, v56
v_exp_f32 v57, v57
v_exp_f32 v58, v58
v_exp_f32 v59, v59
v_exp_f32 v60, v60
v_exp_f32 v61, v61
v_exp_f32 v62, v62
v_exp_f32 v63, v63
v_pk_add_f32 v[48:49], v[48:49], 1.0 op_sel_hi:[1,0]
v_pk_add_f32 v[50:51], v[50:51], 1.0 op_sel_hi:[1,0]
v_pk_add_f32 v[52:53], v[52:53], 1.0 op_sel_hi:[1,0]
v_pk_add_f32 v[54:55], v[54:55], 1.0 op_sel_hi:[1,0]
v_pk_add_f32 v[56:57], v[56:57], 1.0 op_sel_hi:[1,0]
v_pk_add_f32 v[58:59], v[58:59], 1.0 op_sel_hi:[1,0]
v_pk_add_f32 v[60:61], v[60:61], 1.0 op_sel_hi:[1,0]
v_pk_add_f32 v[62:63], v[62:63], 1.0 op_sel_hi:[1,0]
v_rcp_f32 v48, v48
v_rcp_f32 v49, v49
v_rcp_f32 v50, v50
v_rcp_f32 v51, v51
v_rcp_f32 v52, v52
v_rcp_f32 v53, v53
v_rcp_f32 v54, v54
v_rcp_f32 v55, v55
v_rcp_f32 v56, v56
v_rcp_f32 v57, v57
v_rcp_f32 v58, v58
v_rcp_f32 v59, v59
v_rcp_f32 v60, v60
v_rcp_f32 v61, v61
v_rcp_f32 v62, v62
v_rcp_f32 v63, v63
v_pk_mul_f32 v[48:49], v[48:49], v[96:97]
v_pk_mul_f32 v[50:51], v[50:51], v[98:99]
v_pk_mul_f32 v[52:53], v[52:53], v[100:101]
v_pk_mul_f32 v[54:55], v[54:55], v[102:103]
v_pk_mul_f32 v[56:57], v[56:57], v[104:105]
v_pk_mul_f32 v[58:59], v[58:59], v[106:107]
v_pk_mul_f32 v[60:61], v[60:61], v[108:109]
v_pk_mul_f32 v[62:63], v[62:63], v[110:111]
v_cvt_pk_bf16_f32 v96, v48, v49
v_cvt_pk_bf16_f32 v97, v50, v51
v_cvt_pk_bf16_f32 v98, v52, v53
v_cvt_pk_bf16_f32 v99, v54, v55
v_cvt_pk_bf16_f32 v100, v56, v57
v_cvt_pk_bf16_f32 v101, v58, v59
v_cvt_pk_bf16_f32 v102, v60, v61
v_cvt_pk_bf16_f32 v103, v62, v63
buffer_store_dwordx4 v[96:99], v4, s[32:35], s31 offen offset:0 sc1
buffer_store_dwordx4 v[100:103], v4, s[32:35], s31 offen offset:1024 sc1
v_pk_mul_f32 v[48:49], v[112:113], v[112:113]
v_pk_mul_f32 v[50:51], v[114:115], v[114:115]
v_pk_mul_f32 v[52:53], v[116:117], v[116:117]
v_pk_mul_f32 v[54:55], v[118:119], v[118:119]
v_pk_mul_f32 v[56:57], v[120:121], v[120:121]
v_pk_mul_f32 v[58:59], v[122:123], v[122:123]
v_pk_mul_f32 v[60:61], v[124:125], v[124:125]
v_pk_mul_f32 v[62:63], v[126:127], v[126:127]
v_pk_fma_f32 v[48:49], v[48:49], v[164:165], v[164:165] op_sel:[0,1,0] op_sel_hi:[1,1,0]
v_pk_fma_f32 v[50:51], v[50:51], v[164:165], v[164:165] op_sel:[0,1,0] op_sel_hi:[1,1,0]
v_pk_fma_f32 v[52:53], v[52:53], v[164:165], v[164:165] op_sel:[0,1,0] op_sel_hi:[1,1,0]
v_pk_fma_f32 v[54:55], v[54:55], v[164:165], v[164:165] op_sel:[0,1,0] op_sel_hi:[1,1,0]
v_pk_fma_f32 v[56:57], v[56:57], v[164:165], v[164:165] op_sel:[0,1,0] op_sel_hi:[1,1,0]
v_pk_fma_f32 v[58:59], v[58:59], v[164:165], v[164:165] op_sel:[0,1,0] op_sel_hi:[1,1,0]
v_pk_fma_f32 v[60:61], v[60:61], v[164:165], v[164:165] op_sel:[0,1,0] op_sel_hi:[1,1,0]
v_pk_fma_f32 v[62:63], v[62:63], v[164:165], v[164:165] op_sel:[0,1,0] op_sel_hi:[1,1,0]
v_pk_mul_f32 v[48:49], v[48:49], v[112:113]
v_pk_mul_f32 v[50:51], v[50:51], v[114:115]
v_pk_mul_f32 v[52:53], v[52:53], v[116:117]
v_pk_mul_f32 v[54:55], v[54:55], v[118:119]
v_pk_mul_f32 v[56:57], v[56:57], v[120:121]
v_pk_mul_f32 v[58:59], v[58:59], v[122:123]
v_pk_mul_f32 v[60:61], v[60:61], v[124:125]
v_pk_mul_f32 v[62:63], v[62:63], v[126:127]
v_exp_f32 v48, v48
v_exp_f32 v49, v49
v_exp_f32 v50, v50
v_exp_f32 v51, v51
v_exp_f32 v52, v52
v_exp_f32 v53, v53
v_exp_f32 v54, v54
v_exp_f32 v55, v55
v_exp_f32 v56, v56
v_exp_f32 v57, v57
v_exp_f32 v58, v58
v_exp_f32 v59, v59
v_exp_f32 v60, v60
v_exp_f32 v61, v61
v_exp_f32 v62, v62
v_exp_f32 v63, v63
v_pk_add_f32 v[48:49], v[48:49], 1.0 op_sel_hi:[1,0]
v_pk_add_f32 v[50:51], v[50:51], 1.0 op_sel_hi:[1,0]
v_pk_add_f32 v[52:53], v[52:53], 1.0 op_sel_hi:[1,0]
v_pk_add_f32 v[54:55], v[54:55], 1.0 op_sel_hi:[1,0]
v_pk_add_f32 v[56:57], v[56:57], 1.0 op_sel_hi:[1,0]
v_pk_add_f32 v[58:59], v[58:59], 1.0 op_sel_hi:[1,0]
v_pk_add_f32 v[60:61], v[60:61], 1.0 op_sel_hi:[1,0]
v_pk_add_f32 v[62:63], v[62:63], 1.0 op_sel_hi:[1,0]
v_rcp_f32 v48, v48
v_rcp_f32 v49, v49
v_rcp_f32 v50, v50
v_rcp_f32 v51, v51
v_rcp_f32 v52, v52
v_rcp_f32 v53, v53
v_rcp_f32 v54, v54
v_rcp_f32 v55, v55
v_rcp_f32 v56, v56
v_rcp_f32 v57, v57
v_rcp_f32 v58, v58
v_rcp_f32 v59, v59
v_rcp_f32 v60, v60
v_rcp_f32 v61, v61
v_rcp_f32 v62, v62
v_rcp_f32 v63, v63
v_pk_mul_f32 v[48:49], v[48:49], v[112:113]
v_pk_mul_f32 v[50:51], v[50:51], v[114:115]
v_pk_mul_f32 v[52:53], v[52:53], v[116:117]
v_pk_mul_f32 v[54:55], v[54:55], v[118:119]
v_pk_mul_f32 v[56:57], v[56:57], v[120:121]
v_pk_mul_f32 v[58:59], v[58:59], v[122:123]
v_pk_mul_f32 v[60:61], v[60:61], v[124:125]
v_pk_mul_f32 v[62:63], v[62:63], v[126:127]
v_cvt_pk_bf16_f32 v112, v48, v49
v_cvt_pk_bf16_f32 v113, v50, v51
v_cvt_pk_bf16_f32 v114, v52, v53
v_cvt_pk_bf16_f32 v115, v54, v55
v_cvt_pk_bf16_f32 v116, v56, v57
v_cvt_pk_bf16_f32 v117, v58, v59
v_cvt_pk_bf16_f32 v118, v60, v61
v_cvt_pk_bf16_f32 v119, v62, v63
buffer_store_dwordx4 v[112:115], v5, s[32:35], s31 offen offset:0 sc1
buffer_store_dwordx4 v[116:119], v5, s[32:35], s31 offen offset:1024 sc1
s_add_u32 s31, s31, 0x800
.b_end_1097:
s_waitcnt vmcnt(0) lgkmcnt(0)
s_cmp_lg_u32 s20, 7
s_cbranch_scc1 .pw_1101
v_or_b32 v172, s63, v172
v_cmp_ne_u32 vcc, -1, v172
s_and_b64 vcc, vcc, s[60:61]
s_cbranch_scc1 .pslow_1102
.pret_1103:
.pw_1101:
s_barrier
s_cmp_lg_u32 s20, 0
s_cbranch_scc1 .sig_1105
v_lshlrev_b32 v170, 12, v0
v_lshlrev_b32_e64 v171, s2, 1
buffer_atomic_or v171, v170, s[56:59], 0 offen offset:184 sc1
.sig_1105:
s_load_dwordx2 s[32:33], s[0:1], 104
v_lshlrev_b32 v1, 4, v0
s_sub_u32 s16, s2, 224
v_add_u32 v2, 40960, v1
s_lshr_b32 s17, s20, 1
s_lshr_b32 s18, s17, 1
s_add_u32 s18, s18, 1
s_sub_u32 s19, 0, s18
s_bitcmp1_b32 s17, 0
s_cselect_b32 s18, s18, s19
s_lshl_b32 s19, s16, 6
s_add_u32 s18, s18, s19
v_and_b32 v8, 31, v0
v_and_b32 v9, 32, v0
v_mov_b32 v12, 1073741824
v_add_u32 v10, s18, v8
v_lshrrev_b32 v11, 5, v10
v_mul_u32_u24 v11, 0xa000, v11
v_and_b32 v3, 31, v10
v_or_b32 v3, v3, v9
v_lshl_add_u32 v3, v3, 4, v11
v_cmp_gt_u32 vcc, 0x800, v10
s_nop 1
v_cndmask_b32 v3, v12, v3, vcc
v_add_u32 v10, s18, v8
v_add_u32 v10, 32, v10
v_lshrrev_b32 v11, 5, v10
v_mul_u32_u24 v11, 0xa000, v11
v_and_b32 v4, 31, v10
v_or_b32 v4, v4, v9
v_lshl_add_u32 v4, v4, 4, v11
v_cmp_gt_u32 vcc, 0x800, v10
s_nop 1
v_cndmask_b32 v4, v12, v4, vcc
v_lshlrev_b32 v6, 6, v0
v_add_u32 v6, 81920, v6
s_lshl_b32 s17, s20, 3
v_add_u32 v5, s17, v6
s_mul_i32 s17, s20, 3
s_lshl_b32 s18, s20, 1
s_add_u32 s18, s18, 4
s_cmp_lt_u32 s20, 4
s_cselect_b32 s17, s17, s18
s_lshl_b32 s21, s17, 10
s_add_u32 s21, s21, 77971456
s_mul_i32 s22, s20, 7168
s_add_u32 s22, s22, 78790656
s_mul_i32 s23, s16, 81920
s_lshl_b32 s18, s17, 11
s_add_u32 s23, s23, s18
s_mul_i32 s24, s20, 5120
s_lshr_b32 s42, s16, 3
s_mul_i32 s43, s42, 10240
s_sub_u32 s44, s24, s43
s_cselect_b32 s45, 40960, 0
s_add_u32 s44, s44, s45
s_add_u32 s46, s21, 819200
s_add_u32 s47, s22, 2211840
s_mul_i32 s45, s42, 204800
s_add_u32 s21, s21, s45
s_mul_i32 s45, s42, 552960
s_add_u32 s22, s22, s45
s_waitcnt lgkmcnt(0)
s_add_u32 s4, s32, 2621440
s_addc_u32 s5, s33, 0
s_mov_b32 s6, 2621440
s_mov_b32 s7, 0x00020000
s_add_u32 s8, s32, 0
s_addc_u32 s9, s33, 0
s_mov_b32 s10, 81002496
s_mov_b32 s11, 0x00020000
s_add_u32 s12, s32, 0
s_addc_u32 s13, s33, 0
s_mov_b32 s14, 2621440
s_mov_b32 s15, 0x00020000
s_add_u32 s28, s32, 5242880
s_addc_u32 s29, s33, 0
s_mov_b32 s30, 2621440
s_mov_b32 s31, 0x00020000
s_add_u32 s36, s32, 7864320
s_addc_u32 s37, s33, 0
s_mov_b32 s38, 7077888
s_mov_b32 s39, 0x00020000
s_add_u32 s25, s24, 0x1000
s_cmp_ge_u32 s20, 4
s_cbranch_scc1 .b2_two_1106
s_add_u32 s26, s23, 0x1000
buffer_load_dwordx4 v[208:211], v1, s[12:15], s23 offen offset:0
buffer_load_dwordx4 v[212:215], v1, s[12:15], s23 offen offset:1024
buffer_load_dwordx4 v[216:219], v1, s[12:15], s23 offen offset:2048
buffer_load_dwordx4 v[220:223], v1, s[12:15], s23 offen offset:3072
buffer_load_dwordx4 v[224:227], v1, s[12:15], s26 offen offset:0
buffer_load_dwordx4 v[228:231], v1, s[12:15], s26 offen offset:1024
buffer_load_dwordx4 v[232:235], v2, s[12:15], s23 offen offset:0
buffer_load_dwordx4 v[236:239], v2, s[12:15], s23 offen offset:1024
buffer_load_dwordx4 v[240:243], v2, s[12:15], s23 offen offset:2048
buffer_load_dwordx4 v[244:247], v2, s[12:15], s23 offen offset:3072
buffer_load_dwordx4 v[248:251], v2, s[12:15], s26 offen offset:0
buffer_load_dwordx4 v[252:255], v2, s[12:15], s26 offen offset:1024
buffer_load_dwordx4 v[32:35], v1, s[8:11], s21 offen offset:0
buffer_load_dwordx4 v[36:39], v1, s[8:11], s21 offen offset:1024
buffer_load_dwordx4 v[40:43], v1, s[8:11], s21 offen offset:2048
s_add_u32 s21, s21, 20480
buffer_load_dwordx4 v[44:47], v1, s[8:11], s21 offen offset:0
buffer_load_dwordx4 v[48:51], v1, s[8:11], s21 offen offset:1024
buffer_load_dwordx4 v[52:55], v1, s[8:11], s21 offen offset:2048
s_add_u32 s21, s21, 20480
buffer_load_dwordx4 v[56:59], v1, s[8:11], s21 offen offset:0
buffer_load_dwordx4 v[60:63], v1, s[8:11], s21 offen offset:1024
buffer_load_dwordx4 v[64:67], v1, s[8:11], s21 offen offset:2048
s_add_u32 s21, s21, 20480
buffer_load_dwordx4 v[68:71], v1, s[8:11], s21 offen offset:0
buffer_load_dwordx4 v[72:75], v1, s[8:11], s21 offen offset:1024
buffer_load_dwordx4 v[76:79], v1, s[8:11], s21 offen offset:2048
s_add_u32 s21, s21, 20480
buffer_load_dwordx4 v[80:83], v1, s[8:11], s21 offen offset:0
buffer_load_dwordx4 v[84:87], v1, s[8:11], s21 offen offset:1024
buffer_load_dwordx4 v[88:91], v1, s[8:11], s21 offen offset:2048
s_add_u32 s21, s21, 20480
buffer_load_dwordx4 v[92:95], v1, s[8:11], s21 offen offset:0
buffer_load_dwordx4 v[96:99], v1, s[8:11], s21 offen offset:1024
buffer_load_dwordx4 v[100:103], v1, s[8:11], s21 offen offset:2048
s_add_u32 s21, s21, 20480
buffer_load_dwordx4 v[104:107], v1, s[8:11], s21 offen offset:0
buffer_load_dwordx4 v[108:111], v1, s[8:11], s21 offen offset:1024
s_barrier
s_add_u32 m0, s44, 0
s_nop 0
buffer_load_dwordx4 v3, s[4:7], s24 offen offset:0 lds
buffer_load_dwordx4 v3, s[4:7], s24 offen offset:1024 lds
buffer_load_dwordx4 v3, s[4:7], s24 offen offset:2048 lds
buffer_load_dwordx4 v3, s[4:7], s24 offen offset:3072 lds
s_add_u32 m0, s44, 4096
s_nop 0
buffer_load_dwordx4 v3, s[4:7], s25 offen lds
s_add_u32 m0, s44, 40960
s_nop 0
buffer_load_dwordx4 v4, s[4:7], s24 offen offset:0 lds
buffer_load_dwordx4 v4, s[4:7], s24 offen offset:1024 lds
buffer_load_dwordx4 v4, s[4:7], s24 offen offset:2048 lds
buffer_load_dwordx4 v4, s[4:7], s24 offen offset:3072 lds
s_add_u32 m0, s44, 45056
s_nop 0
buffer_load_dwordx4 v4, s[4:7], s25 offen lds
s_waitcnt vmcnt(30)
v_lshlrev_b32 v112, 16, v208
v_and_b32 v113, 0xffff0000, v208
v_lshlrev_b32 v114, 16, v209
v_and_b32 v115, 0xffff0000, v209
v_lshlrev_b32 v116, 16, v210
v_and_b32 v117, 0xffff0000, v210
v_lshlrev_b32 v118, 16, v211
v_and_b32 v119, 0xffff0000, v211
v_lshlrev_b32 v120, 16, v212
v_and_b32 v121, 0xffff0000, v212
v_lshlrev_b32 v122, 16, v213
v_and_b32 v123, 0xffff0000, v213
v_lshlrev_b32 v124, 16, v214
v_and_b32 v125, 0xffff0000, v214
v_lshlrev_b32 v126, 16, v215
v_and_b32 v127, 0xffff0000, v215
v_lshlrev_b32 v144, 16, v216
v_and_b32 v145, 0xffff0000, v216
v_lshlrev_b32 v146, 16, v217
v_and_b32 v147, 0xffff0000, v217
v_lshlrev_b32 v148, 16, v218
v_and_b32 v149, 0xffff0000, v218
v_lshlrev_b32 v150, 16, v219
v_and_b32 v151, 0xffff0000, v219
v_lshlrev_b32 v152, 16, v220
v_and_b32 v153, 0xffff0000, v220
v_lshlrev_b32 v154, 16, v221
v_and_b32 v155, 0xffff0000, v221
v_lshlrev_b32 v156, 16, v222
v_and_b32 v157, 0xffff0000, v222
v_lshlrev_b32 v158, 16, v223
v_and_b32 v159, 0xffff0000, v223
v_lshlrev_b32 v176, 16, v224
v_and_b32 v177, 0xffff0000, v224
v_lshlrev_b32 v178, 16, v225
v_and_b32 v179, 0xffff0000, v225
v_lshlrev_b32 v180, 16, v226
v_and_b32 v181, 0xffff0000, v226
v_lshlrev_b32 v182, 16, v227
v_and_b32 v183, 0xffff0000, v227
v_lshlrev_b32 v184, 16, v228
v_and_b32 v185, 0xffff0000, v228
v_lshlrev_b32 v186, 16, v229
v_and_b32 v187, 0xffff0000, v229
v_lshlrev_b32 v188, 16, v230
v_and_b32 v189, 0xffff0000, v230
v_lshlrev_b32 v190, 16, v231
v_and_b32 v191, 0xffff0000, v231
v_lshlrev_b32 v128, 16, v232
v_and_b32 v129, 0xffff0000, v232
v_lshlrev_b32 v130, 16, v233
v_and_b32 v131, 0xffff0000, v233
v_lshlrev_b32 v132, 16, v234
v_and_b32 v133, 0xffff0000, v234
v_lshlrev_b32 v134, 16, v235
v_and_b32 v135, 0xffff0000, v235
v_lshlrev_b32 v136, 16, v236
v_and_b32 v137, 0xffff0000, v236
v_lshlrev_b32 v138, 16, v237
v_and_b32 v139, 0xffff0000, v237
v_lshlrev_b32 v140, 16, v238
v_and_b32 v141, 0xffff0000, v238
v_lshlrev_b32 v142, 16, v239
v_and_b32 v143, 0xffff0000, v239
v_lshlrev_b32 v160, 16, v240
v_and_b32 v161, 0xffff0000, v240
v_lshlrev_b32 v162, 16, v241
v_and_b32 v163, 0xffff0000, v241
v_lshlrev_b32 v164, 16, v242
v_and_b32 v165, 0xffff0000, v242
v_lshlrev_b32 v166, 16, v243
v_and_b32 v167, 0xffff0000, v243
v_lshlrev_b32 v168, 16, v244
v_and_b32 v169, 0xffff0000, v244
v_lshlrev_b32 v170, 16, v245
v_and_b32 v171, 0xffff0000, v245
v_lshlrev_b32 v172, 16, v246
v_and_b32 v173, 0xffff0000, v246
v_lshlrev_b32 v174, 16, v247
v_and_b32 v175, 0xffff0000, v247
v_lshlrev_b32 v192, 16, v248
v_and_b32 v193, 0xffff0000, v248
v_lshlrev_b32 v194, 16, v249
v_and_b32 v195, 0xffff0000, v249
v_lshlrev_b32 v196, 16, v250
v_and_b32 v197, 0xffff0000, v250
v_lshlrev_b32 v198, 16, v251
v_and_b32 v199, 0xffff0000, v251
v_lshlrev_b32 v200, 16, v252
v_and_b32 v201, 0xffff0000, v252
v_lshlrev_b32 v202, 16, v253
v_and_b32 v203, 0xffff0000, v253
v_lshlrev_b32 v204, 16, v254
v_and_b32 v205, 0xffff0000, v254
v_lshlrev_b32 v206, 16, v255
v_and_b32 v207, 0xffff0000, v255
s_waitcnt vmcnt(0)
s_barrier
ds_read_b128 v[16:19], v1
ds_read_b128 v[20:23], v2
s_waitcnt lgkmcnt(0)
v_mfma_f32_32x32x16_bf16 v[112:127], v[32:35], v[16:19], v[112:127]
ds_read_b128 v[24:27], v1 offset:1024
v_mfma_f32_32x32x16_bf16 v[128:143], v[32:35], v[20:23], v[128:143]
ds_read_b128 v[28:31], v2 offset:1024
buffer_load_dwordx4 v[32:35], v1, s[8:11], s21 offen offset:2048
s_add_u32 s21, s21, 20480
v_mfma_f32_32x32x16_bf16 v[144:159], v[36:39], v[16:19], v[144:159]
v_mfma_f32_32x32x16_bf16 v[160:175], v[36:39], v[20:23], v[160:175]
buffer_load_dwordx4 v[36:39], v1, s[8:11], s21 offen offset:0
v_mfma_f32_32x32x16_bf16 v[176:191], v[40:43], v[16:19], v[176:191]
v_mfma_f32_32x32x16_bf16 v[192:207], v[40:43], v[20:23], v[192:207]
buffer_load_dwordx4 v[40:43], v1, s[8:11], s21 offen offset:1024
s_waitcnt lgkmcnt(0)
v_mfma_f32_32x32x16_bf16 v[112:127], v[44:47], v[24:27], v[112:127]
ds_read_b128 v[16:19], v1 offset:2048
v_mfma_f32_32x32x16_bf16 v[128:143], v[44:47], v[28:31], v[128:143]
ds_read_b128 v[20:23], v2 offset:2048
buffer_load_dwordx4 v[44:47], v1, s[8:11], s21 offen offset:2048
s_add_u32 s21, s21, 20480
v_mfma_f32_32x32x16_bf16 v[144:159], v[48:51], v[24:27], v[144:159]
v_mfma_f32_32x32x16_bf16 v[160:175], v[48:51], v[28:31], v[160:175]
buffer_load_dwordx4 v[48:51], v1, s[8:11], s21 offen offset:0
v_mfma_f32_32x32x16_bf16 v[176:191], v[52:55], v[24:27], v[176:191]
v_mfma_f32_32x32x16_bf16 v[192:207], v[52:55], v[28:31], v[192:207]
buffer_load_dwordx4 v[52:55], v1, s[8:11], s21 offen offset:1024
s_waitcnt lgkmcnt(0)
v_mfma_f32_32x32x16_bf16 v[112:127], v[56:59], v[16:19], v[112:127]
ds_read_b128 v[24:27], v1 offset:3072
v_mfma_f32_32x32x16_bf16 v[128:143], v[56:59], v[20:23], v[128:143]
ds_read_b128 v[28:31], v2 offset:3072
buffer_load_dwordx4 v[56:59], v1, s[8:11], s21 offen offset:2048
s_add_u32 s21, s21, 20480
v_mfma_f32_32x32x16_bf16 v[144:159], v[60:63], v[16:19], v[144:159]
v_mfma_f32_32x32x16_bf16 v[160:175], v[60:63], v[20:23], v[160:175]
buffer_load_dwordx4 v[60:63], v1, s[8:11], s21 offen offset:0
v_mfma_f32_32x32x16_bf16 v[176:191], v[64:67], v[16:19], v[176:191]
v_mfma_f32_32x32x16_bf16 v[192:207], v[64:67], v[20:23], v[192:207]
buffer_load_dwordx4 v[64:67], v1, s[8:11], s21 offen offset:1024
s_waitcnt lgkmcnt(0)
v_mfma_f32_32x32x16_bf16 v[112:127], v[68:71], v[24:27], v[112:127]
ds_read_b128 v[16:19], v1 offset:4096
v_mfma_f32_32x32x16_bf16 v[128:143], v[68:71], v[28:31], v[128:143]
ds_read_b128 v[20:23], v2 offset:4096
buffer_load_dwordx4 v[68:71], v1, s[8:11], s21 offen offset:2048
s_add_u32 s21, s21, 20480
s_cmp_ge_u32 s21, s46
s_cselect_b32 s45, 819200, 0
s_sub_u32 s21, s21, s45
v_mfma_f32_32x32x16_bf16 v[144:159], v[72:75], v[24:27], v[144:159]
v_mfma_f32_32x32x16_bf16 v[160:175], v[72:75], v[28:31], v[160:175]
buffer_load_dwordx4 v[72:75], v1, s[8:11], s21 offen offset:0
v_mfma_f32_32x32x16_bf16 v[176:191], v[76:79], v[24:27], v[176:191]
v_mfma_f32_32x32x16_bf16 v[192:207], v[76:79], v[28:31], v[192:207]
buffer_load_dwordx4 v[76:79], v1, s[8:11], s21 offen offset:1024
s_waitcnt lgkmcnt(0)
v_mfma_f32_32x32x16_bf16 v[112:127], v[80:83], v[16:19], v[112:127]
ds_read_b128 v[24:27], v1 offset:5120
v_mfma_f32_32x32x16_bf16 v[128:143], v[80:83], v[20:23], v[128:143]
ds_read_b128 v[28:31], v2 offset:5120
buffer_load_dwordx4 v[80:83], v1, s[8:11], s21 offen offset:2048
s_add_u32 s21, s21, 20480
v_mfma_f32_32x32x16_bf16 v[144:159], v[84:87], v[16:19], v[144:159]
v_mfma_f32_32x32x16_bf16 v[160:175], v[84:87], v[20:23], v[160:175]
buffer_load_dwordx4 v[84:87], v1, s[8:11], s21 offen offset:0
v_mfma_f32_32x32x16_bf16 v[176:191], v[88:91], v[16:19], v[176:191]
v_mfma_f32_32x32x16_bf16 v[192:207], v[88:91], v[20:23], v[192:207]
buffer_load_dwordx4 v[88:91], v1, s[8:11], s21 offen offset:1024
s_waitcnt lgkmcnt(0)
v_mfma_f32_32x32x16_bf16 v[112:127], v[92:95], v[24:27], v[112:127]
ds_read_b128 v[16:19], v1 offset:6144
v_mfma_f32_32x32x16_bf16 v[128:143], v[92:95], v[28:31], v[128:143]
ds_read_b128 v[20:23], v2 offset:6144
buffer_load_dwordx4 v[92:95], v1, s[8:11], s21 offen offset:2048
s_add_u32 s21, s21, 20480
v_mfma_f32_32x32x16_bf16 v[144:159], v[96:99], v[24:27], v[144:159]
v_mfma_f32_32x32x16_bf16 v[160:175], v[96:99], v[28:31], v[160:175]
buffer_load_dwordx4 v[96:99], v1, s[8:11], s21 offen offset:0
v_mfma_f32_32x32x16_bf16 v[176:191], v[100:103], v[24:27], v[176:191]
v_mfma_f32_32x32x16_bf16 v[192:207], v[100:103], v[28:31], v[192:207]
buffer_load_dwordx4 v[100:103], v1, s[8:11], s21 offen offset:1024
s_waitcnt lgkmcnt(0)
v_mfma_f32_32x32x16_bf16 v[112:127], v[104:107], v[16:19], v[112:127]
ds_read_b128 v[24:27], v1 offset:7168
v_mfma_f32_32x32x16_bf16 v[128:143], v[104:107], v[20:23], v[128:143]
ds_read_b128 v[28:31], v2 offset:7168
buffer_load_dwordx4 v[104:107], v1, s[8:11], s21 offen offset:2048
s_add_u32 s21, s21, 20480
v_mfma_f32_32x32x16_bf16 v[144:159], v[108:111], v[16:19], v[144:159]
v_mfma_f32_32x32x16_bf16 v[160:175], v[108:111], v[20:23], v[160:175]
buffer_load_dwordx4 v[108:111], v1, s[8:11], s21 offen offset:0
s_waitcnt vmcnt(19)
v_mfma_f32_32x32x16_bf16 v[176:191], v[32:35], v[16:19], v[176:191]
v_mfma_f32_32x32x16_bf16 v[192:207], v[32:35], v[20:23], v[192:207]
buffer_load_dwordx4 v[32:35], v1, s[8:11], s21 offen offset:1024
s_waitcnt vmcnt(19)
s_waitcnt lgkmcnt(0)
v_mfma_f32_32x32x16_bf16 v[112:127], v[36:39], v[24:27], v[112:127]
ds_read_b128 v[16:19], v1 offset:8192
v_mfma_f32_32x32x16_bf16 v[128:143], v[36:39], v[28:31], v[128:143]
ds_read_b128 v[20:23], v2 offset:8192
buffer_load_dwordx4 v[36:39], v1, s[8:11], s21 offen offset:2048
s_add_u32 s21, s21, 20480
s_waitcnt vmcnt(19)
v_mfma_f32_32x32x16_bf16 v[144:159], v[40:43], v[24:27], v[144:159]
v_mfma_f32_32x32x16_bf16 v[160:175], v[40:43], v[28:31], v[160:175]
buffer_load_dwordx4 v[40:43], v1, s[8:11], s21 offen offset:0
s_waitcnt vmcnt(19)
v_mfma_f32_32x32x16_bf16 v[176:191], v[44:47], v[24:27], v[176:191]
v_mfma_f32_32x32x16_bf16 v[192:207], v[44:47], v[28:31], v[192:207]
buffer_load_dwordx4 v[44:47], v1, s[8:11], s21 offen offset:1024
s_waitcnt vmcnt(19)
s_waitcnt lgkmcnt(0)
v_mfma_f32_32x32x16_bf16 v[112:127], v[48:51], v[16:19], v[112:127]
ds_read_b128 v[24:27], v1 offset:9216
v_mfma_f32_32x32x16_bf16 v[128:143], v[48:51], v[20:23], v[128:143]
ds_read_b128 v[28:31], v2 offset:9216
buffer_load_dwordx4 v[48:51], v1, s[8:11], s21 offen offset:2048
s_add_u32 s21, s21, 20480
s_waitcnt vmcnt(19)
v_mfma_f32_32x32x16_bf16 v[144:159], v[52:55], v[16:19], v[144:159]
v_mfma_f32_32x32x16_bf16 v[160:175], v[52:55], v[20:23], v[160:175]
buffer_load_dwordx4 v[52:55], v1, s[8:11], s21 offen offset:0
s_waitcnt vmcnt(19)
v_mfma_f32_32x32x16_bf16 v[176:191], v[56:59], v[16:19], v[176:191]
v_mfma_f32_32x32x16_bf16 v[192:207], v[56:59], v[20:23], v[192:207]
buffer_load_dwordx4 v[56:59], v1, s[8:11], s21 offen offset:1024
s_waitcnt vmcnt(19)
s_waitcnt lgkmcnt(0)
v_mfma_f32_32x32x16_bf16 v[112:127], v[60:63], v[24:27], v[112:127]
ds_read_b128 v[16:19], v1 offset:10240
v_mfma_f32_32x32x16_bf16 v[128:143], v[60:63], v[28:31], v[128:143]
ds_read_b128 v[20:23], v2 offset:10240
buffer_load_dwordx4 v[60:63], v1, s[8:11], s21 offen offset:2048
s_add_u32 s21, s21, 20480
s_waitcnt vmcnt(19)
v_mfma_f32_32x32x16_bf16 v[144:159], v[64:67], v[24:27], v[144:159]
v_mfma_f32_32x32x16_bf16 v[160:175], v[64:67], v[28:31], v[160:175]
buffer_load_dwordx4 v[64:67], v1, s[8:11], s21 offen offset:0
s_waitcnt vmcnt(19)
v_mfma_f32_32x32x16_bf16 v[176:191], v[68:71], v[24:27], v[176:191]
v_mfma_f32_32x32x16_bf16 v[192:207], v[68:71], v[28:31], v[192:207]
buffer_load_dwordx4 v[68:71], v1, s[8:11], s21 offen offset:1024
s_waitcnt vmcnt(19)
s_waitcnt lgkmcnt(0)
v_mfma_f32_32x32x16_bf16 v[112:127], v[72:75], v[16:19], v[112:127]
ds_read_b128 v[24:27], v1 offset:11264
v_mfma_f32_32x32x16_bf16 v[128:143], v[72:75], v[20:23], v[128:143]
ds_read_b128 v[28:31], v2 offset:11264
buffer_load_dwordx4 v[72:75], v1, s[8:11], s21 offen offset:2048
s_add_u32 s21, s21, 20480
s_waitcnt vmcnt(19)
v_mfma_f32_32x32x16_bf16 v[144:159], v[76:79], v[16:19], v[144:159]
v_mfma_f32_32x32x16_bf16 v[160:175], v[76:79], v[20:23], v[160:175]
buffer_load_dwordx4 v[76:79], v1, s[8:11], s21 offen offset:0
s_waitcnt vmcnt(19)
v_mfma_f32_32x32x16_bf16 v[176:191], v[80:83], v[16:19], v[176:191]
v_mfma_f32_32x32x16_bf16 v[192:207], v[80:83], v[20:23], v[192:207]
buffer_load_dwordx4 v[80:83], v1, s[8:11], s21 offen offset:1024
s_waitcnt vmcnt(19)
s_waitcnt lgkmcnt(0)
v_mfma_f32_32x32x16_bf16 v[112:127], v[84:87], v[24:27], v[112:127]
ds_read_b128 v[16:19], v1 offset:12288
v_mfma_f32_32x32x16_bf16 v[128:143], v[84:87], v[28:31], v[128:143]
ds_read_b128 v[20:23], v2 offset:12288
buffer_load_dwordx4 v[84:87], v1, s[8:11], s21 offen offset:2048
s_add_u32 s21, s21, 20480
s_waitcnt vmcnt(19)
v_mfma_f32_32x32x16_bf16 v[144:159], v[88:91], v[24:27], v[144:159]
v_mfma_f32_32x32x16_bf16 v[160:175], v[88:91], v[28:31], v[160:175]
buffer_load_dwordx4 v[88:91], v1, s[8:11], s21 offen offset:0
s_waitcnt vmcnt(19)
v_mfma_f32_32x32x16_bf16 v[176:191], v[92:95], v[24:27], v[176:191]
v_mfma_f32_32x32x16_bf16 v[192:207], v[92:95], v[28:31], v[192:207]
buffer_load_dwordx4 v[92:95], v1, s[8:11], s21 offen offset:1024
s_waitcnt vmcnt(19)
s_waitcnt lgkmcnt(0)
v_mfma_f32_32x32x16_bf16 v[112:127], v[96:99], v[16:19], v[112:127]
ds_read_b128 v[24:27], v1 offset:13312
v_mfma_f32_32x32x16_bf16 v[128:143], v[96:99], v[20:23], v[128:143]
ds_read_b128 v[28:31], v2 offset:13312
buffer_load_dwordx4 v[96:99], v1, s[8:11], s21 offen offset:2048
s_add_u32 s21, s21, 20480
s_waitcnt vmcnt(19)
v_mfma_f32_32x32x16_bf16 v[144:159], v[100:103], v[16:19], v[144:159]
v_mfma_f32_32x32x16_bf16 v[160:175], v[100:103], v[20:23], v[160:175]
buffer_load_dwordx4 v[100:103], v1, s[8:11], s21 offen offset:0
s_waitcnt vmcnt(19)
v_mfma_f32_32x32x16_bf16 v[176:191], v[104:107], v[16:19], v[176:191]
v_mfma_f32_32x32x16_bf16 v[192:207], v[104:107], v[20:23], v[192:207]
buffer_load_dwordx4 v[104:107], v1, s[8:11], s21 offen offset:1024
s_waitcnt vmcnt(19)
s_waitcnt lgkmcnt(0)
v_mfma_f32_32x32x16_bf16 v[112:127], v[108:111], v[24:27], v[112:127]
ds_read_b128 v[16:19], v1 offset:14336
v_mfma_f32_32x32x16_bf16 v[128:143], v[108:111], v[28:31], v[128:143]
ds_read_b128 v[20:23], v2 offset:14336
buffer_load_dwordx4 v[108:111], v1, s[8:11], s21 offen offset:2048
s_add_u32 s21, s21, 20480
s_cmp_ge_u32 s21, s46
s_cselect_b32 s45, 819200, 0
s_sub_u32 s21, s21, s45
s_waitcnt vmcnt(19)
v_mfma_f32_32x32x16_bf16 v[144:159], v[32:35], v[24:27], v[144:159]
v_mfma_f32_32x32x16_bf16 v[160:175], v[32:35], v[28:31], v[160:175]
buffer_load_dwordx4 v[32:35], v1, s[8:11], s21 offen offset:0
s_waitcnt vmcnt(19)
v_mfma_f32_32x32x16_bf16 v[176:191], v[36:39], v[24:27], v[176:191]
v_mfma_f32_32x32x16_bf16 v[192:207], v[36:39], v[28:31], v[192:207]
buffer_load_dwordx4 v[36:39], v1, s[8:11], s21 offen offset:1024
s_waitcnt vmcnt(19)
s_waitcnt lgkmcnt(0)
v_mfma_f32_32x32x16_bf16 v[112:127], v[40:43], v[16:19], v[112:127]
ds_read_b128 v[24:27], v1 offset:15360
v_mfma_f32_32x32x16_bf16 v[128:143], v[40:43], v[20:23], v[128:143]
ds_read_b128 v[28:31], v2 offset:15360
buffer_load_dwordx4 v[40:43], v1, s[8:11], s21 offen offset:2048
s_add_u32 s21, s21, 20480
s_waitcnt vmcnt(19)
v_mfma_f32_32x32x16_bf16 v[144:159], v[44:47], v[16:19], v[144:159]
v_mfma_f32_32x32x16_bf16 v[160:175], v[44:47], v[20:23], v[160:175]
buffer_load_dwordx4 v[44:47], v1, s[8:11], s21 offen offset:0
s_waitcnt vmcnt(19)
v_mfma_f32_32x32x16_bf16 v[176:191], v[48:51], v[16:19], v[176:191]
v_mfma_f32_32x32x16_bf16 v[192:207], v[48:51], v[20:23], v[192:207]
buffer_load_dwordx4 v[48:51], v1, s[8:11], s21 offen offset:1024
s_waitcnt vmcnt(19)
s_waitcnt lgkmcnt(0)
v_mfma_f32_32x32x16_bf16 v[112:127], v[52:55], v[24:27], v[112:127]
ds_read_b128 v[16:19], v1 offset:16384
v_mfma_f32_32x32x16_bf16 v[128:143], v[52:55], v[28:31], v[128:143]
ds_read_b128 v[20:23], v2 offset:16384
buffer_load_dwordx4 v[52:55], v1, s[8:11], s21 offen offset:2048
s_add_u32 s21, s21, 20480
s_waitcnt vmcnt(19)
v_mfma_f32_32x32x16_bf16 v[144:159], v[56:59], v[24:27], v[144:159]
v_mfma_f32_32x32x16_bf16 v[160:175], v[56:59], v[28:31], v[160:175]
buffer_load_dwordx4 v[56:59], v1, s[8:11], s21 offen offset:0
s_waitcnt vmcnt(19)
v_mfma_f32_32x32x16_bf16 v[176:191], v[60:63], v[24:27], v[176:191]
v_mfma_f32_32x32x16_bf16 v[192:207], v[60:63], v[28:31], v[192:207]
buffer_load_dwordx4 v[60:63], v1, s[8:11], s21 offen offset:1024
s_waitcnt vmcnt(19)
s_waitcnt lgkmcnt(0)
v_mfma_f32_32x32x16_bf16 v[112:127], v[64:67], v[16:19], v[112:127]
ds_read_b128 v[24:27], v1 offset:17408
v_mfma_f32_32x32x16_bf16 v[128:143], v[64:67], v[20:23], v[128:143]
ds_read_b128 v[28:31], v2 offset:17408
buffer_load_dwordx4 v[64:67], v1, s[8:11], s21 offen offset:2048
s_add_u32 s21, s21, 20480
s_waitcnt vmcnt(19)
v_mfma_f32_32x32x16_bf16 v[144:159], v[68:71], v[16:19], v[144:159]
v_mfma_f32_32x32x16_bf16 v[160:175], v[68:71], v[20:23], v[160:175]
buffer_load_dwordx4 v[68:71], v1, s[8:11], s21 offen offset:0
s_waitcnt vmcnt(19)
v_mfma_f32_32x32x16_bf16 v[176:191], v[72:75], v[16:19], v[176:191]
v_mfma_f32_32x32x16_bf16 v[192:207], v[72:75], v[20:23], v[192:207]
buffer_load_dwordx4 v[72:75], v1, s[8:11], s21 offen offset:1024
s_waitcnt vmcnt(19)
s_waitcnt lgkmcnt(0)
v_mfma_f32_32x32x16_bf16 v[112:127], v[76:79], v[24:27], v[112:127]
ds_read_b128 v[16:19], v1 offset:18432
v_mfma_f32_32x32x16_bf16 v[128:143], v[76:79], v[28:31], v[128:143]
ds_read_b128 v[20:23], v2 offset:18432
buffer_load_dwordx4 v[76:79], v1, s[8:11], s21 offen offset:2048
s_add_u32 s21, s21, 20480
s_waitcnt vmcnt(19)
v_mfma_f32_32x32x16_bf16 v[144:159], v[80:83], v[24:27], v[144:159]
v_mfma_f32_32x32x16_bf16 v[160:175], v[80:83], v[28:31], v[160:175]
buffer_load_dwordx4 v[80:83], v1, s[8:11], s21 offen offset:0
s_waitcnt vmcnt(19)
v_mfma_f32_32x32x16_bf16 v[176:191], v[84:87], v[24:27], v[176:191]
v_mfma_f32_32x32x16_bf16 v[192:207], v[84:87], v[28:31], v[192:207]
buffer_load_dwordx4 v[84:87], v1, s[8:11], s21 offen offset:1024
s_waitcnt vmcnt(19)
s_waitcnt lgkmcnt(0)
v_mfma_f32_32x32x16_bf16 v[112:127], v[88:91], v[16:19], v[112:127]
ds_read_b128 v[24:27], v1 offset:19456
v_mfma_f32_32x32x16_bf16 v[128:143], v[88:91], v[20:23], v[128:143]
ds_read_b128 v[28:31], v2 offset:19456
buffer_load_dwordx4 v[88:91], v1, s[8:11], s21 offen offset:2048
s_add_u32 s21, s21, 20480
s_waitcnt vmcnt(19)
v_mfma_f32_32x32x16_bf16 v[144:159], v[92:95], v[16:19], v[144:159]
v_mfma_f32_32x32x16_bf16 v[160:175], v[92:95], v[20:23], v[160:175]
buffer_load_dwordx4 v[92:95], v1, s[8:11], s21 offen offset:0
s_waitcnt vmcnt(19)
v_mfma_f32_32x32x16_bf16 v[176:191], v[96:99], v[16:19], v[176:191]
v_mfma_f32_32x32x16_bf16 v[192:207], v[96:99], v[20:23], v[192:207]
buffer_load_dwordx4 v[96:99], v1, s[8:11], s21 offen offset:1024
s_waitcnt vmcnt(19)
s_waitcnt lgkmcnt(0)
v_mfma_f32_32x32x16_bf16 v[112:127], v[100:103], v[24:27], v[112:127]
ds_read_b128 v[16:19], v1 offset:20480
v_mfma_f32_32x32x16_bf16 v[128:143], v[100:103], v[28:31], v[128:143]
ds_read_b128 v[20:23], v2 offset:20480
buffer_load_dwordx4 v[100:103], v1, s[8:11], s21 offen offset:2048
s_add_u32 s21, s21, 20480
s_waitcnt vmcnt(19)
v_mfma_f32_32x32x16_bf16 v[144:159], v[104:107], v[24:27], v[144:159]
v_mfma_f32_32x32x16_bf16 v[160:175], v[104:107], v[28:31], v[160:175]
buffer_load_dwordx4 v[104:107], v1, s[8:11], s21 offen offset:0
s_waitcnt vmcnt(19)
v_mfma_f32_32x32x16_bf16 v[176:191], v[108:111], v[24:27], v[176:191]
v_mfma_f32_32x32x16_bf16 v[192:207], v[108:111], v[28:31], v[192:207]
buffer_load_dwordx4 v[108:111], v1, s[8:11], s21 offen offset:1024
s_waitcnt vmcnt(19)
s_waitcnt lgkmcnt(0)
v_mfma_f32_32x32x16_bf16 v[112:127], v[32:35], v[16:19], v[112:127]
ds_read_b128 v[24:27], v1 offset:21504
v_mfma_f32_32x32x16_bf16 v[128:143], v[32:35], v[20:23], v[128:143]
ds_read_b128 v[28:31], v2 offset:21504
buffer_load_dwordx4 v[32:35], v1, s[8:11], s21 offen offset:2048
s_add_u32 s21, s21, 20480
s_waitcnt vmcnt(19)
v_mfma_f32_32x32x16_bf16 v[144:159], v[36:39], v[16:19], v[144:159]
v_mfma_f32_32x32x16_bf16 v[160:175], v[36:39], v[20:23], v[160:175]
buffer_load_dwordx4 v[36:39], v1, s[8:11], s21 offen offset:0
s_waitcnt vmcnt(19)
v_mfma_f32_32x32x16_bf16 v[176:191], v[40:43], v[16:19], v[176:191]
v_mfma_f32_32x32x16_bf16 v[192:207], v[40:43], v[20:23], v[192:207]
buffer_load_dwordx4 v[40:43], v1, s[8:11], s21 offen offset:1024
s_waitcnt vmcnt(19)
s_waitcnt lgkmcnt(0)
v_mfma_f32_32x32x16_bf16 v[112:127], v[44:47], v[24:27], v[112:127]
ds_read_b128 v[16:19], v1 offset:22528
v_mfma_f32_32x32x16_bf16 v[128:143], v[44:47], v[28:31], v[128:143]
ds_read_b128 v[20:23], v2 offset:22528
buffer_load_dwordx4 v[44:47], v1, s[8:11], s21 offen offset:2048
s_add_u32 s21, s21, 20480
s_waitcnt vmcnt(19)
v_mfma_f32_32x32x16_bf16 v[144:159], v[48:51], v[24:27], v[144:159]
v_mfma_f32_32x32x16_bf16 v[160:175], v[48:51], v[28:31], v[160:175]
buffer_load_dwordx4 v[48:51], v1, s[8:11], s21 offen offset:0
s_waitcnt vmcnt(19)
v_mfma_f32_32x32x16_bf16 v[176:191], v[52:55], v[24:27], v[176:191]
v_mfma_f32_32x32x16_bf16 v[192:207], v[52:55], v[28:31], v[192:207]
buffer_load_dwordx4 v[52:55], v1, s[8:11], s21 offen offset:1024
s_waitcnt vmcnt(19)
s_waitcnt lgkmcnt(0)
v_mfma_f32_32x32x16_bf16 v[112:127], v[56:59], v[16:19], v[112:127]
ds_read_b128 v[24:27], v1 offset:23552
v_mfma_f32_32x32x16_bf16 v[128:143], v[56:59], v[20:23], v[128:143]
ds_read_b128 v[28:31], v2 offset:23552
buffer_load_dwordx4 v[56:59], v1, s[8:11], s21 offen offset:2048
s_add_u32 s21, s21, 20480
s_waitcnt vmcnt(19)
v_mfma_f32_32x32x16_bf16 v[144:159], v[60:63], v[16:19], v[144:159]
v_mfma_f32_32x32x16_bf16 v[160:175], v[60:63], v[20:23], v[160:175]
buffer_load_dwordx4 v[60:63], v1, s[8:11], s21 offen offset:0
s_waitcnt vmcnt(19)
v_mfma_f32_32x32x16_bf16 v[176:191], v[64:67], v[16:19], v[176:191]
v_mfma_f32_32x32x16_bf16 v[192:207], v[64:67], v[20:23], v[192:207]
buffer_load_dwordx4 v[64:67], v1, s[8:11], s21 offen offset:1024
s_waitcnt vmcnt(19)
s_waitcnt lgkmcnt(0)
v_mfma_f32_32x32x16_bf16 v[112:127], v[68:71], v[24:27], v[112:127]
ds_read_b128 v[16:19], v1 offset:24576
v_mfma_f32_32x32x16_bf16 v[128:143], v[68:71], v[28:31], v[128:143]
ds_read_b128 v[20:23], v2 offset:24576
buffer_load_dwordx4 v[68:71], v1, s[8:11], s21 offen offset:2048
s_add_u32 s21, s21, 20480
s_cmp_ge_u32 s21, s46
s_cselect_b32 s45, 819200, 0
s_sub_u32 s21, s21, s45
s_waitcnt vmcnt(19)
v_mfma_f32_32x32x16_bf16 v[144:159], v[72:75], v[24:27], v[144:159]
v_mfma_f32_32x32x16_bf16 v[160:175], v[72:75], v[28:31], v[160:175]
buffer_load_dwordx4 v[72:75], v1, s[8:11], s21 offen offset:0
s_waitcnt vmcnt(19)
v_mfma_f32_32x32x16_bf16 v[176:191], v[76:79], v[24:27], v[176:191]
v_mfma_f32_32x32x16_bf16 v[192:207], v[76:79], v[28:31], v[192:207]
buffer_load_dwordx4 v[76:79], v1, s[8:11], s21 offen offset:1024
s_waitcnt vmcnt(19)
s_waitcnt lgkmcnt(0)
v_mfma_f32_32x32x16_bf16 v[112:127], v[80:83], v[16:19], v[112:127]
ds_read_b128 v[24:27], v1 offset:25600
v_mfma_f32_32x32x16_bf16 v[128:143], v[80:83], v[20:23], v[128:143]
ds_read_b128 v[28:31], v2 offset:25600
buffer_load_dwordx4 v[80:83], v1, s[8:11], s21 offen offset:2048
s_add_u32 s21, s21, 20480
s_waitcnt vmcnt(19)
v_mfma_f32_32x32x16_bf16 v[144:159], v[84:87], v[16:19], v[144:159]
v_mfma_f32_32x32x16_bf16 v[160:175], v[84:87], v[20:23], v[160:175]
buffer_load_dwordx4 v[84:87], v1, s[8:11], s21 offen offset:0
s_waitcnt vmcnt(19)
v_mfma_f32_32x32x16_bf16 v[176:191], v[88:91], v[16:19], v[176:191]
v_mfma_f32_32x32x16_bf16 v[192:207], v[88:91], v[20:23], v[192:207]
buffer_load_dwordx4 v[88:91], v1, s[8:11], s21 offen offset:1024
s_waitcnt vmcnt(19)
s_waitcnt lgkmcnt(0)
v_mfma_f32_32x32x16_bf16 v[112:127], v[92:95], v[24:27], v[112:127]
ds_read_b128 v[16:19], v1 offset:26624
v_mfma_f32_32x32x16_bf16 v[128:143], v[92:95], v[28:31], v[128:143]
ds_read_b128 v[20:23], v2 offset:26624
buffer_load_dwordx4 v[92:95], v1, s[8:11], s21 offen offset:2048
s_add_u32 s21, s21, 20480
s_waitcnt vmcnt(19)
v_mfma_f32_32x32x16_bf16 v[144:159], v[96:99], v[24:27], v[144:159]
v_mfma_f32_32x32x16_bf16 v[160:175], v[96:99], v[28:31], v[160:175]
buffer_load_dwordx4 v[96:99], v1, s[8:11], s21 offen offset:0
s_waitcnt vmcnt(19)
v_mfma_f32_32x32x16_bf16 v[176:191], v[100:103], v[24:27], v[176:191]
v_mfma_f32_32x32x16_bf16 v[192:207], v[100:103], v[28:31], v[192:207]
buffer_load_dwordx4 v[100:103], v1, s[8:11], s21 offen offset:1024
s_waitcnt vmcnt(19)
s_waitcnt lgkmcnt(0)
v_mfma_f32_32x32x16_bf16 v[112:127], v[104:107], v[16:19], v[112:127]
ds_read_b128 v[24:27], v1 offset:27648
v_mfma_f32_32x32x16_bf16 v[128:143], v[104:107], v[20:23], v[128:143]
ds_read_b128 v[28:31], v2 offset:27648
buffer_load_dwordx4 v[104:107], v1, s[8:11], s21 offen offset:2048
s_add_u32 s21, s21, 20480
s_waitcnt vmcnt(19)
v_mfma_f32_32x32x16_bf16 v[144:159], v[108:111], v[16:19], v[144:159]
v_mfma_f32_32x32x16_bf16 v[160:175], v[108:111], v[20:23], v[160:175]
buffer_load_dwordx4 v[108:111], v1, s[8:11], s21 offen offset:0
s_waitcnt vmcnt(19)
v_mfma_f32_32x32x16_bf16 v[176:191], v[32:35], v[16:19], v[176:191]
v_mfma_f32_32x32x16_bf16 v[192:207], v[32:35], v[20:23], v[192:207]
buffer_load_dwordx4 v[32:35], v1, s[8:11], s21 offen offset:1024
s_waitcnt vmcnt(19)
s_waitcnt lgkmcnt(0)
v_mfma_f32_32x32x16_bf16 v[112:127], v[36:39], v[24:27], v[112:127]
ds_read_b128 v[16:19], v1 offset:28672
v_mfma_f32_32x32x16_bf16 v[128:143], v[36:39], v[28:31], v[128:143]
ds_read_b128 v[20:23], v2 offset:28672
buffer_load_dwordx4 v[36:39], v1, s[8:11], s21 offen offset:2048
s_add_u32 s21, s21, 20480
s_waitcnt vmcnt(19)
v_mfma_f32_32x32x16_bf16 v[144:159], v[40:43], v[24:27], v[144:159]
v_mfma_f32_32x32x16_bf16 v[160:175], v[40:43], v[28:31], v[160:175]
buffer_load_dwordx4 v[40:43], v1, s[8:11], s21 offen offset:0
s_waitcnt vmcnt(19)
v_mfma_f32_32x32x16_bf16 v[176:191], v[44:47], v[24:27], v[176:191]
v_mfma_f32_32x32x16_bf16 v[192:207], v[44:47], v[28:31], v[192:207]
buffer_load_dwordx4 v[44:47], v1, s[8:11], s21 offen offset:1024
s_waitcnt vmcnt(19)
s_waitcnt lgkmcnt(0)
v_mfma_f32_32x32x16_bf16 v[112:127], v[48:51], v[16:19], v[112:127]
ds_read_b128 v[24:27], v1 offset:29696
v_mfma_f32_32x32x16_bf16 v[128:143], v[48:51], v[20:23], v[128:143]
ds_read_b128 v[28:31], v2 offset:29696
buffer_load_dwordx4 v[48:51], v1, s[8:11], s21 offen offset:2048
s_add_u32 s21, s21, 20480
s_waitcnt vmcnt(19)
v_mfma_f32_32x32x16_bf16 v[144:159], v[52:55], v[16:19], v[144:159]
v_mfma_f32_32x32x16_bf16 v[160:175], v[52:55], v[20:23], v[160:175]
buffer_load_dwordx4 v[52:55], v1, s[8:11], s21 offen offset:0
s_waitcnt vmcnt(19)
v_mfma_f32_32x32x16_bf16 v[176:191], v[56:59], v[16:19], v[176:191]
v_mfma_f32_32x32x16_bf16 v[192:207], v[56:59], v[20:23], v[192:207]
buffer_load_dwordx4 v[56:59], v1, s[8:11], s21 offen offset:1024
s_waitcnt vmcnt(19)
s_waitcnt lgkmcnt(0)
v_mfma_f32_32x32x16_bf16 v[112:127], v[60:63], v[24:27], v[112:127]
ds_read_b128 v[16:19], v1 offset:30720
v_mfma_f32_32x32x16_bf16 v[128:143], v[60:63], v[28:31], v[128:143]
ds_read_b128 v[20:23], v2 offset:30720
buffer_load_dwordx4 v[60:63], v1, s[8:11], s21 offen offset:2048
s_add_u32 s21, s21, 20480
s_waitcnt vmcnt(19)
v_mfma_f32_32x32x16_bf16 v[144:159], v[64:67], v[24:27], v[144:159]
v_mfma_f32_32x32x16_bf16 v[160:175], v[64:67], v[28:31], v[160:175]
buffer_load_dwordx4 v[64:67], v1, s[8:11], s21 offen offset:0
s_waitcnt vmcnt(19)
v_mfma_f32_32x32x16_bf16 v[176:191], v[68:71], v[24:27], v[176:191]
v_mfma_f32_32x32x16_bf16 v[192:207], v[68:71], v[28:31], v[192:207]
buffer_load_dwordx4 v[68:71], v1, s[8:11], s21 offen offset:1024
s_waitcnt vmcnt(19)
s_waitcnt lgkmcnt(0)
v_mfma_f32_32x32x16_bf16 v[112:127], v[72:75], v[16:19], v[112:127]
ds_read_b128 v[24:27], v1 offset:31744
v_mfma_f32_32x32x16_bf16 v[128:143], v[72:75], v[20:23], v[128:143]
ds_read_b128 v[28:31], v2 offset:31744
buffer_load_dwordx4 v[72:75], v1, s[8:11], s21 offen offset:2048
s_add_u32 s21, s21, 20480
s_waitcnt vmcnt(19)
v_mfma_f32_32x32x16_bf16 v[144:159], v[76:79], v[16:19], v[144:159]
v_mfma_f32_32x32x16_bf16 v[160:175], v[76:79], v[20:23], v[160:175]
buffer_load_dwordx4 v[76:79], v1, s[8:11], s21 offen offset:0
s_waitcnt vmcnt(19)
v_mfma_f32_32x32x16_bf16 v[176:191], v[80:83], v[16:19], v[176:191]
v_mfma_f32_32x32x16_bf16 v[192:207], v[80:83], v[20:23], v[192:207]
buffer_load_dwordx4 v[80:83], v1, s[8:11], s21 offen offset:1024
s_waitcnt vmcnt(19)
s_waitcnt lgkmcnt(0)
v_mfma_f32_32x32x16_bf16 v[112:127], v[84:87], v[24:27], v[112:127]
ds_read_b128 v[16:19], v1 offset:32768
v_mfma_f32_32x32x16_bf16 v[128:143], v[84:87], v[28:31], v[128:143]
ds_read_b128 v[20:23], v2 offset:32768
buffer_load_dwordx4 v[84:87], v1, s[8:11], s21 offen offset:2048
s_add_u32 s21, s21, 20480
s_waitcnt vmcnt(19)
v_mfma_f32_32x32x16_bf16 v[144:159], v[88:91], v[24:27], v[144:159]
v_mfma_f32_32x32x16_bf16 v[160:175], v[88:91], v[28:31], v[160:175]
buffer_load_dwordx4 v[88:91], v1, s[8:11], s21 offen offset:0
s_waitcnt vmcnt(19)
v_mfma_f32_32x32x16_bf16 v[176:191], v[92:95], v[24:27], v[176:191]
v_mfma_f32_32x32x16_bf16 v[192:207], v[92:95], v[28:31], v[192:207]
buffer_load_dwordx4 v[92:95], v1, s[8:11], s21 offen offset:1024
s_waitcnt vmcnt(19)
s_waitcnt lgkmcnt(0)
v_mfma_f32_32x32x16_bf16 v[112:127], v[96:99], v[16:19], v[112:127]
ds_read_b128 v[24:27], v1 offset:33792
v_mfma_f32_32x32x16_bf16 v[128:143], v[96:99], v[20:23], v[128:143]
ds_read_b128 v[28:31], v2 offset:33792
buffer_load_dwordx4 v[96:99], v1, s[8:11], s21 offen offset:2048
s_add_u32 s21, s21, 20480
s_waitcnt vmcnt(19)
v_mfma_f32_32x32x16_bf16 v[144:159], v[100:103], v[16:19], v[144:159]
v_mfma_f32_32x32x16_bf16 v[160:175], v[100:103], v[20:23], v[160:175]
buffer_load_dwordx4 v[100:103], v1, s[8:11], s21 offen offset:0
s_waitcnt vmcnt(19)
v_mfma_f32_32x32x16_bf16 v[176:191], v[104:107], v[16:19], v[176:191]
v_mfma_f32_32x32x16_bf16 v[192:207], v[104:107], v[20:23], v[192:207]
buffer_load_dwordx4 v[104:107], v1, s[8:11], s21 offen offset:1024
s_waitcnt vmcnt(19)
s_waitcnt lgkmcnt(0)
v_mfma_f32_32x32x16_bf16 v[112:127], v[108:111], v[24:27], v[112:127]
ds_read_b128 v[16:19], v1 offset:34816
v_mfma_f32_32x32x16_bf16 v[128:143], v[108:111], v[28:31], v[128:143]
ds_read_b128 v[20:23], v2 offset:34816
buffer_load_dwordx4 v[108:111], v1, s[8:11], s21 offen offset:2048
s_add_u32 s21, s21, 20480
s_waitcnt vmcnt(19)
v_mfma_f32_32x32x16_bf16 v[144:159], v[32:35], v[24:27], v[144:159]
v_mfma_f32_32x32x16_bf16 v[160:175], v[32:35], v[28:31], v[160:175]
s_mov_b32 s21, s22
buffer_load_dwordx4 v[32:35], v1, s[8:11], s21 offen offset:0
s_waitcnt vmcnt(19)
v_mfma_f32_32x32x16_bf16 v[176:191], v[36:39], v[24:27], v[176:191]
v_mfma_f32_32x32x16_bf16 v[192:207], v[36:39], v[28:31], v[192:207]
buffer_load_dwordx4 v[36:39], v1, s[8:11], s21 offen offset:1024
s_waitcnt vmcnt(19)
s_waitcnt lgkmcnt(0)
v_mfma_f32_32x32x16_bf16 v[112:127], v[40:43], v[16:19], v[112:127]
ds_read_b128 v[24:27], v1 offset:35840
v_mfma_f32_32x32x16_bf16 v[128:143], v[40:43], v[20:23], v[128:143]
ds_read_b128 v[28:31], v2 offset:35840
buffer_load_dwordx4 v[40:43], v1, s[8:11], s21 offen offset:2048
s_waitcnt vmcnt(19)
v_mfma_f32_32x32x16_bf16 v[144:159], v[44:47], v[16:19], v[144:159]
v_mfma_f32_32x32x16_bf16 v[160:175], v[44:47], v[20:23], v[160:175]
buffer_load_dwordx4 v[44:47], v1, s[8:11], s21 offen offset:3072
s_add_u32 s21, s21, 55296
s_waitcnt vmcnt(19)
v_mfma_f32_32x32x16_bf16 v[176:191], v[48:51], v[16:19], v[176:191]
v_mfma_f32_32x32x16_bf16 v[192:207], v[48:51], v[20:23], v[192:207]
buffer_load_dwordx4 v[48:51], v1, s[8:11], s21 offen offset:0
s_waitcnt vmcnt(19)
s_waitcnt lgkmcnt(0)
v_mfma_f32_32x32x16_bf16 v[112:127], v[52:55], v[24:27], v[112:127]
ds_read_b128 v[16:19], v1 offset:36864
v_mfma_f32_32x32x16_bf16 v[128:143], v[52:55], v[28:31], v[128:143]
ds_read_b128 v[20:23], v2 offset:36864
buffer_load_dwordx4 v[52:55], v1, s[8:11], s21 offen offset:1024
s_waitcnt vmcnt(19)
v_mfma_f32_32x32x16_bf16 v[144:159], v[56:59], v[24:27], v[144:159]
v_mfma_f32_32x32x16_bf16 v[160:175], v[56:59], v[28:31], v[160:175]
buffer_load_dwordx4 v[56:59], v1, s[8:11], s21 offen offset:2048
s_waitcnt vmcnt(19)
v_mfma_f32_32x32x16_bf16 v[176:191], v[60:63], v[24:27], v[176:191]
v_mfma_f32_32x32x16_bf16 v[192:207], v[60:63], v[28:31], v[192:207]
buffer_load_dwordx4 v[60:63], v1, s[8:11], s21 offen offset:3072
s_add_u32 s21, s21, 55296
s_waitcnt vmcnt(19)
s_waitcnt lgkmcnt(0)
v_mfma_f32_32x32x16_bf16 v[112:127], v[64:67], v[16:19], v[112:127]
ds_read_b128 v[24:27], v1 offset:37888
v_mfma_f32_32x32x16_bf16 v[128:143], v[64:67], v[20:23], v[128:143]
ds_read_b128 v[28:31], v2 offset:37888
buffer_load_dwordx4 v[64:67], v1, s[8:11], s21 offen offset:0
s_waitcnt vmcnt(19)
v_mfma_f32_32x32x16_bf16 v[144:159], v[68:71], v[16:19], v[144:159]
v_mfma_f32_32x32x16_bf16 v[160:175], v[68:71], v[20:23], v[160:175]
buffer_load_dwordx4 v[68:71], v1, s[8:11], s21 offen offset:1024
s_waitcnt vmcnt(19)
v_mfma_f32_32x32x16_bf16 v[176:191], v[72:75], v[16:19], v[176:191]
v_mfma_f32_32x32x16_bf16 v[192:207], v[72:75], v[20:23], v[192:207]
buffer_load_dwordx4 v[72:75], v1, s[8:11], s21 offen offset:2048
s_waitcnt vmcnt(19)
s_waitcnt lgkmcnt(0)
v_mfma_f32_32x32x16_bf16 v[112:127], v[76:79], v[24:27], v[112:127]
ds_read_b128 v[16:19], v1 offset:38912
v_mfma_f32_32x32x16_bf16 v[128:143], v[76:79], v[28:31], v[128:143]
ds_read_b128 v[20:23], v2 offset:38912
buffer_load_dwordx4 v[76:79], v1, s[8:11], s21 offen offset:3072
s_add_u32 s21, s21, 55296
s_waitcnt vmcnt(19)
v_mfma_f32_32x32x16_bf16 v[144:159], v[80:83], v[24:27], v[144:159]
v_mfma_f32_32x32x16_bf16 v[160:175], v[80:83], v[28:31], v[160:175]
buffer_load_dwordx4 v[80:83], v1, s[8:11], s21 offen offset:0
s_waitcnt vmcnt(19)
v_mfma_f32_32x32x16_bf16 v[176:191], v[84:87], v[24:27], v[176:191]
v_mfma_f32_32x32x16_bf16 v[192:207], v[84:87], v[28:31], v[192:207]
buffer_load_dwordx4 v[84:87], v1, s[8:11], s21 offen offset:1024
s_waitcnt vmcnt(19)
s_waitcnt lgkmcnt(0)
v_mfma_f32_32x32x16_bf16 v[112:127], v[88:91], v[16:19], v[112:127]
ds_read_b128 v[24:27], v1 offset:39936
v_mfma_f32_32x32x16_bf16 v[128:143], v[88:91], v[20:23], v[128:143]
ds_read_b128 v[28:31], v2 offset:39936
buffer_load_dwordx4 v[88:91], v1, s[8:11], s21 offen offset:2048
s_waitcnt vmcnt(19)
v_mfma_f32_32x32x16_bf16 v[144:159], v[92:95], v[16:19], v[144:159]
v_mfma_f32_32x32x16_bf16 v[160:175], v[92:95], v[20:23], v[160:175]
buffer_load_dwordx4 v[92:95], v1, s[8:11], s21 offen offset:3072
s_add_u32 s21, s21, 55296
s_waitcnt vmcnt(19)
v_mfma_f32_32x32x16_bf16 v[176:191], v[96:99], v[16:19], v[176:191]
v_mfma_f32_32x32x16_bf16 v[192:207], v[96:99], v[20:23], v[192:207]
buffer_load_dwordx4 v[96:99], v1, s[8:11], s21 offen offset:0
s_waitcnt vmcnt(19)
s_waitcnt lgkmcnt(0)
v_mfma_f32_32x32x16_bf16 v[112:127], v[100:103], v[24:27], v[112:127]
v_mfma_f32_32x32x16_bf16 v[128:143], v[100:103], v[28:31], v[128:143]
buffer_load_dwordx4 v[100:103], v1, s[8:11], s21 offen offset:1024
s_waitcnt vmcnt(19)
v_mfma_f32_32x32x16_bf16 v[144:159], v[104:107], v[24:27], v[144:159]
v_mfma_f32_32x32x16_bf16 v[160:175], v[104:107], v[28:31], v[160:175]
buffer_load_dwordx4 v[104:107], v1, s[8:11], s21 offen offset:2048
s_waitcnt vmcnt(19)
v_mfma_f32_32x32x16_bf16 v[176:191], v[108:111], v[24:27], v[176:191]
v_mfma_f32_32x32x16_bf16 v[192:207], v[108:111], v[28:31], v[192:207]
buffer_load_dwordx4 v[108:111], v1, s[8:11], s21 offen offset:3072
s_add_u32 s21, s21, 55296
v_mov_b32 v8, 0
v_mov_b32 v9, 0
v_mov_b32 v10, 0
v_mov_b32 v11, 0
v_cvt_pk_bf16_f32 v208, v112, v113
v_lshlrev_b32 v112, 16, v208
v_and_b32 v113, 0xffff0000, v208
v_add_f32 v8, v8, v112
v_fmac_f32 v9, v112, v112
v_add_f32 v8, v8, v113
v_fmac_f32 v9, v113, v113
v_cvt_pk_bf16_f32 v209, v114, v115
v_lshlrev_b32 v114, 16, v209
v_and_b32 v115, 0xffff0000, v209
v_add_f32 v8, v8, v114
v_fmac_f32 v9, v114, v114
v_add_f32 v8, v8, v115
v_fmac_f32 v9, v115, v115
v_cvt_pk_bf16_f32 v210, v116, v117
v_lshlrev_b32 v116, 16, v210
v_and_b32 v117, 0xffff0000, v210
v_add_f32 v8, v8, v116
v_fmac_f32 v9, v116, v116
v_add_f32 v8, v8, v117
v_fmac_f32 v9, v117, v117
v_cvt_pk_bf16_f32 v211, v118, v119
v_lshlrev_b32 v118, 16, v211
v_and_b32 v119, 0xffff0000, v211
v_add_f32 v8, v8, v118
v_fmac_f32 v9, v118, v118
v_add_f32 v8, v8, v119
v_fmac_f32 v9, v119, v119
v_cvt_pk_bf16_f32 v212, v120, v121
v_lshlrev_b32 v120, 16, v212
v_and_b32 v121, 0xffff0000, v212
v_add_f32 v8, v8, v120
v_fmac_f32 v9, v120, v120
v_add_f32 v8, v8, v121
v_fmac_f32 v9, v121, v121
v_cvt_pk_bf16_f32 v213, v122, v123
v_lshlrev_b32 v122, 16, v213
v_and_b32 v123, 0xffff0000, v213
v_add_f32 v8, v8, v122
v_fmac_f32 v9, v122, v122
v_add_f32 v8, v8, v123
v_fmac_f32 v9, v123, v123
v_cvt_pk_bf16_f32 v214, v124, v125
v_lshlrev_b32 v124, 16, v214
v_and_b32 v125, 0xffff0000, v214
v_add_f32 v8, v8, v124
v_fmac_f32 v9, v124, v124
v_add_f32 v8, v8, v125
v_fmac_f32 v9, v125, v125
v_cvt_pk_bf16_f32 v215, v126, v127
v_lshlrev_b32 v126, 16, v215
v_and_b32 v127, 0xffff0000, v215
v_add_f32 v8, v8, v126
v_fmac_f32 v9, v126, v126
v_add_f32 v8, v8, v127
v_fmac_f32 v9, v127, v127
v_cvt_pk_bf16_f32 v216, v144, v145
v_lshlrev_b32 v144, 16, v216
v_and_b32 v145, 0xffff0000, v216
v_add_f32 v8, v8, v144
v_fmac_f32 v9, v144, v144
v_add_f32 v8, v8, v145
v_fmac_f32 v9, v145, v145
v_cvt_pk_bf16_f32 v217, v146, v147
v_lshlrev_b32 v146, 16, v217
v_and_b32 v147, 0xffff0000, v217
v_add_f32 v8, v8, v146
v_fmac_f32 v9, v146, v146
v_add_f32 v8, v8, v147
v_fmac_f32 v9, v147, v147
v_cvt_pk_bf16_f32 v218, v148, v149
v_lshlrev_b32 v148, 16, v218
v_and_b32 v149, 0xffff0000, v218
v_add_f32 v8, v8, v148
v_fmac_f32 v9, v148, v148
v_add_f32 v8, v8, v149
v_fmac_f32 v9, v149, v149
v_cvt_pk_bf16_f32 v219, v150, v151
v_lshlrev_b32 v150, 16, v219
v_and_b32 v151, 0xffff0000, v219
v_add_f32 v8, v8, v150
v_fmac_f32 v9, v150, v150
v_add_f32 v8, v8, v151
v_fmac_f32 v9, v151, v151
v_cvt_pk_bf16_f32 v220, v152, v153
v_lshlrev_b32 v152, 16, v220
v_and_b32 v153, 0xffff0000, v220
v_add_f32 v8, v8, v152
v_fmac_f32 v9, v152, v152
v_add_f32 v8, v8, v153
v_fmac_f32 v9, v153, v153
v_cvt_pk_bf16_f32 v221, v154, v155
v_lshlrev_b32 v154, 16, v221
v_and_b32 v155, 0xffff0000, v221
v_add_f32 v8, v8, v154
v_fmac_f32 v9, v154, v154
v_add_f32 v8, v8, v155
v_fmac_f32 v9, v155, v155
v_cvt_pk_bf16_f32 v222, v156, v157
v_lshlrev_b32 v156, 16, v222
v_and_b32 v157, 0xffff0000, v222
v_add_f32 v8, v8, v156
v_fmac_f32 v9, v156, v156
v_add_f32 v8, v8, v157
v_fmac_f32 v9, v157, v157
v_cvt_pk_bf16_f32 v223, v158, v159
v_lshlrev_b32 v158, 16, v223
v_and_b32 v159, 0xffff0000, v223
v_add_f32 v8, v8, v158
v_fmac_f32 v9, v158, v158
v_add_f32 v8, v8, v159
v_fmac_f32 v9, v159, v159
v_cvt_pk_bf16_f32 v224, v176, v177
v_lshlrev_b32 v176, 16, v224
v_and_b32 v177, 0xffff0000, v224
v_add_f32 v8, v8, v176
v_fmac_f32 v9, v176, v176
v_add_f32 v8, v8, v177
v_fmac_f32 v9, v177, v177
v_cvt_pk_bf16_f32 v225, v178, v179
v_lshlrev_b32 v178, 16, v225
v_and_b32 v179, 0xffff0000, v225
v_add_f32 v8, v8, v178
v_fmac_f32 v9, v178, v178
v_add_f32 v8, v8, v179
v_fmac_f32 v9, v179, v179
v_cvt_pk_bf16_f32 v226, v180, v181
v_lshlrev_b32 v180, 16, v226
v_and_b32 v181, 0xffff0000, v226
v_add_f32 v8, v8, v180
v_fmac_f32 v9, v180, v180
v_add_f32 v8, v8, v181
v_fmac_f32 v9, v181, v181
v_cvt_pk_bf16_f32 v227, v182, v183
v_lshlrev_b32 v182, 16, v227
v_and_b32 v183, 0xffff0000, v227
v_add_f32 v8, v8, v182
v_fmac_f32 v9, v182, v182
v_add_f32 v8, v8, v183
v_fmac_f32 v9, v183, v183
v_cvt_pk_bf16_f32 v228, v184, v185
v_lshlrev_b32 v184, 16, v228
v_and_b32 v185, 0xffff0000, v228
v_add_f32 v8, v8, v184
v_fmac_f32 v9, v184, v184
v_add_f32 v8, v8, v185
v_fmac_f32 v9, v185, v185
v_cvt_pk_bf16_f32 v229, v186, v187
v_lshlrev_b32 v186, 16, v229
v_and_b32 v187, 0xffff0000, v229
v_add_f32 v8, v8, v186
v_fmac_f32 v9, v186, v186
v_add_f32 v8, v8, v187
v_fmac_f32 v9, v187, v187
v_cvt_pk_bf16_f32 v230, v188, v189
v_lshlrev_b32 v188, 16, v230
v_and_b32 v189, 0xffff0000, v230
v_add_f32 v8, v8, v188
v_fmac_f32 v9, v188, v188
v_add_f32 v8, v8, v189
v_fmac_f32 v9, v189, v189
v_cvt_pk_bf16_f32 v231, v190, v191
v_lshlrev_b32 v190, 16, v231
v_and_b32 v191, 0xffff0000, v231
v_add_f32 v8, v8, v190
v_fmac_f32 v9, v190, v190
v_add_f32 v8, v8, v191
v_fmac_f32 v9, v191, v191
v_cvt_pk_bf16_f32 v232, v128, v129
v_lshlrev_b32 v128, 16, v232
v_and_b32 v129, 0xffff0000, v232
v_add_f32 v10, v10, v128
v_fmac_f32 v11, v128, v128
v_add_f32 v10, v10, v129
v_fmac_f32 v11, v129, v129
v_cvt_pk_bf16_f32 v233, v130, v131
v_lshlrev_b32 v130, 16, v233
v_and_b32 v131, 0xffff0000, v233
v_add_f32 v10, v10, v130
v_fmac_f32 v11, v130, v130
v_add_f32 v10, v10, v131
v_fmac_f32 v11, v131, v131
v_cvt_pk_bf16_f32 v234, v132, v133
v_lshlrev_b32 v132, 16, v234
v_and_b32 v133, 0xffff0000, v234
v_add_f32 v10, v10, v132
v_fmac_f32 v11, v132, v132
v_add_f32 v10, v10, v133
v_fmac_f32 v11, v133, v133
v_cvt_pk_bf16_f32 v235, v134, v135
v_lshlrev_b32 v134, 16, v235
v_and_b32 v135, 0xffff0000, v235
v_add_f32 v10, v10, v134
v_fmac_f32 v11, v134, v134
v_add_f32 v10, v10, v135
v_fmac_f32 v11, v135, v135
v_cvt_pk_bf16_f32 v236, v136, v137
v_lshlrev_b32 v136, 16, v236
v_and_b32 v137, 0xffff0000, v236
v_add_f32 v10, v10, v136
v_fmac_f32 v11, v136, v136
v_add_f32 v10, v10, v137
v_fmac_f32 v11, v137, v137
v_cvt_pk_bf16_f32 v237, v138, v139
v_lshlrev_b32 v138, 16, v237
v_and_b32 v139, 0xffff0000, v237
v_add_f32 v10, v10, v138
v_fmac_f32 v11, v138, v138
v_add_f32 v10, v10, v139
v_fmac_f32 v11, v139, v139
v_cvt_pk_bf16_f32 v238, v140, v141
v_lshlrev_b32 v140, 16, v238
v_and_b32 v141, 0xffff0000, v238
v_add_f32 v10, v10, v140
v_fmac_f32 v11, v140, v140
v_add_f32 v10, v10, v141
v_fmac_f32 v11, v141, v141
v_cvt_pk_bf16_f32 v239, v142, v143
v_lshlrev_b32 v142, 16, v239
v_and_b32 v143, 0xffff0000, v239
v_add_f32 v10, v10, v142
v_fmac_f32 v11, v142, v142
v_add_f32 v10, v10, v143
v_fmac_f32 v11, v143, v143
v_cvt_pk_bf16_f32 v240, v160, v161
v_lshlrev_b32 v160, 16, v240
v_and_b32 v161, 0xffff0000, v240
v_add_f32 v10, v10, v160
v_fmac_f32 v11, v160, v160
v_add_f32 v10, v10, v161
v_fmac_f32 v11, v161, v161
v_cvt_pk_bf16_f32 v241, v162, v163
v_lshlrev_b32 v162, 16, v241
v_and_b32 v163, 0xffff0000, v241
v_add_f32 v10, v10, v162
v_fmac_f32 v11, v162, v162
v_add_f32 v10, v10, v163
v_fmac_f32 v11, v163, v163
v_cvt_pk_bf16_f32 v242, v164, v165
v_lshlrev_b32 v164, 16, v242
v_and_b32 v165, 0xffff0000, v242
v_add_f32 v10, v10, v164
v_fmac_f32 v11, v164, v164
v_add_f32 v10, v10, v165
v_fmac_f32 v11, v165, v165
v_cvt_pk_bf16_f32 v243, v166, v167
v_lshlrev_b32 v166, 16, v243
v_and_b32 v167, 0xffff0000, v243
v_add_f32 v10, v10, v166
v_fmac_f32 v11, v166, v166
v_add_f32 v10, v10, v167
v_fmac_f32 v11, v167, v167
v_cvt_pk_bf16_f32 v244, v168, v169
v_lshlrev_b32 v168, 16, v244
v_and_b32 v169, 0xffff0000, v244
v_add_f32 v10, v10, v168
v_fmac_f32 v11, v168, v168
v_add_f32 v10, v10, v169
v_fmac_f32 v11, v169, v169
v_cvt_pk_bf16_f32 v245, v170, v171
v_lshlrev_b32 v170, 16, v245
v_and_b32 v171, 0xffff0000, v245
v_add_f32 v10, v10, v170
v_fmac_f32 v11, v170, v170
v_add_f32 v10, v10, v171
v_fmac_f32 v11, v171, v171
v_cvt_pk_bf16_f32 v246, v172, v173
v_lshlrev_b32 v172, 16, v246
v_and_b32 v173, 0xffff0000, v246
v_add_f32 v10, v10, v172
v_fmac_f32 v11, v172, v172
v_add_f32 v10, v10, v173
v_fmac_f32 v11, v173, v173
v_cvt_pk_bf16_f32 v247, v174, v175
v_lshlrev_b32 v174, 16, v247
v_and_b32 v175, 0xffff0000, v247
v_add_f32 v10, v10, v174
v_fmac_f32 v11, v174, v174
v_add_f32 v10, v10, v175
v_fmac_f32 v11, v175, v175
v_cvt_pk_bf16_f32 v248, v192, v193
v_lshlrev_b32 v192, 16, v248
v_and_b32 v193, 0xffff0000, v248
v_add_f32 v10, v10, v192
v_fmac_f32 v11, v192, v192
v_add_f32 v10, v10, v193
v_fmac_f32 v11, v193, v193
v_cvt_pk_bf16_f32 v249, v194, v195
v_lshlrev_b32 v194, 16, v249
v_and_b32 v195, 0xffff0000, v249
v_add_f32 v10, v10, v194
v_fmac_f32 v11, v194, v194
v_add_f32 v10, v10, v195
v_fmac_f32 v11, v195, v195
v_cvt_pk_bf16_f32 v250, v196, v197
v_lshlrev_b32 v196, 16, v250
v_and_b32 v197, 0xffff0000, v250
v_add_f32 v10, v10, v196
v_fmac_f32 v11, v196, v196
v_add_f32 v10, v10, v197
v_fmac_f32 v11, v197, v197
v_cvt_pk_bf16_f32 v251, v198, v199
v_lshlrev_b32 v198, 16, v251
v_and_b32 v199, 0xffff0000, v251
v_add_f32 v10, v10, v198
v_fmac_f32 v11, v198, v198
v_add_f32 v10, v10, v199
v_fmac_f32 v11, v199, v199
v_cvt_pk_bf16_f32 v252, v200, v201
v_lshlrev_b32 v200, 16, v252
v_and_b32 v201, 0xffff0000, v252
v_add_f32 v10, v10, v200
v_fmac_f32 v11, v200, v200
v_add_f32 v10, v10, v201
v_fmac_f32 v11, v201, v201
v_cvt_pk_bf16_f32 v253, v202, v203
v_lshlrev_b32 v202, 16, v253
v_and_b32 v203, 0xffff0000, v253
v_add_f32 v10, v10, v202
v_fmac_f32 v11, v202, v202
v_add_f32 v10, v10, v203
v_fmac_f32 v11, v203, v203
v_cvt_pk_bf16_f32 v254, v204, v205
v_lshlrev_b32 v204, 16, v254
v_and_b32 v205, 0xffff0000, v254
v_add_f32 v10, v10, v204
v_fmac_f32 v11, v204, v204
v_add_f32 v10, v10, v205
v_fmac_f32 v11, v205, v205
v_cvt_pk_bf16_f32 v255, v206, v207
v_lshlrev_b32 v206, 16, v255
v_and_b32 v207, 0xffff0000, v255
v_add_f32 v10, v10, v206
v_fmac_f32 v11, v206, v206
v_add_f32 v10, v10, v207
v_fmac_f32 v11, v207, v207
s_nop 0
v_permlane32_swap_b32 v8, v10
v_permlane32_swap_b32 v9, v11
v_add_f32 v8, v8, v10
v_add_f32 v9, v9, v11
ds_write_b64 v5, v[8:9]
v_mov_b32 v12, 163836
v_mov_b32 v13, 0
ds_write_b32 v12, v13
buffer_store_dwordx4 v[208:211], v1, s[28:31], s23 offen offset:0 sc1
buffer_store_dwordx4 v[212:215], v1, s[28:31], s23 offen offset:1024 sc1
buffer_store_dwordx4 v[216:219], v1, s[28:31], s23 offen offset:2048 sc1
buffer_store_dwordx4 v[220:223], v1, s[28:31], s23 offen offset:3072 sc1
buffer_store_dwordx4 v[224:227], v1, s[28:31], s26 offen offset:0 sc1
buffer_store_dwordx4 v[228:231], v1, s[28:31], s26 offen offset:1024 sc1
buffer_store_dwordx4 v[232:235], v2, s[28:31], s23 offen offset:0 sc1
buffer_store_dwordx4 v[236:239], v2, s[28:31], s23 offen offset:1024 sc1
buffer_store_dwordx4 v[240:243], v2, s[28:31], s23 offen offset:2048 sc1
buffer_store_dwordx4 v[244:247], v2, s[28:31], s23 offen offset:3072 sc1
buffer_store_dwordx4 v[248:251], v2, s[28:31], s26 offen offset:0 sc1
buffer_store_dwordx4 v[252:255], v2, s[28:31], s26 offen offset:1024 sc1
s_waitcnt lgkmcnt(0)
s_barrier
ds_read_b128 v[16:19], v6 offset:0
ds_read_b128 v[20:23], v6 offset:16
ds_read_b128 v[24:27], v6 offset:32
ds_read_b128 v[28:31], v6 offset:48
s_waitcnt lgkmcnt(0)
v_add_f32 v8, v16, v18
v_add_f32 v9, v17, v19
v_add_f32 v8, v8, v20
v_add_f32 v9, v9, v21
v_add_f32 v8, v8, v22
v_add_f32 v9, v9, v23
v_add_f32 v8, v8, v24
v_add_f32 v9, v9, v25
v_add_f32 v8, v8, v26
v_add_f32 v9, v9, v27
v_add_f32 v8, v8, v28
v_add_f32 v9, v9, v29
v_add_f32 v8, v8, v30
v_add_f32 v9, v9, v31
v_mul_f32 v8, 0x3acccccd, v8
v_mul_f32 v9, 0x3acccccd, v9
v_fma_f32 v9, -v8, v8, v9
v_max_f32 v9, 0, v9
v_cvt_pk_bf16_f32 v7, v8, v9
v_lshlrev_b32 v12, 16, v7
v_and_b32 v9, 0xffff0000, v7
v_add_f32 v9, 0x3727c5ac, v9
v_cvt_pk_bf16_f32 v7, v9, v9
v_lshlrev_b32 v7, 16, v7
v_sqrt_f32 v7, v7
s_nop 0
v_cvt_pk_bf16_f32 v7, v7, v7
v_lshlrev_b32 v7, 16, v7
v_rcp_f32 v14, v7
s_nop 0
v_mul_f32 v12, v12, v14
v_mov_b32 v15, v14
v_mov_b32 v13, v12
s_nop 0
v_permlane32_swap_b32 v14, v15
v_permlane32_swap_b32 v12, v13
s_add_u32 s48, s18, 0
s_sub_u32 s48, s48, s43
s_cselect_b32 s49, 40960, 0
s_add_u32 s48, s48, s49
v_add_u32 v3, s48, v1
v_fma_f32 v112, v112, v14, -v12
v_fma_f32 v113, v113, v14, -v12
v_cvt_pk_bf16_f32 v112, v112, v113
v_fma_f32 v114, v114, v14, -v12
v_fma_f32 v115, v115, v14, -v12
v_cvt_pk_bf16_f32 v113, v114, v115
v_fma_f32 v116, v116, v14, -v12
v_fma_f32 v117, v117, v14, -v12
v_cvt_pk_bf16_f32 v114, v116, v117
v_fma_f32 v118, v118, v14, -v12
v_fma_f32 v119, v119, v14, -v12
v_cvt_pk_bf16_f32 v115, v118, v119
v_fma_f32 v120, v120, v14, -v12
v_fma_f32 v121, v121, v14, -v12
v_cvt_pk_bf16_f32 v116, v120, v121
v_fma_f32 v122, v122, v14, -v12
v_fma_f32 v123, v123, v14, -v12
v_cvt_pk_bf16_f32 v117, v122, v123
v_fma_f32 v124, v124, v14, -v12
v_fma_f32 v125, v125, v14, -v12
v_cvt_pk_bf16_f32 v118, v124, v125
v_fma_f32 v126, v126, v14, -v12
v_fma_f32 v127, v127, v14, -v12
v_cvt_pk_bf16_f32 v119, v126, v127
ds_write_b128 v3, v[112:115] offset:0
ds_write_b128 v3, v[116:119] offset:1024
s_add_u32 s48, s18, 2048
s_sub_u32 s48, s48, s43
s_cselect_b32 s49, 40960, 0
s_add_u32 s48, s48, s49
v_add_u32 v4, s48, v1
v_fma_f32 v144, v144, v14, -v12
v_fma_f32 v145, v145, v14, -v12
v_cvt_pk_bf16_f32 v144, v144, v145
v_fma_f32 v146, v146, v14, -v12
v_fma_f32 v147, v147, v14, -v12
v_cvt_pk_bf16_f32 v145, v146, v147
v_fma_f32 v148, v148, v14, -v12
v_fma_f32 v149, v149, v14, -v12
v_cvt_pk_bf16_f32 v146, v148, v149
v_fma_f32 v150, v150, v14, -v12
v_fma_f32 v151, v151, v14, -v12
v_cvt_pk_bf16_f32 v147, v150, v151
v_fma_f32 v152, v152, v14, -v12
v_fma_f32 v153, v153, v14, -v12
v_cvt_pk_bf16_f32 v148, v152, v153
v_fma_f32 v154, v154, v14, -v12
v_fma_f32 v155, v155, v14, -v12
v_cvt_pk_bf16_f32 v149, v154, v155
v_fma_f32 v156, v156, v14, -v12
v_fma_f32 v157, v157, v14, -v12
v_cvt_pk_bf16_f32 v150, v156, v157
v_fma_f32 v158, v158, v14, -v12
v_fma_f32 v159, v159, v14, -v12
v_cvt_pk_bf16_f32 v151, v158, v159
ds_write_b128 v4, v[144:147] offset:0
ds_write_b128 v4, v[148:151] offset:1024
s_add_u32 s48, s18, 4096
s_sub_u32 s48, s48, s43
s_cselect_b32 s49, 40960, 0
s_add_u32 s48, s48, s49
v_add_u32 v3, s48, v1
v_fma_f32 v176, v176, v14, -v12
v_fma_f32 v177, v177, v14, -v12
v_cvt_pk_bf16_f32 v176, v176, v177
v_fma_f32 v178, v178, v14, -v12
v_fma_f32 v179, v179, v14, -v12
v_cvt_pk_bf16_f32 v177, v178, v179
v_fma_f32 v180, v180, v14, -v12
v_fma_f32 v181, v181, v14, -v12
v_cvt_pk_bf16_f32 v178, v180, v181
v_fma_f32 v182, v182, v14, -v12
v_fma_f32 v183, v183, v14, -v12
v_cvt_pk_bf16_f32 v179, v182, v183
v_fma_f32 v184, v184, v14, -v12
v_fma_f32 v185, v185, v14, -v12
v_cvt_pk_bf16_f32 v180, v184, v185
v_fma_f32 v186, v186, v14, -v12
v_fma_f32 v187, v187, v14, -v12
v_cvt_pk_bf16_f32 v181, v186, v187
v_fma_f32 v188, v188, v14, -v12
v_fma_f32 v189, v189, v14, -v12
v_cvt_pk_bf16_f32 v182, v188, v189
v_fma_f32 v190, v190, v14, -v12
v_fma_f32 v191, v191, v14, -v12
v_cvt_pk_bf16_f32 v183, v190, v191
ds_write_b128 v3, v[176:179] offset:0
ds_write_b128 v3, v[180:183] offset:1024
s_add_u32 s48, s18, 0
s_sub_u32 s48, s48, s43
s_cselect_b32 s49, 40960, 0
s_add_u32 s48, s48, s49
v_add_u32 v3, s48, v2
v_fma_f32 v128, v128, v15, -v13
v_fma_f32 v129, v129, v15, -v13
v_cvt_pk_bf16_f32 v128, v128, v129
v_fma_f32 v130, v130, v15, -v13
v_fma_f32 v131, v131, v15, -v13
v_cvt_pk_bf16_f32 v129, v130, v131
v_fma_f32 v132, v132, v15, -v13
v_fma_f32 v133, v133, v15, -v13
v_cvt_pk_bf16_f32 v130, v132, v133
v_fma_f32 v134, v134, v15, -v13
v_fma_f32 v135, v135, v15, -v13
v_cvt_pk_bf16_f32 v131, v134, v135
v_fma_f32 v136, v136, v15, -v13
v_fma_f32 v137, v137, v15, -v13
v_cvt_pk_bf16_f32 v132, v136, v137
v_fma_f32 v138, v138, v15, -v13
v_fma_f32 v139, v139, v15, -v13
v_cvt_pk_bf16_f32 v133, v138, v139
v_fma_f32 v140, v140, v15, -v13
v_fma_f32 v141, v141, v15, -v13
v_cvt_pk_bf16_f32 v134, v140, v141
v_fma_f32 v142, v142, v15, -v13
v_fma_f32 v143, v143, v15, -v13
v_cvt_pk_bf16_f32 v135, v142, v143
ds_write_b128 v3, v[128:131] offset:0
ds_write_b128 v3, v[132:135] offset:1024
s_add_u32 s48, s18, 2048
s_sub_u32 s48, s48, s43
s_cselect_b32 s49, 40960, 0
s_add_u32 s48, s48, s49
v_add_u32 v4, s48, v2
v_fma_f32 v160, v160, v15, -v13
v_fma_f32 v161, v161, v15, -v13
v_cvt_pk_bf16_f32 v160, v160, v161
v_fma_f32 v162, v162, v15, -v13
v_fma_f32 v163, v163, v15, -v13
v_cvt_pk_bf16_f32 v161, v162, v163
v_fma_f32 v164, v164, v15, -v13
v_fma_f32 v165, v165, v15, -v13
v_cvt_pk_bf16_f32 v162, v164, v165
v_fma_f32 v166, v166, v15, -v13
v_fma_f32 v167, v167, v15, -v13
v_cvt_pk_bf16_f32 v163, v166, v167
v_fma_f32 v168, v168, v15, -v13
v_fma_f32 v169, v169, v15, -v13
v_cvt_pk_bf16_f32 v164, v168, v169
v_fma_f32 v170, v170, v15, -v13
v_fma_f32 v171, v171, v15, -v13
v_cvt_pk_bf16_f32 v165, v170, v171
v_fma_f32 v172, v172, v15, -v13
v_fma_f32 v173, v173, v15, -v13
v_cvt_pk_bf16_f32 v166, v172, v173
v_fma_f32 v174, v174, v15, -v13
v_fma_f32 v175, v175, v15, -v13
v_cvt_pk_bf16_f32 v167, v174, v175
ds_write_b128 v4, v[160:163] offset:0
ds_write_b128 v4, v[164:167] offset:1024
s_add_u32 s48, s18, 4096
s_sub_u32 s48, s48, s43
s_cselect_b32 s49, 40960, 0
s_add_u32 s48, s48, s49
v_add_u32 v3, s48, v2
v_fma_f32 v192, v192, v15, -v13
v_fma_f32 v193, v193, v15, -v13
v_cvt_pk_bf16_f32 v192, v192, v193
v_fma_f32 v194, v194, v15, -v13
v_fma_f32 v195, v195, v15, -v13
v_cvt_pk_bf16_f32 v193, v194, v195
v_fma_f32 v196, v196, v15, -v13
v_fma_f32 v197, v197, v15, -v13
v_cvt_pk_bf16_f32 v194, v196, v197
v_fma_f32 v198, v198, v15, -v13
v_fma_f32 v199, v199, v15, -v13
v_cvt_pk_bf16_f32 v195, v198, v199
v_fma_f32 v200, v200, v15, -v13
v_fma_f32 v201, v201, v15, -v13
v_cvt_pk_bf16_f32 v196, v200, v201
v_fma_f32 v202, v202, v15, -v13
v_fma_f32 v203, v203, v15, -v13
v_cvt_pk_bf16_f32 v197, v202, v203
v_fma_f32 v204, v204, v15, -v13
v_fma_f32 v205, v205, v15, -v13
v_cvt_pk_bf16_f32 v198, v204, v205
v_fma_f32 v206, v206, v15, -v13
v_fma_f32 v207, v207, v15, -v13
v_cvt_pk_bf16_f32 v199, v206, v207
ds_write_b128 v3, v[192:195] offset:0
ds_write_b128 v3, v[196:199] offset:1024
v_mov_b32 v8, 0xc0135761
v_mov_b32 v9, 0xbdd2d3e8
s_mul_i32 s40, s16, 221184
s_mul_i32 s41, s20, 14336
s_add_u32 s40, s40, s41
v_add_u32 v4, 110592, v1
v_mov_b32 v3, v1
s_waitcnt lgkmcnt(0)
s_waitcnt vmcnt(0)
s_barrier
s_cmp_lg_u32 s20, 0
s_cbranch_scc1 .sig_1108
v_lshlrev_b32 v10, 12, v0
v_lshlrev_b32_e64 v11, s2, 1
buffer_atomic_or v11, v10, s[56:59], 0 offen offset:100 sc1
.sig_1108:
ds_read_b128 v[16:19], v1
ds_read_b128 v[20:23], v2
s_waitcnt lgkmcnt(0)
v_mfma_f32_32x32x16_bf16 v[112:127], v[32:35], v[16:19], 0
ds_read_b128 v[24:27], v1 offset:1024
v_mfma_f32_32x32x16_bf16 v[128:143], v[32:35], v[20:23], 0
ds_read_b128 v[28:31], v2 offset:1024
buffer_load_dwordx4 v[32:35], v1, s[8:11], s21 offen offset:0
v_mfma_f32_32x32x16_bf16 v[144:159], v[36:39], v[16:19], 0
v_mfma_f32_32x32x16_bf16 v[160:175], v[36:39], v[20:23], 0
buffer_load_dwordx4 v[36:39], v1, s[8:11], s21 offen offset:1024
v_mfma_f32_32x32x16_bf16 v[176:191], v[40:43], v[16:19], 0
v_mfma_f32_32x32x16_bf16 v[192:207], v[40:43], v[20:23], 0
buffer_load_dwordx4 v[40:43], v1, s[8:11], s21 offen offset:2048
v_mfma_f32_32x32x16_bf16 v[208:223], v[44:47], v[16:19], 0
v_mfma_f32_32x32x16_bf16 v[224:239], v[44:47], v[20:23], 0
buffer_load_dwordx4 v[44:47], v1, s[8:11], s21 offen offset:3072
s_add_u32 s21, s21, 55296
s_waitcnt lgkmcnt(0)
v_mfma_f32_32x32x16_bf16 v[112:127], v[48:51], v[24:27], v[112:127]
ds_read_b128 v[16:19], v1 offset:2048
v_mfma_f32_32x32x16_bf16 v[128:143], v[48:51], v[28:31], v[128:143]
ds_read_b128 v[20:23], v2 offset:2048
buffer_load_dwordx4 v[48:51], v1, s[8:11], s21 offen offset:0
v_mfma_f32_32x32x16_bf16 v[144:159], v[52:55], v[24:27], v[144:159]
v_mfma_f32_32x32x16_bf16 v[160:175], v[52:55], v[28:31], v[160:175]
buffer_load_dwordx4 v[52:55], v1, s[8:11], s21 offen offset:1024
v_mfma_f32_32x32x16_bf16 v[176:191], v[56:59], v[24:27], v[176:191]
v_mfma_f32_32x32x16_bf16 v[192:207], v[56:59], v[28:31], v[192:207]
buffer_load_dwordx4 v[56:59], v1, s[8:11], s21 offen offset:2048
v_mfma_f32_32x32x16_bf16 v[208:223], v[60:63], v[24:27], v[208:223]
v_mfma_f32_32x32x16_bf16 v[224:239], v[60:63], v[28:31], v[224:239]
buffer_load_dwordx4 v[60:63], v1, s[8:11], s21 offen offset:3072
s_add_u32 s21, s21, 55296
s_waitcnt lgkmcnt(0)
v_mfma_f32_32x32x16_bf16 v[112:127], v[64:67], v[16:19], v[112:127]
ds_read_b128 v[24:27], v1 offset:3072
v_mfma_f32_32x32x16_bf16 v[128:143], v[64:67], v[20:23], v[128:143]
ds_read_b128 v[28:31], v2 offset:3072
buffer_load_dwordx4 v[64:67], v1, s[8:11], s21 offen offset:0
v_mfma_f32_32x32x16_bf16 v[144:159], v[68:71], v[16:19], v[144:159]
v_mfma_f32_32x32x16_bf16 v[160:175], v[68:71], v[20:23], v[160:175]
buffer_load_dwordx4 v[68:71], v1, s[8:11], s21 offen offset:1024
v_mfma_f32_32x32x16_bf16 v[176:191], v[72:75], v[16:19], v[176:191]
v_mfma_f32_32x32x16_bf16 v[192:207], v[72:75], v[20:23], v[192:207]
buffer_load_dwordx4 v[72:75], v1, s[8:11], s21 offen offset:2048
v_mfma_f32_32x32x16_bf16 v[208:223], v[76:79], v[16:19], v[208:223]
v_mfma_f32_32x32x16_bf16 v[224:239], v[76:79], v[20:23], v[224:239]
buffer_load_dwordx4 v[76:79], v1, s[8:11], s21 offen offset:3072
s_add_u32 s21, s21, 55296
s_waitcnt lgkmcnt(0)
v_mfma_f32_32x32x16_bf16 v[112:127], v[80:83], v[24:27], v[112:127]
ds_read_b128 v[16:19], v1 offset:4096
v_mfma_f32_32x32x16_bf16 v[128:143], v[80:83], v[28:31], v[128:143]
ds_read_b128 v[20:23], v2 offset:4096
buffer_load_dwordx4 v[80:83], v1, s[8:11], s21 offen offset:0
v_mfma_f32_32x32x16_bf16 v[144:159], v[84:87], v[24:27], v[144:159]
v_mfma_f32_32x32x16_bf16 v[160:175], v[84:87], v[28:31], v[160:175]
buffer_load_dwordx4 v[84:87], v1, s[8:11], s21 offen offset:1024
v_mfma_f32_32x32x16_bf16 v[176:191], v[88:91], v[24:27], v[176:191]
v_mfma_f32_32x32x16_bf16 v[192:207], v[88:91], v[28:31], v[192:207]
buffer_load_dwordx4 v[88:91], v1, s[8:11], s21 offen offset:2048
v_mfma_f32_32x32x16_bf16 v[208:223], v[92:95], v[24:27], v[208:223]
v_mfma_f32_32x32x16_bf16 v[224:239], v[92:95], v[28:31], v[224:239]
buffer_load_dwordx4 v[92:95], v1, s[8:11], s21 offen offset:3072
s_add_u32 s21, s21, 55296
s_waitcnt lgkmcnt(0)
v_mfma_f32_32x32x16_bf16 v[112:127], v[96:99], v[16:19], v[112:127]
ds_read_b128 v[24:27], v1 offset:5120
v_mfma_f32_32x32x16_bf16 v[128:143], v[96:99], v[20:23], v[128:143]
ds_read_b128 v[28:31], v2 offset:5120
buffer_load_dwordx4 v[96:99], v1, s[8:11], s21 offen offset:0
v_mfma_f32_32x32x16_bf16 v[144:159], v[100:103], v[16:19], v[144:159]
v_mfma_f32_32x32x16_bf16 v[160:175], v[100:103], v[20:23], v[160:175]
buffer_load_dwordx4 v[100:103], v1, s[8:11], s21 offen offset:1024
v_mfma_f32_32x32x16_bf16 v[176:191], v[104:107], v[16:19], v[176:191]
v_mfma_f32_32x32x16_bf16 v[192:207], v[104:107], v[20:23], v[192:207]
buffer_load_dwordx4 v[104:107], v1, s[8:11], s21 offen offset:2048
v_mfma_f32_32x32x16_bf16 v[208:223], v[108:111], v[16:19], v[208:223]
v_mfma_f32_32x32x16_bf16 v[224:239], v[108:111], v[20:23], v[224:239]
buffer_load_dwordx4 v[108:111], v1, s[8:11], s21 offen offset:3072
s_add_u32 s21, s21, 55296
s_cmp_ge_u32 s21, s47
s_cselect_b32 s45, 2211840, 0
s_sub_u32 s21, s21, s45
s_waitcnt vmcnt(19)
s_waitcnt lgkmcnt(0)
v_mfma_f32_32x32x16_bf16 v[112:127], v[32:35], v[24:27], v[112:127]
ds_read_b128 v[16:19], v1 offset:6144
v_mfma_f32_32x32x16_bf16 v[128:143], v[32:35], v[28:31], v[128:143]
ds_read_b128 v[20:23], v2 offset:6144
buffer_load_dwordx4 v[32:35], v1, s[8:11], s21 offen offset:0
s_waitcnt vmcnt(19)
v_mfma_f32_32x32x16_bf16 v[144:159], v[36:39], v[24:27], v[144:159]
v_mfma_f32_32x32x16_bf16 v[160:175], v[36:39], v[28:31], v[160:175]
buffer_load_dwordx4 v[36:39], v1, s[8:11], s21 offen offset:1024
s_waitcnt vmcnt(19)
v_mfma_f32_32x32x16_bf16 v[176:191], v[40:43], v[24:27], v[176:191]
v_mfma_f32_32x32x16_bf16 v[192:207], v[40:43], v[28:31], v[192:207]
buffer_load_dwordx4 v[40:43], v1, s[8:11], s21 offen offset:2048
s_waitcnt vmcnt(19)
v_mfma_f32_32x32x16_bf16 v[208:223], v[44:47], v[24:27], v[208:223]
v_mfma_f32_32x32x16_bf16 v[224:239], v[44:47], v[28:31], v[224:239]
buffer_load_dwordx4 v[44:47], v1, s[8:11], s21 offen offset:3072
s_add_u32 s21, s21, 55296
s_waitcnt vmcnt(19)
s_waitcnt lgkmcnt(0)
v_mfma_f32_32x32x16_bf16 v[112:127], v[48:51], v[16:19], v[112:127]
ds_read_b128 v[24:27], v1 offset:7168
v_mfma_f32_32x32x16_bf16 v[128:143], v[48:51], v[20:23], v[128:143]
ds_read_b128 v[28:31], v2 offset:7168
buffer_load_dwordx4 v[48:51], v1, s[8:11], s21 offen offset:0
s_waitcnt vmcnt(19)
v_mfma_f32_32x32x16_bf16 v[144:159], v[52:55], v[16:19], v[144:159]
v_mfma_f32_32x32x16_bf16 v[160:175], v[52:55], v[20:23], v[160:175]
buffer_load_dwordx4 v[52:55], v1, s[8:11], s21 offen offset:1024
s_waitcnt vmcnt(19)
v_mfma_f32_32x32x16_bf16 v[176:191], v[56:59], v[16:19], v[176:191]
v_mfma_f32_32x32x16_bf16 v[192:207], v[56:59], v[20:23], v[192:207]
buffer_load_dwordx4 v[56:59], v1, s[8:11], s21 offen offset:2048
s_waitcnt vmcnt(19)
v_mfma_f32_32x32x16_bf16 v[208:223], v[60:63], v[16:19], v[208:223]
v_mfma_f32_32x32x16_bf16 v[224:239], v[60:63], v[20:23], v[224:239]
buffer_load_dwordx4 v[60:63], v1, s[8:11], s21 offen offset:3072
s_add_u32 s21, s21, 55296
s_waitcnt vmcnt(19)
s_waitcnt lgkmcnt(0)
v_mfma_f32_32x32x16_bf16 v[112:127], v[64:67], v[24:27], v[112:127]
ds_read_b128 v[16:19], v1 offset:8192
v_mfma_f32_32x32x16_bf16 v[128:143], v[64:67], v[28:31], v[128:143]
ds_read_b128 v[20:23], v2 offset:8192
buffer_load_dwordx4 v[64:67], v1, s[8:11], s21 offen offset:0
s_waitcnt vmcnt(19)
v_mfma_f32_32x32x16_bf16 v[144:159], v[68:71], v[24:27], v[144:159]
v_mfma_f32_32x32x16_bf16 v[160:175], v[68:71], v[28:31], v[160:175]
buffer_load_dwordx4 v[68:71], v1, s[8:11], s21 offen offset:1024
s_waitcnt vmcnt(19)
v_mfma_f32_32x32x16_bf16 v[176:191], v[72:75], v[24:27], v[176:191]
v_mfma_f32_32x32x16_bf16 v[192:207], v[72:75], v[28:31], v[192:207]
buffer_load_dwordx4 v[72:75], v1, s[8:11], s21 offen offset:2048
s_waitcnt vmcnt(19)
v_mfma_f32_32x32x16_bf16 v[208:223], v[76:79], v[24:27], v[208:223]
v_mfma_f32_32x32x16_bf16 v[224:239], v[76:79], v[28:31], v[224:239]
buffer_load_dwordx4 v[76:79], v1, s[8:11], s21 offen offset:3072
s_add_u32 s21, s21, 55296
s_waitcnt vmcnt(19)
s_waitcnt lgkmcnt(0)
v_mfma_f32_32x32x16_bf16 v[112:127], v[80:83], v[16:19], v[112:127]
ds_read_b128 v[24:27], v1 offset:9216
v_mfma_f32_32x32x16_bf16 v[128:143], v[80:83], v[20:23], v[128:143]
ds_read_b128 v[28:31], v2 offset:9216
buffer_load_dwordx4 v[80:83], v1, s[8:11], s21 offen offset:0
s_waitcnt vmcnt(19)
v_mfma_f32_32x32x16_bf16 v[144:159], v[84:87], v[16:19], v[144:159]
v_mfma_f32_32x32x16_bf16 v[160:175], v[84:87], v[20:23], v[160:175]
buffer_load_dwordx4 v[84:87], v1, s[8:11], s21 offen offset:1024
s_waitcnt vmcnt(19)
v_mfma_f32_32x32x16_bf16 v[176:191], v[88:91], v[16:19], v[176:191]
v_mfma_f32_32x32x16_bf16 v[192:207], v[88:91], v[20:23], v[192:207]
buffer_load_dwordx4 v[88:91], v1, s[8:11], s21 offen offset:2048
s_waitcnt vmcnt(19)
v_mfma_f32_32x32x16_bf16 v[208:223], v[92:95], v[16:19], v[208:223]
v_mfma_f32_32x32x16_bf16 v[224:239], v[92:95], v[20:23], v[224:239]
buffer_load_dwordx4 v[92:95], v1, s[8:11], s21 offen offset:3072
s_add_u32 s21, s21, 55296
s_waitcnt vmcnt(19)
s_waitcnt lgkmcnt(0)
v_mfma_f32_32x32x16_bf16 v[112:127], v[96:99], v[24:27], v[112:127]
ds_read_b128 v[16:19], v1 offset:10240
v_mfma_f32_32x32x16_bf16 v[128:143], v[96:99], v[28:31], v[128:143]
ds_read_b128 v[20:23], v2 offset:10240
buffer_load_dwordx4 v[96:99], v1, s[8:11], s21 offen offset:0
s_waitcnt vmcnt(19)
v_mfma_f32_32x32x16_bf16 v[144:159], v[100:103], v[24:27], v[144:159]
v_mfma_f32_32x32x16_bf16 v[160:175], v[100:103], v[28:31], v[160:175]
buffer_load_dwordx4 v[100:103], v1, s[8:11], s21 offen offset:1024
s_waitcnt vmcnt(19)
v_mfma_f32_32x32x16_bf16 v[176:191], v[104:107], v[24:27], v[176:191]
v_mfma_f32_32x32x16_bf16 v[192:207], v[104:107], v[28:31], v[192:207]
buffer_load_dwordx4 v[104:107], v1, s[8:11], s21 offen offset:2048
s_waitcnt vmcnt(19)
v_mfma_f32_32x32x16_bf16 v[208:223], v[108:111], v[24:27], v[208:223]
v_mfma_f32_32x32x16_bf16 v[224:239], v[108:111], v[28:31], v[224:239]
buffer_load_dwordx4 v[108:111], v1, s[8:11], s21 offen offset:3072
s_add_u32 s21, s21, 55296
s_waitcnt vmcnt(19)
s_waitcnt lgkmcnt(0)
v_mfma_f32_32x32x16_bf16 v[112:127], v[32:35], v[16:19], v[112:127]
ds_read_b128 v[24:27], v1 offset:11264
v_mfma_f32_32x32x16_bf16 v[128:143], v[32:35], v[20:23], v[128:143]
ds_read_b128 v[28:31], v2 offset:11264
buffer_load_dwordx4 v[32:35], v1, s[8:11], s21 offen offset:0
s_waitcnt vmcnt(19)
v_mfma_f32_32x32x16_bf16 v[144:159], v[36:39], v[16:19], v[144:159]
v_mfma_f32_32x32x16_bf16 v[160:175], v[36:39], v[20:23], v[160:175]
buffer_load_dwordx4 v[36:39], v1, s[8:11], s21 offen offset:1024
s_waitcnt vmcnt(19)
v_mfma_f32_32x32x16_bf16 v[176:191], v[40:43], v[16:19], v[176:191]
v_mfma_f32_32x32x16_bf16 v[192:207], v[40:43], v[20:23], v[192:207]
buffer_load_dwordx4 v[40:43], v1, s[8:11], s21 offen offset:2048
s_waitcnt vmcnt(19)
v_mfma_f32_32x32x16_bf16 v[208:223], v[44:47], v[16:19], v[208:223]
v_mfma_f32_32x32x16_bf16 v[224:239], v[44:47], v[20:23], v[224:239]
buffer_load_dwordx4 v[44:47], v1, s[8:11], s21 offen offset:3072
s_add_u32 s21, s21, 55296
s_waitcnt vmcnt(19)
s_waitcnt lgkmcnt(0)
v_mfma_f32_32x32x16_bf16 v[112:127], v[48:51], v[24:27], v[112:127]
ds_read_b128 v[16:19], v1 offset:12288
v_mfma_f32_32x32x16_bf16 v[128:143], v[48:51], v[28:31], v[128:143]
ds_read_b128 v[20:23], v2 offset:12288
buffer_load_dwordx4 v[48:51], v1, s[8:11], s21 offen offset:0
s_waitcnt vmcnt(19)
v_mfma_f32_32x32x16_bf16 v[144:159], v[52:55], v[24:27], v[144:159]
v_mfma_f32_32x32x16_bf16 v[160:175], v[52:55], v[28:31], v[160:175]
buffer_load_dwordx4 v[52:55], v1, s[8:11], s21 offen offset:1024
s_waitcnt vmcnt(19)
v_mfma_f32_32x32x16_bf16 v[176:191], v[56:59], v[24:27], v[176:191]
v_mfma_f32_32x32x16_bf16 v[192:207], v[56:59], v[28:31], v[192:207]
buffer_load_dwordx4 v[56:59], v1, s[8:11], s21 offen offset:2048
s_waitcnt vmcnt(19)
v_mfma_f32_32x32x16_bf16 v[208:223], v[60:63], v[24:27], v[208:223]
v_mfma_f32_32x32x16_bf16 v[224:239], v[60:63], v[28:31], v[224:239]
buffer_load_dwordx4 v[60:63], v1, s[8:11], s21 offen offset:3072
s_add_u32 s21, s21, 55296
s_waitcnt vmcnt(19)
s_waitcnt lgkmcnt(0)
v_mfma_f32_32x32x16_bf16 v[112:127], v[64:67], v[16:19], v[112:127]
ds_read_b128 v[24:27], v1 offset:13312
v_mfma_f32_32x32x16_bf16 v[128:143], v[64:67], v[20:23], v[128:143]
ds_read_b128 v[28:31], v2 offset:13312
buffer_load_dwordx4 v[64:67], v1, s[8:11], s21 offen offset:0
s_waitcnt vmcnt(19)
v_mfma_f32_32x32x16_bf16 v[144:159], v[68:71], v[16:19], v[144:159]
v_mfma_f32_32x32x16_bf16 v[160:175], v[68:71], v[20:23], v[160:175]
buffer_load_dwordx4 v[68:71], v1, s[8:11], s21 offen offset:1024
s_waitcnt vmcnt(19)
v_mfma_f32_32x32x16_bf16 v[176:191], v[72:75], v[16:19], v[176:191]
v_mfma_f32_32x32x16_bf16 v[192:207], v[72:75], v[20:23], v[192:207]
buffer_load_dwordx4 v[72:75], v1, s[8:11], s21 offen offset:2048
s_waitcnt vmcnt(19)
v_mfma_f32_32x32x16_bf16 v[208:223], v[76:79], v[16:19], v[208:223]
v_mfma_f32_32x32x16_bf16 v[224:239], v[76:79], v[20:23], v[224:239]
buffer_load_dwordx4 v[76:79], v1, s[8:11], s21 offen offset:3072
s_add_u32 s21, s21, 55296
s_waitcnt vmcnt(19)
s_waitcnt lgkmcnt(0)
v_mfma_f32_32x32x16_bf16 v[112:127], v[80:83], v[24:27], v[112:127]
ds_read_b128 v[16:19], v1 offset:14336
v_mfma_f32_32x32x16_bf16 v[128:143], v[80:83], v[28:31], v[128:143]
ds_read_b128 v[20:23], v2 offset:14336
buffer_load_dwordx4 v[80:83], v1, s[8:11], s21 offen offset:0
s_waitcnt vmcnt(19)
v_mfma_f32_32x32x16_bf16 v[144:159], v[84:87], v[24:27], v[144:159]
v_mfma_f32_32x32x16_bf16 v[160:175], v[84:87], v[28:31], v[160:175]
buffer_load_dwordx4 v[84:87], v1, s[8:11], s21 offen offset:1024
s_waitcnt vmcnt(19)
v_mfma_f32_32x32x16_bf16 v[176:191], v[88:91], v[24:27], v[176:191]
v_mfma_f32_32x32x16_bf16 v[192:207], v[88:91], v[28:31], v[192:207]
buffer_load_dwordx4 v[88:91], v1, s[8:11], s21 offen offset:2048
s_waitcnt vmcnt(19)
v_mfma_f32_32x32x16_bf16 v[208:223], v[92:95], v[24:27], v[208:223]
v_mfma_f32_32x32x16_bf16 v[224:239], v[92:95], v[28:31], v[224:239]
buffer_load_dwordx4 v[92:95], v1, s[8:11], s21 offen offset:3072
s_add_u32 s21, s21, 55296
s_waitcnt vmcnt(19)
s_waitcnt lgkmcnt(0)
v_mfma_f32_32x32x16_bf16 v[112:127], v[96:99], v[16:19], v[112:127]
ds_read_b128 v[24:27], v1 offset:15360
v_mfma_f32_32x32x16_bf16 v[128:143], v[96:99], v[20:23], v[128:143]
ds_read_b128 v[28:31], v2 offset:15360
buffer_load_dwordx4 v[96:99], v1, s[8:11], s21 offen offset:0
s_waitcnt vmcnt(19)
v_mfma_f32_32x32x16_bf16 v[144:159], v[100:103], v[16:19], v[144:159]
v_mfma_f32_32x32x16_bf16 v[160:175], v[100:103], v[20:23], v[160:175]
buffer_load_dwordx4 v[100:103], v1, s[8:11], s21 offen offset:1024
s_waitcnt vmcnt(19)
v_mfma_f32_32x32x16_bf16 v[176:191], v[104:107], v[16:19], v[176:191]
v_mfma_f32_32x32x16_bf16 v[192:207], v[104:107], v[20:23], v[192:207]
buffer_load_dwordx4 v[104:107], v1, s[8:11], s21 offen offset:2048
s_waitcnt vmcnt(19)
v_mfma_f32_32x32x16_bf16 v[208:223], v[108:111], v[16:19], v[208:223]
v_mfma_f32_32x32x16_bf16 v[224:239], v[108:111], v[20:23], v[224:239]
buffer_load_dwordx4 v[108:111], v1, s[8:11], s21 offen offset:3072
s_add_u32 s21, s21, 55296
s_cmp_ge_u32 s21, s47
s_cselect_b32 s45, 2211840, 0
s_sub_u32 s21, s21, s45
s_waitcnt vmcnt(19)
s_waitcnt lgkmcnt(0)
v_mfma_f32_32x32x16_bf16 v[112:127], v[32:35], v[24:27], v[112:127]
ds_read_b128 v[16:19], v1 offset:16384
v_mfma_f32_32x32x16_bf16 v[128:143], v[32:35], v[28:31], v[128:143]
ds_read_b128 v[20:23], v2 offset:16384
buffer_load_dwordx4 v[32:35], v1, s[8:11], s21 offen offset:0
s_waitcnt vmcnt(19)
v_mfma_f32_32x32x16_bf16 v[144:159], v[36:39], v[24:27], v[144:159]
v_mfma_f32_32x32x16_bf16 v[160:175], v[36:39], v[28:31], v[160:175]
buffer_load_dwordx4 v[36:39], v1, s[8:11], s21 offen offset:1024
s_waitcnt vmcnt(19)
v_mfma_f32_32x32x16_bf16 v[176:191], v[40:43], v[24:27], v[176:191]
v_mfma_f32_32x32x16_bf16 v[192:207], v[40:43], v[28:31], v[192:207]
buffer_load_dwordx4 v[40:43], v1, s[8:11], s21 offen offset:2048
s_waitcnt vmcnt(19)
v_mfma_f32_32x32x16_bf16 v[208:223], v[44:47], v[24:27], v[208:223]
v_mfma_f32_32x32x16_bf16 v[224:239], v[44:47], v[28:31], v[224:239]
buffer_load_dwordx4 v[44:47], v1, s[8:11], s21 offen offset:3072
s_add_u32 s21, s21, 55296
s_waitcnt vmcnt(19)
s_waitcnt lgkmcnt(0)
v_mfma_f32_32x32x16_bf16 v[112:127], v[48:51], v[16:19], v[112:127]
ds_read_b128 v[24:27], v1 offset:17408
v_mfma_f32_32x32x16_bf16 v[128:143], v[48:51], v[20:23], v[128:143]
ds_read_b128 v[28:31], v2 offset:17408
buffer_load_dwordx4 v[48:51], v1, s[8:11], s21 offen offset:0
s_waitcnt vmcnt(19)
v_mfma_f32_32x32x16_bf16 v[144:159], v[52:55], v[16:19], v[144:159]
v_mfma_f32_32x32x16_bf16 v[160:175], v[52:55], v[20:23], v[160:175]
buffer_load_dwordx4 v[52:55], v1, s[8:11], s21 offen offset:1024
s_waitcnt vmcnt(19)
v_mfma_f32_32x32x16_bf16 v[176:191], v[56:59], v[16:19], v[176:191]
v_mfma_f32_32x32x16_bf16 v[192:207], v[56:59], v[20:23], v[192:207]
buffer_load_dwordx4 v[56:59], v1, s[8:11], s21 offen offset:2048
s_waitcnt vmcnt(19)
v_mfma_f32_32x32x16_bf16 v[208:223], v[60:63], v[16:19], v[208:223]
v_mfma_f32_32x32x16_bf16 v[224:239], v[60:63], v[20:23], v[224:239]
buffer_load_dwordx4 v[60:63], v1, s[8:11], s21 offen offset:3072
s_add_u32 s21, s21, 55296
s_waitcnt vmcnt(19)
s_waitcnt lgkmcnt(0)
v_mfma_f32_32x32x16_bf16 v[112:127], v[64:67], v[24:27], v[112:127]
ds_read_b128 v[16:19], v1 offset:18432
v_mfma_f32_32x32x16_bf16 v[128:143], v[64:67], v[28:31], v[128:143]
ds_read_b128 v[20:23], v2 offset:18432
buffer_load_dwordx4 v[64:67], v1, s[8:11], s21 offen offset:0
s_waitcnt vmcnt(19)
v_mfma_f32_32x32x16_bf16 v[144:159], v[68:71], v[24:27], v[144:159]
v_mfma_f32_32x32x16_bf16 v[160:175], v[68:71], v[28:31], v[160:175]
buffer_load_dwordx4 v[68:71], v1, s[8:11], s21 offen offset:1024
s_waitcnt vmcnt(19)
v_mfma_f32_32x32x16_bf16 v[176:191], v[72:75], v[24:27], v[176:191]
v_mfma_f32_32x32x16_bf16 v[192:207], v[72:75], v[28:31], v[192:207]
buffer_load_dwordx4 v[72:75], v1, s[8:11], s21 offen offset:2048
s_waitcnt vmcnt(19)
v_mfma_f32_32x32x16_bf16 v[208:223], v[76:79], v[24:27], v[208:223]
v_mfma_f32_32x32x16_bf16 v[224:239], v[76:79], v[28:31], v[224:239]
buffer_load_dwordx4 v[76:79], v1, s[8:11], s21 offen offset:3072
s_add_u32 s21, s21, 55296
s_waitcnt vmcnt(19)
s_waitcnt lgkmcnt(0)
v_mfma_f32_32x32x16_bf16 v[112:127], v[80:83], v[16:19], v[112:127]
ds_read_b128 v[24:27], v1 offset:19456
v_mfma_f32_32x32x16_bf16 v[128:143], v[80:83], v[20:23], v[128:143]
ds_read_b128 v[28:31], v2 offset:19456
buffer_load_dwordx4 v[80:83], v1, s[8:11], s21 offen offset:0
s_waitcnt vmcnt(19)
v_mfma_f32_32x32x16_bf16 v[144:159], v[84:87], v[16:19], v[144:159]
v_mfma_f32_32x32x16_bf16 v[160:175], v[84:87], v[20:23], v[160:175]
buffer_load_dwordx4 v[84:87], v1, s[8:11], s21 offen offset:1024
s_waitcnt vmcnt(19)
v_mfma_f32_32x32x16_bf16 v[176:191], v[88:91], v[16:19], v[176:191]
v_mfma_f32_32x32x16_bf16 v[192:207], v[88:91], v[20:23], v[192:207]
buffer_load_dwordx4 v[88:91], v1, s[8:11], s21 offen offset:2048
s_waitcnt vmcnt(19)
v_mfma_f32_32x32x16_bf16 v[208:223], v[92:95], v[16:19], v[208:223]
v_mfma_f32_32x32x16_bf16 v[224:239], v[92:95], v[20:23], v[224:239]
buffer_load_dwordx4 v[92:95], v1, s[8:11], s21 offen offset:3072
s_add_u32 s21, s21, 55296
s_waitcnt vmcnt(19)
s_waitcnt lgkmcnt(0)
v_mfma_f32_32x32x16_bf16 v[112:127], v[96:99], v[24:27], v[112:127]
ds_read_b128 v[16:19], v1 offset:20480
v_mfma_f32_32x32x16_bf16 v[128:143], v[96:99], v[28:31], v[128:143]
ds_read_b128 v[20:23], v2 offset:20480
buffer_load_dwordx4 v[96:99], v1, s[8:11], s21 offen offset:0
s_waitcnt vmcnt(19)
v_mfma_f32_32x32x16_bf16 v[144:159], v[100:103], v[24:27], v[144:159]
v_mfma_f32_32x32x16_bf16 v[160:175], v[100:103], v[28:31], v[160:175]
buffer_load_dwordx4 v[100:103], v1, s[8:11], s21 offen offset:1024
s_waitcnt vmcnt(19)
v_mfma_f32_32x32x16_bf16 v[176:191], v[104:107], v[24:27], v[176:191]
v_mfma_f32_32x32x16_bf16 v[192:207], v[104:107], v[28:31], v[192:207]
buffer_load_dwordx4 v[104:107], v1, s[8:11], s21 offen offset:2048
s_waitcnt vmcnt(19)
v_mfma_f32_32x32x16_bf16 v[208:223], v[108:111], v[24:27], v[208:223]
v_mfma_f32_32x32x16_bf16 v[224:239], v[108:111], v[28:31], v[224:239]
buffer_load_dwordx4 v[108:111], v1, s[8:11], s21 offen offset:3072
s_add_u32 s21, s21, 55296
s_waitcnt vmcnt(19)
s_waitcnt lgkmcnt(0)
v_mfma_f32_32x32x16_bf16 v[112:127], v[32:35], v[16:19], v[112:127]
ds_read_b128 v[24:27], v1 offset:21504
v_mfma_f32_32x32x16_bf16 v[128:143], v[32:35], v[20:23], v[128:143]
ds_read_b128 v[28:31], v2 offset:21504
buffer_load_dwordx4 v[32:35], v1, s[8:11], s21 offen offset:0
s_waitcnt vmcnt(19)
v_mfma_f32_32x32x16_bf16 v[144:159], v[36:39], v[16:19], v[144:159]
v_mfma_f32_32x32x16_bf16 v[160:175], v[36:39], v[20:23], v[160:175]
buffer_load_dwordx4 v[36:39], v1, s[8:11], s21 offen offset:1024
s_waitcnt vmcnt(19)
v_mfma_f32_32x32x16_bf16 v[176:191], v[40:43], v[16:19], v[176:191]
v_mfma_f32_32x32x16_bf16 v[192:207], v[40:43], v[20:23], v[192:207]
buffer_load_dwordx4 v[40:43], v1, s[8:11], s21 offen offset:2048
s_waitcnt vmcnt(19)
v_mfma_f32_32x32x16_bf16 v[208:223], v[44:47], v[16:19], v[208:223]
v_mfma_f32_32x32x16_bf16 v[224:239], v[44:47], v[20:23], v[224:239]
buffer_load_dwordx4 v[44:47], v1, s[8:11], s21 offen offset:3072
s_add_u32 s21, s21, 55296
s_waitcnt vmcnt(19)
s_waitcnt lgkmcnt(0)
v_mfma_f32_32x32x16_bf16 v[112:127], v[48:51], v[24:27], v[112:127]
ds_read_b128 v[16:19], v1 offset:22528
v_mfma_f32_32x32x16_bf16 v[128:143], v[48:51], v[28:31], v[128:143]
ds_read_b128 v[20:23], v2 offset:22528
buffer_load_dwordx4 v[48:51], v1, s[8:11], s21 offen offset:0
s_waitcnt vmcnt(19)
v_mfma_f32_32x32x16_bf16 v[144:159], v[52:55], v[24:27], v[144:159]
v_mfma_f32_32x32x16_bf16 v[160:175], v[52:55], v[28:31], v[160:175]
buffer_load_dwordx4 v[52:55], v1, s[8:11], s21 offen offset:1024
s_waitcnt vmcnt(19)
v_mfma_f32_32x32x16_bf16 v[176:191], v[56:59], v[24:27], v[176:191]
v_mfma_f32_32x32x16_bf16 v[192:207], v[56:59], v[28:31], v[192:207]
buffer_load_dwordx4 v[56:59], v1, s[8:11], s21 offen offset:2048
s_waitcnt vmcnt(19)
v_mfma_f32_32x32x16_bf16 v[208:223], v[60:63], v[24:27], v[208:223]
v_mfma_f32_32x32x16_bf16 v[224:239], v[60:63], v[28:31], v[224:239]
buffer_load_dwordx4 v[60:63], v1, s[8:11], s21 offen offset:3072
s_add_u32 s21, s21, 55296
s_waitcnt vmcnt(19)
s_waitcnt lgkmcnt(0)
v_mfma_f32_32x32x16_bf16 v[112:127], v[64:67], v[16:19], v[112:127]
ds_read_b128 v[24:27], v1 offset:23552
v_mfma_f32_32x32x16_bf16 v[128:143], v[64:67], v[20:23], v[128:143]
ds_read_b128 v[28:31], v2 offset:23552
buffer_load_dwordx4 v[64:67], v1, s[8:11], s21 offen offset:0
s_waitcnt vmcnt(19)
v_mfma_f32_32x32x16_bf16 v[144:159], v[68:71], v[16:19], v[144:159]
v_mfma_f32_32x32x16_bf16 v[160:175], v[68:71], v[20:23], v[160:175]
buffer_load_dwordx4 v[68:71], v1, s[8:11], s21 offen offset:1024
s_waitcnt vmcnt(19)
v_mfma_f32_32x32x16_bf16 v[176:191], v[72:75], v[16:19], v[176:191]
v_mfma_f32_32x32x16_bf16 v[192:207], v[72:75], v[20:23], v[192:207]
buffer_load_dwordx4 v[72:75], v1, s[8:11], s21 offen offset:2048
s_waitcnt vmcnt(19)
v_mfma_f32_32x32x16_bf16 v[208:223], v[76:79], v[16:19], v[208:223]
v_mfma_f32_32x32x16_bf16 v[224:239], v[76:79], v[20:23], v[224:239]
buffer_load_dwordx4 v[76:79], v1, s[8:11], s21 offen offset:3072
s_add_u32 s21, s21, 55296
s_waitcnt vmcnt(19)
s_waitcnt lgkmcnt(0)
v_mfma_f32_32x32x16_bf16 v[112:127], v[80:83], v[24:27], v[112:127]
ds_read_b128 v[16:19], v1 offset:24576
v_mfma_f32_32x32x16_bf16 v[128:143], v[80:83], v[28:31], v[128:143]
ds_read_b128 v[20:23], v2 offset:24576
buffer_load_dwordx4 v[80:83], v1, s[8:11], s21 offen offset:0
s_waitcnt vmcnt(19)
v_mfma_f32_32x32x16_bf16 v[144:159], v[84:87], v[24:27], v[144:159]
v_mfma_f32_32x32x16_bf16 v[160:175], v[84:87], v[28:31], v[160:175]
buffer_load_dwordx4 v[84:87], v1, s[8:11], s21 offen offset:1024
s_waitcnt vmcnt(19)
v_mfma_f32_32x32x16_bf16 v[176:191], v[88:91], v[24:27], v[176:191]
v_mfma_f32_32x32x16_bf16 v[192:207], v[88:91], v[28:31], v[192:207]
buffer_load_dwordx4 v[88:91], v1, s[8:11], s21 offen offset:2048
s_waitcnt vmcnt(19)
v_mfma_f32_32x32x16_bf16 v[208:223], v[92:95], v[24:27], v[208:223]
v_mfma_f32_32x32x16_bf16 v[224:239], v[92:95], v[28:31], v[224:239]
buffer_load_dwordx4 v[92:95], v1, s[8:11], s21 offen offset:3072
s_add_u32 s21, s21, 55296
s_waitcnt vmcnt(19)
s_waitcnt lgkmcnt(0)
v_mfma_f32_32x32x16_bf16 v[112:127], v[96:99], v[16:19], v[112:127]
ds_read_b128 v[24:27], v1 offset:25600
v_mfma_f32_32x32x16_bf16 v[128:143], v[96:99], v[20:23], v[128:143]
ds_read_b128 v[28:31], v2 offset:25600
buffer_load_dwordx4 v[96:99], v1, s[8:11], s21 offen offset:0
s_waitcnt vmcnt(19)
v_mfma_f32_32x32x16_bf16 v[144:159], v[100:103], v[16:19], v[144:159]
v_mfma_f32_32x32x16_bf16 v[160:175], v[100:103], v[20:23], v[160:175]
buffer_load_dwordx4 v[100:103], v1, s[8:11], s21 offen offset:1024
s_waitcnt vmcnt(19)
v_mfma_f32_32x32x16_bf16 v[176:191], v[104:107], v[16:19], v[176:191]
v_mfma_f32_32x32x16_bf16 v[192:207], v[104:107], v[20:23], v[192:207]
buffer_load_dwordx4 v[104:107], v1, s[8:11], s21 offen offset:2048
s_waitcnt vmcnt(19)
v_mfma_f32_32x32x16_bf16 v[208:223], v[108:111], v[16:19], v[208:223]
v_mfma_f32_32x32x16_bf16 v[224:239], v[108:111], v[20:23], v[224:239]
buffer_load_dwordx4 v[108:111], v1, s[8:11], s21 offen offset:3072
s_add_u32 s21, s21, 55296
s_cmp_ge_u32 s21, s47
s_cselect_b32 s45, 2211840, 0
s_sub_u32 s21, s21, s45
s_waitcnt vmcnt(19)
s_waitcnt lgkmcnt(0)
v_mfma_f32_32x32x16_bf16 v[112:127], v[32:35], v[24:27], v[112:127]
ds_read_b128 v[16:19], v1 offset:26624
v_mfma_f32_32x32x16_bf16 v[128:143], v[32:35], v[28:31], v[128:143]
ds_read_b128 v[20:23], v2 offset:26624
buffer_load_dwordx4 v[32:35], v1, s[8:11], s21 offen offset:0
s_waitcnt vmcnt(19)
v_mfma_f32_32x32x16_bf16 v[144:159], v[36:39], v[24:27], v[144:159]
v_mfma_f32_32x32x16_bf16 v[160:175], v[36:39], v[28:31], v[160:175]
buffer_load_dwordx4 v[36:39], v1, s[8:11], s21 offen offset:1024
s_waitcnt vmcnt(19)
v_mfma_f32_32x32x16_bf16 v[176:191], v[40:43], v[24:27], v[176:191]
v_mfma_f32_32x32x16_bf16 v[192:207], v[40:43], v[28:31], v[192:207]
buffer_load_dwordx4 v[40:43], v1, s[8:11], s21 offen offset:2048
s_waitcnt vmcnt(19)
v_mfma_f32_32x32x16_bf16 v[208:223], v[44:47], v[24:27], v[208:223]
v_mfma_f32_32x32x16_bf16 v[224:239], v[44:47], v[28:31], v[224:239]
buffer_load_dwordx4 v[44:47], v1, s[8:11], s21 offen offset:3072
s_add_u32 s21, s21, 55296
s_waitcnt vmcnt(19)
s_waitcnt lgkmcnt(0)
v_mfma_f32_32x32x16_bf16 v[112:127], v[48:51], v[16:19], v[112:127]
ds_read_b128 v[24:27], v1 offset:27648
v_mfma_f32_32x32x16_bf16 v[128:143], v[48:51], v[20:23], v[128:143]
ds_read_b128 v[28:31], v2 offset:27648
buffer_load_dwordx4 v[48:51], v1, s[8:11], s21 offen offset:0
s_waitcnt vmcnt(19)
v_mfma_f32_32x32x16_bf16 v[144:159], v[52:55], v[16:19], v[144:159]
v_mfma_f32_32x32x16_bf16 v[160:175], v[52:55], v[20:23], v[160:175]
buffer_load_dwordx4 v[52:55], v1, s[8:11], s21 offen offset:1024
s_waitcnt vmcnt(19)
v_mfma_f32_32x32x16_bf16 v[176:191], v[56:59], v[16:19], v[176:191]
v_mfma_f32_32x32x16_bf16 v[192:207], v[56:59], v[20:23], v[192:207]
buffer_load_dwordx4 v[56:59], v1, s[8:11], s21 offen offset:2048
s_waitcnt vmcnt(19)
v_mfma_f32_32x32x16_bf16 v[208:223], v[60:63], v[16:19], v[208:223]
v_mfma_f32_32x32x16_bf16 v[224:239], v[60:63], v[20:23], v[224:239]
buffer_load_dwordx4 v[60:63], v1, s[8:11], s21 offen offset:3072
s_add_u32 s21, s21, 55296
s_waitcnt vmcnt(19)
s_waitcnt lgkmcnt(0)
v_mfma_f32_32x32x16_bf16 v[112:127], v[64:67], v[24:27], v[112:127]
ds_read_b128 v[16:19], v1 offset:28672
v_mfma_f32_32x32x16_bf16 v[128:143], v[64:67], v[28:31], v[128:143]
ds_read_b128 v[20:23], v2 offset:28672
buffer_load_dwordx4 v[64:67], v1, s[8:11], s21 offen offset:0
s_waitcnt vmcnt(19)
v_mfma_f32_32x32x16_bf16 v[144:159], v[68:71], v[24:27], v[144:159]
v_mfma_f32_32x32x16_bf16 v[160:175], v[68:71], v[28:31], v[160:175]
buffer_load_dwordx4 v[68:71], v1, s[8:11], s21 offen offset:1024
s_waitcnt vmcnt(19)
v_mfma_f32_32x32x16_bf16 v[176:191], v[72:75], v[24:27], v[176:191]
v_mfma_f32_32x32x16_bf16 v[192:207], v[72:75], v[28:31], v[192:207]
buffer_load_dwordx4 v[72:75], v1, s[8:11], s21 offen offset:2048
s_waitcnt vmcnt(19)
v_mfma_f32_32x32x16_bf16 v[208:223], v[76:79], v[24:27], v[208:223]
v_mfma_f32_32x32x16_bf16 v[224:239], v[76:79], v[28:31], v[224:239]
buffer_load_dwordx4 v[76:79], v1, s[8:11], s21 offen offset:3072
s_add_u32 s21, s21, 55296
s_waitcnt vmcnt(19)
s_waitcnt lgkmcnt(0)
v_mfma_f32_32x32x16_bf16 v[112:127], v[80:83], v[16:19], v[112:127]
ds_read_b128 v[24:27], v1 offset:29696
v_mfma_f32_32x32x16_bf16 v[128:143], v[80:83], v[20:23], v[128:143]
ds_read_b128 v[28:31], v2 offset:29696
buffer_load_dwordx4 v[80:83], v1, s[8:11], s21 offen offset:0
s_waitcnt vmcnt(19)
v_mfma_f32_32x32x16_bf16 v[144:159], v[84:87], v[16:19], v[144:159]
v_mfma_f32_32x32x16_bf16 v[160:175], v[84:87], v[20:23], v[160:175]
buffer_load_dwordx4 v[84:87], v1, s[8:11], s21 offen offset:1024
s_waitcnt vmcnt(19)
v_mfma_f32_32x32x16_bf16 v[176:191], v[88:91], v[16:19], v[176:191]
v_mfma_f32_32x32x16_bf16 v[192:207], v[88:91], v[20:23], v[192:207]
buffer_load_dwordx4 v[88:91], v1, s[8:11], s21 offen offset:2048
s_waitcnt vmcnt(19)
v_mfma_f32_32x32x16_bf16 v[208:223], v[92:95], v[16:19], v[208:223]
v_mfma_f32_32x32x16_bf16 v[224:239], v[92:95], v[20:23], v[224:239]
buffer_load_dwordx4 v[92:95], v1, s[8:11], s21 offen offset:3072
s_add_u32 s21, s21, 55296
s_waitcnt vmcnt(19)
s_waitcnt lgkmcnt(0)
v_mfma_f32_32x32x16_bf16 v[112:127], v[96:99], v[24:27], v[112:127]
ds_read_b128 v[16:19], v1 offset:30720
v_mfma_f32_32x32x16_bf16 v[128:143], v[96:99], v[28:31], v[128:143]
ds_read_b128 v[20:23], v2 offset:30720
buffer_load_dwordx4 v[96:99], v1, s[8:11], s21 offen offset:0
s_waitcnt vmcnt(19)
v_mfma_f32_32x32x16_bf16 v[144:159], v[100:103], v[24:27], v[144:159]
v_mfma_f32_32x32x16_bf16 v[160:175], v[100:103], v[28:31], v[160:175]
buffer_load_dwordx4 v[100:103], v1, s[8:11], s21 offen offset:1024
s_waitcnt vmcnt(19)
v_mfma_f32_32x32x16_bf16 v[176:191], v[104:107], v[24:27], v[176:191]
v_mfma_f32_32x32x16_bf16 v[192:207], v[104:107], v[28:31], v[192:207]
buffer_load_dwordx4 v[104:107], v1, s[8:11], s21 offen offset:2048
s_waitcnt vmcnt(19)
v_mfma_f32_32x32x16_bf16 v[208:223], v[108:111], v[24:27], v[208:223]
v_mfma_f32_32x32x16_bf16 v[224:239], v[108:111], v[28:31], v[224:239]
buffer_load_dwordx4 v[108:111], v1, s[8:11], s21 offen offset:3072
s_add_u32 s21, s21, 55296
s_waitcnt vmcnt(19)
s_waitcnt lgkmcnt(0)
v_mfma_f32_32x32x16_bf16 v[112:127], v[32:35], v[16:19], v[112:127]
ds_read_b128 v[24:27], v1 offset:31744
v_mfma_f32_32x32x16_bf16 v[128:143], v[32:35], v[20:23], v[128:143]
ds_read_b128 v[28:31], v2 offset:31744
buffer_load_dwordx4 v[32:35], v1, s[8:11], s21 offen offset:0
s_waitcnt vmcnt(19)
v_mfma_f32_32x32x16_bf16 v[144:159], v[36:39], v[16:19], v[144:159]
v_mfma_f32_32x32x16_bf16 v[160:175], v[36:39], v[20:23], v[160:175]
buffer_load_dwordx4 v[36:39], v1, s[8:11], s21 offen offset:1024
s_waitcnt vmcnt(19)
v_mfma_f32_32x32x16_bf16 v[176:191], v[40:43], v[16:19], v[176:191]
v_mfma_f32_32x32x16_bf16 v[192:207], v[40:43], v[20:23], v[192:207]
buffer_load_dwordx4 v[40:43], v1, s[8:11], s21 offen offset:2048
s_waitcnt vmcnt(19)
v_mfma_f32_32x32x16_bf16 v[208:223], v[44:47], v[16:19], v[208:223]
v_mfma_f32_32x32x16_bf16 v[224:239], v[44:47], v[20:23], v[224:239]
buffer_load_dwordx4 v[44:47], v1, s[8:11], s21 offen offset:3072
s_add_u32 s21, s21, 55296
s_waitcnt vmcnt(19)
s_waitcnt lgkmcnt(0)
v_mfma_f32_32x32x16_bf16 v[112:127], v[48:51], v[24:27], v[112:127]
ds_read_b128 v[16:19], v1 offset:32768
v_mfma_f32_32x32x16_bf16 v[128:143], v[48:51], v[28:31], v[128:143]
ds_read_b128 v[20:23], v2 offset:32768
buffer_load_dwordx4 v[48:51], v1, s[8:11], s21 offen offset:0
s_waitcnt vmcnt(19)
v_mfma_f32_32x32x16_bf16 v[144:159], v[52:55], v[24:27], v[144:159]
v_mfma_f32_32x32x16_bf16 v[160:175], v[52:55], v[28:31], v[160:175]
buffer_load_dwordx4 v[52:55], v1, s[8:11], s21 offen offset:1024
s_waitcnt vmcnt(19)
v_mfma_f32_32x32x16_bf16 v[176:191], v[56:59], v[24:27], v[176:191]
v_mfma_f32_32x32x16_bf16 v[192:207], v[56:59], v[28:31], v[192:207]
buffer_load_dwordx4 v[56:59], v1, s[8:11], s21 offen offset:2048
s_waitcnt vmcnt(19)
v_mfma_f32_32x32x16_bf16 v[208:223], v[60:63], v[24:27], v[208:223]
v_mfma_f32_32x32x16_bf16 v[224:239], v[60:63], v[28:31], v[224:239]
buffer_load_dwordx4 v[60:63], v1, s[8:11], s21 offen offset:3072
s_add_u32 s21, s21, 55296
s_waitcnt vmcnt(19)
s_waitcnt lgkmcnt(0)
v_mfma_f32_32x32x16_bf16 v[112:127], v[64:67], v[16:19], v[112:127]
ds_read_b128 v[24:27], v1 offset:33792
v_mfma_f32_32x32x16_bf16 v[128:143], v[64:67], v[20:23], v[128:143]
ds_read_b128 v[28:31], v2 offset:33792
buffer_load_dwordx4 v[64:67], v1, s[8:11], s21 offen offset:0
s_waitcnt vmcnt(19)
v_mfma_f32_32x32x16_bf16 v[144:159], v[68:71], v[16:19], v[144:159]
v_mfma_f32_32x32x16_bf16 v[160:175], v[68:71], v[20:23], v[160:175]
buffer_load_dwordx4 v[68:71], v1, s[8:11], s21 offen offset:1024
s_waitcnt vmcnt(19)
v_mfma_f32_32x32x16_bf16 v[176:191], v[72:75], v[16:19], v[176:191]
v_mfma_f32_32x32x16_bf16 v[192:207], v[72:75], v[20:23], v[192:207]
buffer_load_dwordx4 v[72:75], v1, s[8:11], s21 offen offset:2048
s_waitcnt vmcnt(19)
v_mfma_f32_32x32x16_bf16 v[208:223], v[76:79], v[16:19], v[208:223]
v_mfma_f32_32x32x16_bf16 v[224:239], v[76:79], v[20:23], v[224:239]
buffer_load_dwordx4 v[76:79], v1, s[8:11], s21 offen offset:3072
s_add_u32 s21, s21, 55296
s_waitcnt vmcnt(19)
s_waitcnt lgkmcnt(0)
v_mfma_f32_32x32x16_bf16 v[112:127], v[80:83], v[24:27], v[112:127]
ds_read_b128 v[16:19], v1 offset:34816
v_mfma_f32_32x32x16_bf16 v[128:143], v[80:83], v[28:31], v[128:143]
ds_read_b128 v[20:23], v2 offset:34816
buffer_load_dwordx4 v[80:83], v1, s[8:11], s21 offen offset:0
s_waitcnt vmcnt(19)
v_mfma_f32_32x32x16_bf16 v[144:159], v[84:87], v[24:27], v[144:159]
v_mfma_f32_32x32x16_bf16 v[160:175], v[84:87], v[28:31], v[160:175]
buffer_load_dwordx4 v[84:87], v1, s[8:11], s21 offen offset:1024
s_waitcnt vmcnt(19)
v_mfma_f32_32x32x16_bf16 v[176:191], v[88:91], v[24:27], v[176:191]
v_mfma_f32_32x32x16_bf16 v[192:207], v[88:91], v[28:31], v[192:207]
buffer_load_dwordx4 v[88:91], v1, s[8:11], s21 offen offset:2048
s_waitcnt vmcnt(19)
v_mfma_f32_32x32x16_bf16 v[208:223], v[92:95], v[24:27], v[208:223]
v_mfma_f32_32x32x16_bf16 v[224:239], v[92:95], v[28:31], v[224:239]
buffer_load_dwordx4 v[92:95], v1, s[8:11], s21 offen offset:3072
s_add_u32 s21, s21, 55296
s_waitcnt vmcnt(19)
s_waitcnt lgkmcnt(0)
v_mfma_f32_32x32x16_bf16 v[112:127], v[96:99], v[16:19], v[112:127]
ds_read_b128 v[24:27], v1 offset:35840
v_mfma_f32_32x32x16_bf16 v[128:143], v[96:99], v[20:23], v[128:143]
ds_read_b128 v[28:31], v2 offset:35840
buffer_load_dwordx4 v[96:99], v1, s[8:11], s21 offen offset:0
s_waitcnt vmcnt(19)
v_mfma_f32_32x32x16_bf16 v[144:159], v[100:103], v[16:19], v[144:159]
v_mfma_f32_32x32x16_bf16 v[160:175], v[100:103], v[20:23], v[160:175]
buffer_load_dwordx4 v[100:103], v1, s[8:11], s21 offen offset:1024
s_waitcnt vmcnt(19)
v_mfma_f32_32x32x16_bf16 v[176:191], v[104:107], v[16:19], v[176:191]
v_mfma_f32_32x32x16_bf16 v[192:207], v[104:107], v[20:23], v[192:207]
buffer_load_dwordx4 v[104:107], v1, s[8:11], s21 offen offset:2048
s_waitcnt vmcnt(19)
v_mfma_f32_32x32x16_bf16 v[208:223], v[108:111], v[16:19], v[208:223]
v_mfma_f32_32x32x16_bf16 v[224:239], v[108:111], v[20:23], v[224:239]
buffer_load_dwordx4 v[108:111], v1, s[8:11], s21 offen offset:3072
s_add_u32 s21, s21, 55296
s_waitcnt vmcnt(19)
s_waitcnt lgkmcnt(0)
v_mfma_f32_32x32x16_bf16 v[112:127], v[32:35], v[24:27], v[112:127]
ds_read_b128 v[16:19], v1 offset:36864
v_mfma_f32_32x32x16_bf16 v[128:143], v[32:35], v[28:31], v[128:143]
ds_read_b128 v[20:23], v2 offset:36864
s_add_u32 s21, s22, 0x1000
buffer_load_dwordx4 v[32:35], v1, s[8:11], s21 offen offset:0
s_waitcnt vmcnt(19)
v_mfma_f32_32x32x16_bf16 v[144:159], v[36:39], v[24:27], v[144:159]
v_mfma_f32_32x32x16_bf16 v[160:175], v[36:39], v[28:31], v[160:175]
buffer_load_dwordx4 v[36:39], v1, s[8:11], s21 offen offset:1024
s_waitcnt vmcnt(19)
v_mfma_f32_32x32x16_bf16 v[176:191], v[40:43], v[24:27], v[176:191]
v_mfma_f32_32x32x16_bf16 v[192:207], v[40:43], v[28:31], v[192:207]
buffer_load_dwordx4 v[40:43], v1, s[8:11], s21 offen offset:2048
s_add_u32 s21, s21, 55296
s_waitcnt vmcnt(19)
v_mfma_f32_32x32x16_bf16 v[208:223], v[44:47], v[24:27], v[208:223]
v_mfma_f32_32x32x16_bf16 v[224:239], v[44:47], v[28:31], v[224:239]
buffer_load_dwordx4 v[44:47], v1, s[8:11], s21 offen offset:0
s_waitcnt vmcnt(19)
s_waitcnt lgkmcnt(0)
v_mfma_f32_32x32x16_bf16 v[112:127], v[48:51], v[16:19], v[112:127]
ds_read_b128 v[24:27], v1 offset:37888
v_mfma_f32_32x32x16_bf16 v[128:143], v[48:51], v[20:23], v[128:143]
ds_read_b128 v[28:31], v2 offset:37888
buffer_load_dwordx4 v[48:51], v1, s[8:11], s21 offen offset:1024
s_waitcnt vmcnt(19)
v_mfma_f32_32x32x16_bf16 v[144:159], v[52:55], v[16:19], v[144:159]
v_mfma_f32_32x32x16_bf16 v[160:175], v[52:55], v[20:23], v[160:175]
buffer_load_dwordx4 v[52:55], v1, s[8:11], s21 offen offset:2048
s_add_u32 s21, s21, 55296
s_waitcnt vmcnt(19)
v_mfma_f32_32x32x16_bf16 v[176:191], v[56:59], v[16:19], v[176:191]
v_mfma_f32_32x32x16_bf16 v[192:207], v[56:59], v[20:23], v[192:207]
buffer_load_dwordx4 v[56:59], v1, s[8:11], s21 offen offset:0
s_waitcnt vmcnt(19)
v_mfma_f32_32x32x16_bf16 v[208:223], v[60:63], v[16:19], v[208:223]
v_mfma_f32_32x32x16_bf16 v[224:239], v[60:63], v[20:23], v[224:239]
buffer_load_dwordx4 v[60:63], v1, s[8:11], s21 offen offset:1024
s_waitcnt vmcnt(19)
s_waitcnt lgkmcnt(0)
v_mfma_f32_32x32x16_bf16 v[112:127], v[64:67], v[24:27], v[112:127]
ds_read_b128 v[16:19], v1 offset:38912
v_mfma_f32_32x32x16_bf16 v[128:143], v[64:67], v[28:31], v[128:143]
ds_read_b128 v[20:23], v2 offset:38912
buffer_load_dwordx4 v[64:67], v1, s[8:11], s21 offen offset:2048
s_add_u32 s21, s21, 55296
s_waitcnt vmcnt(19)
v_mfma_f32_32x32x16_bf16 v[144:159], v[68:71], v[24:27], v[144:159]
v_mfma_f32_32x32x16_bf16 v[160:175], v[68:71], v[28:31], v[160:175]
buffer_load_dwordx4 v[68:71], v1, s[8:11], s21 offen offset:0
s_waitcnt vmcnt(19)
v_mfma_f32_32x32x16_bf16 v[176:191], v[72:75], v[24:27], v[176:191]
v_mfma_f32_32x32x16_bf16 v[192:207], v[72:75], v[28:31], v[192:207]
buffer_load_dwordx4 v[72:75], v1, s[8:11], s21 offen offset:1024
s_waitcnt vmcnt(19)
v_mfma_f32_32x32x16_bf16 v[208:223], v[76:79], v[24:27], v[208:223]
v_mfma_f32_32x32x16_bf16 v[224:239], v[76:79], v[28:31], v[224:239]
buffer_load_dwordx4 v[76:79], v1, s[8:11], s21 offen offset:2048
s_add_u32 s21, s21, 55296
s_waitcnt vmcnt(19)
s_waitcnt lgkmcnt(0)
v_mfma_f32_32x32x16_bf16 v[112:127], v[80:83], v[16:19], v[112:127]
ds_read_b128 v[24:27], v1 offset:39936
v_mfma_f32_32x32x16_bf16 v[128:143], v[80:83], v[20:23], v[128:143]
ds_read_b128 v[28:31], v2 offset:39936
buffer_load_dwordx4 v[80:83], v1, s[8:11], s21 offen offset:0
s_waitcnt vmcnt(19)
v_mfma_f32_32x32x16_bf16 v[144:159], v[84:87], v[16:19], v[144:159]
v_mfma_f32_32x32x16_bf16 v[160:175], v[84:87], v[20:23], v[160:175]
buffer_load_dwordx4 v[84:87], v1, s[8:11], s21 offen offset:1024
s_waitcnt vmcnt(19)
v_mfma_f32_32x32x16_bf16 v[176:191], v[88:91], v[16:19], v[176:191]
v_mfma_f32_32x32x16_bf16 v[192:207], v[88:91], v[20:23], v[192:207]
buffer_load_dwordx4 v[88:91], v1, s[8:11], s21 offen offset:2048
s_add_u32 s21, s21, 55296
s_waitcnt vmcnt(19)
v_mfma_f32_32x32x16_bf16 v[208:223], v[92:95], v[16:19], v[208:223]
v_mfma_f32_32x32x16_bf16 v[224:239], v[92:95], v[20:23], v[224:239]
buffer_load_dwordx4 v[92:95], v1, s[8:11], s21 offen offset:0
s_waitcnt vmcnt(19)
s_waitcnt lgkmcnt(0)
v_mfma_f32_32x32x16_bf16 v[112:127], v[96:99], v[24:27], v[112:127]
v_mfma_f32_32x32x16_bf16 v[128:143], v[96:99], v[28:31], v[128:143]
buffer_load_dwordx4 v[96:99], v1, s[8:11], s21 offen offset:1024
s_waitcnt vmcnt(19)
v_mfma_f32_32x32x16_bf16 v[144:159], v[100:103], v[24:27], v[144:159]
v_mfma_f32_32x32x16_bf16 v[160:175], v[100:103], v[28:31], v[160:175]
buffer_load_dwordx4 v[100:103], v1, s[8:11], s21 offen offset:2048
s_add_u32 s21, s21, 55296
s_waitcnt vmcnt(19)
v_mfma_f32_32x32x16_bf16 v[176:191], v[104:107], v[24:27], v[176:191]
v_mfma_f32_32x32x16_bf16 v[192:207], v[104:107], v[28:31], v[192:207]
buffer_load_dwordx4 v[104:107], v1, s[8:11], s21 offen offset:0
s_waitcnt vmcnt(19)
v_mfma_f32_32x32x16_bf16 v[208:223], v[108:111], v[24:27], v[208:223]
v_mfma_f32_32x32x16_bf16 v[224:239], v[108:111], v[28:31], v[224:239]
buffer_load_dwordx4 v[108:111], v1, s[8:11], s21 offen offset:1024
v_pk_mul_f32 v[240:241], v[112:113], v[112:113]
v_pk_mul_f32 v[242:243], v[114:115], v[114:115]
v_pk_mul_f32 v[244:245], v[116:117], v[116:117]
v_pk_mul_f32 v[246:247], v[118:119], v[118:119]
v_pk_mul_f32 v[248:249], v[120:121], v[120:121]
v_pk_mul_f32 v[250:251], v[122:123], v[122:123]
v_pk_mul_f32 v[252:253], v[124:125], v[124:125]
v_pk_mul_f32 v[254:255], v[126:127], v[126:127]
v_pk_fma_f32 v[240:241], v[240:241], v[8:9], v[8:9] op_sel:[0,1,0] op_sel_hi:[1,1,0]
v_pk_fma_f32 v[242:243], v[242:243], v[8:9], v[8:9] op_sel:[0,1,0] op_sel_hi:[1,1,0]
v_pk_fma_f32 v[244:245], v[244:245], v[8:9], v[8:9] op_sel:[0,1,0] op_sel_hi:[1,1,0]
v_pk_fma_f32 v[246:247], v[246:247], v[8:9], v[8:9] op_sel:[0,1,0] op_sel_hi:[1,1,0]
v_pk_fma_f32 v[248:249], v[248:249], v[8:9], v[8:9] op_sel:[0,1,0] op_sel_hi:[1,1,0]
v_pk_fma_f32 v[250:251], v[250:251], v[8:9], v[8:9] op_sel:[0,1,0] op_sel_hi:[1,1,0]
v_pk_fma_f32 v[252:253], v[252:253], v[8:9], v[8:9] op_sel:[0,1,0] op_sel_hi:[1,1,0]
v_pk_fma_f32 v[254:255], v[254:255], v[8:9], v[8:9] op_sel:[0,1,0] op_sel_hi:[1,1,0]
v_pk_mul_f32 v[240:241], v[240:241], v[112:113]
v_pk_mul_f32 v[242:243], v[242:243], v[114:115]
v_pk_mul_f32 v[244:245], v[244:245], v[116:117]
v_pk_mul_f32 v[246:247], v[246:247], v[118:119]
v_pk_mul_f32 v[248:249], v[248:249], v[120:121]
v_pk_mul_f32 v[250:251], v[250:251], v[122:123]
v_pk_mul_f32 v[252:253], v[252:253], v[124:125]
v_pk_mul_f32 v[254:255], v[254:255], v[126:127]
v_exp_f32 v240, v240
v_exp_f32 v241, v241
v_exp_f32 v242, v242
v_exp_f32 v243, v243
v_exp_f32 v244, v244
v_exp_f32 v245, v245
v_exp_f32 v246, v246
v_exp_f32 v247, v247
v_exp_f32 v248, v248
v_exp_f32 v249, v249
v_exp_f32 v250, v250
v_exp_f32 v251, v251
v_exp_f32 v252, v252
v_exp_f32 v253, v253
v_exp_f32 v254, v254
v_exp_f32 v255, v255
v_pk_add_f32 v[240:241], v[240:241], 1.0 op_sel_hi:[1,0]
v_pk_add_f32 v[242:243], v[242:243], 1.0 op_sel_hi:[1,0]
v_pk_add_f32 v[244:245], v[244:245], 1.0 op_sel_hi:[1,0]
v_pk_add_f32 v[246:247], v[246:247], 1.0 op_sel_hi:[1,0]
v_pk_add_f32 v[248:249], v[248:249], 1.0 op_sel_hi:[1,0]
v_pk_add_f32 v[250:251], v[250:251], 1.0 op_sel_hi:[1,0]
v_pk_add_f32 v[252:253], v[252:253], 1.0 op_sel_hi:[1,0]
v_pk_add_f32 v[254:255], v[254:255], 1.0 op_sel_hi:[1,0]
v_rcp_f32 v240, v240
v_rcp_f32 v241, v241
v_rcp_f32 v242, v242
v_rcp_f32 v243, v243
v_rcp_f32 v244, v244
v_rcp_f32 v245, v245
v_rcp_f32 v246, v246
v_rcp_f32 v247, v247
v_rcp_f32 v248, v248
v_rcp_f32 v249, v249
v_rcp_f32 v250, v250
v_rcp_f32 v251, v251
v_rcp_f32 v252, v252
v_rcp_f32 v253, v253
v_rcp_f32 v254, v254
v_rcp_f32 v255, v255
v_pk_mul_f32 v[240:241], v[240:241], v[112:113]
v_pk_mul_f32 v[242:243], v[242:243], v[114:115]
v_pk_mul_f32 v[244:245], v[244:245], v[116:117]
v_pk_mul_f32 v[246:247], v[246:247], v[118:119]
v_pk_mul_f32 v[248:249], v[248:249], v[120:121]
v_pk_mul_f32 v[250:251], v[250:251], v[122:123]
v_pk_mul_f32 v[252:253], v[252:253], v[124:125]
v_pk_mul_f32 v[254:255], v[254:255], v[126:127]
v_cvt_pk_bf16_f32 v112, v240, v241
v_cvt_pk_bf16_f32 v113, v242, v243
v_cvt_pk_bf16_f32 v114, v244, v245
v_cvt_pk_bf16_f32 v115, v246, v247
v_cvt_pk_bf16_f32 v116, v248, v249
v_cvt_pk_bf16_f32 v117, v250, v251
v_cvt_pk_bf16_f32 v118, v252, v253
v_cvt_pk_bf16_f32 v119, v254, v255
buffer_store_dwordx4 v[112:115], v3, s[36:39], s40 offen offset:0 sc1
buffer_store_dwordx4 v[116:119], v3, s[36:39], s40 offen offset:1024 sc1
v_pk_mul_f32 v[240:241], v[128:129], v[128:129]
v_pk_mul_f32 v[242:243], v[130:131], v[130:131]
v_pk_mul_f32 v[244:245], v[132:133], v[132:133]
v_pk_mul_f32 v[246:247], v[134:135], v[134:135]
v_pk_mul_f32 v[248:249], v[136:137], v[136:137]
v_pk_mul_f32 v[250:251], v[138:139], v[138:139]
v_pk_mul_f32 v[252:253], v[140:141], v[140:141]
v_pk_mul_f32 v[254:255], v[142:143], v[142:143]
v_pk_fma_f32 v[240:241], v[240:241], v[8:9], v[8:9] op_sel:[0,1,0] op_sel_hi:[1,1,0]
v_pk_fma_f32 v[242:243], v[242:243], v[8:9], v[8:9] op_sel:[0,1,0] op_sel_hi:[1,1,0]
v_pk_fma_f32 v[244:245], v[244:245], v[8:9], v[8:9] op_sel:[0,1,0] op_sel_hi:[1,1,0]
v_pk_fma_f32 v[246:247], v[246:247], v[8:9], v[8:9] op_sel:[0,1,0] op_sel_hi:[1,1,0]
v_pk_fma_f32 v[248:249], v[248:249], v[8:9], v[8:9] op_sel:[0,1,0] op_sel_hi:[1,1,0]
v_pk_fma_f32 v[250:251], v[250:251], v[8:9], v[8:9] op_sel:[0,1,0] op_sel_hi:[1,1,0]
v_pk_fma_f32 v[252:253], v[252:253], v[8:9], v[8:9] op_sel:[0,1,0] op_sel_hi:[1,1,0]
v_pk_fma_f32 v[254:255], v[254:255], v[8:9], v[8:9] op_sel:[0,1,0] op_sel_hi:[1,1,0]
v_pk_mul_f32 v[240:241], v[240:241], v[128:129]
v_pk_mul_f32 v[242:243], v[242:243], v[130:131]
v_pk_mul_f32 v[244:245], v[244:245], v[132:133]
v_pk_mul_f32 v[246:247], v[246:247], v[134:135]
v_pk_mul_f32 v[248:249], v[248:249], v[136:137]
v_pk_mul_f32 v[250:251], v[250:251], v[138:139]
v_pk_mul_f32 v[252:253], v[252:253], v[140:141]
v_pk_mul_f32 v[254:255], v[254:255], v[142:143]
v_exp_f32 v240, v240
v_exp_f32 v241, v241
v_exp_f32 v242, v242
v_exp_f32 v243, v243
v_exp_f32 v244, v244
v_exp_f32 v245, v245
v_exp_f32 v246, v246
v_exp_f32 v247, v247
v_exp_f32 v248, v248
v_exp_f32 v249, v249
v_exp_f32 v250, v250
v_exp_f32 v251, v251
v_exp_f32 v252, v252
v_exp_f32 v253, v253
v_exp_f32 v254, v254
v_exp_f32 v255, v255
v_pk_add_f32 v[240:241], v[240:241], 1.0 op_sel_hi:[1,0]
v_pk_add_f32 v[242:243], v[242:243], 1.0 op_sel_hi:[1,0]
v_pk_add_f32 v[244:245], v[244:245], 1.0 op_sel_hi:[1,0]
v_pk_add_f32 v[246:247], v[246:247], 1.0 op_sel_hi:[1,0]
v_pk_add_f32 v[248:249], v[248:249], 1.0 op_sel_hi:[1,0]
v_pk_add_f32 v[250:251], v[250:251], 1.0 op_sel_hi:[1,0]
v_pk_add_f32 v[252:253], v[252:253], 1.0 op_sel_hi:[1,0]
v_pk_add_f32 v[254:255], v[254:255], 1.0 op_sel_hi:[1,0]
v_rcp_f32 v240, v240
v_rcp_f32 v241, v241
v_rcp_f32 v242, v242
v_rcp_f32 v243, v243
v_rcp_f32 v244, v244
v_rcp_f32 v245, v245
v_rcp_f32 v246, v246
v_rcp_f32 v247, v247
v_rcp_f32 v248, v248
v_rcp_f32 v249, v249
v_rcp_f32 v250, v250
v_rcp_f32 v251, v251
v_rcp_f32 v252, v252
v_rcp_f32 v253, v253
v_rcp_f32 v254, v254
v_rcp_f32 v255, v255
v_pk_mul_f32 v[240:241], v[240:241], v[128:129]
v_pk_mul_f32 v[242:243], v[242:243], v[130:131]
v_pk_mul_f32 v[244:245], v[244:245], v[132:133]
v_pk_mul_f32 v[246:247], v[246:247], v[134:135]
v_pk_mul_f32 v[248:249], v[248:249], v[136:137]
v_pk_mul_f32 v[250:251], v[250:251], v[138:139]
v_pk_mul_f32 v[252:253], v[252:253], v[140:141]
v_pk_mul_f32 v[254:255], v[254:255], v[142:143]
v_cvt_pk_bf16_f32 v128, v240, v241
v_cvt_pk_bf16_f32 v129, v242, v243
v_cvt_pk_bf16_f32 v130, v244, v245
v_cvt_pk_bf16_f32 v131, v246, v247
v_cvt_pk_bf16_f32 v132, v248, v249
v_cvt_pk_bf16_f32 v133, v250, v251
v_cvt_pk_bf16_f32 v134, v252, v253
v_cvt_pk_bf16_f32 v135, v254, v255
buffer_store_dwordx4 v[128:131], v4, s[36:39], s40 offen offset:0 sc1
buffer_store_dwordx4 v[132:135], v4, s[36:39], s40 offen offset:1024 sc1
s_add_u32 s40, s40, 0x800
v_pk_mul_f32 v[240:241], v[144:145], v[144:145]
v_pk_mul_f32 v[242:243], v[146:147], v[146:147]
v_pk_mul_f32 v[244:245], v[148:149], v[148:149]
v_pk_mul_f32 v[246:247], v[150:151], v[150:151]
v_pk_mul_f32 v[248:249], v[152:153], v[152:153]
v_pk_mul_f32 v[250:251], v[154:155], v[154:155]
v_pk_mul_f32 v[252:253], v[156:157], v[156:157]
v_pk_mul_f32 v[254:255], v[158:159], v[158:159]
v_pk_fma_f32 v[240:241], v[240:241], v[8:9], v[8:9] op_sel:[0,1,0] op_sel_hi:[1,1,0]
v_pk_fma_f32 v[242:243], v[242:243], v[8:9], v[8:9] op_sel:[0,1,0] op_sel_hi:[1,1,0]
v_pk_fma_f32 v[244:245], v[244:245], v[8:9], v[8:9] op_sel:[0,1,0] op_sel_hi:[1,1,0]
v_pk_fma_f32 v[246:247], v[246:247], v[8:9], v[8:9] op_sel:[0,1,0] op_sel_hi:[1,1,0]
v_pk_fma_f32 v[248:249], v[248:249], v[8:9], v[8:9] op_sel:[0,1,0] op_sel_hi:[1,1,0]
v_pk_fma_f32 v[250:251], v[250:251], v[8:9], v[8:9] op_sel:[0,1,0] op_sel_hi:[1,1,0]
v_pk_fma_f32 v[252:253], v[252:253], v[8:9], v[8:9] op_sel:[0,1,0] op_sel_hi:[1,1,0]
v_pk_fma_f32 v[254:255], v[254:255], v[8:9], v[8:9] op_sel:[0,1,0] op_sel_hi:[1,1,0]
v_pk_mul_f32 v[240:241], v[240:241], v[144:145]
v_pk_mul_f32 v[242:243], v[242:243], v[146:147]
v_pk_mul_f32 v[244:245], v[244:245], v[148:149]
v_pk_mul_f32 v[246:247], v[246:247], v[150:151]
v_pk_mul_f32 v[248:249], v[248:249], v[152:153]
v_pk_mul_f32 v[250:251], v[250:251], v[154:155]
v_pk_mul_f32 v[252:253], v[252:253], v[156:157]
v_pk_mul_f32 v[254:255], v[254:255], v[158:159]
v_exp_f32 v240, v240
v_exp_f32 v241, v241
v_exp_f32 v242, v242
v_exp_f32 v243, v243
v_exp_f32 v244, v244
v_exp_f32 v245, v245
v_exp_f32 v246, v246
v_exp_f32 v247, v247
v_exp_f32 v248, v248
v_exp_f32 v249, v249
v_exp_f32 v250, v250
v_exp_f32 v251, v251
v_exp_f32 v252, v252
v_exp_f32 v253, v253
v_exp_f32 v254, v254
v_exp_f32 v255, v255
v_pk_add_f32 v[240:241], v[240:241], 1.0 op_sel_hi:[1,0]
v_pk_add_f32 v[242:243], v[242:243], 1.0 op_sel_hi:[1,0]
v_pk_add_f32 v[244:245], v[244:245], 1.0 op_sel_hi:[1,0]
v_pk_add_f32 v[246:247], v[246:247], 1.0 op_sel_hi:[1,0]
v_pk_add_f32 v[248:249], v[248:249], 1.0 op_sel_hi:[1,0]
v_pk_add_f32 v[250:251], v[250:251], 1.0 op_sel_hi:[1,0]
v_pk_add_f32 v[252:253], v[252:253], 1.0 op_sel_hi:[1,0]
v_pk_add_f32 v[254:255], v[254:255], 1.0 op_sel_hi:[1,0]
v_rcp_f32 v240, v240
v_rcp_f32 v241, v241
v_rcp_f32 v242, v242
v_rcp_f32 v243, v243
v_rcp_f32 v244, v244
v_rcp_f32 v245, v245
v_rcp_f32 v246, v246
v_rcp_f32 v247, v247
v_rcp_f32 v248, v248
v_rcp_f32 v249, v249
v_rcp_f32 v250, v250
v_rcp_f32 v251, v251
v_rcp_f32 v252, v252
v_rcp_f32 v253, v253
v_rcp_f32 v254, v254
v_rcp_f32 v255, v255
v_pk_mul_f32 v[240:241], v[240:241], v[144:145]
v_pk_mul_f32 v[242:243], v[242:243], v[146:147]
v_pk_mul_f32 v[244:245], v[244:245], v[148:149]
v_pk_mul_f32 v[246:247], v[246:247], v[150:151]
v_pk_mul_f32 v[248:249], v[248:249], v[152:153]
v_pk_mul_f32 v[250:251], v[250:251], v[154:155]
v_pk_mul_f32 v[252:253], v[252:253], v[156:157]
v_pk_mul_f32 v[254:255], v[254:255], v[158:159]
v_cvt_pk_bf16_f32 v144, v240, v241
v_cvt_pk_bf16_f32 v145, v242, v243
v_cvt_pk_bf16_f32 v146, v244, v245
v_cvt_pk_bf16_f32 v147, v246, v247
v_cvt_pk_bf16_f32 v148, v248, v249
v_cvt_pk_bf16_f32 v149, v250, v251
v_cvt_pk_bf16_f32 v150, v252, v253
v_cvt_pk_bf16_f32 v151, v254, v255
buffer_store_dwordx4 v[144:147], v3, s[36:39], s40 offen offset:0 sc1
buffer_store_dwordx4 v[148:151], v3, s[36:39], s40 offen offset:1024 sc1
v_pk_mul_f32 v[240:241], v[160:161], v[160:161]
v_pk_mul_f32 v[242:243], v[162:163], v[162:163]
v_pk_mul_f32 v[244:245], v[164:165], v[164:165]
v_pk_mul_f32 v[246:247], v[166:167], v[166:167]
v_pk_mul_f32 v[248:249], v[168:169], v[168:169]
v_pk_mul_f32 v[250:251], v[170:171], v[170:171]
v_pk_mul_f32 v[252:253], v[172:173], v[172:173]
v_pk_mul_f32 v[254:255], v[174:175], v[174:175]
v_pk_fma_f32 v[240:241], v[240:241], v[8:9], v[8:9] op_sel:[0,1,0] op_sel_hi:[1,1,0]
v_pk_fma_f32 v[242:243], v[242:243], v[8:9], v[8:9] op_sel:[0,1,0] op_sel_hi:[1,1,0]
v_pk_fma_f32 v[244:245], v[244:245], v[8:9], v[8:9] op_sel:[0,1,0] op_sel_hi:[1,1,0]
v_pk_fma_f32 v[246:247], v[246:247], v[8:9], v[8:9] op_sel:[0,1,0] op_sel_hi:[1,1,0]
v_pk_fma_f32 v[248:249], v[248:249], v[8:9], v[8:9] op_sel:[0,1,0] op_sel_hi:[1,1,0]
v_pk_fma_f32 v[250:251], v[250:251], v[8:9], v[8:9] op_sel:[0,1,0] op_sel_hi:[1,1,0]
v_pk_fma_f32 v[252:253], v[252:253], v[8:9], v[8:9] op_sel:[0,1,0] op_sel_hi:[1,1,0]
v_pk_fma_f32 v[254:255], v[254:255], v[8:9], v[8:9] op_sel:[0,1,0] op_sel_hi:[1,1,0]
v_pk_mul_f32 v[240:241], v[240:241], v[160:161]
v_pk_mul_f32 v[242:243], v[242:243], v[162:163]
v_pk_mul_f32 v[244:245], v[244:245], v[164:165]
v_pk_mul_f32 v[246:247], v[246:247], v[166:167]
v_pk_mul_f32 v[248:249], v[248:249], v[168:169]
v_pk_mul_f32 v[250:251], v[250:251], v[170:171]
v_pk_mul_f32 v[252:253], v[252:253], v[172:173]
v_pk_mul_f32 v[254:255], v[254:255], v[174:175]
v_exp_f32 v240, v240
v_exp_f32 v241, v241
v_exp_f32 v242, v242
v_exp_f32 v243, v243
v_exp_f32 v244, v244
v_exp_f32 v245, v245
v_exp_f32 v246, v246
v_exp_f32 v247, v247
v_exp_f32 v248, v248
v_exp_f32 v249, v249
v_exp_f32 v250, v250
v_exp_f32 v251, v251
v_exp_f32 v252, v252
v_exp_f32 v253, v253
v_exp_f32 v254, v254
v_exp_f32 v255, v255
v_pk_add_f32 v[240:241], v[240:241], 1.0 op_sel_hi:[1,0]
v_pk_add_f32 v[242:243], v[242:243], 1.0 op_sel_hi:[1,0]
v_pk_add_f32 v[244:245], v[244:245], 1.0 op_sel_hi:[1,0]
v_pk_add_f32 v[246:247], v[246:247], 1.0 op_sel_hi:[1,0]
v_pk_add_f32 v[248:249], v[248:249], 1.0 op_sel_hi:[1,0]
v_pk_add_f32 v[250:251], v[250:251], 1.0 op_sel_hi:[1,0]
v_pk_add_f32 v[252:253], v[252:253], 1.0 op_sel_hi:[1,0]
v_pk_add_f32 v[254:255], v[254:255], 1.0 op_sel_hi:[1,0]
v_rcp_f32 v240, v240
v_rcp_f32 v241, v241
v_rcp_f32 v242, v242
v_rcp_f32 v243, v243
v_rcp_f32 v244, v244
v_rcp_f32 v245, v245
v_rcp_f32 v246, v246
v_rcp_f32 v247, v247
v_rcp_f32 v248, v248
v_rcp_f32 v249, v249
v_rcp_f32 v250, v250
v_rcp_f32 v251, v251
v_rcp_f32 v252, v252
v_rcp_f32 v253, v253
v_rcp_f32 v254, v254
v_rcp_f32 v255, v255
v_pk_mul_f32 v[240:241], v[240:241], v[160:161]
v_pk_mul_f32 v[242:243], v[242:243], v[162:163]
v_pk_mul_f32 v[244:245], v[244:245], v[164:165]
v_pk_mul_f32 v[246:247], v[246:247], v[166:167]
v_pk_mul_f32 v[248:249], v[248:249], v[168:169]
v_pk_mul_f32 v[250:251], v[250:251], v[170:171]
v_pk_mul_f32 v[252:253], v[252:253], v[172:173]
v_pk_mul_f32 v[254:255], v[254:255], v[174:175]
v_cvt_pk_bf16_f32 v160, v240, v241
v_cvt_pk_bf16_f32 v161, v242, v243
v_cvt_pk_bf16_f32 v162, v244, v245
v_cvt_pk_bf16_f32 v163, v246, v247
v_cvt_pk_bf16_f32 v164, v248, v249
v_cvt_pk_bf16_f32 v165, v250, v251
v_cvt_pk_bf16_f32 v166, v252, v253
v_cvt_pk_bf16_f32 v167, v254, v255
buffer_store_dwordx4 v[160:163], v4, s[36:39], s40 offen offset:0 sc1
buffer_store_dwordx4 v[164:167], v4, s[36:39], s40 offen offset:1024 sc1
s_add_u32 s40, s40, 0x800
v_pk_mul_f32 v[240:241], v[176:177], v[176:177]
v_pk_mul_f32 v[242:243], v[178:179], v[178:179]
v_pk_mul_f32 v[244:245], v[180:181], v[180:181]
v_pk_mul_f32 v[246:247], v[182:183], v[182:183]
v_pk_mul_f32 v[248:249], v[184:185], v[184:185]
v_pk_mul_f32 v[250:251], v[186:187], v[186:187]
v_pk_mul_f32 v[252:253], v[188:189], v[188:189]
v_pk_mul_f32 v[254:255], v[190:191], v[190:191]
v_pk_fma_f32 v[240:241], v[240:241], v[8:9], v[8:9] op_sel:[0,1,0] op_sel_hi:[1,1,0]
v_pk_fma_f32 v[242:243], v[242:243], v[8:9], v[8:9] op_sel:[0,1,0] op_sel_hi:[1,1,0]
v_pk_fma_f32 v[244:245], v[244:245], v[8:9], v[8:9] op_sel:[0,1,0] op_sel_hi:[1,1,0]
v_pk_fma_f32 v[246:247], v[246:247], v[8:9], v[8:9] op_sel:[0,1,0] op_sel_hi:[1,1,0]
v_pk_fma_f32 v[248:249], v[248:249], v[8:9], v[8:9] op_sel:[0,1,0] op_sel_hi:[1,1,0]
v_pk_fma_f32 v[250:251], v[250:251], v[8:9], v[8:9] op_sel:[0,1,0] op_sel_hi:[1,1,0]
v_pk_fma_f32 v[252:253], v[252:253], v[8:9], v[8:9] op_sel:[0,1,0] op_sel_hi:[1,1,0]
v_pk_fma_f32 v[254:255], v[254:255], v[8:9], v[8:9] op_sel:[0,1,0] op_sel_hi:[1,1,0]
v_pk_mul_f32 v[240:241], v[240:241], v[176:177]
v_pk_mul_f32 v[242:243], v[242:243], v[178:179]
v_pk_mul_f32 v[244:245], v[244:245], v[180:181]
v_pk_mul_f32 v[246:247], v[246:247], v[182:183]
v_pk_mul_f32 v[248:249], v[248:249], v[184:185]
v_pk_mul_f32 v[250:251], v[250:251], v[186:187]
v_pk_mul_f32 v[252:253], v[252:253], v[188:189]
v_pk_mul_f32 v[254:255], v[254:255], v[190:191]
v_exp_f32 v240, v240
v_exp_f32 v241, v241
v_exp_f32 v242, v242
v_exp_f32 v243, v243
v_exp_f32 v244, v244
v_exp_f32 v245, v245
v_exp_f32 v246, v246
v_exp_f32 v247, v247
v_exp_f32 v248, v248
v_exp_f32 v249, v249
v_exp_f32 v250, v250
v_exp_f32 v251, v251
v_exp_f32 v252, v252
v_exp_f32 v253, v253
v_exp_f32 v254, v254
v_exp_f32 v255, v255
v_pk_add_f32 v[240:241], v[240:241], 1.0 op_sel_hi:[1,0]
v_pk_add_f32 v[242:243], v[242:243], 1.0 op_sel_hi:[1,0]
v_pk_add_f32 v[244:245], v[244:245], 1.0 op_sel_hi:[1,0]
v_pk_add_f32 v[246:247], v[246:247], 1.0 op_sel_hi:[1,0]
v_pk_add_f32 v[248:249], v[248:249], 1.0 op_sel_hi:[1,0]
v_pk_add_f32 v[250:251], v[250:251], 1.0 op_sel_hi:[1,0]
v_pk_add_f32 v[252:253], v[252:253], 1.0 op_sel_hi:[1,0]
v_pk_add_f32 v[254:255], v[254:255], 1.0 op_sel_hi:[1,0]
v_rcp_f32 v240, v240
v_rcp_f32 v241, v241
v_rcp_f32 v242, v242
v_rcp_f32 v243, v243
v_rcp_f32 v244, v244
v_rcp_f32 v245, v245
v_rcp_f32 v246, v246
v_rcp_f32 v247, v247
v_rcp_f32 v248, v248
v_rcp_f32 v249, v249
v_rcp_f32 v250, v250
v_rcp_f32 v251, v251
v_rcp_f32 v252, v252
v_rcp_f32 v253, v253
v_rcp_f32 v254, v254
v_rcp_f32 v255, v255
v_pk_mul_f32 v[240:241], v[240:241], v[176:177]
v_pk_mul_f32 v[242:243], v[242:243], v[178:179]
v_pk_mul_f32 v[244:245], v[244:245], v[180:181]
v_pk_mul_f32 v[246:247], v[246:247], v[182:183]
v_pk_mul_f32 v[248:249], v[248:249], v[184:185]
v_pk_mul_f32 v[250:251], v[250:251], v[186:187]
v_pk_mul_f32 v[252:253], v[252:253], v[188:189]
v_pk_mul_f32 v[254:255], v[254:255], v[190:191]
v_cvt_pk_bf16_f32 v176, v240, v241
v_cvt_pk_bf16_f32 v177, v242, v243
v_cvt_pk_bf16_f32 v178, v244, v245
v_cvt_pk_bf16_f32 v179, v246, v247
v_cvt_pk_bf16_f32 v180, v248, v249
v_cvt_pk_bf16_f32 v181, v250, v251
v_cvt_pk_bf16_f32 v182, v252, v253
v_cvt_pk_bf16_f32 v183, v254, v255
buffer_store_dwordx4 v[176:179], v3, s[36:39], s40 offen offset:0 sc1
buffer_store_dwordx4 v[180:183], v3, s[36:39], s40 offen offset:1024 sc1
v_pk_mul_f32 v[240:241], v[192:193], v[192:193]
v_pk_mul_f32 v[242:243], v[194:195], v[194:195]
v_pk_mul_f32 v[244:245], v[196:197], v[196:197]
v_pk_mul_f32 v[246:247], v[198:199], v[198:199]
v_pk_mul_f32 v[248:249], v[200:201], v[200:201]
v_pk_mul_f32 v[250:251], v[202:203], v[202:203]
v_pk_mul_f32 v[252:253], v[204:205], v[204:205]
v_pk_mul_f32 v[254:255], v[206:207], v[206:207]
v_pk_fma_f32 v[240:241], v[240:241], v[8:9], v[8:9] op_sel:[0,1,0] op_sel_hi:[1,1,0]
v_pk_fma_f32 v[242:243], v[242:243], v[8:9], v[8:9] op_sel:[0,1,0] op_sel_hi:[1,1,0]
v_pk_fma_f32 v[244:245], v[244:245], v[8:9], v[8:9] op_sel:[0,1,0] op_sel_hi:[1,1,0]
v_pk_fma_f32 v[246:247], v[246:247], v[8:9], v[8:9] op_sel:[0,1,0] op_sel_hi:[1,1,0]
v_pk_fma_f32 v[248:249], v[248:249], v[8:9], v[8:9] op_sel:[0,1,0] op_sel_hi:[1,1,0]
v_pk_fma_f32 v[250:251], v[250:251], v[8:9], v[8:9] op_sel:[0,1,0] op_sel_hi:[1,1,0]
v_pk_fma_f32 v[252:253], v[252:253], v[8:9], v[8:9] op_sel:[0,1,0] op_sel_hi:[1,1,0]
v_pk_fma_f32 v[254:255], v[254:255], v[8:9], v[8:9] op_sel:[0,1,0] op_sel_hi:[1,1,0]
v_pk_mul_f32 v[240:241], v[240:241], v[192:193]
v_pk_mul_f32 v[242:243], v[242:243], v[194:195]
v_pk_mul_f32 v[244:245], v[244:245], v[196:197]
v_pk_mul_f32 v[246:247], v[246:247], v[198:199]
v_pk_mul_f32 v[248:249], v[248:249], v[200:201]
v_pk_mul_f32 v[250:251], v[250:251], v[202:203]
v_pk_mul_f32 v[252:253], v[252:253], v[204:205]
v_pk_mul_f32 v[254:255], v[254:255], v[206:207]
v_exp_f32 v240, v240
v_exp_f32 v241, v241
v_exp_f32 v242, v242
v_exp_f32 v243, v243
v_exp_f32 v244, v244
v_exp_f32 v245, v245
v_exp_f32 v246, v246
v_exp_f32 v247, v247
v_exp_f32 v248, v248
v_exp_f32 v249, v249
v_exp_f32 v250, v250
v_exp_f32 v251, v251
v_exp_f32 v252, v252
v_exp_f32 v253, v253
v_exp_f32 v254, v254
v_exp_f32 v255, v255
v_pk_add_f32 v[240:241], v[240:241], 1.0 op_sel_hi:[1,0]
v_pk_add_f32 v[242:243], v[242:243], 1.0 op_sel_hi:[1,0]
v_pk_add_f32 v[244:245], v[244:245], 1.0 op_sel_hi:[1,0]
v_pk_add_f32 v[246:247], v[246:247], 1.0 op_sel_hi:[1,0]
v_pk_add_f32 v[248:249], v[248:249], 1.0 op_sel_hi:[1,0]
v_pk_add_f32 v[250:251], v[250:251], 1.0 op_sel_hi:[1,0]
v_pk_add_f32 v[252:253], v[252:253], 1.0 op_sel_hi:[1,0]
v_pk_add_f32 v[254:255], v[254:255], 1.0 op_sel_hi:[1,0]
v_rcp_f32 v240, v240
v_rcp_f32 v241, v241
v_rcp_f32 v242, v242
v_rcp_f32 v243, v243
v_rcp_f32 v244, v244
v_rcp_f32 v245, v245
v_rcp_f32 v246, v246
v_rcp_f32 v247, v247
v_rcp_f32 v248, v248
v_rcp_f32 v249, v249
v_rcp_f32 v250, v250
v_rcp_f32 v251, v251
v_rcp_f32 v252, v252
v_rcp_f32 v253, v253
v_rcp_f32 v254, v254
v_rcp_f32 v255, v255
v_pk_mul_f32 v[240:241], v[240:241], v[192:193]
v_pk_mul_f32 v[242:243], v[242:243], v[194:195]
v_pk_mul_f32 v[244:245], v[244:245], v[196:197]
v_pk_mul_f32 v[246:247], v[246:247], v[198:199]
v_pk_mul_f32 v[248:249], v[248:249], v[200:201]
v_pk_mul_f32 v[250:251], v[250:251], v[202:203]
v_pk_mul_f32 v[252:253], v[252:253], v[204:205]
v_pk_mul_f32 v[254:255], v[254:255], v[206:207]
v_cvt_pk_bf16_f32 v192, v240, v241
v_cvt_pk_bf16_f32 v193, v242, v243
v_cvt_pk_bf16_f32 v194, v244, v245
v_cvt_pk_bf16_f32 v195, v246, v247
v_cvt_pk_bf16_f32 v196, v248, v249
v_cvt_pk_bf16_f32 v197, v250, v251
v_cvt_pk_bf16_f32 v198, v252, v253
v_cvt_pk_bf16_f32 v199, v254, v255
buffer_store_dwordx4 v[192:195], v4, s[36:39], s40 offen offset:0 sc1
buffer_store_dwordx4 v[196:199], v4, s[36:39], s40 offen offset:1024 sc1
s_add_u32 s40, s40, 0x800
v_pk_mul_f32 v[240:241], v[208:209], v[208:209]
v_pk_mul_f32 v[242:243], v[210:211], v[210:211]
v_pk_mul_f32 v[244:245], v[212:213], v[212:213]
v_pk_mul_f32 v[246:247], v[214:215], v[214:215]
v_pk_mul_f32 v[248:249], v[216:217], v[216:217]
v_pk_mul_f32 v[250:251], v[218:219], v[218:219]
v_pk_mul_f32 v[252:253], v[220:221], v[220:221]
v_pk_mul_f32 v[254:255], v[222:223], v[222:223]
v_pk_fma_f32 v[240:241], v[240:241], v[8:9], v[8:9] op_sel:[0,1,0] op_sel_hi:[1,1,0]
v_pk_fma_f32 v[242:243], v[242:243], v[8:9], v[8:9] op_sel:[0,1,0] op_sel_hi:[1,1,0]
v_pk_fma_f32 v[244:245], v[244:245], v[8:9], v[8:9] op_sel:[0,1,0] op_sel_hi:[1,1,0]
v_pk_fma_f32 v[246:247], v[246:247], v[8:9], v[8:9] op_sel:[0,1,0] op_sel_hi:[1,1,0]
v_pk_fma_f32 v[248:249], v[248:249], v[8:9], v[8:9] op_sel:[0,1,0] op_sel_hi:[1,1,0]
v_pk_fma_f32 v[250:251], v[250:251], v[8:9], v[8:9] op_sel:[0,1,0] op_sel_hi:[1,1,0]
v_pk_fma_f32 v[252:253], v[252:253], v[8:9], v[8:9] op_sel:[0,1,0] op_sel_hi:[1,1,0]
v_pk_fma_f32 v[254:255], v[254:255], v[8:9], v[8:9] op_sel:[0,1,0] op_sel_hi:[1,1,0]
v_pk_mul_f32 v[240:241], v[240:241], v[208:209]
v_pk_mul_f32 v[242:243], v[242:243], v[210:211]
v_pk_mul_f32 v[244:245], v[244:245], v[212:213]
v_pk_mul_f32 v[246:247], v[246:247], v[214:215]
v_pk_mul_f32 v[248:249], v[248:249], v[216:217]
v_pk_mul_f32 v[250:251], v[250:251], v[218:219]
v_pk_mul_f32 v[252:253], v[252:253], v[220:221]
v_pk_mul_f32 v[254:255], v[254:255], v[222:223]
v_exp_f32 v240, v240
v_exp_f32 v241, v241
v_exp_f32 v242, v242
v_exp_f32 v243, v243
v_exp_f32 v244, v244
v_exp_f32 v245, v245
v_exp_f32 v246, v246
v_exp_f32 v247, v247
v_exp_f32 v248, v248
v_exp_f32 v249, v249
v_exp_f32 v250, v250
v_exp_f32 v251, v251
v_exp_f32 v252, v252
v_exp_f32 v253, v253
v_exp_f32 v254, v254
v_exp_f32 v255, v255
v_pk_add_f32 v[240:241], v[240:241], 1.0 op_sel_hi:[1,0]
v_pk_add_f32 v[242:243], v[242:243], 1.0 op_sel_hi:[1,0]
v_pk_add_f32 v[244:245], v[244:245], 1.0 op_sel_hi:[1,0]
v_pk_add_f32 v[246:247], v[246:247], 1.0 op_sel_hi:[1,0]
v_pk_add_f32 v[248:249], v[248:249], 1.0 op_sel_hi:[1,0]
v_pk_add_f32 v[250:251], v[250:251], 1.0 op_sel_hi:[1,0]
v_pk_add_f32 v[252:253], v[252:253], 1.0 op_sel_hi:[1,0]
v_pk_add_f32 v[254:255], v[254:255], 1.0 op_sel_hi:[1,0]
v_rcp_f32 v240, v240
v_rcp_f32 v241, v241
v_rcp_f32 v242, v242
v_rcp_f32 v243, v243
v_rcp_f32 v244, v244
v_rcp_f32 v245, v245
v_rcp_f32 v246, v246
v_rcp_f32 v247, v247
v_rcp_f32 v248, v248
v_rcp_f32 v249, v249
v_rcp_f32 v250, v250
v_rcp_f32 v251, v251
v_rcp_f32 v252, v252
v_rcp_f32 v253, v253
v_rcp_f32 v254, v254
v_rcp_f32 v255, v255
v_pk_mul_f32 v[240:241], v[240:241], v[208:209]
v_pk_mul_f32 v[242:243], v[242:243], v[210:211]
v_pk_mul_f32 v[244:245], v[244:245], v[212:213]
v_pk_mul_f32 v[246:247], v[246:247], v[214:215]
v_pk_mul_f32 v[248:249], v[248:249], v[216:217]
v_pk_mul_f32 v[250:251], v[250:251], v[218:219]
v_pk_mul_f32 v[252:253], v[252:253], v[220:221]
v_pk_mul_f32 v[254:255], v[254:255], v[222:223]
v_cvt_pk_bf16_f32 v208, v240, v241
v_cvt_pk_bf16_f32 v209, v242, v243
v_cvt_pk_bf16_f32 v210, v244, v245
v_cvt_pk_bf16_f32 v211, v246, v247
v_cvt_pk_bf16_f32 v212, v248, v249
v_cvt_pk_bf16_f32 v213, v250, v251
v_cvt_pk_bf16_f32 v214, v252, v253
v_cvt_pk_bf16_f32 v215, v254, v255
buffer_store_dwordx4 v[208:211], v3, s[36:39], s40 offen offset:0 sc1
buffer_store_dwordx4 v[212:215], v3, s[36:39], s40 offen offset:1024 sc1
v_pk_mul_f32 v[240:241], v[224:225], v[224:225]
v_pk_mul_f32 v[242:243], v[226:227], v[226:227]
v_pk_mul_f32 v[244:245], v[228:229], v[228:229]
v_pk_mul_f32 v[246:247], v[230:231], v[230:231]
v_pk_mul_f32 v[248:249], v[232:233], v[232:233]
v_pk_mul_f32 v[250:251], v[234:235], v[234:235]
v_pk_mul_f32 v[252:253], v[236:237], v[236:237]
v_pk_mul_f32 v[254:255], v[238:239], v[238:239]
v_pk_fma_f32 v[240:241], v[240:241], v[8:9], v[8:9] op_sel:[0,1,0] op_sel_hi:[1,1,0]
v_pk_fma_f32 v[242:243], v[242:243], v[8:9], v[8:9] op_sel:[0,1,0] op_sel_hi:[1,1,0]
v_pk_fma_f32 v[244:245], v[244:245], v[8:9], v[8:9] op_sel:[0,1,0] op_sel_hi:[1,1,0]
v_pk_fma_f32 v[246:247], v[246:247], v[8:9], v[8:9] op_sel:[0,1,0] op_sel_hi:[1,1,0]
v_pk_fma_f32 v[248:249], v[248:249], v[8:9], v[8:9] op_sel:[0,1,0] op_sel_hi:[1,1,0]
v_pk_fma_f32 v[250:251], v[250:251], v[8:9], v[8:9] op_sel:[0,1,0] op_sel_hi:[1,1,0]
v_pk_fma_f32 v[252:253], v[252:253], v[8:9], v[8:9] op_sel:[0,1,0] op_sel_hi:[1,1,0]
v_pk_fma_f32 v[254:255], v[254:255], v[8:9], v[8:9] op_sel:[0,1,0] op_sel_hi:[1,1,0]
v_pk_mul_f32 v[240:241], v[240:241], v[224:225]
v_pk_mul_f32 v[242:243], v[242:243], v[226:227]
v_pk_mul_f32 v[244:245], v[244:245], v[228:229]
v_pk_mul_f32 v[246:247], v[246:247], v[230:231]
v_pk_mul_f32 v[248:249], v[248:249], v[232:233]
v_pk_mul_f32 v[250:251], v[250:251], v[234:235]
v_pk_mul_f32 v[252:253], v[252:253], v[236:237]
v_pk_mul_f32 v[254:255], v[254:255], v[238:239]
v_exp_f32 v240, v240
v_exp_f32 v241, v241
v_exp_f32 v242, v242
v_exp_f32 v243, v243
v_exp_f32 v244, v244
v_exp_f32 v245, v245
v_exp_f32 v246, v246
v_exp_f32 v247, v247
v_exp_f32 v248, v248
v_exp_f32 v249, v249
v_exp_f32 v250, v250
v_exp_f32 v251, v251
v_exp_f32 v252, v252
v_exp_f32 v253, v253
v_exp_f32 v254, v254
v_exp_f32 v255, v255
v_pk_add_f32 v[240:241], v[240:241], 1.0 op_sel_hi:[1,0]
v_pk_add_f32 v[242:243], v[242:243], 1.0 op_sel_hi:[1,0]
v_pk_add_f32 v[244:245], v[244:245], 1.0 op_sel_hi:[1,0]
v_pk_add_f32 v[246:247], v[246:247], 1.0 op_sel_hi:[1,0]
v_pk_add_f32 v[248:249], v[248:249], 1.0 op_sel_hi:[1,0]
v_pk_add_f32 v[250:251], v[250:251], 1.0 op_sel_hi:[1,0]
v_pk_add_f32 v[252:253], v[252:253], 1.0 op_sel_hi:[1,0]
v_pk_add_f32 v[254:255], v[254:255], 1.0 op_sel_hi:[1,0]
v_rcp_f32 v240, v240
v_rcp_f32 v241, v241
v_rcp_f32 v242, v242
v_rcp_f32 v243, v243
v_rcp_f32 v244, v244
v_rcp_f32 v245, v245
v_rcp_f32 v246, v246
v_rcp_f32 v247, v247
v_rcp_f32 v248, v248
v_rcp_f32 v249, v249
v_rcp_f32 v250, v250
v_rcp_f32 v251, v251
v_rcp_f32 v252, v252
v_rcp_f32 v253, v253
v_rcp_f32 v254, v254
v_rcp_f32 v255, v255
v_pk_mul_f32 v[240:241], v[240:241], v[224:225]
v_pk_mul_f32 v[242:243], v[242:243], v[226:227]
v_pk_mul_f32 v[244:245], v[244:245], v[228:229]
v_pk_mul_f32 v[246:247], v[246:247], v[230:231]
v_pk_mul_f32 v[248:249], v[248:249], v[232:233]
v_pk_mul_f32 v[250:251], v[250:251], v[234:235]
v_pk_mul_f32 v[252:253], v[252:253], v[236:237]
v_pk_mul_f32 v[254:255], v[254:255], v[238:239]
v_cvt_pk_bf16_f32 v224, v240, v241
v_cvt_pk_bf16_f32 v225, v242, v243
v_cvt_pk_bf16_f32 v226, v244, v245
v_cvt_pk_bf16_f32 v227, v246, v247
v_cvt_pk_bf16_f32 v228, v248, v249
v_cvt_pk_bf16_f32 v229, v250, v251
v_cvt_pk_bf16_f32 v230, v252, v253
v_cvt_pk_bf16_f32 v231, v254, v255
buffer_store_dwordx4 v[224:227], v4, s[36:39], s40 offen offset:0 sc1
buffer_store_dwordx4 v[228:231], v4, s[36:39], s40 offen offset:1024 sc1
s_add_u32 s40, s40, 0x800
ds_read_b128 v[16:19], v1
ds_read_b128 v[20:23], v2
s_waitcnt vmcnt(35)
s_waitcnt lgkmcnt(0)
v_mfma_f32_32x32x16_bf16 v[112:127], v[32:35], v[16:19], 0
ds_read_b128 v[24:27], v1 offset:1024
v_mfma_f32_32x32x16_bf16 v[128:143], v[32:35], v[20:23], 0
ds_read_b128 v[28:31], v2 offset:1024
buffer_load_dwordx4 v[32:35], v1, s[8:11], s21 offen offset:2048
s_add_u32 s21, s21, 55296
s_waitcnt vmcnt(35)
v_mfma_f32_32x32x16_bf16 v[144:159], v[36:39], v[16:19], 0
v_mfma_f32_32x32x16_bf16 v[160:175], v[36:39], v[20:23], 0
buffer_load_dwordx4 v[36:39], v1, s[8:11], s21 offen offset:0
s_waitcnt vmcnt(35)
v_mfma_f32_32x32x16_bf16 v[176:191], v[40:43], v[16:19], 0
v_mfma_f32_32x32x16_bf16 v[192:207], v[40:43], v[20:23], 0
buffer_load_dwordx4 v[40:43], v1, s[8:11], s21 offen offset:1024
s_waitcnt vmcnt(35)
s_waitcnt lgkmcnt(0)
v_mfma_f32_32x32x16_bf16 v[112:127], v[44:47], v[24:27], v[112:127]
ds_read_b128 v[16:19], v1 offset:2048
v_mfma_f32_32x32x16_bf16 v[128:143], v[44:47], v[28:31], v[128:143]
ds_read_b128 v[20:23], v2 offset:2048
buffer_load_dwordx4 v[44:47], v1, s[8:11], s21 offen offset:2048
s_add_u32 s21, s21, 55296
s_waitcnt vmcnt(35)
v_mfma_f32_32x32x16_bf16 v[144:159], v[48:51], v[24:27], v[144:159]
v_mfma_f32_32x32x16_bf16 v[160:175], v[48:51], v[28:31], v[160:175]
buffer_load_dwordx4 v[48:51], v1, s[8:11], s21 offen offset:0
s_waitcnt vmcnt(35)
v_mfma_f32_32x32x16_bf16 v[176:191], v[52:55], v[24:27], v[176:191]
v_mfma_f32_32x32x16_bf16 v[192:207], v[52:55], v[28:31], v[192:207]
buffer_load_dwordx4 v[52:55], v1, s[8:11], s21 offen offset:1024
s_waitcnt vmcnt(35)
s_waitcnt lgkmcnt(0)
v_mfma_f32_32x32x16_bf16 v[112:127], v[56:59], v[16:19], v[112:127]
ds_read_b128 v[24:27], v1 offset:3072
v_mfma_f32_32x32x16_bf16 v[128:143], v[56:59], v[20:23], v[128:143]
ds_read_b128 v[28:31], v2 offset:3072
buffer_load_dwordx4 v[56:59], v1, s[8:11], s21 offen offset:2048
s_add_u32 s21, s21, 55296
s_waitcnt vmcnt(35)
v_mfma_f32_32x32x16_bf16 v[144:159], v[60:63], v[16:19], v[144:159]
v_mfma_f32_32x32x16_bf16 v[160:175], v[60:63], v[20:23], v[160:175]
buffer_load_dwordx4 v[60:63], v1, s[8:11], s21 offen offset:0
s_waitcnt vmcnt(35)
v_mfma_f32_32x32x16_bf16 v[176:191], v[64:67], v[16:19], v[176:191]
v_mfma_f32_32x32x16_bf16 v[192:207], v[64:67], v[20:23], v[192:207]
buffer_load_dwordx4 v[64:67], v1, s[8:11], s21 offen offset:1024
s_waitcnt vmcnt(35)
s_waitcnt lgkmcnt(0)
v_mfma_f32_32x32x16_bf16 v[112:127], v[68:71], v[24:27], v[112:127]
ds_read_b128 v[16:19], v1 offset:4096
v_mfma_f32_32x32x16_bf16 v[128:143], v[68:71], v[28:31], v[128:143]
ds_read_b128 v[20:23], v2 offset:4096
buffer_load_dwordx4 v[68:71], v1, s[8:11], s21 offen offset:2048
s_add_u32 s21, s21, 55296
s_cmp_ge_u32 s21, s47
s_cselect_b32 s45, 2211840, 0
s_sub_u32 s21, s21, s45
s_waitcnt vmcnt(35)
v_mfma_f32_32x32x16_bf16 v[144:159], v[72:75], v[24:27], v[144:159]
v_mfma_f32_32x32x16_bf16 v[160:175], v[72:75], v[28:31], v[160:175]
buffer_load_dwordx4 v[72:75], v1, s[8:11], s21 offen offset:0
s_waitcnt vmcnt(35)
v_mfma_f32_32x32x16_bf16 v[176:191], v[76:79], v[24:27], v[176:191]
v_mfma_f32_32x32x16_bf16 v[192:207], v[76:79], v[28:31], v[192:207]
buffer_load_dwordx4 v[76:79], v1, s[8:11], s21 offen offset:1024
s_waitcnt vmcnt(35)
s_waitcnt lgkmcnt(0)
v_mfma_f32_32x32x16_bf16 v[112:127], v[80:83], v[16:19], v[112:127]
ds_read_b128 v[24:27], v1 offset:5120
v_mfma_f32_32x32x16_bf16 v[128:143], v[80:83], v[20:23], v[128:143]
ds_read_b128 v[28:31], v2 offset:5120
buffer_load_dwordx4 v[80:83], v1, s[8:11], s21 offen offset:2048
s_add_u32 s21, s21, 55296
s_waitcnt vmcnt(35)
v_mfma_f32_32x32x16_bf16 v[144:159], v[84:87], v[16:19], v[144:159]
v_mfma_f32_32x32x16_bf16 v[160:175], v[84:87], v[20:23], v[160:175]
buffer_load_dwordx4 v[84:87], v1, s[8:11], s21 offen offset:0
s_waitcnt vmcnt(35)
v_mfma_f32_32x32x16_bf16 v[176:191], v[88:91], v[16:19], v[176:191]
v_mfma_f32_32x32x16_bf16 v[192:207], v[88:91], v[20:23], v[192:207]
buffer_load_dwordx4 v[88:91], v1, s[8:11], s21 offen offset:1024
s_waitcnt vmcnt(35)
s_waitcnt lgkmcnt(0)
v_mfma_f32_32x32x16_bf16 v[112:127], v[92:95], v[24:27], v[112:127]
ds_read_b128 v[16:19], v1 offset:6144
v_mfma_f32_32x32x16_bf16 v[128:143], v[92:95], v[28:31], v[128:143]
ds_read_b128 v[20:23], v2 offset:6144
buffer_load_dwordx4 v[92:95], v1, s[8:11], s21 offen offset:2048
s_add_u32 s21, s21, 55296
s_waitcnt vmcnt(35)
v_mfma_f32_32x32x16_bf16 v[144:159], v[96:99], v[24:27], v[144:159]
v_mfma_f32_32x32x16_bf16 v[160:175], v[96:99], v[28:31], v[160:175]
buffer_load_dwordx4 v[96:99], v1, s[8:11], s21 offen offset:0
s_waitcnt vmcnt(35)
v_mfma_f32_32x32x16_bf16 v[176:191], v[100:103], v[24:27], v[176:191]
v_mfma_f32_32x32x16_bf16 v[192:207], v[100:103], v[28:31], v[192:207]
buffer_load_dwordx4 v[100:103], v1, s[8:11], s21 offen offset:1024
s_waitcnt vmcnt(35)
s_waitcnt lgkmcnt(0)
v_mfma_f32_32x32x16_bf16 v[112:127], v[104:107], v[16:19], v[112:127]
ds_read_b128 v[24:27], v1 offset:7168
v_mfma_f32_32x32x16_bf16 v[128:143], v[104:107], v[20:23], v[128:143]
ds_read_b128 v[28:31], v2 offset:7168
buffer_load_dwordx4 v[104:107], v1, s[8:11], s21 offen offset:2048
s_add_u32 s21, s21, 55296
s_waitcnt vmcnt(35)
v_mfma_f32_32x32x16_bf16 v[144:159], v[108:111], v[16:19], v[144:159]
v_mfma_f32_32x32x16_bf16 v[160:175], v[108:111], v[20:23], v[160:175]
buffer_load_dwordx4 v[108:111], v1, s[8:11], s21 offen offset:0
s_waitcnt vmcnt(19)
v_mfma_f32_32x32x16_bf16 v[176:191], v[32:35], v[16:19], v[176:191]
v_mfma_f32_32x32x16_bf16 v[192:207], v[32:35], v[20:23], v[192:207]
buffer_load_dwordx4 v[32:35], v1, s[8:11], s21 offen offset:1024
s_waitcnt vmcnt(19)
s_waitcnt lgkmcnt(0)
v_mfma_f32_32x32x16_bf16 v[112:127], v[36:39], v[24:27], v[112:127]
ds_read_b128 v[16:19], v1 offset:8192
v_mfma_f32_32x32x16_bf16 v[128:143], v[36:39], v[28:31], v[128:143]
ds_read_b128 v[20:23], v2 offset:8192
buffer_load_dwordx4 v[36:39], v1, s[8:11], s21 offen offset:2048
s_add_u32 s21, s21, 55296
s_waitcnt vmcnt(19)
v_mfma_f32_32x32x16_bf16 v[144:159], v[40:43], v[24:27], v[144:159]
v_mfma_f32_32x32x16_bf16 v[160:175], v[40:43], v[28:31], v[160:175]
buffer_load_dwordx4 v[40:43], v1, s[8:11], s21 offen offset:0
s_waitcnt vmcnt(19)
v_mfma_f32_32x32x16_bf16 v[176:191], v[44:47], v[24:27], v[176:191]
v_mfma_f32_32x32x16_bf16 v[192:207], v[44:47], v[28:31], v[192:207]
buffer_load_dwordx4 v[44:47], v1, s[8:11], s21 offen offset:1024
s_waitcnt vmcnt(19)
s_waitcnt lgkmcnt(0)
v_mfma_f32_32x32x16_bf16 v[112:127], v[48:51], v[16:19], v[112:127]
ds_read_b128 v[24:27], v1 offset:9216
v_mfma_f32_32x32x16_bf16 v[128:143], v[48:51], v[20:23], v[128:143]
ds_read_b128 v[28:31], v2 offset:9216
buffer_load_dwordx4 v[48:51], v1, s[8:11], s21 offen offset:2048
s_add_u32 s21, s21, 55296
s_waitcnt vmcnt(19)
v_mfma_f32_32x32x16_bf16 v[144:159], v[52:55], v[16:19], v[144:159]
v_mfma_f32_32x32x16_bf16 v[160:175], v[52:55], v[20:23], v[160:175]
buffer_load_dwordx4 v[52:55], v1, s[8:11], s21 offen offset:0
s_waitcnt vmcnt(19)
v_mfma_f32_32x32x16_bf16 v[176:191], v[56:59], v[16:19], v[176:191]
v_mfma_f32_32x32x16_bf16 v[192:207], v[56:59], v[20:23], v[192:207]
buffer_load_dwordx4 v[56:59], v1, s[8:11], s21 offen offset:1024
s_waitcnt vmcnt(19)
s_waitcnt lgkmcnt(0)
v_mfma_f32_32x32x16_bf16 v[112:127], v[60:63], v[24:27], v[112:127]
ds_read_b128 v[16:19], v1 offset:10240
v_mfma_f32_32x32x16_bf16 v[128:143], v[60:63], v[28:31], v[128:143]
ds_read_b128 v[20:23], v2 offset:10240
buffer_load_dwordx4 v[60:63], v1, s[8:11], s21 offen offset:2048
s_add_u32 s21, s21, 55296
s_waitcnt vmcnt(19)
v_mfma_f32_32x32x16_bf16 v[144:159], v[64:67], v[24:27], v[144:159]
v_mfma_f32_32x32x16_bf16 v[160:175], v[64:67], v[28:31], v[160:175]
buffer_load_dwordx4 v[64:67], v1, s[8:11], s21 offen offset:0
s_waitcnt vmcnt(19)
v_mfma_f32_32x32x16_bf16 v[176:191], v[68:71], v[24:27], v[176:191]
v_mfma_f32_32x32x16_bf16 v[192:207], v[68:71], v[28:31], v[192:207]
buffer_load_dwordx4 v[68:71], v1, s[8:11], s21 offen offset:1024
s_waitcnt vmcnt(19)
s_waitcnt lgkmcnt(0)
v_mfma_f32_32x32x16_bf16 v[112:127], v[72:75], v[16:19], v[112:127]
ds_read_b128 v[24:27], v1 offset:11264
v_mfma_f32_32x32x16_bf16 v[128:143], v[72:75], v[20:23], v[128:143]
ds_read_b128 v[28:31], v2 offset:11264
buffer_load_dwordx4 v[72:75], v1, s[8:11], s21 offen offset:2048
s_add_u32 s21, s21, 55296
s_waitcnt vmcnt(19)
v_mfma_f32_32x32x16_bf16 v[144:159], v[76:79], v[16:19], v[144:159]
v_mfma_f32_32x32x16_bf16 v[160:175], v[76:79], v[20:23], v[160:175]
buffer_load_dwordx4 v[76:79], v1, s[8:11], s21 offen offset:0
s_waitcnt vmcnt(19)
v_mfma_f32_32x32x16_bf16 v[176:191], v[80:83], v[16:19], v[176:191]
v_mfma_f32_32x32x16_bf16 v[192:207], v[80:83], v[20:23], v[192:207]
buffer_load_dwordx4 v[80:83], v1, s[8:11], s21 offen offset:1024
s_waitcnt vmcnt(19)
s_waitcnt lgkmcnt(0)
v_mfma_f32_32x32x16_bf16 v[112:127], v[84:87], v[24:27], v[112:127]
ds_read_b128 v[16:19], v1 offset:12288
v_mfma_f32_32x32x16_bf16 v[128:143], v[84:87], v[28:31], v[128:143]
ds_read_b128 v[20:23], v2 offset:12288
buffer_load_dwordx4 v[84:87], v1, s[8:11], s21 offen offset:2048
s_add_u32 s21, s21, 55296
s_waitcnt vmcnt(19)
v_mfma_f32_32x32x16_bf16 v[144:159], v[88:91], v[24:27], v[144:159]
v_mfma_f32_32x32x16_bf16 v[160:175], v[88:91], v[28:31], v[160:175]
buffer_load_dwordx4 v[88:91], v1, s[8:11], s21 offen offset:0
s_waitcnt vmcnt(19)
v_mfma_f32_32x32x16_bf16 v[176:191], v[92:95], v[24:27], v[176:191]
v_mfma_f32_32x32x16_bf16 v[192:207], v[92:95], v[28:31], v[192:207]
buffer_load_dwordx4 v[92:95], v1, s[8:11], s21 offen offset:1024
s_waitcnt vmcnt(19)
s_waitcnt lgkmcnt(0)
v_mfma_f32_32x32x16_bf16 v[112:127], v[96:99], v[16:19], v[112:127]
ds_read_b128 v[24:27], v1 offset:13312
v_mfma_f32_32x32x16_bf16 v[128:143], v[96:99], v[20:23], v[128:143]
ds_read_b128 v[28:31], v2 offset:13312
buffer_load_dwordx4 v[96:99], v1, s[8:11], s21 offen offset:2048
s_add_u32 s21, s21, 55296
s_waitcnt vmcnt(19)
v_mfma_f32_32x32x16_bf16 v[144:159], v[100:103], v[16:19], v[144:159]
v_mfma_f32_32x32x16_bf16 v[160:175], v[100:103], v[20:23], v[160:175]
buffer_load_dwordx4 v[100:103], v1, s[8:11], s21 offen offset:0
s_waitcnt vmcnt(19)
v_mfma_f32_32x32x16_bf16 v[176:191], v[104:107], v[16:19], v[176:191]
v_mfma_f32_32x32x16_bf16 v[192:207], v[104:107], v[20:23], v[192:207]
buffer_load_dwordx4 v[104:107], v1, s[8:11], s21 offen offset:1024
s_waitcnt vmcnt(19)
s_waitcnt lgkmcnt(0)
v_mfma_f32_32x32x16_bf16 v[112:127], v[108:111], v[24:27], v[112:127]
ds_read_b128 v[16:19], v1 offset:14336
v_mfma_f32_32x32x16_bf16 v[128:143], v[108:111], v[28:31], v[128:143]
ds_read_b128 v[20:23], v2 offset:14336
buffer_load_dwordx4 v[108:111], v1, s[8:11], s21 offen offset:2048
s_add_u32 s21, s21, 55296
s_cmp_ge_u32 s21, s47
s_cselect_b32 s45, 2211840, 0
s_sub_u32 s21, s21, s45
s_waitcnt vmcnt(19)
v_mfma_f32_32x32x16_bf16 v[144:159], v[32:35], v[24:27], v[144:159]
v_mfma_f32_32x32x16_bf16 v[160:175], v[32:35], v[28:31], v[160:175]
buffer_load_dwordx4 v[32:35], v1, s[8:11], s21 offen offset:0
s_waitcnt vmcnt(19)
v_mfma_f32_32x32x16_bf16 v[176:191], v[36:39], v[24:27], v[176:191]
v_mfma_f32_32x32x16_bf16 v[192:207], v[36:39], v[28:31], v[192:207]
buffer_load_dwordx4 v[36:39], v1, s[8:11], s21 offen offset:1024
s_waitcnt vmcnt(19)
s_waitcnt lgkmcnt(0)
v_mfma_f32_32x32x16_bf16 v[112:127], v[40:43], v[16:19], v[112:127]
ds_read_b128 v[24:27], v1 offset:15360
v_mfma_f32_32x32x16_bf16 v[128:143], v[40:43], v[20:23], v[128:143]
ds_read_b128 v[28:31], v2 offset:15360
buffer_load_dwordx4 v[40:43], v1, s[8:11], s21 offen offset:2048
s_add_u32 s21, s21, 55296
s_waitcnt vmcnt(19)
v_mfma_f32_32x32x16_bf16 v[144:159], v[44:47], v[16:19], v[144:159]
v_mfma_f32_32x32x16_bf16 v[160:175], v[44:47], v[20:23], v[160:175]
buffer_load_dwordx4 v[44:47], v1, s[8:11], s21 offen offset:0
s_waitcnt vmcnt(19)
v_mfma_f32_32x32x16_bf16 v[176:191], v[48:51], v[16:19], v[176:191]
v_mfma_f32_32x32x16_bf16 v[192:207], v[48:51], v[20:23], v[192:207]
buffer_load_dwordx4 v[48:51], v1, s[8:11], s21 offen offset:1024
s_waitcnt vmcnt(19)
s_waitcnt lgkmcnt(0)
v_mfma_f32_32x32x16_bf16 v[112:127], v[52:55], v[24:27], v[112:127]
ds_read_b128 v[16:19], v1 offset:16384
v_mfma_f32_32x32x16_bf16 v[128:143], v[52:55], v[28:31], v[128:143]
ds_read_b128 v[20:23], v2 offset:16384
buffer_load_dwordx4 v[52:55], v1, s[8:11], s21 offen offset:2048
s_add_u32 s21, s21, 55296
s_waitcnt vmcnt(19)
v_mfma_f32_32x32x16_bf16 v[144:159], v[56:59], v[24:27], v[144:159]
v_mfma_f32_32x32x16_bf16 v[160:175], v[56:59], v[28:31], v[160:175]
buffer_load_dwordx4 v[56:59], v1, s[8:11], s21 offen offset:0
s_waitcnt vmcnt(19)
v_mfma_f32_32x32x16_bf16 v[176:191], v[60:63], v[24:27], v[176:191]
v_mfma_f32_32x32x16_bf16 v[192:207], v[60:63], v[28:31], v[192:207]
buffer_load_dwordx4 v[60:63], v1, s[8:11], s21 offen offset:1024
s_waitcnt vmcnt(19)
s_waitcnt lgkmcnt(0)
v_mfma_f32_32x32x16_bf16 v[112:127], v[64:67], v[16:19], v[112:127]
ds_read_b128 v[24:27], v1 offset:17408
v_mfma_f32_32x32x16_bf16 v[128:143], v[64:67], v[20:23], v[128:143]
ds_read_b128 v[28:31], v2 offset:17408
buffer_load_dwordx4 v[64:67], v1, s[8:11], s21 offen offset:2048
s_add_u32 s21, s21, 55296
s_waitcnt vmcnt(19)
v_mfma_f32_32x32x16_bf16 v[144:159], v[68:71], v[16:19], v[144:159]
v_mfma_f32_32x32x16_bf16 v[160:175], v[68:71], v[20:23], v[160:175]
buffer_load_dwordx4 v[68:71], v1, s[8:11], s21 offen offset:0
s_waitcnt vmcnt(19)
v_mfma_f32_32x32x16_bf16 v[176:191], v[72:75], v[16:19], v[176:191]
v_mfma_f32_32x32x16_bf16 v[192:207], v[72:75], v[20:23], v[192:207]
buffer_load_dwordx4 v[72:75], v1, s[8:11], s21 offen offset:1024
s_waitcnt vmcnt(19)
s_waitcnt lgkmcnt(0)
v_mfma_f32_32x32x16_bf16 v[112:127], v[76:79], v[24:27], v[112:127]
ds_read_b128 v[16:19], v1 offset:18432
v_mfma_f32_32x32x16_bf16 v[128:143], v[76:79], v[28:31], v[128:143]
ds_read_b128 v[20:23], v2 offset:18432
buffer_load_dwordx4 v[76:79], v1, s[8:11], s21 offen offset:2048
s_add_u32 s21, s21, 55296
s_waitcnt vmcnt(19)
v_mfma_f32_32x32x16_bf16 v[144:159], v[80:83], v[24:27], v[144:159]
v_mfma_f32_32x32x16_bf16 v[160:175], v[80:83], v[28:31], v[160:175]
buffer_load_dwordx4 v[80:83], v1, s[8:11], s21 offen offset:0
s_waitcnt vmcnt(19)
v_mfma_f32_32x32x16_bf16 v[176:191], v[84:87], v[24:27], v[176:191]
v_mfma_f32_32x32x16_bf16 v[192:207], v[84:87], v[28:31], v[192:207]
buffer_load_dwordx4 v[84:87], v1, s[8:11], s21 offen offset:1024
s_waitcnt vmcnt(19)
s_waitcnt lgkmcnt(0)
v_mfma_f32_32x32x16_bf16 v[112:127], v[88:91], v[16:19], v[112:127]
ds_read_b128 v[24:27], v1 offset:19456
v_mfma_f32_32x32x16_bf16 v[128:143], v[88:91], v[20:23], v[128:143]
ds_read_b128 v[28:31], v2 offset:19456
buffer_load_dwordx4 v[88:91], v1, s[8:11], s21 offen offset:2048
s_add_u32 s21, s21, 55296
s_waitcnt vmcnt(19)
v_mfma_f32_32x32x16_bf16 v[144:159], v[92:95], v[16:19], v[144:159]
v_mfma_f32_32x32x16_bf16 v[160:175], v[92:95], v[20:23], v[160:175]
buffer_load_dwordx4 v[92:95], v1, s[8:11], s21 offen offset:0
s_waitcnt vmcnt(19)
v_mfma_f32_32x32x16_bf16 v[176:191], v[96:99], v[16:19], v[176:191]
v_mfma_f32_32x32x16_bf16 v[192:207], v[96:99], v[20:23], v[192:207]
buffer_load_dwordx4 v[96:99], v1, s[8:11], s21 offen offset:1024
s_waitcnt vmcnt(19)
s_waitcnt lgkmcnt(0)
v_mfma_f32_32x32x16_bf16 v[112:127], v[100:103], v[24:27], v[112:127]
ds_read_b128 v[16:19], v1 offset:20480
v_mfma_f32_32x32x16_bf16 v[128:143], v[100:103], v[28:31], v[128:143]
ds_read_b128 v[20:23], v2 offset:20480
buffer_load_dwordx4 v[100:103], v1, s[8:11], s21 offen offset:2048
s_add_u32 s21, s21, 55296
s_waitcnt vmcnt(19)
v_mfma_f32_32x32x16_bf16 v[144:159], v[104:107], v[24:27], v[144:159]
v_mfma_f32_32x32x16_bf16 v[160:175], v[104:107], v[28:31], v[160:175]
buffer_load_dwordx4 v[104:107], v1, s[8:11], s21 offen offset:0
s_waitcnt vmcnt(19)
v_mfma_f32_32x32x16_bf16 v[176:191], v[108:111], v[24:27], v[176:191]
v_mfma_f32_32x32x16_bf16 v[192:207], v[108:111], v[28:31], v[192:207]
buffer_load_dwordx4 v[108:111], v1, s[8:11], s21 offen offset:1024
s_waitcnt vmcnt(19)
s_waitcnt lgkmcnt(0)
v_mfma_f32_32x32x16_bf16 v[112:127], v[32:35], v[16:19], v[112:127]
ds_read_b128 v[24:27], v1 offset:21504
v_mfma_f32_32x32x16_bf16 v[128:143], v[32:35], v[20:23], v[128:143]
ds_read_b128 v[28:31], v2 offset:21504
buffer_load_dwordx4 v[32:35], v1, s[8:11], s21 offen offset:2048
s_add_u32 s21, s21, 55296
s_waitcnt vmcnt(19)
v_mfma_f32_32x32x16_bf16 v[144:159], v[36:39], v[16:19], v[144:159]
v_mfma_f32_32x32x16_bf16 v[160:175], v[36:39], v[20:23], v[160:175]
buffer_load_dwordx4 v[36:39], v1, s[8:11], s21 offen offset:0
s_waitcnt vmcnt(19)
v_mfma_f32_32x32x16_bf16 v[176:191], v[40:43], v[16:19], v[176:191]
v_mfma_f32_32x32x16_bf16 v[192:207], v[40:43], v[20:23], v[192:207]
buffer_load_dwordx4 v[40:43], v1, s[8:11], s21 offen offset:1024
s_waitcnt vmcnt(19)
s_waitcnt lgkmcnt(0)
v_mfma_f32_32x32x16_bf16 v[112:127], v[44:47], v[24:27], v[112:127]
ds_read_b128 v[16:19], v1 offset:22528
v_mfma_f32_32x32x16_bf16 v[128:143], v[44:47], v[28:31], v[128:143]
ds_read_b128 v[20:23], v2 offset:22528
buffer_load_dwordx4 v[44:47], v1, s[8:11], s21 offen offset:2048
s_add_u32 s21, s21, 55296
s_waitcnt vmcnt(19)
v_mfma_f32_32x32x16_bf16 v[144:159], v[48:51], v[24:27], v[144:159]
v_mfma_f32_32x32x16_bf16 v[160:175], v[48:51], v[28:31], v[160:175]
buffer_load_dwordx4 v[48:51], v1, s[8:11], s21 offen offset:0
s_waitcnt vmcnt(19)
v_mfma_f32_32x32x16_bf16 v[176:191], v[52:55], v[24:27], v[176:191]
v_mfma_f32_32x32x16_bf16 v[192:207], v[52:55], v[28:31], v[192:207]
buffer_load_dwordx4 v[52:55], v1, s[8:11], s21 offen offset:1024
s_waitcnt vmcnt(19)
s_waitcnt lgkmcnt(0)
v_mfma_f32_32x32x16_bf16 v[112:127], v[56:59], v[16:19], v[112:127]
ds_read_b128 v[24:27], v1 offset:23552
v_mfma_f32_32x32x16_bf16 v[128:143], v[56:59], v[20:23], v[128:143]
ds_read_b128 v[28:31], v2 offset:23552
buffer_load_dwordx4 v[56:59], v1, s[8:11], s21 offen offset:2048
s_add_u32 s21, s21, 55296
s_waitcnt vmcnt(19)
v_mfma_f32_32x32x16_bf16 v[144:159], v[60:63], v[16:19], v[144:159]
v_mfma_f32_32x32x16_bf16 v[160:175], v[60:63], v[20:23], v[160:175]
buffer_load_dwordx4 v[60:63], v1, s[8:11], s21 offen offset:0
s_waitcnt vmcnt(19)
v_mfma_f32_32x32x16_bf16 v[176:191], v[64:67], v[16:19], v[176:191]
v_mfma_f32_32x32x16_bf16 v[192:207], v[64:67], v[20:23], v[192:207]
buffer_load_dwordx4 v[64:67], v1, s[8:11], s21 offen offset:1024
s_waitcnt vmcnt(19)
s_waitcnt lgkmcnt(0)
v_mfma_f32_32x32x16_bf16 v[112:127], v[68:71], v[24:27], v[112:127]
ds_read_b128 v[16:19], v1 offset:24576
v_mfma_f32_32x32x16_bf16 v[128:143], v[68:71], v[28:31], v[128:143]
ds_read_b128 v[20:23], v2 offset:24576
buffer_load_dwordx4 v[68:71], v1, s[8:11], s21 offen offset:2048
s_add_u32 s21, s21, 55296
s_cmp_ge_u32 s21, s47
s_cselect_b32 s45, 2211840, 0
s_sub_u32 s21, s21, s45
s_waitcnt vmcnt(19)
v_mfma_f32_32x32x16_bf16 v[144:159], v[72:75], v[24:27], v[144:159]
v_mfma_f32_32x32x16_bf16 v[160:175], v[72:75], v[28:31], v[160:175]
buffer_load_dwordx4 v[72:75], v1, s[8:11], s21 offen offset:0
s_waitcnt vmcnt(19)
v_mfma_f32_32x32x16_bf16 v[176:191], v[76:79], v[24:27], v[176:191]
v_mfma_f32_32x32x16_bf16 v[192:207], v[76:79], v[28:31], v[192:207]
buffer_load_dwordx4 v[76:79], v1, s[8:11], s21 offen offset:1024
s_waitcnt vmcnt(19)
s_waitcnt lgkmcnt(0)
v_mfma_f32_32x32x16_bf16 v[112:127], v[80:83], v[16:19], v[112:127]
ds_read_b128 v[24:27], v1 offset:25600
v_mfma_f32_32x32x16_bf16 v[128:143], v[80:83], v[20:23], v[128:143]
ds_read_b128 v[28:31], v2 offset:25600
buffer_load_dwordx4 v[80:83], v1, s[8:11], s21 offen offset:2048
s_add_u32 s21, s21, 55296
s_waitcnt vmcnt(19)
v_mfma_f32_32x32x16_bf16 v[144:159], v[84:87], v[16:19], v[144:159]
v_mfma_f32_32x32x16_bf16 v[160:175], v[84:87], v[20:23], v[160:175]
buffer_load_dwordx4 v[84:87], v1, s[8:11], s21 offen offset:0
s_waitcnt vmcnt(19)
v_mfma_f32_32x32x16_bf16 v[176:191], v[88:91], v[16:19], v[176:191]
v_mfma_f32_32x32x16_bf16 v[192:207], v[88:91], v[20:23], v[192:207]
buffer_load_dwordx4 v[88:91], v1, s[8:11], s21 offen offset:1024
s_waitcnt vmcnt(19)
s_waitcnt lgkmcnt(0)
v_mfma_f32_32x32x16_bf16 v[112:127], v[92:95], v[24:27], v[112:127]
ds_read_b128 v[16:19], v1 offset:26624
v_mfma_f32_32x32x16_bf16 v[128:143], v[92:95], v[28:31], v[128:143]
ds_read_b128 v[20:23], v2 offset:26624
buffer_load_dwordx4 v[92:95], v1, s[8:11], s21 offen offset:2048
s_add_u32 s21, s21, 55296
s_waitcnt vmcnt(19)
v_mfma_f32_32x32x16_bf16 v[144:159], v[96:99], v[24:27], v[144:159]
v_mfma_f32_32x32x16_bf16 v[160:175], v[96:99], v[28:31], v[160:175]
buffer_load_dwordx4 v[96:99], v1, s[8:11], s21 offen offset:0
s_waitcnt vmcnt(19)
v_mfma_f32_32x32x16_bf16 v[176:191], v[100:103], v[24:27], v[176:191]
v_mfma_f32_32x32x16_bf16 v[192:207], v[100:103], v[28:31], v[192:207]
buffer_load_dwordx4 v[100:103], v1, s[8:11], s21 offen offset:1024
s_waitcnt vmcnt(19)
s_waitcnt lgkmcnt(0)
v_mfma_f32_32x32x16_bf16 v[112:127], v[104:107], v[16:19], v[112:127]
ds_read_b128 v[24:27], v1 offset:27648
v_mfma_f32_32x32x16_bf16 v[128:143], v[104:107], v[20:23], v[128:143]
ds_read_b128 v[28:31], v2 offset:27648
buffer_load_dwordx4 v[104:107], v1, s[8:11], s21 offen offset:2048
s_add_u32 s21, s21, 55296
s_waitcnt vmcnt(19)
v_mfma_f32_32x32x16_bf16 v[144:159], v[108:111], v[16:19], v[144:159]
v_mfma_f32_32x32x16_bf16 v[160:175], v[108:111], v[20:23], v[160:175]
buffer_load_dwordx4 v[108:111], v1, s[8:11], s21 offen offset:0
s_waitcnt vmcnt(19)
v_mfma_f32_32x32x16_bf16 v[176:191], v[32:35], v[16:19], v[176:191]
v_mfma_f32_32x32x16_bf16 v[192:207], v[32:35], v[20:23], v[192:207]
buffer_load_dwordx4 v[32:35], v1, s[8:11], s21 offen offset:1024
s_waitcnt vmcnt(19)
s_waitcnt lgkmcnt(0)
v_mfma_f32_32x32x16_bf16 v[112:127], v[36:39], v[24:27], v[112:127]
ds_read_b128 v[16:19], v1 offset:28672
v_mfma_f32_32x32x16_bf16 v[128:143], v[36:39], v[28:31], v[128:143]
ds_read_b128 v[20:23], v2 offset:28672
buffer_load_dwordx4 v[36:39], v1, s[8:11], s21 offen offset:2048
s_add_u32 s21, s21, 55296
s_waitcnt vmcnt(19)
v_mfma_f32_32x32x16_bf16 v[144:159], v[40:43], v[24:27], v[144:159]
v_mfma_f32_32x32x16_bf16 v[160:175], v[40:43], v[28:31], v[160:175]
buffer_load_dwordx4 v[40:43], v1, s[8:11], s21 offen offset:0
s_waitcnt vmcnt(19)
v_mfma_f32_32x32x16_bf16 v[176:191], v[44:47], v[24:27], v[176:191]
v_mfma_f32_32x32x16_bf16 v[192:207], v[44:47], v[28:31], v[192:207]
buffer_load_dwordx4 v[44:47], v1, s[8:11], s21 offen offset:1024
s_waitcnt vmcnt(19)
s_waitcnt lgkmcnt(0)
v_mfma_f32_32x32x16_bf16 v[112:127], v[48:51], v[16:19], v[112:127]
ds_read_b128 v[24:27], v1 offset:29696
v_mfma_f32_32x32x16_bf16 v[128:143], v[48:51], v[20:23], v[128:143]
ds_read_b128 v[28:31], v2 offset:29696
buffer_load_dwordx4 v[48:51], v1, s[8:11], s21 offen offset:2048
s_add_u32 s21, s21, 55296
s_waitcnt vmcnt(19)
v_mfma_f32_32x32x16_bf16 v[144:159], v[52:55], v[16:19], v[144:159]
v_mfma_f32_32x32x16_bf16 v[160:175], v[52:55], v[20:23], v[160:175]
buffer_load_dwordx4 v[52:55], v1, s[8:11], s21 offen offset:0
s_waitcnt vmcnt(19)
v_mfma_f32_32x32x16_bf16 v[176:191], v[56:59], v[16:19], v[176:191]
v_mfma_f32_32x32x16_bf16 v[192:207], v[56:59], v[20:23], v[192:207]
buffer_load_dwordx4 v[56:59], v1, s[8:11], s21 offen offset:1024
s_waitcnt vmcnt(19)
s_waitcnt lgkmcnt(0)
v_mfma_f32_32x32x16_bf16 v[112:127], v[60:63], v[24:27], v[112:127]
ds_read_b128 v[16:19], v1 offset:30720
v_mfma_f32_32x32x16_bf16 v[128:143], v[60:63], v[28:31], v[128:143]
ds_read_b128 v[20:23], v2 offset:30720
buffer_load_dwordx4 v[60:63], v1, s[8:11], s21 offen offset:2048
s_add_u32 s21, s21, 55296
s_waitcnt vmcnt(19)
v_mfma_f32_32x32x16_bf16 v[144:159], v[64:67], v[24:27], v[144:159]
v_mfma_f32_32x32x16_bf16 v[160:175], v[64:67], v[28:31], v[160:175]
buffer_load_dwordx4 v[64:67], v1, s[8:11], s21 offen offset:0
s_waitcnt vmcnt(19)
v_mfma_f32_32x32x16_bf16 v[176:191], v[68:71], v[24:27], v[176:191]
v_mfma_f32_32x32x16_bf16 v[192:207], v[68:71], v[28:31], v[192:207]
buffer_load_dwordx4 v[68:71], v1, s[8:11], s21 offen offset:1024
s_waitcnt vmcnt(19)
s_waitcnt lgkmcnt(0)
v_mfma_f32_32x32x16_bf16 v[112:127], v[72:75], v[16:19], v[112:127]
ds_read_b128 v[24:27], v1 offset:31744
v_mfma_f32_32x32x16_bf16 v[128:143], v[72:75], v[20:23], v[128:143]
ds_read_b128 v[28:31], v2 offset:31744
buffer_load_dwordx4 v[72:75], v1, s[8:11], s21 offen offset:2048
s_add_u32 s21, s21, 55296
s_waitcnt vmcnt(19)
v_mfma_f32_32x32x16_bf16 v[144:159], v[76:79], v[16:19], v[144:159]
v_mfma_f32_32x32x16_bf16 v[160:175], v[76:79], v[20:23], v[160:175]
buffer_load_dwordx4 v[76:79], v1, s[8:11], s21 offen offset:0
s_waitcnt vmcnt(19)
v_mfma_f32_32x32x16_bf16 v[176:191], v[80:83], v[16:19], v[176:191]
v_mfma_f32_32x32x16_bf16 v[192:207], v[80:83], v[20:23], v[192:207]
buffer_load_dwordx4 v[80:83], v1, s[8:11], s21 offen offset:1024
s_waitcnt vmcnt(19)
s_waitcnt lgkmcnt(0)
v_mfma_f32_32x32x16_bf16 v[112:127], v[84:87], v[24:27], v[112:127]
ds_read_b128 v[16:19], v1 offset:32768
v_mfma_f32_32x32x16_bf16 v[128:143], v[84:87], v[28:31], v[128:143]
ds_read_b128 v[20:23], v2 offset:32768
buffer_load_dwordx4 v[84:87], v1, s[8:11], s21 offen offset:2048
s_add_u32 s21, s21, 55296
s_waitcnt vmcnt(19)
v_mfma_f32_32x32x16_bf16 v[144:159], v[88:91], v[24:27], v[144:159]
v_mfma_f32_32x32x16_bf16 v[160:175], v[88:91], v[28:31], v[160:175]
buffer_load_dwordx4 v[88:91], v1, s[8:11], s21 offen offset:0
s_waitcnt vmcnt(19)
v_mfma_f32_32x32x16_bf16 v[176:191], v[92:95], v[24:27], v[176:191]
v_mfma_f32_32x32x16_bf16 v[192:207], v[92:95], v[28:31], v[192:207]
buffer_load_dwordx4 v[92:95], v1, s[8:11], s21 offen offset:1024
s_waitcnt vmcnt(19)
s_waitcnt lgkmcnt(0)
v_mfma_f32_32x32x16_bf16 v[112:127], v[96:99], v[16:19], v[112:127]
ds_read_b128 v[24:27], v1 offset:33792
v_mfma_f32_32x32x16_bf16 v[128:143], v[96:99], v[20:23], v[128:143]
ds_read_b128 v[28:31], v2 offset:33792
buffer_load_dwordx4 v[96:99], v1, s[8:11], s21 offen offset:2048
s_add_u32 s21, s21, 55296
s_waitcnt vmcnt(19)
v_mfma_f32_32x32x16_bf16 v[144:159], v[100:103], v[16:19], v[144:159]
v_mfma_f32_32x32x16_bf16 v[160:175], v[100:103], v[20:23], v[160:175]
buffer_load_dwordx4 v[100:103], v1, s[8:11], s21 offen offset:0
s_waitcnt vmcnt(19)
v_mfma_f32_32x32x16_bf16 v[176:191], v[104:107], v[16:19], v[176:191]
v_mfma_f32_32x32x16_bf16 v[192:207], v[104:107], v[20:23], v[192:207]
buffer_load_dwordx4 v[104:107], v1, s[8:11], s21 offen offset:1024
s_waitcnt vmcnt(19)
s_waitcnt lgkmcnt(0)
v_mfma_f32_32x32x16_bf16 v[112:127], v[108:111], v[24:27], v[112:127]
ds_read_b128 v[16:19], v1 offset:34816
v_mfma_f32_32x32x16_bf16 v[128:143], v[108:111], v[28:31], v[128:143]
ds_read_b128 v[20:23], v2 offset:34816
buffer_load_dwordx4 v[108:111], v1, s[8:11], s21 offen offset:2048
s_add_u32 s21, s21, 55296
s_waitcnt vmcnt(19)
v_mfma_f32_32x32x16_bf16 v[144:159], v[32:35], v[24:27], v[144:159]
v_mfma_f32_32x32x16_bf16 v[160:175], v[32:35], v[28:31], v[160:175]
s_waitcnt vmcnt(18)
v_mfma_f32_32x32x16_bf16 v[176:191], v[36:39], v[24:27], v[176:191]
v_mfma_f32_32x32x16_bf16 v[192:207], v[36:39], v[28:31], v[192:207]
s_waitcnt vmcnt(17)
s_waitcnt lgkmcnt(0)
v_mfma_f32_32x32x16_bf16 v[112:127], v[40:43], v[16:19], v[112:127]
ds_read_b128 v[24:27], v1 offset:35840
v_mfma_f32_32x32x16_bf16 v[128:143], v[40:43], v[20:23], v[128:143]
ds_read_b128 v[28:31], v2 offset:35840
s_waitcnt vmcnt(16)
v_mfma_f32_32x32x16_bf16 v[144:159], v[44:47], v[16:19], v[144:159]
v_mfma_f32_32x32x16_bf16 v[160:175], v[44:47], v[20:23], v[160:175]
s_waitcnt vmcnt(15)
v_mfma_f32_32x32x16_bf16 v[176:191], v[48:51], v[16:19], v[176:191]
v_mfma_f32_32x32x16_bf16 v[192:207], v[48:51], v[20:23], v[192:207]
s_waitcnt vmcnt(14)
s_waitcnt lgkmcnt(0)
v_mfma_f32_32x32x16_bf16 v[112:127], v[52:55], v[24:27], v[112:127]
ds_read_b128 v[16:19], v1 offset:36864
v_mfma_f32_32x32x16_bf16 v[128:143], v[52:55], v[28:31], v[128:143]
ds_read_b128 v[20:23], v2 offset:36864
s_waitcnt vmcnt(13)
v_mfma_f32_32x32x16_bf16 v[144:159], v[56:59], v[24:27], v[144:159]
v_mfma_f32_32x32x16_bf16 v[160:175], v[56:59], v[28:31], v[160:175]
s_waitcnt vmcnt(12)
v_mfma_f32_32x32x16_bf16 v[176:191], v[60:63], v[24:27], v[176:191]
v_mfma_f32_32x32x16_bf16 v[192:207], v[60:63], v[28:31], v[192:207]
s_waitcnt vmcnt(11)
s_waitcnt lgkmcnt(0)
v_mfma_f32_32x32x16_bf16 v[112:127], v[64:67], v[16:19], v[112:127]
ds_read_b128 v[24:27], v1 offset:37888
v_mfma_f32_32x32x16_bf16 v[128:143], v[64:67], v[20:23], v[128:143]
ds_read_b128 v[28:31], v2 offset:37888
s_waitcnt vmcnt(10)
v_mfma_f32_32x32x16_bf16 v[144:159], v[68:71], v[16:19], v[144:159]
v_mfma_f32_32x32x16_bf16 v[160:175], v[68:71], v[20:23], v[160:175]
s_waitcnt vmcnt(9)
v_mfma_f32_32x32x16_bf16 v[176:191], v[72:75], v[16:19], v[176:191]
v_mfma_f32_32x32x16_bf16 v[192:207], v[72:75], v[20:23], v[192:207]
s_waitcnt vmcnt(8)
s_waitcnt lgkmcnt(0)
v_mfma_f32_32x32x16_bf16 v[112:127], v[76:79], v[24:27], v[112:127]
ds_read_b128 v[16:19], v1 offset:38912
v_mfma_f32_32x32x16_bf16 v[128:143], v[76:79], v[28:31], v[128:143]
ds_read_b128 v[20:23], v2 offset:38912
s_waitcnt vmcnt(7)
v_mfma_f32_32x32x16_bf16 v[144:159], v[80:83], v[24:27], v[144:159]
v_mfma_f32_32x32x16_bf16 v[160:175], v[80:83], v[28:31], v[160:175]
s_waitcnt vmcnt(6)
v_mfma_f32_32x32x16_bf16 v[176:191], v[84:87], v[24:27], v[176:191]
v_mfma_f32_32x32x16_bf16 v[192:207], v[84:87], v[28:31], v[192:207]
s_waitcnt vmcnt(5)
s_waitcnt lgkmcnt(0)
v_mfma_f32_32x32x16_bf16 v[112:127], v[88:91], v[16:19], v[112:127]
ds_read_b128 v[24:27], v1 offset:39936
v_mfma_f32_32x32x16_bf16 v[128:143], v[88:91], v[20:23], v[128:143]
ds_read_b128 v[28:31], v2 offset:39936
s_waitcnt vmcnt(4)
v_mfma_f32_32x32x16_bf16 v[144:159], v[92:95], v[16:19], v[144:159]
v_mfma_f32_32x32x16_bf16 v[160:175], v[92:95], v[20:23], v[160:175]
s_waitcnt vmcnt(3)
v_mfma_f32_32x32x16_bf16 v[176:191], v[96:99], v[16:19], v[176:191]
v_mfma_f32_32x32x16_bf16 v[192:207], v[96:99], v[20:23], v[192:207]
s_waitcnt vmcnt(2)
s_waitcnt lgkmcnt(0)
v_mfma_f32_32x32x16_bf16 v[112:127], v[100:103], v[24:27], v[112:127]
v_mfma_f32_32x32x16_bf16 v[128:143], v[100:103], v[28:31], v[128:143]
s_waitcnt vmcnt(1)
v_mfma_f32_32x32x16_bf16 v[144:159], v[104:107], v[24:27], v[144:159]
v_mfma_f32_32x32x16_bf16 v[160:175], v[104:107], v[28:31], v[160:175]
s_waitcnt vmcnt(0)
v_mfma_f32_32x32x16_bf16 v[176:191], v[108:111], v[24:27], v[176:191]
v_mfma_f32_32x32x16_bf16 v[192:207], v[108:111], v[28:31], v[192:207]
s_nop 4
v_pk_mul_f32 v[240:241], v[112:113], v[112:113]
v_pk_mul_f32 v[242:243], v[114:115], v[114:115]
v_pk_mul_f32 v[244:245], v[116:117], v[116:117]
v_pk_mul_f32 v[246:247], v[118:119], v[118:119]
v_pk_mul_f32 v[248:249], v[120:121], v[120:121]
v_pk_mul_f32 v[250:251], v[122:123], v[122:123]
v_pk_mul_f32 v[252:253], v[124:125], v[124:125]
v_pk_mul_f32 v[254:255], v[126:127], v[126:127]
v_pk_fma_f32 v[240:241], v[240:241], v[8:9], v[8:9] op_sel:[0,1,0] op_sel_hi:[1,1,0]
v_pk_fma_f32 v[242:243], v[242:243], v[8:9], v[8:9] op_sel:[0,1,0] op_sel_hi:[1,1,0]
v_pk_fma_f32 v[244:245], v[244:245], v[8:9], v[8:9] op_sel:[0,1,0] op_sel_hi:[1,1,0]
v_pk_fma_f32 v[246:247], v[246:247], v[8:9], v[8:9] op_sel:[0,1,0] op_sel_hi:[1,1,0]
v_pk_fma_f32 v[248:249], v[248:249], v[8:9], v[8:9] op_sel:[0,1,0] op_sel_hi:[1,1,0]
v_pk_fma_f32 v[250:251], v[250:251], v[8:9], v[8:9] op_sel:[0,1,0] op_sel_hi:[1,1,0]
v_pk_fma_f32 v[252:253], v[252:253], v[8:9], v[8:9] op_sel:[0,1,0] op_sel_hi:[1,1,0]
v_pk_fma_f32 v[254:255], v[254:255], v[8:9], v[8:9] op_sel:[0,1,0] op_sel_hi:[1,1,0]
v_pk_mul_f32 v[240:241], v[240:241], v[112:113]
v_pk_mul_f32 v[242:243], v[242:243], v[114:115]
v_pk_mul_f32 v[244:245], v[244:245], v[116:117]
v_pk_mul_f32 v[246:247], v[246:247], v[118:119]
v_pk_mul_f32 v[248:249], v[248:249], v[120:121]
v_pk_mul_f32 v[250:251], v[250:251], v[122:123]
v_pk_mul_f32 v[252:253], v[252:253], v[124:125]
v_pk_mul_f32 v[254:255], v[254:255], v[126:127]
v_exp_f32 v240, v240
v_exp_f32 v241, v241
v_exp_f32 v242, v242
v_exp_f32 v243, v243
v_exp_f32 v244, v244
v_exp_f32 v245, v245
v_exp_f32 v246, v246
v_exp_f32 v247, v247
v_exp_f32 v248, v248
v_exp_f32 v249, v249
v_exp_f32 v250, v250
v_exp_f32 v251, v251
v_exp_f32 v252, v252
v_exp_f32 v253, v253
v_exp_f32 v254, v254
v_exp_f32 v255, v255
v_pk_add_f32 v[240:241], v[240:241], 1.0 op_sel_hi:[1,0]
v_pk_add_f32 v[242:243], v[242:243], 1.0 op_sel_hi:[1,0]
v_pk_add_f32 v[244:245], v[244:245], 1.0 op_sel_hi:[1,0]
v_pk_add_f32 v[246:247], v[246:247], 1.0 op_sel_hi:[1,0]
v_pk_add_f32 v[248:249], v[248:249], 1.0 op_sel_hi:[1,0]
v_pk_add_f32 v[250:251], v[250:251], 1.0 op_sel_hi:[1,0]
v_pk_add_f32 v[252:253], v[252:253], 1.0 op_sel_hi:[1,0]
v_pk_add_f32 v[254:255], v[254:255], 1.0 op_sel_hi:[1,0]
v_rcp_f32 v240, v240
v_rcp_f32 v241, v241
v_rcp_f32 v242, v242
v_rcp_f32 v243, v243
v_rcp_f32 v244, v244
v_rcp_f32 v245, v245
v_rcp_f32 v246, v246
v_rcp_f32 v247, v247
v_rcp_f32 v248, v248
v_rcp_f32 v249, v249
v_rcp_f32 v250, v250
v_rcp_f32 v251, v251
v_rcp_f32 v252, v252
v_rcp_f32 v253, v253
v_rcp_f32 v254, v254
v_rcp_f32 v255, v255
v_pk_mul_f32 v[240:241], v[240:241], v[112:113]
v_pk_mul_f32 v[242:243], v[242:243], v[114:115]
v_pk_mul_f32 v[244:245], v[244:245], v[116:117]
v_pk_mul_f32 v[246:247], v[246:247], v[118:119]
v_pk_mul_f32 v[248:249], v[248:249], v[120:121]
v_pk_mul_f32 v[250:251], v[250:251], v[122:123]
v_pk_mul_f32 v[252:253], v[252:253], v[124:125]
v_pk_mul_f32 v[254:255], v[254:255], v[126:127]
v_cvt_pk_bf16_f32 v112, v240, v241
v_cvt_pk_bf16_f32 v113, v242, v243
v_cvt_pk_bf16_f32 v114, v244, v245
v_cvt_pk_bf16_f32 v115, v246, v247
v_cvt_pk_bf16_f32 v116, v248, v249
v_cvt_pk_bf16_f32 v117, v250, v251
v_cvt_pk_bf16_f32 v118, v252, v253
v_cvt_pk_bf16_f32 v119, v254, v255
buffer_store_dwordx4 v[112:115], v3, s[36:39], s40 offen offset:0 sc1
buffer_store_dwordx4 v[116:119], v3, s[36:39], s40 offen offset:1024 sc1
v_pk_mul_f32 v[240:241], v[128:129], v[128:129]
v_pk_mul_f32 v[242:243], v[130:131], v[130:131]
v_pk_mul_f32 v[244:245], v[132:133], v[132:133]
v_pk_mul_f32 v[246:247], v[134:135], v[134:135]
v_pk_mul_f32 v[248:249], v[136:137], v[136:137]
v_pk_mul_f32 v[250:251], v[138:139], v[138:139]
v_pk_mul_f32 v[252:253], v[140:141], v[140:141]
v_pk_mul_f32 v[254:255], v[142:143], v[142:143]
v_pk_fma_f32 v[240:241], v[240:241], v[8:9], v[8:9] op_sel:[0,1,0] op_sel_hi:[1,1,0]
v_pk_fma_f32 v[242:243], v[242:243], v[8:9], v[8:9] op_sel:[0,1,0] op_sel_hi:[1,1,0]
v_pk_fma_f32 v[244:245], v[244:245], v[8:9], v[8:9] op_sel:[0,1,0] op_sel_hi:[1,1,0]
v_pk_fma_f32 v[246:247], v[246:247], v[8:9], v[8:9] op_sel:[0,1,0] op_sel_hi:[1,1,0]
v_pk_fma_f32 v[248:249], v[248:249], v[8:9], v[8:9] op_sel:[0,1,0] op_sel_hi:[1,1,0]
v_pk_fma_f32 v[250:251], v[250:251], v[8:9], v[8:9] op_sel:[0,1,0] op_sel_hi:[1,1,0]
v_pk_fma_f32 v[252:253], v[252:253], v[8:9], v[8:9] op_sel:[0,1,0] op_sel_hi:[1,1,0]
v_pk_fma_f32 v[254:255], v[254:255], v[8:9], v[8:9] op_sel:[0,1,0] op_sel_hi:[1,1,0]
v_pk_mul_f32 v[240:241], v[240:241], v[128:129]
v_pk_mul_f32 v[242:243], v[242:243], v[130:131]
v_pk_mul_f32 v[244:245], v[244:245], v[132:133]
v_pk_mul_f32 v[246:247], v[246:247], v[134:135]
v_pk_mul_f32 v[248:249], v[248:249], v[136:137]
v_pk_mul_f32 v[250:251], v[250:251], v[138:139]
v_pk_mul_f32 v[252:253], v[252:253], v[140:141]
v_pk_mul_f32 v[254:255], v[254:255], v[142:143]
v_exp_f32 v240, v240
v_exp_f32 v241, v241
v_exp_f32 v242, v242
v_exp_f32 v243, v243
v_exp_f32 v244, v244
v_exp_f32 v245, v245
v_exp_f32 v246, v246
v_exp_f32 v247, v247
v_exp_f32 v248, v248
v_exp_f32 v249, v249
v_exp_f32 v250, v250
v_exp_f32 v251, v251
v_exp_f32 v252, v252
v_exp_f32 v253, v253
v_exp_f32 v254, v254
v_exp_f32 v255, v255
v_pk_add_f32 v[240:241], v[240:241], 1.0 op_sel_hi:[1,0]
v_pk_add_f32 v[242:243], v[242:243], 1.0 op_sel_hi:[1,0]
v_pk_add_f32 v[244:245], v[244:245], 1.0 op_sel_hi:[1,0]
v_pk_add_f32 v[246:247], v[246:247], 1.0 op_sel_hi:[1,0]
v_pk_add_f32 v[248:249], v[248:249], 1.0 op_sel_hi:[1,0]
v_pk_add_f32 v[250:251], v[250:251], 1.0 op_sel_hi:[1,0]
v_pk_add_f32 v[252:253], v[252:253], 1.0 op_sel_hi:[1,0]
v_pk_add_f32 v[254:255], v[254:255], 1.0 op_sel_hi:[1,0]
v_rcp_f32 v240, v240
v_rcp_f32 v241, v241
v_rcp_f32 v242, v242
v_rcp_f32 v243, v243
v_rcp_f32 v244, v244
v_rcp_f32 v245, v245
v_rcp_f32 v246, v246
v_rcp_f32 v247, v247
v_rcp_f32 v248, v248
v_rcp_f32 v249, v249
v_rcp_f32 v250, v250
v_rcp_f32 v251, v251
v_rcp_f32 v252, v252
v_rcp_f32 v253, v253
v_rcp_f32 v254, v254
v_rcp_f32 v255, v255
v_pk_mul_f32 v[240:241], v[240:241], v[128:129]
v_pk_mul_f32 v[242:243], v[242:243], v[130:131]
v_pk_mul_f32 v[244:245], v[244:245], v[132:133]
v_pk_mul_f32 v[246:247], v[246:247], v[134:135]
v_pk_mul_f32 v[248:249], v[248:249], v[136:137]
v_pk_mul_f32 v[250:251], v[250:251], v[138:139]
v_pk_mul_f32 v[252:253], v[252:253], v[140:141]
v_pk_mul_f32 v[254:255], v[254:255], v[142:143]
v_cvt_pk_bf16_f32 v128, v240, v241
v_cvt_pk_bf16_f32 v129, v242, v243
v_cvt_pk_bf16_f32 v130, v244, v245
v_cvt_pk_bf16_f32 v131, v246, v247
v_cvt_pk_bf16_f32 v132, v248, v249
v_cvt_pk_bf16_f32 v133, v250, v251
v_cvt_pk_bf16_f32 v134, v252, v253
v_cvt_pk_bf16_f32 v135, v254, v255
buffer_store_dwordx4 v[128:131], v4, s[36:39], s40 offen offset:0 sc1
buffer_store_dwordx4 v[132:135], v4, s[36:39], s40 offen offset:1024 sc1
s_add_u32 s40, s40, 0x800
s_cmp_eq_u32 s20, 7
s_cselect_b32 s40, 1073741824, s40
v_pk_mul_f32 v[240:241], v[144:145], v[144:145]
v_pk_mul_f32 v[242:243], v[146:147], v[146:147]
v_pk_mul_f32 v[244:245], v[148:149], v[148:149]
v_pk_mul_f32 v[246:247], v[150:151], v[150:151]
v_pk_mul_f32 v[248:249], v[152:153], v[152:153]
v_pk_mul_f32 v[250:251], v[154:155], v[154:155]
v_pk_mul_f32 v[252:253], v[156:157], v[156:157]
v_pk_mul_f32 v[254:255], v[158:159], v[158:159]
v_pk_fma_f32 v[240:241], v[240:241], v[8:9], v[8:9] op_sel:[0,1,0] op_sel_hi:[1,1,0]
v_pk_fma_f32 v[242:243], v[242:243], v[8:9], v[8:9] op_sel:[0,1,0] op_sel_hi:[1,1,0]
v_pk_fma_f32 v[244:245], v[244:245], v[8:9], v[8:9] op_sel:[0,1,0] op_sel_hi:[1,1,0]
v_pk_fma_f32 v[246:247], v[246:247], v[8:9], v[8:9] op_sel:[0,1,0] op_sel_hi:[1,1,0]
v_pk_fma_f32 v[248:249], v[248:249], v[8:9], v[8:9] op_sel:[0,1,0] op_sel_hi:[1,1,0]
v_pk_fma_f32 v[250:251], v[250:251], v[8:9], v[8:9] op_sel:[0,1,0] op_sel_hi:[1,1,0]
v_pk_fma_f32 v[252:253], v[252:253], v[8:9], v[8:9] op_sel:[0,1,0] op_sel_hi:[1,1,0]
v_pk_fma_f32 v[254:255], v[254:255], v[8:9], v[8:9] op_sel:[0,1,0] op_sel_hi:[1,1,0]
v_pk_mul_f32 v[240:241], v[240:241], v[144:145]
v_pk_mul_f32 v[242:243], v[242:243], v[146:147]
v_pk_mul_f32 v[244:245], v[244:245], v[148:149]
v_pk_mul_f32 v[246:247], v[246:247], v[150:151]
v_pk_mul_f32 v[248:249], v[248:249], v[152:153]
v_pk_mul_f32 v[250:251], v[250:251], v[154:155]
v_pk_mul_f32 v[252:253], v[252:253], v[156:157]
v_pk_mul_f32 v[254:255], v[254:255], v[158:159]
v_exp_f32 v240, v240
v_exp_f32 v241, v241
v_exp_f32 v242, v242
v_exp_f32 v243, v243
v_exp_f32 v244, v244
v_exp_f32 v245, v245
v_exp_f32 v246, v246
v_exp_f32 v247, v247
v_exp_f32 v248, v248
v_exp_f32 v249, v249
v_exp_f32 v250, v250
v_exp_f32 v251, v251
v_exp_f32 v252, v252
v_exp_f32 v253, v253
v_exp_f32 v254, v254
v_exp_f32 v255, v255
v_pk_add_f32 v[240:241], v[240:241], 1.0 op_sel_hi:[1,0]
v_pk_add_f32 v[242:243], v[242:243], 1.0 op_sel_hi:[1,0]
v_pk_add_f32 v[244:245], v[244:245], 1.0 op_sel_hi:[1,0]
v_pk_add_f32 v[246:247], v[246:247], 1.0 op_sel_hi:[1,0]
v_pk_add_f32 v[248:249], v[248:249], 1.0 op_sel_hi:[1,0]
v_pk_add_f32 v[250:251], v[250:251], 1.0 op_sel_hi:[1,0]
v_pk_add_f32 v[252:253], v[252:253], 1.0 op_sel_hi:[1,0]
v_pk_add_f32 v[254:255], v[254:255], 1.0 op_sel_hi:[1,0]
v_rcp_f32 v240, v240
v_rcp_f32 v241, v241
v_rcp_f32 v242, v242
v_rcp_f32 v243, v243
v_rcp_f32 v244, v244
v_rcp_f32 v245, v245
v_rcp_f32 v246, v246
v_rcp_f32 v247, v247
v_rcp_f32 v248, v248
v_rcp_f32 v249, v249
v_rcp_f32 v250, v250
v_rcp_f32 v251, v251
v_rcp_f32 v252, v252
v_rcp_f32 v253, v253
v_rcp_f32 v254, v254
v_rcp_f32 v255, v255
v_pk_mul_f32 v[240:241], v[240:241], v[144:145]
v_pk_mul_f32 v[242:243], v[242:243], v[146:147]
v_pk_mul_f32 v[244:245], v[244:245], v[148:149]
v_pk_mul_f32 v[246:247], v[246:247], v[150:151]
v_pk_mul_f32 v[248:249], v[248:249], v[152:153]
v_pk_mul_f32 v[250:251], v[250:251], v[154:155]
v_pk_mul_f32 v[252:253], v[252:253], v[156:157]
v_pk_mul_f32 v[254:255], v[254:255], v[158:159]
v_cvt_pk_bf16_f32 v144, v240, v241
v_cvt_pk_bf16_f32 v145, v242, v243
v_cvt_pk_bf16_f32 v146, v244, v245
v_cvt_pk_bf16_f32 v147, v246, v247
v_cvt_pk_bf16_f32 v148, v248, v249
v_cvt_pk_bf16_f32 v149, v250, v251
v_cvt_pk_bf16_f32 v150, v252, v253
v_cvt_pk_bf16_f32 v151, v254, v255
buffer_store_dwordx4 v[144:147], v3, s[36:39], s40 offen offset:0 sc1
buffer_store_dwordx4 v[148:151], v3, s[36:39], s40 offen offset:1024 sc1
v_pk_mul_f32 v[240:241], v[160:161], v[160:161]
v_pk_mul_f32 v[242:243], v[162:163], v[162:163]
v_pk_mul_f32 v[244:245], v[164:165], v[164:165]
v_pk_mul_f32 v[246:247], v[166:167], v[166:167]
v_pk_mul_f32 v[248:249], v[168:169], v[168:169]
v_pk_mul_f32 v[250:251], v[170:171], v[170:171]
v_pk_mul_f32 v[252:253], v[172:173], v[172:173]
v_pk_mul_f32 v[254:255], v[174:175], v[174:175]
v_pk_fma_f32 v[240:241], v[240:241], v[8:9], v[8:9] op_sel:[0,1,0] op_sel_hi:[1,1,0]
v_pk_fma_f32 v[242:243], v[242:243], v[8:9], v[8:9] op_sel:[0,1,0] op_sel_hi:[1,1,0]
v_pk_fma_f32 v[244:245], v[244:245], v[8:9], v[8:9] op_sel:[0,1,0] op_sel_hi:[1,1,0]
v_pk_fma_f32 v[246:247], v[246:247], v[8:9], v[8:9] op_sel:[0,1,0] op_sel_hi:[1,1,0]
v_pk_fma_f32 v[248:249], v[248:249], v[8:9], v[8:9] op_sel:[0,1,0] op_sel_hi:[1,1,0]
v_pk_fma_f32 v[250:251], v[250:251], v[8:9], v[8:9] op_sel:[0,1,0] op_sel_hi:[1,1,0]
v_pk_fma_f32 v[252:253], v[252:253], v[8:9], v[8:9] op_sel:[0,1,0] op_sel_hi:[1,1,0]
v_pk_fma_f32 v[254:255], v[254:255], v[8:9], v[8:9] op_sel:[0,1,0] op_sel_hi:[1,1,0]
v_pk_mul_f32 v[240:241], v[240:241], v[160:161]
v_pk_mul_f32 v[242:243], v[242:243], v[162:163]
v_pk_mul_f32 v[244:245], v[244:245], v[164:165]
v_pk_mul_f32 v[246:247], v[246:247], v[166:167]
v_pk_mul_f32 v[248:249], v[248:249], v[168:169]
v_pk_mul_f32 v[250:251], v[250:251], v[170:171]
v_pk_mul_f32 v[252:253], v[252:253], v[172:173]
v_pk_mul_f32 v[254:255], v[254:255], v[174:175]
v_exp_f32 v240, v240
v_exp_f32 v241, v241
v_exp_f32 v242, v242
v_exp_f32 v243, v243
v_exp_f32 v244, v244
v_exp_f32 v245, v245
v_exp_f32 v246, v246
v_exp_f32 v247, v247
v_exp_f32 v248, v248
v_exp_f32 v249, v249
v_exp_f32 v250, v250
v_exp_f32 v251, v251
v_exp_f32 v252, v252
v_exp_f32 v253, v253
v_exp_f32 v254, v254
v_exp_f32 v255, v255
v_pk_add_f32 v[240:241], v[240:241], 1.0 op_sel_hi:[1,0]
v_pk_add_f32 v[242:243], v[242:243], 1.0 op_sel_hi:[1,0]
v_pk_add_f32 v[244:245], v[244:245], 1.0 op_sel_hi:[1,0]
v_pk_add_f32 v[246:247], v[246:247], 1.0 op_sel_hi:[1,0]
v_pk_add_f32 v[248:249], v[248:249], 1.0 op_sel_hi:[1,0]
v_pk_add_f32 v[250:251], v[250:251], 1.0 op_sel_hi:[1,0]
v_pk_add_f32 v[252:253], v[252:253], 1.0 op_sel_hi:[1,0]
v_pk_add_f32 v[254:255], v[254:255], 1.0 op_sel_hi:[1,0]
v_rcp_f32 v240, v240
v_rcp_f32 v241, v241
v_rcp_f32 v242, v242
v_rcp_f32 v243, v243
v_rcp_f32 v244, v244
v_rcp_f32 v245, v245
v_rcp_f32 v246, v246
v_rcp_f32 v247, v247
v_rcp_f32 v248, v248
v_rcp_f32 v249, v249
v_rcp_f32 v250, v250
v_rcp_f32 v251, v251
v_rcp_f32 v252, v252
v_rcp_f32 v253, v253
v_rcp_f32 v254, v254
v_rcp_f32 v255, v255
v_pk_mul_f32 v[240:241], v[240:241], v[160:161]
v_pk_mul_f32 v[242:243], v[242:243], v[162:163]
v_pk_mul_f32 v[244:245], v[244:245], v[164:165]
v_pk_mul_f32 v[246:247], v[246:247], v[166:167]
v_pk_mul_f32 v[248:249], v[248:249], v[168:169]
v_pk_mul_f32 v[250:251], v[250:251], v[170:171]
v_pk_mul_f32 v[252:253], v[252:253], v[172:173]
v_pk_mul_f32 v[254:255], v[254:255], v[174:175]
v_cvt_pk_bf16_f32 v160, v240, v241
v_cvt_pk_bf16_f32 v161, v242, v243
v_cvt_pk_bf16_f32 v162, v244, v245
v_cvt_pk_bf16_f32 v163, v246, v247
v_cvt_pk_bf16_f32 v164, v248, v249
v_cvt_pk_bf16_f32 v165, v250, v251
v_cvt_pk_bf16_f32 v166, v252, v253
v_cvt_pk_bf16_f32 v167, v254, v255
buffer_store_dwordx4 v[160:163], v4, s[36:39], s40 offen offset:0 sc1
buffer_store_dwordx4 v[164:167], v4, s[36:39], s40 offen offset:1024 sc1
s_add_u32 s40, s40, 0x800
v_pk_mul_f32 v[240:241], v[176:177], v[176:177]
v_pk_mul_f32 v[242:243], v[178:179], v[178:179]
v_pk_mul_f32 v[244:245], v[180:181], v[180:181]
v_pk_mul_f32 v[246:247], v[182:183], v[182:183]
v_pk_mul_f32 v[248:249], v[184:185], v[184:185]
v_pk_mul_f32 v[250:251], v[186:187], v[186:187]
v_pk_mul_f32 v[252:253], v[188:189], v[188:189]
v_pk_mul_f32 v[254:255], v[190:191], v[190:191]
v_pk_fma_f32 v[240:241], v[240:241], v[8:9], v[8:9] op_sel:[0,1,0] op_sel_hi:[1,1,0]
v_pk_fma_f32 v[242:243], v[242:243], v[8:9], v[8:9] op_sel:[0,1,0] op_sel_hi:[1,1,0]
v_pk_fma_f32 v[244:245], v[244:245], v[8:9], v[8:9] op_sel:[0,1,0] op_sel_hi:[1,1,0]
v_pk_fma_f32 v[246:247], v[246:247], v[8:9], v[8:9] op_sel:[0,1,0] op_sel_hi:[1,1,0]
v_pk_fma_f32 v[248:249], v[248:249], v[8:9], v[8:9] op_sel:[0,1,0] op_sel_hi:[1,1,0]
v_pk_fma_f32 v[250:251], v[250:251], v[8:9], v[8:9] op_sel:[0,1,0] op_sel_hi:[1,1,0]
v_pk_fma_f32 v[252:253], v[252:253], v[8:9], v[8:9] op_sel:[0,1,0] op_sel_hi:[1,1,0]
v_pk_fma_f32 v[254:255], v[254:255], v[8:9], v[8:9] op_sel:[0,1,0] op_sel_hi:[1,1,0]
v_pk_mul_f32 v[240:241], v[240:241], v[176:177]
v_pk_mul_f32 v[242:243], v[242:243], v[178:179]
v_pk_mul_f32 v[244:245], v[244:245], v[180:181]
v_pk_mul_f32 v[246:247], v[246:247], v[182:183]
v_pk_mul_f32 v[248:249], v[248:249], v[184:185]
v_pk_mul_f32 v[250:251], v[250:251], v[186:187]
v_pk_mul_f32 v[252:253], v[252:253], v[188:189]
v_pk_mul_f32 v[254:255], v[254:255], v[190:191]
v_exp_f32 v240, v240
v_exp_f32 v241, v241
v_exp_f32 v242, v242
v_exp_f32 v243, v243
v_exp_f32 v244, v244
v_exp_f32 v245, v245
v_exp_f32 v246, v246
v_exp_f32 v247, v247
v_exp_f32 v248, v248
v_exp_f32 v249, v249
v_exp_f32 v250, v250
v_exp_f32 v251, v251
v_exp_f32 v252, v252
v_exp_f32 v253, v253
v_exp_f32 v254, v254
v_exp_f32 v255, v255
v_pk_add_f32 v[240:241], v[240:241], 1.0 op_sel_hi:[1,0]
v_pk_add_f32 v[242:243], v[242:243], 1.0 op_sel_hi:[1,0]
v_pk_add_f32 v[244:245], v[244:245], 1.0 op_sel_hi:[1,0]
v_pk_add_f32 v[246:247], v[246:247], 1.0 op_sel_hi:[1,0]
v_pk_add_f32 v[248:249], v[248:249], 1.0 op_sel_hi:[1,0]
v_pk_add_f32 v[250:251], v[250:251], 1.0 op_sel_hi:[1,0]
v_pk_add_f32 v[252:253], v[252:253], 1.0 op_sel_hi:[1,0]
v_pk_add_f32 v[254:255], v[254:255], 1.0 op_sel_hi:[1,0]
v_rcp_f32 v240, v240
v_rcp_f32 v241, v241
v_rcp_f32 v242, v242
v_rcp_f32 v243, v243
v_rcp_f32 v244, v244
v_rcp_f32 v245, v245
v_rcp_f32 v246, v246
v_rcp_f32 v247, v247
v_rcp_f32 v248, v248
v_rcp_f32 v249, v249
v_rcp_f32 v250, v250
v_rcp_f32 v251, v251
v_rcp_f32 v252, v252
v_rcp_f32 v253, v253
v_rcp_f32 v254, v254
v_rcp_f32 v255, v255
v_pk_mul_f32 v[240:241], v[240:241], v[176:177]
v_pk_mul_f32 v[242:243], v[242:243], v[178:179]
v_pk_mul_f32 v[244:245], v[244:245], v[180:181]
v_pk_mul_f32 v[246:247], v[246:247], v[182:183]
v_pk_mul_f32 v[248:249], v[248:249], v[184:185]
v_pk_mul_f32 v[250:251], v[250:251], v[186:187]
v_pk_mul_f32 v[252:253], v[252:253], v[188:189]
v_pk_mul_f32 v[254:255], v[254:255], v[190:191]
v_cvt_pk_bf16_f32 v176, v240, v241
v_cvt_pk_bf16_f32 v177, v242, v243
v_cvt_pk_bf16_f32 v178, v244, v245
v_cvt_pk_bf16_f32 v179, v246, v247
v_cvt_pk_bf16_f32 v180, v248, v249
v_cvt_pk_bf16_f32 v181, v250, v251
v_cvt_pk_bf16_f32 v182, v252, v253
v_cvt_pk_bf16_f32 v183, v254, v255
buffer_store_dwordx4 v[176:179], v3, s[36:39], s40 offen offset:0 sc1
buffer_store_dwordx4 v[180:183], v3, s[36:39], s40 offen offset:1024 sc1
v_pk_mul_f32 v[240:241], v[192:193], v[192:193]
v_pk_mul_f32 v[242:243], v[194:195], v[194:195]
v_pk_mul_f32 v[244:245], v[196:197], v[196:197]
v_pk_mul_f32 v[246:247], v[198:199], v[198:199]
v_pk_mul_f32 v[248:249], v[200:201], v[200:201]
v_pk_mul_f32 v[250:251], v[202:203], v[202:203]
v_pk_mul_f32 v[252:253], v[204:205], v[204:205]
v_pk_mul_f32 v[254:255], v[206:207], v[206:207]
v_pk_fma_f32 v[240:241], v[240:241], v[8:9], v[8:9] op_sel:[0,1,0] op_sel_hi:[1,1,0]
v_pk_fma_f32 v[242:243], v[242:243], v[8:9], v[8:9] op_sel:[0,1,0] op_sel_hi:[1,1,0]
v_pk_fma_f32 v[244:245], v[244:245], v[8:9], v[8:9] op_sel:[0,1,0] op_sel_hi:[1,1,0]
v_pk_fma_f32 v[246:247], v[246:247], v[8:9], v[8:9] op_sel:[0,1,0] op_sel_hi:[1,1,0]
v_pk_fma_f32 v[248:249], v[248:249], v[8:9], v[8:9] op_sel:[0,1,0] op_sel_hi:[1,1,0]
v_pk_fma_f32 v[250:251], v[250:251], v[8:9], v[8:9] op_sel:[0,1,0] op_sel_hi:[1,1,0]
v_pk_fma_f32 v[252:253], v[252:253], v[8:9], v[8:9] op_sel:[0,1,0] op_sel_hi:[1,1,0]
v_pk_fma_f32 v[254:255], v[254:255], v[8:9], v[8:9] op_sel:[0,1,0] op_sel_hi:[1,1,0]
v_pk_mul_f32 v[240:241], v[240:241], v[192:193]
v_pk_mul_f32 v[242:243], v[242:243], v[194:195]
v_pk_mul_f32 v[244:245], v[244:245], v[196:197]
v_pk_mul_f32 v[246:247], v[246:247], v[198:199]
v_pk_mul_f32 v[248:249], v[248:249], v[200:201]
v_pk_mul_f32 v[250:251], v[250:251], v[202:203]
v_pk_mul_f32 v[252:253], v[252:253], v[204:205]
v_pk_mul_f32 v[254:255], v[254:255], v[206:207]
v_exp_f32 v240, v240
v_exp_f32 v241, v241
v_exp_f32 v242, v242
v_exp_f32 v243, v243
v_exp_f32 v244, v244
v_exp_f32 v245, v245
v_exp_f32 v246, v246
v_exp_f32 v247, v247
v_exp_f32 v248, v248
v_exp_f32 v249, v249
v_exp_f32 v250, v250
v_exp_f32 v251, v251
v_exp_f32 v252, v252
v_exp_f32 v253, v253
v_exp_f32 v254, v254
v_exp_f32 v255, v255
v_pk_add_f32 v[240:241], v[240:241], 1.0 op_sel_hi:[1,0]
v_pk_add_f32 v[242:243], v[242:243], 1.0 op_sel_hi:[1,0]
v_pk_add_f32 v[244:245], v[244:245], 1.0 op_sel_hi:[1,0]
v_pk_add_f32 v[246:247], v[246:247], 1.0 op_sel_hi:[1,0]
v_pk_add_f32 v[248:249], v[248:249], 1.0 op_sel_hi:[1,0]
v_pk_add_f32 v[250:251], v[250:251], 1.0 op_sel_hi:[1,0]
v_pk_add_f32 v[252:253], v[252:253], 1.0 op_sel_hi:[1,0]
v_pk_add_f32 v[254:255], v[254:255], 1.0 op_sel_hi:[1,0]
v_rcp_f32 v240, v240
v_rcp_f32 v241, v241
v_rcp_f32 v242, v242
v_rcp_f32 v243, v243
v_rcp_f32 v244, v244
v_rcp_f32 v245, v245
v_rcp_f32 v246, v246
v_rcp_f32 v247, v247
v_rcp_f32 v248, v248
v_rcp_f32 v249, v249
v_rcp_f32 v250, v250
v_rcp_f32 v251, v251
v_rcp_f32 v252, v252
v_rcp_f32 v253, v253
v_rcp_f32 v254, v254
v_rcp_f32 v255, v255
v_pk_mul_f32 v[240:241], v[240:241], v[192:193]
v_pk_mul_f32 v[242:243], v[242:243], v[194:195]
v_pk_mul_f32 v[244:245], v[244:245], v[196:197]
v_pk_mul_f32 v[246:247], v[246:247], v[198:199]
v_pk_mul_f32 v[248:249], v[248:249], v[200:201]
v_pk_mul_f32 v[250:251], v[250:251], v[202:203]
v_pk_mul_f32 v[252:253], v[252:253], v[204:205]
v_pk_mul_f32 v[254:255], v[254:255], v[206:207]
v_cvt_pk_bf16_f32 v192, v240, v241
v_cvt_pk_bf16_f32 v193, v242, v243
v_cvt_pk_bf16_f32 v194, v244, v245
v_cvt_pk_bf16_f32 v195, v246, v247
v_cvt_pk_bf16_f32 v196, v248, v249
v_cvt_pk_bf16_f32 v197, v250, v251
v_cvt_pk_bf16_f32 v198, v252, v253
v_cvt_pk_bf16_f32 v199, v254, v255
buffer_store_dwordx4 v[192:195], v4, s[36:39], s40 offen offset:0 sc1
buffer_store_dwordx4 v[196:199], v4, s[36:39], s40 offen offset:1024 sc1
s_add_u32 s40, s40, 0x800
s_branch .b2_end_1107
.b2_two_1106:
s_add_u32 s26, s23, 0x1000
buffer_load_dwordx4 v[208:211], v1, s[12:15], s23 offen offset:0
buffer_load_dwordx4 v[212:215], v1, s[12:15], s23 offen offset:1024
buffer_load_dwordx4 v[216:219], v1, s[12:15], s23 offen offset:2048
buffer_load_dwordx4 v[220:223], v1, s[12:15], s23 offen offset:3072
buffer_load_dwordx4 v[224:227], v2, s[12:15], s23 offen offset:0
buffer_load_dwordx4 v[228:231], v2, s[12:15], s23 offen offset:1024
buffer_load_dwordx4 v[232:235], v2, s[12:15], s23 offen offset:2048
buffer_load_dwordx4 v[236:239], v2, s[12:15], s23 offen offset:3072
s_cmp_lg_u32 s20, 7
s_cbranch_scc1 .pw_1109
s_lshl_b64 s[62:63], 5, s16
s_lshr_b64 s[62:63], s[62:63], 1
s_not_b32 s63, s62
s_mov_b32 s60, 0x0
s_mov_b32 s61, 0x4000
v_lshlrev_b32 v8, 2, v0
v_mov_b32 v7, 0
s_mov_b64 exec, s[60:61]
buffer_atomic_or v7, v8, s[56:59], 0 offen sc0 sc1
s_mov_b64 exec, -1
.pw_1109:
s_cmp_lg_u32 s20, 7
s_cbranch_scc1 .pw_1110
s_waitcnt vmcnt(0)
v_or_b32 v7, s63, v7
v_cmp_ne_u32 vcc, -1, v7
s_and_b64 vcc, vcc, s[60:61]
s_cbranch_scc1 .pslow_1111
.pret_1112:
.pw_1110:
buffer_load_dwordx4 v[32:35], v1, s[8:11], s21 offen offset:0
buffer_load_dwordx4 v[36:39], v1, s[8:11], s21 offen offset:1024
s_add_u32 s21, s21, 20480
buffer_load_dwordx4 v[40:43], v1, s[8:11], s21 offen offset:0
buffer_load_dwordx4 v[44:47], v1, s[8:11], s21 offen offset:1024
s_add_u32 s21, s21, 20480
buffer_load_dwordx4 v[48:51], v1, s[8:11], s21 offen offset:0
buffer_load_dwordx4 v[52:55], v1, s[8:11], s21 offen offset:1024
s_add_u32 s21, s21, 20480
buffer_load_dwordx4 v[56:59], v1, s[8:11], s21 offen offset:0
buffer_load_dwordx4 v[60:63], v1, s[8:11], s21 offen offset:1024
s_add_u32 s21, s21, 20480
buffer_load_dwordx4 v[64:67], v1, s[8:11], s21 offen offset:0
buffer_load_dwordx4 v[68:71], v1, s[8:11], s21 offen offset:1024
s_add_u32 s21, s21, 20480
buffer_load_dwordx4 v[72:75], v1, s[8:11], s21 offen offset:0
buffer_load_dwordx4 v[76:79], v1, s[8:11], s21 offen offset:1024
s_add_u32 s21, s21, 20480
buffer_load_dwordx4 v[80:83], v1, s[8:11], s21 offen offset:0
buffer_load_dwordx4 v[84:87], v1, s[8:11], s21 offen offset:1024
s_add_u32 s21, s21, 20480
buffer_load_dwordx4 v[88:91], v1, s[8:11], s21 offen offset:0
buffer_load_dwordx4 v[92:95], v1, s[8:11], s21 offen offset:1024
s_add_u32 s21, s21, 20480
buffer_load_dwordx4 v[96:99], v1, s[8:11], s21 offen offset:0
buffer_load_dwordx4 v[100:103], v1, s[8:11], s21 offen offset:1024
s_add_u32 s21, s21, 20480
buffer_load_dwordx4 v[104:107], v1, s[8:11], s21 offen offset:0
buffer_load_dwordx4 v[108:111], v1, s[8:11], s21 offen offset:1024
s_add_u32 s21, s21, 20480
s_cmp_ge_u32 s21, s46
s_cselect_b32 s45, 819200, 0
s_sub_u32 s21, s21, s45
s_barrier
s_add_u32 m0, s44, 0
s_nop 0
buffer_load_dwordx4 v3, s[4:7], s24 offen offset:0 lds
buffer_load_dwordx4 v3, s[4:7], s24 offen offset:1024 lds
buffer_load_dwordx4 v3, s[4:7], s24 offen offset:2048 lds
buffer_load_dwordx4 v3, s[4:7], s24 offen offset:3072 lds
s_add_u32 m0, s44, 4096
s_nop 0
buffer_load_dwordx4 v3, s[4:7], s25 offen lds
s_add_u32 m0, s44, 40960
s_nop 0
buffer_load_dwordx4 v4, s[4:7], s24 offen offset:0 lds
buffer_load_dwordx4 v4, s[4:7], s24 offen offset:1024 lds
buffer_load_dwordx4 v4, s[4:7], s24 offen offset:2048 lds
buffer_load_dwordx4 v4, s[4:7], s24 offen offset:3072 lds
s_add_u32 m0, s44, 45056
s_nop 0
buffer_load_dwordx4 v4, s[4:7], s25 offen lds
s_waitcnt vmcnt(30)
v_lshlrev_b32 v112, 16, v208
v_and_b32 v113, 0xffff0000, v208
v_lshlrev_b32 v114, 16, v209
v_and_b32 v115, 0xffff0000, v209
v_lshlrev_b32 v116, 16, v210
v_and_b32 v117, 0xffff0000, v210
v_lshlrev_b32 v118, 16, v211
v_and_b32 v119, 0xffff0000, v211
v_lshlrev_b32 v120, 16, v212
v_and_b32 v121, 0xffff0000, v212
v_lshlrev_b32 v122, 16, v213
v_and_b32 v123, 0xffff0000, v213
v_lshlrev_b32 v124, 16, v214
v_and_b32 v125, 0xffff0000, v214
v_lshlrev_b32 v126, 16, v215
v_and_b32 v127, 0xffff0000, v215
v_lshlrev_b32 v144, 16, v216
v_and_b32 v145, 0xffff0000, v216
v_lshlrev_b32 v146, 16, v217
v_and_b32 v147, 0xffff0000, v217
v_lshlrev_b32 v148, 16, v218
v_and_b32 v149, 0xffff0000, v218
v_lshlrev_b32 v150, 16, v219
v_and_b32 v151, 0xffff0000, v219
v_lshlrev_b32 v152, 16, v220
v_and_b32 v153, 0xffff0000, v220
v_lshlrev_b32 v154, 16, v221
v_and_b32 v155, 0xffff0000, v221
v_lshlrev_b32 v156, 16, v222
v_and_b32 v157, 0xffff0000, v222
v_lshlrev_b32 v158, 16, v223
v_and_b32 v159, 0xffff0000, v223
v_lshlrev_b32 v128, 16, v224
v_and_b32 v129, 0xffff0000, v224
v_lshlrev_b32 v130, 16, v225
v_and_b32 v131, 0xffff0000, v225
v_lshlrev_b32 v132, 16, v226
v_and_b32 v133, 0xffff0000, v226
v_lshlrev_b32 v134, 16, v227
v_and_b32 v135, 0xffff0000, v227
v_lshlrev_b32 v136, 16, v228
v_and_b32 v137, 0xffff0000, v228
v_lshlrev_b32 v138, 16, v229
v_and_b32 v139, 0xffff0000, v229
v_lshlrev_b32 v140, 16, v230
v_and_b32 v141, 0xffff0000, v230
v_lshlrev_b32 v142, 16, v231
v_and_b32 v143, 0xffff0000, v231
v_lshlrev_b32 v160, 16, v232
v_and_b32 v161, 0xffff0000, v232
v_lshlrev_b32 v162, 16, v233
v_and_b32 v163, 0xffff0000, v233
v_lshlrev_b32 v164, 16, v234
v_and_b32 v165, 0xffff0000, v234
v_lshlrev_b32 v166, 16, v235
v_and_b32 v167, 0xffff0000, v235
v_lshlrev_b32 v168, 16, v236
v_and_b32 v169, 0xffff0000, v236
v_lshlrev_b32 v170, 16, v237
v_and_b32 v171, 0xffff0000, v237
v_lshlrev_b32 v172, 16, v238
v_and_b32 v173, 0xffff0000, v238
v_lshlrev_b32 v174, 16, v239
v_and_b32 v175, 0xffff0000, v239
s_waitcnt vmcnt(0)
s_barrier
ds_read_b128 v[16:19], v1
ds_read_b128 v[20:23], v2
s_waitcnt lgkmcnt(0)
v_mfma_f32_32x32x16_bf16 v[112:127], v[32:35], v[16:19], v[112:127]
ds_read_b128 v[24:27], v1 offset:1024
v_mfma_f32_32x32x16_bf16 v[128:143], v[32:35], v[20:23], v[128:143]
ds_read_b128 v[28:31], v2 offset:1024
buffer_load_dwordx4 v[32:35], v1, s[8:11], s21 offen offset:0
v_mfma_f32_32x32x16_bf16 v[144:159], v[36:39], v[16:19], v[144:159]
v_mfma_f32_32x32x16_bf16 v[160:175], v[36:39], v[20:23], v[160:175]
buffer_load_dwordx4 v[36:39], v1, s[8:11], s21 offen offset:1024
s_add_u32 s21, s21, 20480
s_waitcnt lgkmcnt(0)
v_mfma_f32_32x32x16_bf16 v[112:127], v[40:43], v[24:27], v[112:127]
ds_read_b128 v[16:19], v1 offset:2048
v_mfma_f32_32x32x16_bf16 v[128:143], v[40:43], v[28:31], v[128:143]
ds_read_b128 v[20:23], v2 offset:2048
buffer_load_dwordx4 v[40:43], v1, s[8:11], s21 offen offset:0
v_mfma_f32_32x32x16_bf16 v[144:159], v[44:47], v[24:27], v[144:159]
v_mfma_f32_32x32x16_bf16 v[160:175], v[44:47], v[28:31], v[160:175]
buffer_load_dwordx4 v[44:47], v1, s[8:11], s21 offen offset:1024
s_add_u32 s21, s21, 20480
s_waitcnt lgkmcnt(0)
v_mfma_f32_32x32x16_bf16 v[112:127], v[48:51], v[16:19], v[112:127]
ds_read_b128 v[24:27], v1 offset:3072
v_mfma_f32_32x32x16_bf16 v[128:143], v[48:51], v[20:23], v[128:143]
ds_read_b128 v[28:31], v2 offset:3072
buffer_load_dwordx4 v[48:51], v1, s[8:11], s21 offen offset:0
v_mfma_f32_32x32x16_bf16 v[144:159], v[52:55], v[16:19], v[144:159]
v_mfma_f32_32x32x16_bf16 v[160:175], v[52:55], v[20:23], v[160:175]
buffer_load_dwordx4 v[52:55], v1, s[8:11], s21 offen offset:1024
s_add_u32 s21, s21, 20480
s_waitcnt lgkmcnt(0)
v_mfma_f32_32x32x16_bf16 v[112:127], v[56:59], v[24:27], v[112:127]
ds_read_b128 v[16:19], v1 offset:4096
v_mfma_f32_32x32x16_bf16 v[128:143], v[56:59], v[28:31], v[128:143]
ds_read_b128 v[20:23], v2 offset:4096
buffer_load_dwordx4 v[56:59], v1, s[8:11], s21 offen offset:0
v_mfma_f32_32x32x16_bf16 v[144:159], v[60:63], v[24:27], v[144:159]
v_mfma_f32_32x32x16_bf16 v[160:175], v[60:63], v[28:31], v[160:175]
buffer_load_dwordx4 v[60:63], v1, s[8:11], s21 offen offset:1024
s_add_u32 s21, s21, 20480
s_waitcnt lgkmcnt(0)
v_mfma_f32_32x32x16_bf16 v[112:127], v[64:67], v[16:19], v[112:127]
ds_read_b128 v[24:27], v1 offset:5120
v_mfma_f32_32x32x16_bf16 v[128:143], v[64:67], v[20:23], v[128:143]
ds_read_b128 v[28:31], v2 offset:5120
buffer_load_dwordx4 v[64:67], v1, s[8:11], s21 offen offset:0
v_mfma_f32_32x32x16_bf16 v[144:159], v[68:71], v[16:19], v[144:159]
v_mfma_f32_32x32x16_bf16 v[160:175], v[68:71], v[20:23], v[160:175]
buffer_load_dwordx4 v[68:71], v1, s[8:11], s21 offen offset:1024
s_add_u32 s21, s21, 20480
s_waitcnt lgkmcnt(0)
v_mfma_f32_32x32x16_bf16 v[112:127], v[72:75], v[24:27], v[112:127]
ds_read_b128 v[16:19], v1 offset:6144
v_mfma_f32_32x32x16_bf16 v[128:143], v[72:75], v[28:31], v[128:143]
ds_read_b128 v[20:23], v2 offset:6144
buffer_load_dwordx4 v[72:75], v1, s[8:11], s21 offen offset:0
v_mfma_f32_32x32x16_bf16 v[144:159], v[76:79], v[24:27], v[144:159]
v_mfma_f32_32x32x16_bf16 v[160:175], v[76:79], v[28:31], v[160:175]
buffer_load_dwordx4 v[76:79], v1, s[8:11], s21 offen offset:1024
s_add_u32 s21, s21, 20480
s_waitcnt lgkmcnt(0)
v_mfma_f32_32x32x16_bf16 v[112:127], v[80:83], v[16:19], v[112:127]
ds_read_b128 v[24:27], v1 offset:7168
v_mfma_f32_32x32x16_bf16 v[128:143], v[80:83], v[20:23], v[128:143]
ds_read_b128 v[28:31], v2 offset:7168
buffer_load_dwordx4 v[80:83], v1, s[8:11], s21 offen offset:0
v_mfma_f32_32x32x16_bf16 v[144:159], v[84:87], v[16:19], v[144:159]
v_mfma_f32_32x32x16_bf16 v[160:175], v[84:87], v[20:23], v[160:175]
buffer_load_dwordx4 v[84:87], v1, s[8:11], s21 offen offset:1024
s_add_u32 s21, s21, 20480
s_waitcnt lgkmcnt(0)
v_mfma_f32_32x32x16_bf16 v[112:127], v[88:91], v[24:27], v[112:127]
ds_read_b128 v[16:19], v1 offset:8192
v_mfma_f32_32x32x16_bf16 v[128:143], v[88:91], v[28:31], v[128:143]
ds_read_b128 v[20:23], v2 offset:8192
buffer_load_dwordx4 v[88:91], v1, s[8:11], s21 offen offset:0
v_mfma_f32_32x32x16_bf16 v[144:159], v[92:95], v[24:27], v[144:159]
v_mfma_f32_32x32x16_bf16 v[160:175], v[92:95], v[28:31], v[160:175]
buffer_load_dwordx4 v[92:95], v1, s[8:11], s21 offen offset:1024
s_add_u32 s21, s21, 20480
s_waitcnt lgkmcnt(0)
v_mfma_f32_32x32x16_bf16 v[112:127], v[96:99], v[16:19], v[112:127]
ds_read_b128 v[24:27], v1 offset:9216
v_mfma_f32_32x32x16_bf16 v[128:143], v[96:99], v[20:23], v[128:143]
ds_read_b128 v[28:31], v2 offset:9216
buffer_load_dwordx4 v[96:99], v1, s[8:11], s21 offen offset:0
v_mfma_f32_32x32x16_bf16 v[144:159], v[100:103], v[16:19], v[144:159]
v_mfma_f32_32x32x16_bf16 v[160:175], v[100:103], v[20:23], v[160:175]
buffer_load_dwordx4 v[100:103], v1, s[8:11], s21 offen offset:1024
s_add_u32 s21, s21, 20480
s_waitcnt lgkmcnt(0)
v_mfma_f32_32x32x16_bf16 v[112:127], v[104:107], v[24:27], v[112:127]
ds_read_b128 v[16:19], v1 offset:10240
v_mfma_f32_32x32x16_bf16 v[128:143], v[104:107], v[28:31], v[128:143]
ds_read_b128 v[20:23], v2 offset:10240
buffer_load_dwordx4 v[104:107], v1, s[8:11], s21 offen offset:0
v_mfma_f32_32x32x16_bf16 v[144:159], v[108:111], v[24:27], v[144:159]
v_mfma_f32_32x32x16_bf16 v[160:175], v[108:111], v[28:31], v[160:175]
buffer_load_dwordx4 v[108:111], v1, s[8:11], s21 offen offset:1024
s_add_u32 s21, s21, 20480
s_cmp_ge_u32 s21, s46
s_cselect_b32 s45, 819200, 0
s_sub_u32 s21, s21, s45
s_waitcnt vmcnt(19)
s_waitcnt lgkmcnt(0)
v_mfma_f32_32x32x16_bf16 v[112:127], v[32:35], v[16:19], v[112:127]
ds_read_b128 v[24:27], v1 offset:11264
v_mfma_f32_32x32x16_bf16 v[128:143], v[32:35], v[20:23], v[128:143]
ds_read_b128 v[28:31], v2 offset:11264
buffer_load_dwordx4 v[32:35], v1, s[8:11], s21 offen offset:0
s_waitcnt vmcnt(19)
v_mfma_f32_32x32x16_bf16 v[144:159], v[36:39], v[16:19], v[144:159]
v_mfma_f32_32x32x16_bf16 v[160:175], v[36:39], v[20:23], v[160:175]
buffer_load_dwordx4 v[36:39], v1, s[8:11], s21 offen offset:1024
s_add_u32 s21, s21, 20480
s_waitcnt vmcnt(19)
s_waitcnt lgkmcnt(0)
v_mfma_f32_32x32x16_bf16 v[112:127], v[40:43], v[24:27], v[112:127]
ds_read_b128 v[16:19], v1 offset:12288
v_mfma_f32_32x32x16_bf16 v[128:143], v[40:43], v[28:31], v[128:143]
ds_read_b128 v[20:23], v2 offset:12288
buffer_load_dwordx4 v[40:43], v1, s[8:11], s21 offen offset:0
s_waitcnt vmcnt(19)
v_mfma_f32_32x32x16_bf16 v[144:159], v[44:47], v[24:27], v[144:159]
v_mfma_f32_32x32x16_bf16 v[160:175], v[44:47], v[28:31], v[160:175]
buffer_load_dwordx4 v[44:47], v1, s[8:11], s21 offen offset:1024
s_add_u32 s21, s21, 20480
s_waitcnt vmcnt(19)
s_waitcnt lgkmcnt(0)
v_mfma_f32_32x32x16_bf16 v[112:127], v[48:51], v[16:19], v[112:127]
ds_read_b128 v[24:27], v1 offset:13312
v_mfma_f32_32x32x16_bf16 v[128:143], v[48:51], v[20:23], v[128:143]
ds_read_b128 v[28:31], v2 offset:13312
buffer_load_dwordx4 v[48:51], v1, s[8:11], s21 offen offset:0
s_waitcnt vmcnt(19)
v_mfma_f32_32x32x16_bf16 v[144:159], v[52:55], v[16:19], v[144:159]
v_mfma_f32_32x32x16_bf16 v[160:175], v[52:55], v[20:23], v[160:175]
buffer_load_dwordx4 v[52:55], v1, s[8:11], s21 offen offset:1024
s_add_u32 s21, s21, 20480
s_waitcnt vmcnt(19)
s_waitcnt lgkmcnt(0)
v_mfma_f32_32x32x16_bf16 v[112:127], v[56:59], v[24:27], v[112:127]
ds_read_b128 v[16:19], v1 offset:14336
v_mfma_f32_32x32x16_bf16 v[128:143], v[56:59], v[28:31], v[128:143]
ds_read_b128 v[20:23], v2 offset:14336
buffer_load_dwordx4 v[56:59], v1, s[8:11], s21 offen offset:0
s_waitcnt vmcnt(19)
v_mfma_f32_32x32x16_bf16 v[144:159], v[60:63], v[24:27], v[144:159]
v_mfma_f32_32x32x16_bf16 v[160:175], v[60:63], v[28:31], v[160:175]
buffer_load_dwordx4 v[60:63], v1, s[8:11], s21 offen offset:1024
s_add_u32 s21, s21, 20480
s_waitcnt vmcnt(19)
s_waitcnt lgkmcnt(0)
v_mfma_f32_32x32x16_bf16 v[112:127], v[64:67], v[16:19], v[112:127]
ds_read_b128 v[24:27], v1 offset:15360
v_mfma_f32_32x32x16_bf16 v[128:143], v[64:67], v[20:23], v[128:143]
ds_read_b128 v[28:31], v2 offset:15360
buffer_load_dwordx4 v[64:67], v1, s[8:11], s21 offen offset:0
s_waitcnt vmcnt(19)
v_mfma_f32_32x32x16_bf16 v[144:159], v[68:71], v[16:19], v[144:159]
v_mfma_f32_32x32x16_bf16 v[160:175], v[68:71], v[20:23], v[160:175]
buffer_load_dwordx4 v[68:71], v1, s[8:11], s21 offen offset:1024
s_add_u32 s21, s21, 20480
s_waitcnt vmcnt(19)
s_waitcnt lgkmcnt(0)
v_mfma_f32_32x32x16_bf16 v[112:127], v[72:75], v[24:27], v[112:127]
ds_read_b128 v[16:19], v1 offset:16384
v_mfma_f32_32x32x16_bf16 v[128:143], v[72:75], v[28:31], v[128:143]
ds_read_b128 v[20:23], v2 offset:16384
buffer_load_dwordx4 v[72:75], v1, s[8:11], s21 offen offset:0
s_waitcnt vmcnt(19)
v_mfma_f32_32x32x16_bf16 v[144:159], v[76:79], v[24:27], v[144:159]
v_mfma_f32_32x32x16_bf16 v[160:175], v[76:79], v[28:31], v[160:175]
buffer_load_dwordx4 v[76:79], v1, s[8:11], s21 offen offset:1024
s_add_u32 s21, s21, 20480
s_waitcnt vmcnt(19)
s_waitcnt lgkmcnt(0)
v_mfma_f32_32x32x16_bf16 v[112:127], v[80:83], v[16:19], v[112:127]
ds_read_b128 v[24:27], v1 offset:17408
v_mfma_f32_32x32x16_bf16 v[128:143], v[80:83], v[20:23], v[128:143]
ds_read_b128 v[28:31], v2 offset:17408
buffer_load_dwordx4 v[80:83], v1, s[8:11], s21 offen offset:0
s_waitcnt vmcnt(19)
v_mfma_f32_32x32x16_bf16 v[144:159], v[84:87], v[16:19], v[144:159]
v_mfma_f32_32x32x16_bf16 v[160:175], v[84:87], v[20:23], v[160:175]
buffer_load_dwordx4 v[84:87], v1, s[8:11], s21 offen offset:1024
s_add_u32 s21, s21, 20480
s_waitcnt vmcnt(19)
s_waitcnt lgkmcnt(0)
v_mfma_f32_32x32x16_bf16 v[112:127], v[88:91], v[24:27], v[112:127]
ds_read_b128 v[16:19], v1 offset:18432
v_mfma_f32_32x32x16_bf16 v[128:143], v[88:91], v[28:31], v[128:143]
ds_read_b128 v[20:23], v2 offset:18432
buffer_load_dwordx4 v[88:91], v1, s[8:11], s21 offen offset:0
s_waitcnt vmcnt(19)
v_mfma_f32_32x32x16_bf16 v[144:159], v[92:95], v[24:27], v[144:159]
v_mfma_f32_32x32x16_bf16 v[160:175], v[92:95], v[28:31], v[160:175]
buffer_load_dwordx4 v[92:95], v1, s[8:11], s21 offen offset:1024
s_add_u32 s21, s21, 20480
s_waitcnt vmcnt(19)
s_waitcnt lgkmcnt(0)
v_mfma_f32_32x32x16_bf16 v[112:127], v[96:99], v[16:19], v[112:127]
ds_read_b128 v[24:27], v1 offset:19456
v_mfma_f32_32x32x16_bf16 v[128:143], v[96:99], v[20:23], v[128:143]
ds_read_b128 v[28:31], v2 offset:19456
buffer_load_dwordx4 v[96:99], v1, s[8:11], s21 offen offset:0
s_waitcnt vmcnt(19)
v_mfma_f32_32x32x16_bf16 v[144:159], v[100:103], v[16:19], v[144:159]
v_mfma_f32_32x32x16_bf16 v[160:175], v[100:103], v[20:23], v[160:175]
buffer_load_dwordx4 v[100:103], v1, s[8:11], s21 offen offset:1024
s_add_u32 s21, s21, 20480
s_waitcnt vmcnt(19)
s_waitcnt lgkmcnt(0)
v_mfma_f32_32x32x16_bf16 v[112:127], v[104:107], v[24:27], v[112:127]
ds_read_b128 v[16:19], v1 offset:20480
v_mfma_f32_32x32x16_bf16 v[128:143], v[104:107], v[28:31], v[128:143]
ds_read_b128 v[20:23], v2 offset:20480
buffer_load_dwordx4 v[104:107], v1, s[8:11], s21 offen offset:0
s_waitcnt vmcnt(19)
v_mfma_f32_32x32x16_bf16 v[144:159], v[108:111], v[24:27], v[144:159]
v_mfma_f32_32x32x16_bf16 v[160:175], v[108:111], v[28:31], v[160:175]
buffer_load_dwordx4 v[108:111], v1, s[8:11], s21 offen offset:1024
s_add_u32 s21, s21, 20480
s_cmp_ge_u32 s21, s46
s_cselect_b32 s45, 819200, 0
s_sub_u32 s21, s21, s45
s_waitcnt vmcnt(19)
s_waitcnt lgkmcnt(0)
v_mfma_f32_32x32x16_bf16 v[112:127], v[32:35], v[16:19], v[112:127]
ds_read_b128 v[24:27], v1 offset:21504
v_mfma_f32_32x32x16_bf16 v[128:143], v[32:35], v[20:23], v[128:143]
ds_read_b128 v[28:31], v2 offset:21504
buffer_load_dwordx4 v[32:35], v1, s[8:11], s21 offen offset:0
s_waitcnt vmcnt(19)
v_mfma_f32_32x32x16_bf16 v[144:159], v[36:39], v[16:19], v[144:159]
v_mfma_f32_32x32x16_bf16 v[160:175], v[36:39], v[20:23], v[160:175]
buffer_load_dwordx4 v[36:39], v1, s[8:11], s21 offen offset:1024
s_add_u32 s21, s21, 20480
s_waitcnt vmcnt(19)
s_waitcnt lgkmcnt(0)
v_mfma_f32_32x32x16_bf16 v[112:127], v[40:43], v[24:27], v[112:127]
ds_read_b128 v[16:19], v1 offset:22528
v_mfma_f32_32x32x16_bf16 v[128:143], v[40:43], v[28:31], v[128:143]
ds_read_b128 v[20:23], v2 offset:22528
buffer_load_dwordx4 v[40:43], v1, s[8:11], s21 offen offset:0
s_waitcnt vmcnt(19)
v_mfma_f32_32x32x16_bf16 v[144:159], v[44:47], v[24:27], v[144:159]
v_mfma_f32_32x32x16_bf16 v[160:175], v[44:47], v[28:31], v[160:175]
buffer_load_dwordx4 v[44:47], v1, s[8:11], s21 offen offset:1024
s_add_u32 s21, s21, 20480
s_waitcnt vmcnt(19)
s_waitcnt lgkmcnt(0)
v_mfma_f32_32x32x16_bf16 v[112:127], v[48:51], v[16:19], v[112:127]
ds_read_b128 v[24:27], v1 offset:23552
v_mfma_f32_32x32x16_bf16 v[128:143], v[48:51], v[20:23], v[128:143]
ds_read_b128 v[28:31], v2 offset:23552
buffer_load_dwordx4 v[48:51], v1, s[8:11], s21 offen offset:0
s_waitcnt vmcnt(19)
v_mfma_f32_32x32x16_bf16 v[144:159], v[52:55], v[16:19], v[144:159]
v_mfma_f32_32x32x16_bf16 v[160:175], v[52:55], v[20:23], v[160:175]
buffer_load_dwordx4 v[52:55], v1, s[8:11], s21 offen offset:1024
s_add_u32 s21, s21, 20480
s_waitcnt vmcnt(19)
s_waitcnt lgkmcnt(0)
v_mfma_f32_32x32x16_bf16 v[112:127], v[56:59], v[24:27], v[112:127]
ds_read_b128 v[16:19], v1 offset:24576
v_mfma_f32_32x32x16_bf16 v[128:143], v[56:59], v[28:31], v[128:143]
ds_read_b128 v[20:23], v2 offset:24576
buffer_load_dwordx4 v[56:59], v1, s[8:11], s21 offen offset:0
s_waitcnt vmcnt(19)
v_mfma_f32_32x32x16_bf16 v[144:159], v[60:63], v[24:27], v[144:159]
v_mfma_f32_32x32x16_bf16 v[160:175], v[60:63], v[28:31], v[160:175]
buffer_load_dwordx4 v[60:63], v1, s[8:11], s21 offen offset:1024
s_add_u32 s21, s21, 20480
s_waitcnt vmcnt(19)
s_waitcnt lgkmcnt(0)
v_mfma_f32_32x32x16_bf16 v[112:127], v[64:67], v[16:19], v[112:127]
ds_read_b128 v[24:27], v1 offset:25600
v_mfma_f32_32x32x16_bf16 v[128:143], v[64:67], v[20:23], v[128:143]
ds_read_b128 v[28:31], v2 offset:25600
buffer_load_dwordx4 v[64:67], v1, s[8:11], s21 offen offset:0
s_waitcnt vmcnt(19)
v_mfma_f32_32x32x16_bf16 v[144:159], v[68:71], v[16:19], v[144:159]
v_mfma_f32_32x32x16_bf16 v[160:175], v[68:71], v[20:23], v[160:175]
buffer_load_dwordx4 v[68:71], v1, s[8:11], s21 offen offset:1024
s_add_u32 s21, s21, 20480
s_waitcnt vmcnt(19)
s_waitcnt lgkmcnt(0)
v_mfma_f32_32x32x16_bf16 v[112:127], v[72:75], v[24:27], v[112:127]
ds_read_b128 v[16:19], v1 offset:26624
v_mfma_f32_32x32x16_bf16 v[128:143], v[72:75], v[28:31], v[128:143]
ds_read_b128 v[20:23], v2 offset:26624
buffer_load_dwordx4 v[72:75], v1, s[8:11], s21 offen offset:0
s_waitcnt vmcnt(19)
v_mfma_f32_32x32x16_bf16 v[144:159], v[76:79], v[24:27], v[144:159]
v_mfma_f32_32x32x16_bf16 v[160:175], v[76:79], v[28:31], v[160:175]
buffer_load_dwordx4 v[76:79], v1, s[8:11], s21 offen offset:1024
s_add_u32 s21, s21, 20480
s_waitcnt vmcnt(19)
s_waitcnt lgkmcnt(0)
v_mfma_f32_32x32x16_bf16 v[112:127], v[80:83], v[16:19], v[112:127]
ds_read_b128 v[24:27], v1 offset:27648
v_mfma_f32_32x32x16_bf16 v[128:143], v[80:83], v[20:23], v[128:143]
ds_read_b128 v[28:31], v2 offset:27648
buffer_load_dwordx4 v[80:83], v1, s[8:11], s21 offen offset:0
s_waitcnt vmcnt(19)
v_mfma_f32_32x32x16_bf16 v[144:159], v[84:87], v[16:19], v[144:159]
v_mfma_f32_32x32x16_bf16 v[160:175], v[84:87], v[20:23], v[160:175]
buffer_load_dwordx4 v[84:87], v1, s[8:11], s21 offen offset:1024
s_add_u32 s21, s21, 20480
s_waitcnt vmcnt(19)
s_waitcnt lgkmcnt(0)
v_mfma_f32_32x32x16_bf16 v[112:127], v[88:91], v[24:27], v[112:127]
ds_read_b128 v[16:19], v1 offset:28672
v_mfma_f32_32x32x16_bf16 v[128:143], v[88:91], v[28:31], v[128:143]
ds_read_b128 v[20:23], v2 offset:28672
buffer_load_dwordx4 v[88:91], v1, s[8:11], s21 offen offset:0
s_waitcnt vmcnt(19)
v_mfma_f32_32x32x16_bf16 v[144:159], v[92:95], v[24:27], v[144:159]
v_mfma_f32_32x32x16_bf16 v[160:175], v[92:95], v[28:31], v[160:175]
buffer_load_dwordx4 v[92:95], v1, s[8:11], s21 offen offset:1024
s_add_u32 s21, s21, 20480
s_waitcnt vmcnt(19)
s_waitcnt lgkmcnt(0)
v_mfma_f32_32x32x16_bf16 v[112:127], v[96:99], v[16:19], v[112:127]
ds_read_b128 v[24:27], v1 offset:29696
v_mfma_f32_32x32x16_bf16 v[128:143], v[96:99], v[20:23], v[128:143]
ds_read_b128 v[28:31], v2 offset:29696
buffer_load_dwordx4 v[96:99], v1, s[8:11], s21 offen offset:0
s_waitcnt vmcnt(19)
v_mfma_f32_32x32x16_bf16 v[144:159], v[100:103], v[16:19], v[144:159]
v_mfma_f32_32x32x16_bf16 v[160:175], v[100:103], v[20:23], v[160:175]
buffer_load_dwordx4 v[100:103], v1, s[8:11], s21 offen offset:1024
s_add_u32 s21, s21, 20480
s_waitcnt vmcnt(19)
s_waitcnt lgkmcnt(0)
v_mfma_f32_32x32x16_bf16 v[112:127], v[104:107], v[24:27], v[112:127]
ds_read_b128 v[16:19], v1 offset:30720
v_mfma_f32_32x32x16_bf16 v[128:143], v[104:107], v[28:31], v[128:143]
ds_read_b128 v[20:23], v2 offset:30720
buffer_load_dwordx4 v[104:107], v1, s[8:11], s21 offen offset:0
s_waitcnt vmcnt(19)
v_mfma_f32_32x32x16_bf16 v[144:159], v[108:111], v[24:27], v[144:159]
v_mfma_f32_32x32x16_bf16 v[160:175], v[108:111], v[28:31], v[160:175]
buffer_load_dwordx4 v[108:111], v1, s[8:11], s21 offen offset:1024
s_add_u32 s21, s21, 20480
s_waitcnt vmcnt(19)
s_waitcnt lgkmcnt(0)
v_mfma_f32_32x32x16_bf16 v[112:127], v[32:35], v[16:19], v[112:127]
ds_read_b128 v[24:27], v1 offset:31744
v_mfma_f32_32x32x16_bf16 v[128:143], v[32:35], v[20:23], v[128:143]
ds_read_b128 v[28:31], v2 offset:31744
s_mov_b32 s21, s22
buffer_load_dwordx4 v[32:35], v1, s[8:11], s21 offen offset:0
s_waitcnt vmcnt(19)
v_mfma_f32_32x32x16_bf16 v[144:159], v[36:39], v[16:19], v[144:159]
v_mfma_f32_32x32x16_bf16 v[160:175], v[36:39], v[20:23], v[160:175]
buffer_load_dwordx4 v[36:39], v1, s[8:11], s21 offen offset:1024
s_waitcnt vmcnt(19)
s_waitcnt lgkmcnt(0)
v_mfma_f32_32x32x16_bf16 v[112:127], v[40:43], v[24:27], v[112:127]
ds_read_b128 v[16:19], v1 offset:32768
v_mfma_f32_32x32x16_bf16 v[128:143], v[40:43], v[28:31], v[128:143]
ds_read_b128 v[20:23], v2 offset:32768
buffer_load_dwordx4 v[40:43], v1, s[8:11], s21 offen offset:2048
s_waitcnt vmcnt(19)
v_mfma_f32_32x32x16_bf16 v[144:159], v[44:47], v[24:27], v[144:159]
v_mfma_f32_32x32x16_bf16 v[160:175], v[44:47], v[28:31], v[160:175]
buffer_load_dwordx4 v[44:47], v1, s[8:11], s21 offen offset:3072
s_add_u32 s21, s21, 55296
s_waitcnt vmcnt(19)
s_waitcnt lgkmcnt(0)
v_mfma_f32_32x32x16_bf16 v[112:127], v[48:51], v[16:19], v[112:127]
ds_read_b128 v[24:27], v1 offset:33792
v_mfma_f32_32x32x16_bf16 v[128:143], v[48:51], v[20:23], v[128:143]
ds_read_b128 v[28:31], v2 offset:33792
buffer_load_dwordx4 v[48:51], v1, s[8:11], s21 offen offset:0
s_waitcnt vmcnt(19)
v_mfma_f32_32x32x16_bf16 v[144:159], v[52:55], v[16:19], v[144:159]
v_mfma_f32_32x32x16_bf16 v[160:175], v[52:55], v[20:23], v[160:175]
buffer_load_dwordx4 v[52:55], v1, s[8:11], s21 offen offset:1024
s_waitcnt vmcnt(19)
s_waitcnt lgkmcnt(0)
v_mfma_f32_32x32x16_bf16 v[112:127], v[56:59], v[24:27], v[112:127]
ds_read_b128 v[16:19], v1 offset:34816
v_mfma_f32_32x32x16_bf16 v[128:143], v[56:59], v[28:31], v[128:143]
ds_read_b128 v[20:23], v2 offset:34816
buffer_load_dwordx4 v[56:59], v1, s[8:11], s21 offen offset:2048
s_waitcnt vmcnt(19)
v_mfma_f32_32x32x16_bf16 v[144:159], v[60:63], v[24:27], v[144:159]
v_mfma_f32_32x32x16_bf16 v[160:175], v[60:63], v[28:31], v[160:175]
buffer_load_dwordx4 v[60:63], v1, s[8:11], s21 offen offset:3072
s_add_u32 s21, s21, 55296
s_waitcnt vmcnt(19)
s_waitcnt lgkmcnt(0)
v_mfma_f32_32x32x16_bf16 v[112:127], v[64:67], v[16:19], v[112:127]
ds_read_b128 v[24:27], v1 offset:35840
v_mfma_f32_32x32x16_bf16 v[128:143], v[64:67], v[20:23], v[128:143]
ds_read_b128 v[28:31], v2 offset:35840
buffer_load_dwordx4 v[64:67], v1, s[8:11], s21 offen offset:0
s_waitcnt vmcnt(19)
v_mfma_f32_32x32x16_bf16 v[144:159], v[68:71], v[16:19], v[144:159]
v_mfma_f32_32x32x16_bf16 v[160:175], v[68:71], v[20:23], v[160:175]
buffer_load_dwordx4 v[68:71], v1, s[8:11], s21 offen offset:1024
s_waitcnt vmcnt(19)
s_waitcnt lgkmcnt(0)
v_mfma_f32_32x32x16_bf16 v[112:127], v[72:75], v[24:27], v[112:127]
ds_read_b128 v[16:19], v1 offset:36864
v_mfma_f32_32x32x16_bf16 v[128:143], v[72:75], v[28:31], v[128:143]
ds_read_b128 v[20:23], v2 offset:36864
buffer_load_dwordx4 v[72:75], v1, s[8:11], s21 offen offset:2048
s_waitcnt vmcnt(19)
v_mfma_f32_32x32x16_bf16 v[144:159], v[76:79], v[24:27], v[144:159]
v_mfma_f32_32x32x16_bf16 v[160:175], v[76:79], v[28:31], v[160:175]
buffer_load_dwordx4 v[76:79], v1, s[8:11], s21 offen offset:3072
s_add_u32 s21, s21, 55296
s_waitcnt vmcnt(19)
s_waitcnt lgkmcnt(0)
v_mfma_f32_32x32x16_bf16 v[112:127], v[80:83], v[16:19], v[112:127]
ds_read_b128 v[24:27], v1 offset:37888
v_mfma_f32_32x32x16_bf16 v[128:143], v[80:83], v[20:23], v[128:143]
ds_read_b128 v[28:31], v2 offset:37888
buffer_load_dwordx4 v[80:83], v1, s[8:11], s21 offen offset:0
s_waitcnt vmcnt(19)
v_mfma_f32_32x32x16_bf16 v[144:159], v[84:87], v[16:19], v[144:159]
v_mfma_f32_32x32x16_bf16 v[160:175], v[84:87], v[20:23], v[160:175]
buffer_load_dwordx4 v[84:87], v1, s[8:11], s21 offen offset:1024
s_waitcnt vmcnt(19)
s_waitcnt lgkmcnt(0)
v_mfma_f32_32x32x16_bf16 v[112:127], v[88:91], v[24:27], v[112:127]
ds_read_b128 v[16:19], v1 offset:38912
v_mfma_f32_32x32x16_bf16 v[128:143], v[88:91], v[28:31], v[128:143]
ds_read_b128 v[20:23], v2 offset:38912
buffer_load_dwordx4 v[88:91], v1, s[8:11], s21 offen offset:2048
s_waitcnt vmcnt(19)
v_mfma_f32_32x32x16_bf16 v[144:159], v[92:95], v[24:27], v[144:159]
v_mfma_f32_32x32x16_bf16 v[160:175], v[92:95], v[28:31], v[160:175]
buffer_load_dwordx4 v[92:95], v1, s[8:11], s21 offen offset:3072
s_add_u32 s21, s21, 55296
s_waitcnt vmcnt(19)
s_waitcnt lgkmcnt(0)
v_mfma_f32_32x32x16_bf16 v[112:127], v[96:99], v[16:19], v[112:127]
ds_read_b128 v[24:27], v1 offset:39936
v_mfma_f32_32x32x16_bf16 v[128:143], v[96:99], v[20:23], v[128:143]
ds_read_b128 v[28:31], v2 offset:39936
buffer_load_dwordx4 v[96:99], v1, s[8:11], s21 offen offset:0
s_waitcnt vmcnt(19)
v_mfma_f32_32x32x16_bf16 v[144:159], v[100:103], v[16:19], v[144:159]
v_mfma_f32_32x32x16_bf16 v[160:175], v[100:103], v[20:23], v[160:175]
buffer_load_dwordx4 v[100:103], v1, s[8:11], s21 offen offset:1024
s_waitcnt vmcnt(19)
s_waitcnt lgkmcnt(0)
v_mfma_f32_32x32x16_bf16 v[112:127], v[104:107], v[24:27], v[112:127]
v_mfma_f32_32x32x16_bf16 v[128:143], v[104:107], v[28:31], v[128:143]
buffer_load_dwordx4 v[104:107], v1, s[8:11], s21 offen offset:2048
s_waitcnt vmcnt(19)
v_mfma_f32_32x32x16_bf16 v[144:159], v[108:111], v[24:27], v[144:159]
v_mfma_f32_32x32x16_bf16 v[160:175], v[108:111], v[28:31], v[160:175]
buffer_load_dwordx4 v[108:111], v1, s[8:11], s21 offen offset:3072
s_add_u32 s21, s21, 55296
v_mov_b32 v8, 0
v_mov_b32 v9, 0
v_mov_b32 v10, 0
v_mov_b32 v11, 0
s_nop 0
v_cvt_pk_bf16_f32 v208, v112, v113
v_lshlrev_b32 v112, 16, v208
v_and_b32 v113, 0xffff0000, v208
v_add_f32 v8, v8, v112
v_fmac_f32 v9, v112, v112
v_add_f32 v8, v8, v113
v_fmac_f32 v9, v113, v113
v_cvt_pk_bf16_f32 v209, v114, v115
v_lshlrev_b32 v114, 16, v209
v_and_b32 v115, 0xffff0000, v209
v_add_f32 v8, v8, v114
v_fmac_f32 v9, v114, v114
v_add_f32 v8, v8, v115
v_fmac_f32 v9, v115, v115
v_cvt_pk_bf16_f32 v210, v116, v117
v_lshlrev_b32 v116, 16, v210
v_and_b32 v117, 0xffff0000, v210
v_add_f32 v8, v8, v116
v_fmac_f32 v9, v116, v116
v_add_f32 v8, v8, v117
v_fmac_f32 v9, v117, v117
v_cvt_pk_bf16_f32 v211, v118, v119
v_lshlrev_b32 v118, 16, v211
v_and_b32 v119, 0xffff0000, v211
v_add_f32 v8, v8, v118
v_fmac_f32 v9, v118, v118
v_add_f32 v8, v8, v119
v_fmac_f32 v9, v119, v119
v_cvt_pk_bf16_f32 v212, v120, v121
v_lshlrev_b32 v120, 16, v212
v_and_b32 v121, 0xffff0000, v212
v_add_f32 v8, v8, v120
v_fmac_f32 v9, v120, v120
v_add_f32 v8, v8, v121
v_fmac_f32 v9, v121, v121
v_cvt_pk_bf16_f32 v213, v122, v123
v_lshlrev_b32 v122, 16, v213
v_and_b32 v123, 0xffff0000, v213
v_add_f32 v8, v8, v122
v_fmac_f32 v9, v122, v122
v_add_f32 v8, v8, v123
v_fmac_f32 v9, v123, v123
v_cvt_pk_bf16_f32 v214, v124, v125
v_lshlrev_b32 v124, 16, v214
v_and_b32 v125, 0xffff0000, v214
v_add_f32 v8, v8, v124
v_fmac_f32 v9, v124, v124
v_add_f32 v8, v8, v125
v_fmac_f32 v9, v125, v125
v_cvt_pk_bf16_f32 v215, v126, v127
v_lshlrev_b32 v126, 16, v215
v_and_b32 v127, 0xffff0000, v215
v_add_f32 v8, v8, v126
v_fmac_f32 v9, v126, v126
v_add_f32 v8, v8, v127
v_fmac_f32 v9, v127, v127
v_cvt_pk_bf16_f32 v216, v144, v145
v_lshlrev_b32 v144, 16, v216
v_and_b32 v145, 0xffff0000, v216
v_add_f32 v8, v8, v144
v_fmac_f32 v9, v144, v144
v_add_f32 v8, v8, v145
v_fmac_f32 v9, v145, v145
v_cvt_pk_bf16_f32 v217, v146, v147
v_lshlrev_b32 v146, 16, v217
v_and_b32 v147, 0xffff0000, v217
v_add_f32 v8, v8, v146
v_fmac_f32 v9, v146, v146
v_add_f32 v8, v8, v147
v_fmac_f32 v9, v147, v147
v_cvt_pk_bf16_f32 v218, v148, v149
v_lshlrev_b32 v148, 16, v218
v_and_b32 v149, 0xffff0000, v218
v_add_f32 v8, v8, v148
v_fmac_f32 v9, v148, v148
v_add_f32 v8, v8, v149
v_fmac_f32 v9, v149, v149
v_cvt_pk_bf16_f32 v219, v150, v151
v_lshlrev_b32 v150, 16, v219
v_and_b32 v151, 0xffff0000, v219
v_add_f32 v8, v8, v150
v_fmac_f32 v9, v150, v150
v_add_f32 v8, v8, v151
v_fmac_f32 v9, v151, v151
v_cvt_pk_bf16_f32 v220, v152, v153
v_lshlrev_b32 v152, 16, v220
v_and_b32 v153, 0xffff0000, v220
v_add_f32 v8, v8, v152
v_fmac_f32 v9, v152, v152
v_add_f32 v8, v8, v153
v_fmac_f32 v9, v153, v153
v_cvt_pk_bf16_f32 v221, v154, v155
v_lshlrev_b32 v154, 16, v221
v_and_b32 v155, 0xffff0000, v221
v_add_f32 v8, v8, v154
v_fmac_f32 v9, v154, v154
v_add_f32 v8, v8, v155
v_fmac_f32 v9, v155, v155
v_cvt_pk_bf16_f32 v222, v156, v157
v_lshlrev_b32 v156, 16, v222
v_and_b32 v157, 0xffff0000, v222
v_add_f32 v8, v8, v156
v_fmac_f32 v9, v156, v156
v_add_f32 v8, v8, v157
v_fmac_f32 v9, v157, v157
v_cvt_pk_bf16_f32 v223, v158, v159
v_lshlrev_b32 v158, 16, v223
v_and_b32 v159, 0xffff0000, v223
v_add_f32 v8, v8, v158
v_fmac_f32 v9, v158, v158
v_add_f32 v8, v8, v159
v_fmac_f32 v9, v159, v159
v_cvt_pk_bf16_f32 v224, v128, v129
v_lshlrev_b32 v128, 16, v224
v_and_b32 v129, 0xffff0000, v224
v_add_f32 v10, v10, v128
v_fmac_f32 v11, v128, v128
v_add_f32 v10, v10, v129
v_fmac_f32 v11, v129, v129
v_cvt_pk_bf16_f32 v225, v130, v131
v_lshlrev_b32 v130, 16, v225
v_and_b32 v131, 0xffff0000, v225
v_add_f32 v10, v10, v130
v_fmac_f32 v11, v130, v130
v_add_f32 v10, v10, v131
v_fmac_f32 v11, v131, v131
v_cvt_pk_bf16_f32 v226, v132, v133
v_lshlrev_b32 v132, 16, v226
v_and_b32 v133, 0xffff0000, v226
v_add_f32 v10, v10, v132
v_fmac_f32 v11, v132, v132
v_add_f32 v10, v10, v133
v_fmac_f32 v11, v133, v133
v_cvt_pk_bf16_f32 v227, v134, v135
v_lshlrev_b32 v134, 16, v227
v_and_b32 v135, 0xffff0000, v227
v_add_f32 v10, v10, v134
v_fmac_f32 v11, v134, v134
v_add_f32 v10, v10, v135
v_fmac_f32 v11, v135, v135
v_cvt_pk_bf16_f32 v228, v136, v137
v_lshlrev_b32 v136, 16, v228
v_and_b32 v137, 0xffff0000, v228
v_add_f32 v10, v10, v136
v_fmac_f32 v11, v136, v136
v_add_f32 v10, v10, v137
v_fmac_f32 v11, v137, v137
v_cvt_pk_bf16_f32 v229, v138, v139
v_lshlrev_b32 v138, 16, v229
v_and_b32 v139, 0xffff0000, v229
v_add_f32 v10, v10, v138
v_fmac_f32 v11, v138, v138
v_add_f32 v10, v10, v139
v_fmac_f32 v11, v139, v139
v_cvt_pk_bf16_f32 v230, v140, v141
v_lshlrev_b32 v140, 16, v230
v_and_b32 v141, 0xffff0000, v230
v_add_f32 v10, v10, v140
v_fmac_f32 v11, v140, v140
v_add_f32 v10, v10, v141
v_fmac_f32 v11, v141, v141
v_cvt_pk_bf16_f32 v231, v142, v143
v_lshlrev_b32 v142, 16, v231
v_and_b32 v143, 0xffff0000, v231
v_add_f32 v10, v10, v142
v_fmac_f32 v11, v142, v142
v_add_f32 v10, v10, v143
v_fmac_f32 v11, v143, v143
v_cvt_pk_bf16_f32 v232, v160, v161
v_lshlrev_b32 v160, 16, v232
v_and_b32 v161, 0xffff0000, v232
v_add_f32 v10, v10, v160
v_fmac_f32 v11, v160, v160
v_add_f32 v10, v10, v161
v_fmac_f32 v11, v161, v161
v_cvt_pk_bf16_f32 v233, v162, v163
v_lshlrev_b32 v162, 16, v233
v_and_b32 v163, 0xffff0000, v233
v_add_f32 v10, v10, v162
v_fmac_f32 v11, v162, v162
v_add_f32 v10, v10, v163
v_fmac_f32 v11, v163, v163
v_cvt_pk_bf16_f32 v234, v164, v165
v_lshlrev_b32 v164, 16, v234
v_and_b32 v165, 0xffff0000, v234
v_add_f32 v10, v10, v164
v_fmac_f32 v11, v164, v164
v_add_f32 v10, v10, v165
v_fmac_f32 v11, v165, v165
v_cvt_pk_bf16_f32 v235, v166, v167
v_lshlrev_b32 v166, 16, v235
v_and_b32 v167, 0xffff0000, v235
v_add_f32 v10, v10, v166
v_fmac_f32 v11, v166, v166
v_add_f32 v10, v10, v167
v_fmac_f32 v11, v167, v167
v_cvt_pk_bf16_f32 v236, v168, v169
v_lshlrev_b32 v168, 16, v236
v_and_b32 v169, 0xffff0000, v236
v_add_f32 v10, v10, v168
v_fmac_f32 v11, v168, v168
v_add_f32 v10, v10, v169
v_fmac_f32 v11, v169, v169
v_cvt_pk_bf16_f32 v237, v170, v171
v_lshlrev_b32 v170, 16, v237
v_and_b32 v171, 0xffff0000, v237
v_add_f32 v10, v10, v170
v_fmac_f32 v11, v170, v170
v_add_f32 v10, v10, v171
v_fmac_f32 v11, v171, v171
v_cvt_pk_bf16_f32 v238, v172, v173
v_lshlrev_b32 v172, 16, v238
v_and_b32 v173, 0xffff0000, v238
v_add_f32 v10, v10, v172
v_fmac_f32 v11, v172, v172
v_add_f32 v10, v10, v173
v_fmac_f32 v11, v173, v173
v_cvt_pk_bf16_f32 v239, v174, v175
v_lshlrev_b32 v174, 16, v239
v_and_b32 v175, 0xffff0000, v239
v_add_f32 v10, v10, v174
v_fmac_f32 v11, v174, v174
v_add_f32 v10, v10, v175
v_fmac_f32 v11, v175, v175
s_nop 0
v_permlane32_swap_b32 v8, v10
v_permlane32_swap_b32 v9, v11
v_add_f32 v8, v8, v10
v_add_f32 v9, v9, v11
ds_write_b64 v5, v[8:9]
v_mov_b32 v12, 163836
v_mov_b32 v13, 0
ds_write_b32 v12, v13
s_cmp_lg_u32 s20, 7
s_cbranch_scc1 .pw_1114
s_mov_b32 s63, 0
s_mov_b32 s60, 0x7f
s_mov_b32 s61, 0x0
v_lshlrev_b32 v255, 2, v0
v_mov_b32 v254, 0
s_mov_b64 exec, s[60:61]
buffer_atomic_or v254, v255, s[56:59], 0 offen sc0 sc1
s_mov_b64 exec, -1
.pw_1114:
buffer_store_dwordx4 v[208:211], v1, s[28:31], s23 offen offset:0 sc1
buffer_store_dwordx4 v[212:215], v1, s[28:31], s23 offen offset:1024 sc1
buffer_store_dwordx4 v[216:219], v1, s[28:31], s23 offen offset:2048 sc1
buffer_store_dwordx4 v[220:223], v1, s[28:31], s23 offen offset:3072 sc1
buffer_store_dwordx4 v[224:227], v2, s[28:31], s23 offen offset:0 sc1
buffer_store_dwordx4 v[228:231], v2, s[28:31], s23 offen offset:1024 sc1
buffer_store_dwordx4 v[232:235], v2, s[28:31], s23 offen offset:2048 sc1
buffer_store_dwordx4 v[236:239], v2, s[28:31], s23 offen offset:3072 sc1
s_waitcnt lgkmcnt(0)
s_barrier
ds_read_b128 v[16:19], v6 offset:0
ds_read_b128 v[20:23], v6 offset:16
ds_read_b128 v[24:27], v6 offset:32
ds_read_b128 v[28:31], v6 offset:48
s_waitcnt lgkmcnt(0)
v_add_f32 v8, v16, v18
v_add_f32 v9, v17, v19
v_add_f32 v8, v8, v20
v_add_f32 v9, v9, v21
v_add_f32 v8, v8, v22
v_add_f32 v9, v9, v23
v_add_f32 v8, v8, v24
v_add_f32 v9, v9, v25
v_add_f32 v8, v8, v26
v_add_f32 v9, v9, v27
v_add_f32 v8, v8, v28
v_add_f32 v9, v9, v29
v_add_f32 v8, v8, v30
v_add_f32 v9, v9, v31
v_mul_f32 v8, 0x3acccccd, v8
v_mul_f32 v9, 0x3acccccd, v9
v_fma_f32 v9, -v8, v8, v9
v_max_f32 v9, 0, v9
v_cvt_pk_bf16_f32 v7, v8, v9
v_lshlrev_b32 v12, 16, v7
v_and_b32 v9, 0xffff0000, v7
v_add_f32 v9, 0x3727c5ac, v9
v_cvt_pk_bf16_f32 v7, v9, v9
v_lshlrev_b32 v7, 16, v7
v_sqrt_f32 v7, v7
s_nop 0
v_cvt_pk_bf16_f32 v7, v7, v7
v_lshlrev_b32 v7, 16, v7
v_rcp_f32 v14, v7
s_nop 0
v_mul_f32 v12, v12, v14
v_mov_b32 v15, v14
v_mov_b32 v13, v12
s_nop 0
v_permlane32_swap_b32 v14, v15
v_permlane32_swap_b32 v12, v13
s_add_u32 s48, s18, 0
s_sub_u32 s48, s48, s43
s_cselect_b32 s49, 40960, 0
s_add_u32 s48, s48, s49
v_add_u32 v3, s48, v1
v_fma_f32 v112, v112, v14, -v12
v_fma_f32 v113, v113, v14, -v12
v_cvt_pk_bf16_f32 v112, v112, v113
v_fma_f32 v114, v114, v14, -v12
v_fma_f32 v115, v115, v14, -v12
v_cvt_pk_bf16_f32 v113, v114, v115
v_fma_f32 v116, v116, v14, -v12
v_fma_f32 v117, v117, v14, -v12
v_cvt_pk_bf16_f32 v114, v116, v117
v_fma_f32 v118, v118, v14, -v12
v_fma_f32 v119, v119, v14, -v12
v_cvt_pk_bf16_f32 v115, v118, v119
v_fma_f32 v120, v120, v14, -v12
v_fma_f32 v121, v121, v14, -v12
v_cvt_pk_bf16_f32 v116, v120, v121
v_fma_f32 v122, v122, v14, -v12
v_fma_f32 v123, v123, v14, -v12
v_cvt_pk_bf16_f32 v117, v122, v123
v_fma_f32 v124, v124, v14, -v12
v_fma_f32 v125, v125, v14, -v12
v_cvt_pk_bf16_f32 v118, v124, v125
v_fma_f32 v126, v126, v14, -v12
v_fma_f32 v127, v127, v14, -v12
v_cvt_pk_bf16_f32 v119, v126, v127
ds_write_b128 v3, v[112:115] offset:0
ds_write_b128 v3, v[116:119] offset:1024
s_add_u32 s48, s18, 2048
s_sub_u32 s48, s48, s43
s_cselect_b32 s49, 40960, 0
s_add_u32 s48, s48, s49
v_add_u32 v4, s48, v1
v_fma_f32 v144, v144, v14, -v12
v_fma_f32 v145, v145, v14, -v12
v_cvt_pk_bf16_f32 v144, v144, v145
v_fma_f32 v146, v146, v14, -v12
v_fma_f32 v147, v147, v14, -v12
v_cvt_pk_bf16_f32 v145, v146, v147
v_fma_f32 v148, v148, v14, -v12
v_fma_f32 v149, v149, v14, -v12
v_cvt_pk_bf16_f32 v146, v148, v149
v_fma_f32 v150, v150, v14, -v12
v_fma_f32 v151, v151, v14, -v12
v_cvt_pk_bf16_f32 v147, v150, v151
v_fma_f32 v152, v152, v14, -v12
v_fma_f32 v153, v153, v14, -v12
v_cvt_pk_bf16_f32 v148, v152, v153
v_fma_f32 v154, v154, v14, -v12
v_fma_f32 v155, v155, v14, -v12
v_cvt_pk_bf16_f32 v149, v154, v155
v_fma_f32 v156, v156, v14, -v12
v_fma_f32 v157, v157, v14, -v12
v_cvt_pk_bf16_f32 v150, v156, v157
v_fma_f32 v158, v158, v14, -v12
v_fma_f32 v159, v159, v14, -v12
v_cvt_pk_bf16_f32 v151, v158, v159
ds_write_b128 v4, v[144:147] offset:0
ds_write_b128 v4, v[148:151] offset:1024
s_add_u32 s48, s18, 0
s_sub_u32 s48, s48, s43
s_cselect_b32 s49, 40960, 0
s_add_u32 s48, s48, s49
v_add_u32 v3, s48, v2
v_fma_f32 v128, v128, v15, -v13
v_fma_f32 v129, v129, v15, -v13
v_cvt_pk_bf16_f32 v128, v128, v129
v_fma_f32 v130, v130, v15, -v13
v_fma_f32 v131, v131, v15, -v13
v_cvt_pk_bf16_f32 v129, v130, v131
v_fma_f32 v132, v132, v15, -v13
v_fma_f32 v133, v133, v15, -v13
v_cvt_pk_bf16_f32 v130, v132, v133
v_fma_f32 v134, v134, v15, -v13
v_fma_f32 v135, v135, v15, -v13
v_cvt_pk_bf16_f32 v131, v134, v135
v_fma_f32 v136, v136, v15, -v13
v_fma_f32 v137, v137, v15, -v13
v_cvt_pk_bf16_f32 v132, v136, v137
v_fma_f32 v138, v138, v15, -v13
v_fma_f32 v139, v139, v15, -v13
v_cvt_pk_bf16_f32 v133, v138, v139
v_fma_f32 v140, v140, v15, -v13
v_fma_f32 v141, v141, v15, -v13
v_cvt_pk_bf16_f32 v134, v140, v141
v_fma_f32 v142, v142, v15, -v13
v_fma_f32 v143, v143, v15, -v13
v_cvt_pk_bf16_f32 v135, v142, v143
ds_write_b128 v3, v[128:131] offset:0
ds_write_b128 v3, v[132:135] offset:1024
s_add_u32 s48, s18, 2048
s_sub_u32 s48, s48, s43
s_cselect_b32 s49, 40960, 0
s_add_u32 s48, s48, s49
v_add_u32 v4, s48, v2
v_fma_f32 v160, v160, v15, -v13
v_fma_f32 v161, v161, v15, -v13
v_cvt_pk_bf16_f32 v160, v160, v161
v_fma_f32 v162, v162, v15, -v13
v_fma_f32 v163, v163, v15, -v13
v_cvt_pk_bf16_f32 v161, v162, v163
v_fma_f32 v164, v164, v15, -v13
v_fma_f32 v165, v165, v15, -v13
v_cvt_pk_bf16_f32 v162, v164, v165
v_fma_f32 v166, v166, v15, -v13
v_fma_f32 v167, v167, v15, -v13
v_cvt_pk_bf16_f32 v163, v166, v167
v_fma_f32 v168, v168, v15, -v13
v_fma_f32 v169, v169, v15, -v13
v_cvt_pk_bf16_f32 v164, v168, v169
v_fma_f32 v170, v170, v15, -v13
v_fma_f32 v171, v171, v15, -v13
v_cvt_pk_bf16_f32 v165, v170, v171
v_fma_f32 v172, v172, v15, -v13
v_fma_f32 v173, v173, v15, -v13
v_cvt_pk_bf16_f32 v166, v172, v173
v_fma_f32 v174, v174, v15, -v13
v_fma_f32 v175, v175, v15, -v13
v_cvt_pk_bf16_f32 v167, v174, v175
ds_write_b128 v4, v[160:163] offset:0
ds_write_b128 v4, v[164:167] offset:1024
v_mov_b32 v8, 0xc0135761
v_mov_b32 v9, 0xbdd2d3e8
s_mul_i32 s40, s16, 221184
s_mul_i32 s41, s20, 14336
s_add_u32 s40, s40, s41
v_add_u32 v4, 110592, v1
v_mov_b32 v3, v1
s_waitcnt lgkmcnt(0)
s_waitcnt vmcnt(0)
s_cmp_lg_u32 s20, 7
s_cbranch_scc1 .pw_1115
v_or_b32 v254, s63, v254
v_cmp_ne_u32 vcc, -1, v254
s_and_b64 vcc, vcc, s[60:61]
s_cbranch_scc1 .pslow_1116
.pret_1117:
.pw_1115:
s_barrier
s_cmp_lg_u32 s20, 0
s_cbranch_scc1 .sig_1119
v_lshlrev_b32 v10, 12, v0
v_lshlrev_b32_e64 v11, s2, 1
buffer_atomic_or v11, v10, s[56:59], 0 offen offset:100 sc1
.sig_1119:
ds_read_b128 v[16:19], v1
ds_read_b128 v[20:23], v2
s_waitcnt lgkmcnt(0)
v_mfma_f32_32x32x16_bf16 v[112:127], v[32:35], v[16:19], 0
ds_read_b128 v[24:27], v1 offset:1024
v_mfma_f32_32x32x16_bf16 v[128:143], v[32:35], v[20:23], 0
ds_read_b128 v[28:31], v2 offset:1024
buffer_load_dwordx4 v[32:35], v1, s[8:11], s21 offen offset:0
v_mfma_f32_32x32x16_bf16 v[144:159], v[36:39], v[16:19], 0
v_mfma_f32_32x32x16_bf16 v[160:175], v[36:39], v[20:23], 0
buffer_load_dwordx4 v[36:39], v1, s[8:11], s21 offen offset:1024
v_mfma_f32_32x32x16_bf16 v[176:191], v[40:43], v[16:19], 0
v_mfma_f32_32x32x16_bf16 v[192:207], v[40:43], v[20:23], 0
buffer_load_dwordx4 v[40:43], v1, s[8:11], s21 offen offset:2048
v_mfma_f32_32x32x16_bf16 v[208:223], v[44:47], v[16:19], 0
v_mfma_f32_32x32x16_bf16 v[224:239], v[44:47], v[20:23], 0
buffer_load_dwordx4 v[44:47], v1, s[8:11], s21 offen offset:3072
s_add_u32 s21, s21, 55296
s_waitcnt lgkmcnt(0)
v_mfma_f32_32x32x16_bf16 v[112:127], v[48:51], v[24:27], v[112:127]
ds_read_b128 v[16:19], v1 offset:2048
v_mfma_f32_32x32x16_bf16 v[128:143], v[48:51], v[28:31], v[128:143]
ds_read_b128 v[20:23], v2 offset:2048
buffer_load_dwordx4 v[48:51], v1, s[8:11], s21 offen offset:0
v_mfma_f32_32x32x16_bf16 v[144:159], v[52:55], v[24:27], v[144:159]
v_mfma_f32_32x32x16_bf16 v[160:175], v[52:55], v[28:31], v[160:175]
buffer_load_dwordx4 v[52:55], v1, s[8:11], s21 offen offset:1024
v_mfma_f32_32x32x16_bf16 v[176:191], v[56:59], v[24:27], v[176:191]
v_mfma_f32_32x32x16_bf16 v[192:207], v[56:59], v[28:31], v[192:207]
buffer_load_dwordx4 v[56:59], v1, s[8:11], s21 offen offset:2048
v_mfma_f32_32x32x16_bf16 v[208:223], v[60:63], v[24:27], v[208:223]
v_mfma_f32_32x32x16_bf16 v[224:239], v[60:63], v[28:31], v[224:239]
buffer_load_dwordx4 v[60:63], v1, s[8:11], s21 offen offset:3072
s_add_u32 s21, s21, 55296
s_waitcnt lgkmcnt(0)
v_mfma_f32_32x32x16_bf16 v[112:127], v[64:67], v[16:19], v[112:127]
ds_read_b128 v[24:27], v1 offset:3072
v_mfma_f32_32x32x16_bf16 v[128:143], v[64:67], v[20:23], v[128:143]
ds_read_b128 v[28:31], v2 offset:3072
buffer_load_dwordx4 v[64:67], v1, s[8:11], s21 offen offset:0
v_mfma_f32_32x32x16_bf16 v[144:159], v[68:71], v[16:19], v[144:159]
v_mfma_f32_32x32x16_bf16 v[160:175], v[68:71], v[20:23], v[160:175]
buffer_load_dwordx4 v[68:71], v1, s[8:11], s21 offen offset:1024
v_mfma_f32_32x32x16_bf16 v[176:191], v[72:75], v[16:19], v[176:191]
v_mfma_f32_32x32x16_bf16 v[192:207], v[72:75], v[20:23], v[192:207]
buffer_load_dwordx4 v[72:75], v1, s[8:11], s21 offen offset:2048
v_mfma_f32_32x32x16_bf16 v[208:223], v[76:79], v[16:19], v[208:223]
v_mfma_f32_32x32x16_bf16 v[224:239], v[76:79], v[20:23], v[224:239]
buffer_load_dwordx4 v[76:79], v1, s[8:11], s21 offen offset:3072
s_add_u32 s21, s21, 55296
s_waitcnt lgkmcnt(0)
v_mfma_f32_32x32x16_bf16 v[112:127], v[80:83], v[24:27], v[112:127]
ds_read_b128 v[16:19], v1 offset:4096
v_mfma_f32_32x32x16_bf16 v[128:143], v[80:83], v[28:31], v[128:143]
ds_read_b128 v[20:23], v2 offset:4096
buffer_load_dwordx4 v[80:83], v1, s[8:11], s21 offen offset:0
v_mfma_f32_32x32x16_bf16 v[144:159], v[84:87], v[24:27], v[144:159]
v_mfma_f32_32x32x16_bf16 v[160:175], v[84:87], v[28:31], v[160:175]
buffer_load_dwordx4 v[84:87], v1, s[8:11], s21 offen offset:1024
v_mfma_f32_32x32x16_bf16 v[176:191], v[88:91], v[24:27], v[176:191]
v_mfma_f32_32x32x16_bf16 v[192:207], v[88:91], v[28:31], v[192:207]
buffer_load_dwordx4 v[88:91], v1, s[8:11], s21 offen offset:2048
v_mfma_f32_32x32x16_bf16 v[208:223], v[92:95], v[24:27], v[208:223]
v_mfma_f32_32x32x16_bf16 v[224:239], v[92:95], v[28:31], v[224:239]
buffer_load_dwordx4 v[92:95], v1, s[8:11], s21 offen offset:3072
s_add_u32 s21, s21, 55296
s_waitcnt lgkmcnt(0)
v_mfma_f32_32x32x16_bf16 v[112:127], v[96:99], v[16:19], v[112:127]
ds_read_b128 v[24:27], v1 offset:5120
v_mfma_f32_32x32x16_bf16 v[128:143], v[96:99], v[20:23], v[128:143]
ds_read_b128 v[28:31], v2 offset:5120
buffer_load_dwordx4 v[96:99], v1, s[8:11], s21 offen offset:0
v_mfma_f32_32x32x16_bf16 v[144:159], v[100:103], v[16:19], v[144:159]
v_mfma_f32_32x32x16_bf16 v[160:175], v[100:103], v[20:23], v[160:175]
buffer_load_dwordx4 v[100:103], v1, s[8:11], s21 offen offset:1024
v_mfma_f32_32x32x16_bf16 v[176:191], v[104:107], v[16:19], v[176:191]
v_mfma_f32_32x32x16_bf16 v[192:207], v[104:107], v[20:23], v[192:207]
buffer_load_dwordx4 v[104:107], v1, s[8:11], s21 offen offset:2048
v_mfma_f32_32x32x16_bf16 v[208:223], v[108:111], v[16:19], v[208:223]
v_mfma_f32_32x32x16_bf16 v[224:239], v[108:111], v[20:23], v[224:239]
buffer_load_dwordx4 v[108:111], v1, s[8:11], s21 offen offset:3072
s_add_u32 s21, s21, 55296
s_cmp_ge_u32 s21, s47
s_cselect_b32 s45, 2211840, 0
s_sub_u32 s21, s21, s45
s_waitcnt vmcnt(19)
s_waitcnt lgkmcnt(0)
v_mfma_f32_32x32x16_bf16 v[112:127], v[32:35], v[24:27], v[112:127]
ds_read_b128 v[16:19], v1 offset:6144
v_mfma_f32_32x32x16_bf16 v[128:143], v[32:35], v[28:31], v[128:143]
ds_read_b128 v[20:23], v2 offset:6144
buffer_load_dwordx4 v[32:35], v1, s[8:11], s21 offen offset:0
s_waitcnt vmcnt(19)
v_mfma_f32_32x32x16_bf16 v[144:159], v[36:39], v[24:27], v[144:159]
v_mfma_f32_32x32x16_bf16 v[160:175], v[36:39], v[28:31], v[160:175]
buffer_load_dwordx4 v[36:39], v1, s[8:11], s21 offen offset:1024
s_waitcnt vmcnt(19)
v_mfma_f32_32x32x16_bf16 v[176:191], v[40:43], v[24:27], v[176:191]
v_mfma_f32_32x32x16_bf16 v[192:207], v[40:43], v[28:31], v[192:207]
buffer_load_dwordx4 v[40:43], v1, s[8:11], s21 offen offset:2048
s_waitcnt vmcnt(19)
v_mfma_f32_32x32x16_bf16 v[208:223], v[44:47], v[24:27], v[208:223]
v_mfma_f32_32x32x16_bf16 v[224:239], v[44:47], v[28:31], v[224:239]
buffer_load_dwordx4 v[44:47], v1, s[8:11], s21 offen offset:3072
s_add_u32 s21, s21, 55296
s_waitcnt vmcnt(19)
s_waitcnt lgkmcnt(0)
v_mfma_f32_32x32x16_bf16 v[112:127], v[48:51], v[16:19], v[112:127]
ds_read_b128 v[24:27], v1 offset:7168
v_mfma_f32_32x32x16_bf16 v[128:143], v[48:51], v[20:23], v[128:143]
ds_read_b128 v[28:31], v2 offset:7168
buffer_load_dwordx4 v[48:51], v1, s[8:11], s21 offen offset:0
s_waitcnt vmcnt(19)
v_mfma_f32_32x32x16_bf16 v[144:159], v[52:55], v[16:19], v[144:159]
v_mfma_f32_32x32x16_bf16 v[160:175], v[52:55], v[20:23], v[160:175]
buffer_load_dwordx4 v[52:55], v1, s[8:11], s21 offen offset:1024
s_waitcnt vmcnt(19)
v_mfma_f32_32x32x16_bf16 v[176:191], v[56:59], v[16:19], v[176:191]
v_mfma_f32_32x32x16_bf16 v[192:207], v[56:59], v[20:23], v[192:207]
buffer_load_dwordx4 v[56:59], v1, s[8:11], s21 offen offset:2048
s_waitcnt vmcnt(19)
v_mfma_f32_32x32x16_bf16 v[208:223], v[60:63], v[16:19], v[208:223]
v_mfma_f32_32x32x16_bf16 v[224:239], v[60:63], v[20:23], v[224:239]
buffer_load_dwordx4 v[60:63], v1, s[8:11], s21 offen offset:3072
s_add_u32 s21, s21, 55296
s_waitcnt vmcnt(19)
s_waitcnt lgkmcnt(0)
v_mfma_f32_32x32x16_bf16 v[112:127], v[64:67], v[24:27], v[112:127]
ds_read_b128 v[16:19], v1 offset:8192
v_mfma_f32_32x32x16_bf16 v[128:143], v[64:67], v[28:31], v[128:143]
ds_read_b128 v[20:23], v2 offset:8192
buffer_load_dwordx4 v[64:67], v1, s[8:11], s21 offen offset:0
s_waitcnt vmcnt(19)
v_mfma_f32_32x32x16_bf16 v[144:159], v[68:71], v[24:27], v[144:159]
v_mfma_f32_32x32x16_bf16 v[160:175], v[68:71], v[28:31], v[160:175]
buffer_load_dwordx4 v[68:71], v1, s[8:11], s21 offen offset:1024
s_waitcnt vmcnt(19)
v_mfma_f32_32x32x16_bf16 v[176:191], v[72:75], v[24:27], v[176:191]
v_mfma_f32_32x32x16_bf16 v[192:207], v[72:75], v[28:31], v[192:207]
buffer_load_dwordx4 v[72:75], v1, s[8:11], s21 offen offset:2048
s_waitcnt vmcnt(19)
v_mfma_f32_32x32x16_bf16 v[208:223], v[76:79], v[24:27], v[208:223]
v_mfma_f32_32x32x16_bf16 v[224:239], v[76:79], v[28:31], v[224:239]
buffer_load_dwordx4 v[76:79], v1, s[8:11], s21 offen offset:3072
s_add_u32 s21, s21, 55296
s_waitcnt vmcnt(19)
s_waitcnt lgkmcnt(0)
v_mfma_f32_32x32x16_bf16 v[112:127], v[80:83], v[16:19], v[112:127]
ds_read_b128 v[24:27], v1 offset:9216
v_mfma_f32_32x32x16_bf16 v[128:143], v[80:83], v[20:23], v[128:143]
ds_read_b128 v[28:31], v2 offset:9216
buffer_load_dwordx4 v[80:83], v1, s[8:11], s21 offen offset:0
s_waitcnt vmcnt(19)
v_mfma_f32_32x32x16_bf16 v[144:159], v[84:87], v[16:19], v[144:159]
v_mfma_f32_32x32x16_bf16 v[160:175], v[84:87], v[20:23], v[160:175]
buffer_load_dwordx4 v[84:87], v1, s[8:11], s21 offen offset:1024
s_waitcnt vmcnt(19)
v_mfma_f32_32x32x16_bf16 v[176:191], v[88:91], v[16:19], v[176:191]
v_mfma_f32_32x32x16_bf16 v[192:207], v[88:91], v[20:23], v[192:207]
buffer_load_dwordx4 v[88:91], v1, s[8:11], s21 offen offset:2048
s_waitcnt vmcnt(19)
v_mfma_f32_32x32x16_bf16 v[208:223], v[92:95], v[16:19], v[208:223]
v_mfma_f32_32x32x16_bf16 v[224:239], v[92:95], v[20:23], v[224:239]
buffer_load_dwordx4 v[92:95], v1, s[8:11], s21 offen offset:3072
s_add_u32 s21, s21, 55296
s_waitcnt vmcnt(19)
s_waitcnt lgkmcnt(0)
v_mfma_f32_32x32x16_bf16 v[112:127], v[96:99], v[24:27], v[112:127]
ds_read_b128 v[16:19], v1 offset:10240
v_mfma_f32_32x32x16_bf16 v[128:143], v[96:99], v[28:31], v[128:143]
ds_read_b128 v[20:23], v2 offset:10240
buffer_load_dwordx4 v[96:99], v1, s[8:11], s21 offen offset:0
s_waitcnt vmcnt(19)
v_mfma_f32_32x32x16_bf16 v[144:159], v[100:103], v[24:27], v[144:159]
v_mfma_f32_32x32x16_bf16 v[160:175], v[100:103], v[28:31], v[160:175]
buffer_load_dwordx4 v[100:103], v1, s[8:11], s21 offen offset:1024
s_waitcnt vmcnt(19)
v_mfma_f32_32x32x16_bf16 v[176:191], v[104:107], v[24:27], v[176:191]
v_mfma_f32_32x32x16_bf16 v[192:207], v[104:107], v[28:31], v[192:207]
buffer_load_dwordx4 v[104:107], v1, s[8:11], s21 offen offset:2048
s_waitcnt vmcnt(19)
v_mfma_f32_32x32x16_bf16 v[208:223], v[108:111], v[24:27], v[208:223]
v_mfma_f32_32x32x16_bf16 v[224:239], v[108:111], v[28:31], v[224:239]
buffer_load_dwordx4 v[108:111], v1, s[8:11], s21 offen offset:3072
s_add_u32 s21, s21, 55296
s_waitcnt vmcnt(19)
s_waitcnt lgkmcnt(0)
v_mfma_f32_32x32x16_bf16 v[112:127], v[32:35], v[16:19], v[112:127]
ds_read_b128 v[24:27], v1 offset:11264
v_mfma_f32_32x32x16_bf16 v[128:143], v[32:35], v[20:23], v[128:143]
ds_read_b128 v[28:31], v2 offset:11264
buffer_load_dwordx4 v[32:35], v1, s[8:11], s21 offen offset:0
s_waitcnt vmcnt(19)
v_mfma_f32_32x32x16_bf16 v[144:159], v[36:39], v[16:19], v[144:159]
v_mfma_f32_32x32x16_bf16 v[160:175], v[36:39], v[20:23], v[160:175]
buffer_load_dwordx4 v[36:39], v1, s[8:11], s21 offen offset:1024
s_waitcnt vmcnt(19)
v_mfma_f32_32x32x16_bf16 v[176:191], v[40:43], v[16:19], v[176:191]
v_mfma_f32_32x32x16_bf16 v[192:207], v[40:43], v[20:23], v[192:207]
buffer_load_dwordx4 v[40:43], v1, s[8:11], s21 offen offset:2048
s_waitcnt vmcnt(19)
v_mfma_f32_32x32x16_bf16 v[208:223], v[44:47], v[16:19], v[208:223]
v_mfma_f32_32x32x16_bf16 v[224:239], v[44:47], v[20:23], v[224:239]
buffer_load_dwordx4 v[44:47], v1, s[8:11], s21 offen offset:3072
s_add_u32 s21, s21, 55296
s_waitcnt vmcnt(19)
s_waitcnt lgkmcnt(0)
v_mfma_f32_32x32x16_bf16 v[112:127], v[48:51], v[24:27], v[112:127]
ds_read_b128 v[16:19], v1 offset:12288
v_mfma_f32_32x32x16_bf16 v[128:143], v[48:51], v[28:31], v[128:143]
ds_read_b128 v[20:23], v2 offset:12288
buffer_load_dwordx4 v[48:51], v1, s[8:11], s21 offen offset:0
s_waitcnt vmcnt(19)
v_mfma_f32_32x32x16_bf16 v[144:159], v[52:55], v[24:27], v[144:159]
v_mfma_f32_32x32x16_bf16 v[160:175], v[52:55], v[28:31], v[160:175]
buffer_load_dwordx4 v[52:55], v1, s[8:11], s21 offen offset:1024
s_waitcnt vmcnt(19)
v_mfma_f32_32x32x16_bf16 v[176:191], v[56:59], v[24:27], v[176:191]
v_mfma_f32_32x32x16_bf16 v[192:207], v[56:59], v[28:31], v[192:207]
buffer_load_dwordx4 v[56:59], v1, s[8:11], s21 offen offset:2048
s_waitcnt vmcnt(19)
v_mfma_f32_32x32x16_bf16 v[208:223], v[60:63], v[24:27], v[208:223]
v_mfma_f32_32x32x16_bf16 v[224:239], v[60:63], v[28:31], v[224:239]
buffer_load_dwordx4 v[60:63], v1, s[8:11], s21 offen offset:3072
s_add_u32 s21, s21, 55296
s_waitcnt vmcnt(19)
s_waitcnt lgkmcnt(0)
v_mfma_f32_32x32x16_bf16 v[112:127], v[64:67], v[16:19], v[112:127]
ds_read_b128 v[24:27], v1 offset:13312
v_mfma_f32_32x32x16_bf16 v[128:143], v[64:67], v[20:23], v[128:143]
ds_read_b128 v[28:31], v2 offset:13312
buffer_load_dwordx4 v[64:67], v1, s[8:11], s21 offen offset:0
s_waitcnt vmcnt(19)
v_mfma_f32_32x32x16_bf16 v[144:159], v[68:71], v[16:19], v[144:159]
v_mfma_f32_32x32x16_bf16 v[160:175], v[68:71], v[20:23], v[160:175]
buffer_load_dwordx4 v[68:71], v1, s[8:11], s21 offen offset:1024
s_waitcnt vmcnt(19)
v_mfma_f32_32x32x16_bf16 v[176:191], v[72:75], v[16:19], v[176:191]
v_mfma_f32_32x32x16_bf16 v[192:207], v[72:75], v[20:23], v[192:207]
buffer_load_dwordx4 v[72:75], v1, s[8:11], s21 offen offset:2048
s_waitcnt vmcnt(19)
v_mfma_f32_32x32x16_bf16 v[208:223], v[76:79], v[16:19], v[208:223]
v_mfma_f32_32x32x16_bf16 v[224:239], v[76:79], v[20:23], v[224:239]
buffer_load_dwordx4 v[76:79], v1, s[8:11], s21 offen offset:3072
s_add_u32 s21, s21, 55296
s_waitcnt vmcnt(19)
s_waitcnt lgkmcnt(0)
v_mfma_f32_32x32x16_bf16 v[112:127], v[80:83], v[24:27], v[112:127]
ds_read_b128 v[16:19], v1 offset:14336
v_mfma_f32_32x32x16_bf16 v[128:143], v[80:83], v[28:31], v[128:143]
ds_read_b128 v[20:23], v2 offset:14336
buffer_load_dwordx4 v[80:83], v1, s[8:11], s21 offen offset:0
s_waitcnt vmcnt(19)
v_mfma_f32_32x32x16_bf16 v[144:159], v[84:87], v[24:27], v[144:159]
v_mfma_f32_32x32x16_bf16 v[160:175], v[84:87], v[28:31], v[160:175]
buffer_load_dwordx4 v[84:87], v1, s[8:11], s21 offen offset:1024
s_waitcnt vmcnt(19)
v_mfma_f32_32x32x16_bf16 v[176:191], v[88:91], v[24:27], v[176:191]
v_mfma_f32_32x32x16_bf16 v[192:207], v[88:91], v[28:31], v[192:207]
buffer_load_dwordx4 v[88:91], v1, s[8:11], s21 offen offset:2048
s_waitcnt vmcnt(19)
v_mfma_f32_32x32x16_bf16 v[208:223], v[92:95], v[24:27], v[208:223]
v_mfma_f32_32x32x16_bf16 v[224:239], v[92:95], v[28:31], v[224:239]
buffer_load_dwordx4 v[92:95], v1, s[8:11], s21 offen offset:3072
s_add_u32 s21, s21, 55296
s_waitcnt vmcnt(19)
s_waitcnt lgkmcnt(0)
v_mfma_f32_32x32x16_bf16 v[112:127], v[96:99], v[16:19], v[112:127]
ds_read_b128 v[24:27], v1 offset:15360
v_mfma_f32_32x32x16_bf16 v[128:143], v[96:99], v[20:23], v[128:143]
ds_read_b128 v[28:31], v2 offset:15360
buffer_load_dwordx4 v[96:99], v1, s[8:11], s21 offen offset:0
s_waitcnt vmcnt(19)
v_mfma_f32_32x32x16_bf16 v[144:159], v[100:103], v[16:19], v[144:159]
v_mfma_f32_32x32x16_bf16 v[160:175], v[100:103], v[20:23], v[160:175]
buffer_load_dwordx4 v[100:103], v1, s[8:11], s21 offen offset:1024
s_waitcnt vmcnt(19)
v_mfma_f32_32x32x16_bf16 v[176:191], v[104:107], v[16:19], v[176:191]
v_mfma_f32_32x32x16_bf16 v[192:207], v[104:107], v[20:23], v[192:207]
buffer_load_dwordx4 v[104:107], v1, s[8:11], s21 offen offset:2048
s_waitcnt vmcnt(19)
v_mfma_f32_32x32x16_bf16 v[208:223], v[108:111], v[16:19], v[208:223]
v_mfma_f32_32x32x16_bf16 v[224:239], v[108:111], v[20:23], v[224:239]
buffer_load_dwordx4 v[108:111], v1, s[8:11], s21 offen offset:3072
s_add_u32 s21, s21, 55296
s_cmp_ge_u32 s21, s47
s_cselect_b32 s45, 2211840, 0
s_sub_u32 s21, s21, s45
s_waitcnt vmcnt(19)
s_waitcnt lgkmcnt(0)
v_mfma_f32_32x32x16_bf16 v[112:127], v[32:35], v[24:27], v[112:127]
ds_read_b128 v[16:19], v1 offset:16384
v_mfma_f32_32x32x16_bf16 v[128:143], v[32:35], v[28:31], v[128:143]
ds_read_b128 v[20:23], v2 offset:16384
buffer_load_dwordx4 v[32:35], v1, s[8:11], s21 offen offset:0
s_waitcnt vmcnt(19)
v_mfma_f32_32x32x16_bf16 v[144:159], v[36:39], v[24:27], v[144:159]
v_mfma_f32_32x32x16_bf16 v[160:175], v[36:39], v[28:31], v[160:175]
buffer_load_dwordx4 v[36:39], v1, s[8:11], s21 offen offset:1024
s_waitcnt vmcnt(19)
v_mfma_f32_32x32x16_bf16 v[176:191], v[40:43], v[24:27], v[176:191]
v_mfma_f32_32x32x16_bf16 v[192:207], v[40:43], v[28:31], v[192:207]
buffer_load_dwordx4 v[40:43], v1, s[8:11], s21 offen offset:2048
s_waitcnt vmcnt(19)
v_mfma_f32_32x32x16_bf16 v[208:223], v[44:47], v[24:27], v[208:223]
v_mfma_f32_32x32x16_bf16 v[224:239], v[44:47], v[28:31], v[224:239]
buffer_load_dwordx4 v[44:47], v1, s[8:11], s21 offen offset:3072
s_add_u32 s21, s21, 55296
s_waitcnt vmcnt(19)
s_waitcnt lgkmcnt(0)
v_mfma_f32_32x32x16_bf16 v[112:127], v[48:51], v[16:19], v[112:127]
ds_read_b128 v[24:27], v1 offset:17408
v_mfma_f32_32x32x16_bf16 v[128:143], v[48:51], v[20:23], v[128:143]
ds_read_b128 v[28:31], v2 offset:17408
buffer_load_dwordx4 v[48:51], v1, s[8:11], s21 offen offset:0
s_waitcnt vmcnt(19)
v_mfma_f32_32x32x16_bf16 v[144:159], v[52:55], v[16:19], v[144:159]
v_mfma_f32_32x32x16_bf16 v[160:175], v[52:55], v[20:23], v[160:175]
buffer_load_dwordx4 v[52:55], v1, s[8:11], s21 offen offset:1024
s_waitcnt vmcnt(19)
v_mfma_f32_32x32x16_bf16 v[176:191], v[56:59], v[16:19], v[176:191]
v_mfma_f32_32x32x16_bf16 v[192:207], v[56:59], v[20:23], v[192:207]
buffer_load_dwordx4 v[56:59], v1, s[8:11], s21 offen offset:2048
s_waitcnt vmcnt(19)
v_mfma_f32_32x32x16_bf16 v[208:223], v[60:63], v[16:19], v[208:223]
v_mfma_f32_32x32x16_bf16 v[224:239], v[60:63], v[20:23], v[224:239]
buffer_load_dwordx4 v[60:63], v1, s[8:11], s21 offen offset:3072
s_add_u32 s21, s21, 55296
s_waitcnt vmcnt(19)
s_waitcnt lgkmcnt(0)
v_mfma_f32_32x32x16_bf16 v[112:127], v[64:67], v[24:27], v[112:127]
ds_read_b128 v[16:19], v1 offset:18432
v_mfma_f32_32x32x16_bf16 v[128:143], v[64:67], v[28:31], v[128:143]
ds_read_b128 v[20:23], v2 offset:18432
buffer_load_dwordx4 v[64:67], v1, s[8:11], s21 offen offset:0
s_waitcnt vmcnt(19)
v_mfma_f32_32x32x16_bf16 v[144:159], v[68:71], v[24:27], v[144:159]
v_mfma_f32_32x32x16_bf16 v[160:175], v[68:71], v[28:31], v[160:175]
buffer_load_dwordx4 v[68:71], v1, s[8:11], s21 offen offset:1024
s_waitcnt vmcnt(19)
v_mfma_f32_32x32x16_bf16 v[176:191], v[72:75], v[24:27], v[176:191]
v_mfma_f32_32x32x16_bf16 v[192:207], v[72:75], v[28:31], v[192:207]
buffer_load_dwordx4 v[72:75], v1, s[8:11], s21 offen offset:2048
s_waitcnt vmcnt(19)
v_mfma_f32_32x32x16_bf16 v[208:223], v[76:79], v[24:27], v[208:223]
v_mfma_f32_32x32x16_bf16 v[224:239], v[76:79], v[28:31], v[224:239]
buffer_load_dwordx4 v[76:79], v1, s[8:11], s21 offen offset:3072
s_add_u32 s21, s21, 55296
s_waitcnt vmcnt(19)
s_waitcnt lgkmcnt(0)
v_mfma_f32_32x32x16_bf16 v[112:127], v[80:83], v[16:19], v[112:127]
ds_read_b128 v[24:27], v1 offset:19456
v_mfma_f32_32x32x16_bf16 v[128:143], v[80:83], v[20:23], v[128:143]
ds_read_b128 v[28:31], v2 offset:19456
buffer_load_dwordx4 v[80:83], v1, s[8:11], s21 offen offset:0
s_waitcnt vmcnt(19)
v_mfma_f32_32x32x16_bf16 v[144:159], v[84:87], v[16:19], v[144:159]
v_mfma_f32_32x32x16_bf16 v[160:175], v[84:87], v[20:23], v[160:175]
buffer_load_dwordx4 v[84:87], v1, s[8:11], s21 offen offset:1024
s_waitcnt vmcnt(19)
v_mfma_f32_32x32x16_bf16 v[176:191], v[88:91], v[16:19], v[176:191]
v_mfma_f32_32x32x16_bf16 v[192:207], v[88:91], v[20:23], v[192:207]
buffer_load_dwordx4 v[88:91], v1, s[8:11], s21 offen offset:2048
s_waitcnt vmcnt(19)
v_mfma_f32_32x32x16_bf16 v[208:223], v[92:95], v[16:19], v[208:223]
v_mfma_f32_32x32x16_bf16 v[224:239], v[92:95], v[20:23], v[224:239]
buffer_load_dwordx4 v[92:95], v1, s[8:11], s21 offen offset:3072
s_add_u32 s21, s21, 55296
s_waitcnt vmcnt(19)
s_waitcnt lgkmcnt(0)
v_mfma_f32_32x32x16_bf16 v[112:127], v[96:99], v[24:27], v[112:127]
ds_read_b128 v[16:19], v1 offset:20480
v_mfma_f32_32x32x16_bf16 v[128:143], v[96:99], v[28:31], v[128:143]
ds_read_b128 v[20:23], v2 offset:20480
buffer_load_dwordx4 v[96:99], v1, s[8:11], s21 offen offset:0
s_waitcnt vmcnt(19)
v_mfma_f32_32x32x16_bf16 v[144:159], v[100:103], v[24:27], v[144:159]
v_mfma_f32_32x32x16_bf16 v[160:175], v[100:103], v[28:31], v[160:175]
buffer_load_dwordx4 v[100:103], v1, s[8:11], s21 offen offset:1024
s_waitcnt vmcnt(19)
v_mfma_f32_32x32x16_bf16 v[176:191], v[104:107], v[24:27], v[176:191]
v_mfma_f32_32x32x16_bf16 v[192:207], v[104:107], v[28:31], v[192:207]
buffer_load_dwordx4 v[104:107], v1, s[8:11], s21 offen offset:2048
s_waitcnt vmcnt(19)
v_mfma_f32_32x32x16_bf16 v[208:223], v[108:111], v[24:27], v[208:223]
v_mfma_f32_32x32x16_bf16 v[224:239], v[108:111], v[28:31], v[224:239]
buffer_load_dwordx4 v[108:111], v1, s[8:11], s21 offen offset:3072
s_add_u32 s21, s21, 55296
s_waitcnt vmcnt(19)
s_waitcnt lgkmcnt(0)
v_mfma_f32_32x32x16_bf16 v[112:127], v[32:35], v[16:19], v[112:127]
ds_read_b128 v[24:27], v1 offset:21504
v_mfma_f32_32x32x16_bf16 v[128:143], v[32:35], v[20:23], v[128:143]
ds_read_b128 v[28:31], v2 offset:21504
buffer_load_dwordx4 v[32:35], v1, s[8:11], s21 offen offset:0
s_waitcnt vmcnt(19)
v_mfma_f32_32x32x16_bf16 v[144:159], v[36:39], v[16:19], v[144:159]
v_mfma_f32_32x32x16_bf16 v[160:175], v[36:39], v[20:23], v[160:175]
buffer_load_dwordx4 v[36:39], v1, s[8:11], s21 offen offset:1024
s_waitcnt vmcnt(19)
v_mfma_f32_32x32x16_bf16 v[176:191], v[40:43], v[16:19], v[176:191]
v_mfma_f32_32x32x16_bf16 v[192:207], v[40:43], v[20:23], v[192:207]
buffer_load_dwordx4 v[40:43], v1, s[8:11], s21 offen offset:2048
s_waitcnt vmcnt(19)
v_mfma_f32_32x32x16_bf16 v[208:223], v[44:47], v[16:19], v[208:223]
v_mfma_f32_32x32x16_bf16 v[224:239], v[44:47], v[20:23], v[224:239]
buffer_load_dwordx4 v[44:47], v1, s[8:11], s21 offen offset:3072
s_add_u32 s21, s21, 55296
s_waitcnt vmcnt(19)
s_waitcnt lgkmcnt(0)
v_mfma_f32_32x32x16_bf16 v[112:127], v[48:51], v[24:27], v[112:127]
ds_read_b128 v[16:19], v1 offset:22528
v_mfma_f32_32x32x16_bf16 v[128:143], v[48:51], v[28:31], v[128:143]
ds_read_b128 v[20:23], v2 offset:22528
buffer_load_dwordx4 v[48:51], v1, s[8:11], s21 offen offset:0
s_waitcnt vmcnt(19)
v_mfma_f32_32x32x16_bf16 v[144:159], v[52:55], v[24:27], v[144:159]
v_mfma_f32_32x32x16_bf16 v[160:175], v[52:55], v[28:31], v[160:175]
buffer_load_dwordx4 v[52:55], v1, s[8:11], s21 offen offset:1024
s_waitcnt vmcnt(19)
v_mfma_f32_32x32x16_bf16 v[176:191], v[56:59], v[24:27], v[176:191]
v_mfma_f32_32x32x16_bf16 v[192:207], v[56:59], v[28:31], v[192:207]
buffer_load_dwordx4 v[56:59], v1, s[8:11], s21 offen offset:2048
s_waitcnt vmcnt(19)
v_mfma_f32_32x32x16_bf16 v[208:223], v[60:63], v[24:27], v[208:223]
v_mfma_f32_32x32x16_bf16 v[224:239], v[60:63], v[28:31], v[224:239]
buffer_load_dwordx4 v[60:63], v1, s[8:11], s21 offen offset:3072
s_add_u32 s21, s21, 55296
s_waitcnt vmcnt(19)
s_waitcnt lgkmcnt(0)
v_mfma_f32_32x32x16_bf16 v[112:127], v[64:67], v[16:19], v[112:127]
ds_read_b128 v[24:27], v1 offset:23552
v_mfma_f32_32x32x16_bf16 v[128:143], v[64:67], v[20:23], v[128:143]
ds_read_b128 v[28:31], v2 offset:23552
buffer_load_dwordx4 v[64:67], v1, s[8:11], s21 offen offset:0
s_waitcnt vmcnt(19)
v_mfma_f32_32x32x16_bf16 v[144:159], v[68:71], v[16:19], v[144:159]
v_mfma_f32_32x32x16_bf16 v[160:175], v[68:71], v[20:23], v[160:175]
buffer_load_dwordx4 v[68:71], v1, s[8:11], s21 offen offset:1024
s_waitcnt vmcnt(19)
v_mfma_f32_32x32x16_bf16 v[176:191], v[72:75], v[16:19], v[176:191]
v_mfma_f32_32x32x16_bf16 v[192:207], v[72:75], v[20:23], v[192:207]
buffer_load_dwordx4 v[72:75], v1, s[8:11], s21 offen offset:2048
s_waitcnt vmcnt(19)
v_mfma_f32_32x32x16_bf16 v[208:223], v[76:79], v[16:19], v[208:223]
v_mfma_f32_32x32x16_bf16 v[224:239], v[76:79], v[20:23], v[224:239]
buffer_load_dwordx4 v[76:79], v1, s[8:11], s21 offen offset:3072
s_add_u32 s21, s21, 55296
s_waitcnt vmcnt(19)
s_waitcnt lgkmcnt(0)
v_mfma_f32_32x32x16_bf16 v[112:127], v[80:83], v[24:27], v[112:127]
ds_read_b128 v[16:19], v1 offset:24576
v_mfma_f32_32x32x16_bf16 v[128:143], v[80:83], v[28:31], v[128:143]
ds_read_b128 v[20:23], v2 offset:24576
buffer_load_dwordx4 v[80:83], v1, s[8:11], s21 offen offset:0
s_waitcnt vmcnt(19)
v_mfma_f32_32x32x16_bf16 v[144:159], v[84:87], v[24:27], v[144:159]
v_mfma_f32_32x32x16_bf16 v[160:175], v[84:87], v[28:31], v[160:175]
buffer_load_dwordx4 v[84:87], v1, s[8:11], s21 offen offset:1024
s_waitcnt vmcnt(19)
v_mfma_f32_32x32x16_bf16 v[176:191], v[88:91], v[24:27], v[176:191]
v_mfma_f32_32x32x16_bf16 v[192:207], v[88:91], v[28:31], v[192:207]
buffer_load_dwordx4 v[88:91], v1, s[8:11], s21 offen offset:2048
s_waitcnt vmcnt(19)
v_mfma_f32_32x32x16_bf16 v[208:223], v[92:95], v[24:27], v[208:223]
v_mfma_f32_32x32x16_bf16 v[224:239], v[92:95], v[28:31], v[224:239]
buffer_load_dwordx4 v[92:95], v1, s[8:11], s21 offen offset:3072
s_add_u32 s21, s21, 55296
s_waitcnt vmcnt(19)
s_waitcnt lgkmcnt(0)
v_mfma_f32_32x32x16_bf16 v[112:127], v[96:99], v[16:19], v[112:127]
ds_read_b128 v[24:27], v1 offset:25600
v_mfma_f32_32x32x16_bf16 v[128:143], v[96:99], v[20:23], v[128:143]
ds_read_b128 v[28:31], v2 offset:25600
buffer_load_dwordx4 v[96:99], v1, s[8:11], s21 offen offset:0
s_waitcnt vmcnt(19)
v_mfma_f32_32x32x16_bf16 v[144:159], v[100:103], v[16:19], v[144:159]
v_mfma_f32_32x32x16_bf16 v[160:175], v[100:103], v[20:23], v[160:175]
buffer_load_dwordx4 v[100:103], v1, s[8:11], s21 offen offset:1024
s_waitcnt vmcnt(19)
v_mfma_f32_32x32x16_bf16 v[176:191], v[104:107], v[16:19], v[176:191]
v_mfma_f32_32x32x16_bf16 v[192:207], v[104:107], v[20:23], v[192:207]
buffer_load_dwordx4 v[104:107], v1, s[8:11], s21 offen offset:2048
s_waitcnt vmcnt(19)
v_mfma_f32_32x32x16_bf16 v[208:223], v[108:111], v[16:19], v[208:223]
v_mfma_f32_32x32x16_bf16 v[224:239], v[108:111], v[20:23], v[224:239]
buffer_load_dwordx4 v[108:111], v1, s[8:11], s21 offen offset:3072
s_add_u32 s21, s21, 55296
s_cmp_ge_u32 s21, s47
s_cselect_b32 s45, 2211840, 0
s_sub_u32 s21, s21, s45
s_waitcnt vmcnt(19)
s_waitcnt lgkmcnt(0)
v_mfma_f32_32x32x16_bf16 v[112:127], v[32:35], v[24:27], v[112:127]
ds_read_b128 v[16:19], v1 offset:26624
v_mfma_f32_32x32x16_bf16 v[128:143], v[32:35], v[28:31], v[128:143]
ds_read_b128 v[20:23], v2 offset:26624
buffer_load_dwordx4 v[32:35], v1, s[8:11], s21 offen offset:0
s_waitcnt vmcnt(19)
v_mfma_f32_32x32x16_bf16 v[144:159], v[36:39], v[24:27], v[144:159]
v_mfma_f32_32x32x16_bf16 v[160:175], v[36:39], v[28:31], v[160:175]
buffer_load_dwordx4 v[36:39], v1, s[8:11], s21 offen offset:1024
s_waitcnt vmcnt(19)
v_mfma_f32_32x32x16_bf16 v[176:191], v[40:43], v[24:27], v[176:191]
v_mfma_f32_32x32x16_bf16 v[192:207], v[40:43], v[28:31], v[192:207]
buffer_load_dwordx4 v[40:43], v1, s[8:11], s21 offen offset:2048
s_waitcnt vmcnt(19)
v_mfma_f32_32x32x16_bf16 v[208:223], v[44:47], v[24:27], v[208:223]
v_mfma_f32_32x32x16_bf16 v[224:239], v[44:47], v[28:31], v[224:239]
buffer_load_dwordx4 v[44:47], v1, s[8:11], s21 offen offset:3072
s_add_u32 s21, s21, 55296
s_waitcnt vmcnt(19)
s_waitcnt lgkmcnt(0)
v_mfma_f32_32x32x16_bf16 v[112:127], v[48:51], v[16:19], v[112:127]
ds_read_b128 v[24:27], v1 offset:27648
v_mfma_f32_32x32x16_bf16 v[128:143], v[48:51], v[20:23], v[128:143]
ds_read_b128 v[28:31], v2 offset:27648
buffer_load_dwordx4 v[48:51], v1, s[8:11], s21 offen offset:0
s_waitcnt vmcnt(19)
v_mfma_f32_32x32x16_bf16 v[144:159], v[52:55], v[16:19], v[144:159]
v_mfma_f32_32x32x16_bf16 v[160:175], v[52:55], v[20:23], v[160:175]
buffer_load_dwordx4 v[52:55], v1, s[8:11], s21 offen offset:1024
s_waitcnt vmcnt(19)
v_mfma_f32_32x32x16_bf16 v[176:191], v[56:59], v[16:19], v[176:191]
v_mfma_f32_32x32x16_bf16 v[192:207], v[56:59], v[20:23], v[192:207]
buffer_load_dwordx4 v[56:59], v1, s[8:11], s21 offen offset:2048
s_waitcnt vmcnt(19)
v_mfma_f32_32x32x16_bf16 v[208:223], v[60:63], v[16:19], v[208:223]
v_mfma_f32_32x32x16_bf16 v[224:239], v[60:63], v[20:23], v[224:239]
buffer_load_dwordx4 v[60:63], v1, s[8:11], s21 offen offset:3072
s_add_u32 s21, s21, 55296
s_waitcnt vmcnt(19)
s_waitcnt lgkmcnt(0)
v_mfma_f32_32x32x16_bf16 v[112:127], v[64:67], v[24:27], v[112:127]
ds_read_b128 v[16:19], v1 offset:28672
v_mfma_f32_32x32x16_bf16 v[128:143], v[64:67], v[28:31], v[128:143]
ds_read_b128 v[20:23], v2 offset:28672
buffer_load_dwordx4 v[64:67], v1, s[8:11], s21 offen offset:0
s_waitcnt vmcnt(19)
v_mfma_f32_32x32x16_bf16 v[144:159], v[68:71], v[24:27], v[144:159]
v_mfma_f32_32x32x16_bf16 v[160:175], v[68:71], v[28:31], v[160:175]
buffer_load_dwordx4 v[68:71], v1, s[8:11], s21 offen offset:1024
s_waitcnt vmcnt(19)
v_mfma_f32_32x32x16_bf16 v[176:191], v[72:75], v[24:27], v[176:191]
v_mfma_f32_32x32x16_bf16 v[192:207], v[72:75], v[28:31], v[192:207]
buffer_load_dwordx4 v[72:75], v1, s[8:11], s21 offen offset:2048
s_waitcnt vmcnt(19)
v_mfma_f32_32x32x16_bf16 v[208:223], v[76:79], v[24:27], v[208:223]
v_mfma_f32_32x32x16_bf16 v[224:239], v[76:79], v[28:31], v[224:239]
buffer_load_dwordx4 v[76:79], v1, s[8:11], s21 offen offset:3072
s_add_u32 s21, s21, 55296
s_waitcnt vmcnt(19)
s_waitcnt lgkmcnt(0)
v_mfma_f32_32x32x16_bf16 v[112:127], v[80:83], v[16:19], v[112:127]
ds_read_b128 v[24:27], v1 offset:29696
v_mfma_f32_32x32x16_bf16 v[128:143], v[80:83], v[20:23], v[128:143]
ds_read_b128 v[28:31], v2 offset:29696
buffer_load_dwordx4 v[80:83], v1, s[8:11], s21 offen offset:0
s_waitcnt vmcnt(19)
v_mfma_f32_32x32x16_bf16 v[144:159], v[84:87], v[16:19], v[144:159]
v_mfma_f32_32x32x16_bf16 v[160:175], v[84:87], v[20:23], v[160:175]
buffer_load_dwordx4 v[84:87], v1, s[8:11], s21 offen offset:1024
s_waitcnt vmcnt(19)
v_mfma_f32_32x32x16_bf16 v[176:191], v[88:91], v[16:19], v[176:191]
v_mfma_f32_32x32x16_bf16 v[192:207], v[88:91], v[20:23], v[192:207]
buffer_load_dwordx4 v[88:91], v1, s[8:11], s21 offen offset:2048
s_waitcnt vmcnt(19)
v_mfma_f32_32x32x16_bf16 v[208:223], v[92:95], v[16:19], v[208:223]
v_mfma_f32_32x32x16_bf16 v[224:239], v[92:95], v[20:23], v[224:239]
buffer_load_dwordx4 v[92:95], v1, s[8:11], s21 offen offset:3072
s_add_u32 s21, s21, 55296
s_waitcnt vmcnt(19)
s_waitcnt lgkmcnt(0)
v_mfma_f32_32x32x16_bf16 v[112:127], v[96:99], v[24:27], v[112:127]
ds_read_b128 v[16:19], v1 offset:30720
v_mfma_f32_32x32x16_bf16 v[128:143], v[96:99], v[28:31], v[128:143]
ds_read_b128 v[20:23], v2 offset:30720
buffer_load_dwordx4 v[96:99], v1, s[8:11], s21 offen offset:0
s_waitcnt vmcnt(19)
v_mfma_f32_32x32x16_bf16 v[144:159], v[100:103], v[24:27], v[144:159]
v_mfma_f32_32x32x16_bf16 v[160:175], v[100:103], v[28:31], v[160:175]
buffer_load_dwordx4 v[100:103], v1, s[8:11], s21 offen offset:1024
s_waitcnt vmcnt(19)
v_mfma_f32_32x32x16_bf16 v[176:191], v[104:107], v[24:27], v[176:191]
v_mfma_f32_32x32x16_bf16 v[192:207], v[104:107], v[28:31], v[192:207]
buffer_load_dwordx4 v[104:107], v1, s[8:11], s21 offen offset:2048
s_waitcnt vmcnt(19)
v_mfma_f32_32x32x16_bf16 v[208:223], v[108:111], v[24:27], v[208:223]
v_mfma_f32_32x32x16_bf16 v[224:239], v[108:111], v[28:31], v[224:239]
buffer_load_dwordx4 v[108:111], v1, s[8:11], s21 offen offset:3072
s_add_u32 s21, s21, 55296
s_waitcnt vmcnt(19)
s_waitcnt lgkmcnt(0)
v_mfma_f32_32x32x16_bf16 v[112:127], v[32:35], v[16:19], v[112:127]
ds_read_b128 v[24:27], v1 offset:31744
v_mfma_f32_32x32x16_bf16 v[128:143], v[32:35], v[20:23], v[128:143]
ds_read_b128 v[28:31], v2 offset:31744
buffer_load_dwordx4 v[32:35], v1, s[8:11], s21 offen offset:0
s_waitcnt vmcnt(19)
v_mfma_f32_32x32x16_bf16 v[144:159], v[36:39], v[16:19], v[144:159]
v_mfma_f32_32x32x16_bf16 v[160:175], v[36:39], v[20:23], v[160:175]
buffer_load_dwordx4 v[36:39], v1, s[8:11], s21 offen offset:1024
s_waitcnt vmcnt(19)
v_mfma_f32_32x32x16_bf16 v[176:191], v[40:43], v[16:19], v[176:191]
v_mfma_f32_32x32x16_bf16 v[192:207], v[40:43], v[20:23], v[192:207]
buffer_load_dwordx4 v[40:43], v1, s[8:11], s21 offen offset:2048
s_waitcnt vmcnt(19)
v_mfma_f32_32x32x16_bf16 v[208:223], v[44:47], v[16:19], v[208:223]
v_mfma_f32_32x32x16_bf16 v[224:239], v[44:47], v[20:23], v[224:239]
buffer_load_dwordx4 v[44:47], v1, s[8:11], s21 offen offset:3072
s_add_u32 s21, s21, 55296
s_waitcnt vmcnt(19)
s_waitcnt lgkmcnt(0)
v_mfma_f32_32x32x16_bf16 v[112:127], v[48:51], v[24:27], v[112:127]
ds_read_b128 v[16:19], v1 offset:32768
v_mfma_f32_32x32x16_bf16 v[128:143], v[48:51], v[28:31], v[128:143]
ds_read_b128 v[20:23], v2 offset:32768
buffer_load_dwordx4 v[48:51], v1, s[8:11], s21 offen offset:0
s_waitcnt vmcnt(19)
v_mfma_f32_32x32x16_bf16 v[144:159], v[52:55], v[24:27], v[144:159]
v_mfma_f32_32x32x16_bf16 v[160:175], v[52:55], v[28:31], v[160:175]
buffer_load_dwordx4 v[52:55], v1, s[8:11], s21 offen offset:1024
s_waitcnt vmcnt(19)
v_mfma_f32_32x32x16_bf16 v[176:191], v[56:59], v[24:27], v[176:191]
v_mfma_f32_32x32x16_bf16 v[192:207], v[56:59], v[28:31], v[192:207]
buffer_load_dwordx4 v[56:59], v1, s[8:11], s21 offen offset:2048
s_waitcnt vmcnt(19)
v_mfma_f32_32x32x16_bf16 v[208:223], v[60:63], v[24:27], v[208:223]
v_mfma_f32_32x32x16_bf16 v[224:239], v[60:63], v[28:31], v[224:239]
buffer_load_dwordx4 v[60:63], v1, s[8:11], s21 offen offset:3072
s_add_u32 s21, s21, 55296
s_waitcnt vmcnt(19)
s_waitcnt lgkmcnt(0)
v_mfma_f32_32x32x16_bf16 v[112:127], v[64:67], v[16:19], v[112:127]
ds_read_b128 v[24:27], v1 offset:33792
v_mfma_f32_32x32x16_bf16 v[128:143], v[64:67], v[20:23], v[128:143]
ds_read_b128 v[28:31], v2 offset:33792
buffer_load_dwordx4 v[64:67], v1, s[8:11], s21 offen offset:0
s_waitcnt vmcnt(19)
v_mfma_f32_32x32x16_bf16 v[144:159], v[68:71], v[16:19], v[144:159]
v_mfma_f32_32x32x16_bf16 v[160:175], v[68:71], v[20:23], v[160:175]
buffer_load_dwordx4 v[68:71], v1, s[8:11], s21 offen offset:1024
s_waitcnt vmcnt(19)
v_mfma_f32_32x32x16_bf16 v[176:191], v[72:75], v[16:19], v[176:191]
v_mfma_f32_32x32x16_bf16 v[192:207], v[72:75], v[20:23], v[192:207]
buffer_load_dwordx4 v[72:75], v1, s[8:11], s21 offen offset:2048
s_waitcnt vmcnt(19)
v_mfma_f32_32x32x16_bf16 v[208:223], v[76:79], v[16:19], v[208:223]
v_mfma_f32_32x32x16_bf16 v[224:239], v[76:79], v[20:23], v[224:239]
buffer_load_dwordx4 v[76:79], v1, s[8:11], s21 offen offset:3072
s_add_u32 s21, s21, 55296
s_waitcnt vmcnt(19)
s_waitcnt lgkmcnt(0)
v_mfma_f32_32x32x16_bf16 v[112:127], v[80:83], v[24:27], v[112:127]
ds_read_b128 v[16:19], v1 offset:34816
v_mfma_f32_32x32x16_bf16 v[128:143], v[80:83], v[28:31], v[128:143]
ds_read_b128 v[20:23], v2 offset:34816
buffer_load_dwordx4 v[80:83], v1, s[8:11], s21 offen offset:0
s_waitcnt vmcnt(19)
v_mfma_f32_32x32x16_bf16 v[144:159], v[84:87], v[24:27], v[144:159]
v_mfma_f32_32x32x16_bf16 v[160:175], v[84:87], v[28:31], v[160:175]
buffer_load_dwordx4 v[84:87], v1, s[8:11], s21 offen offset:1024
s_waitcnt vmcnt(19)
v_mfma_f32_32x32x16_bf16 v[176:191], v[88:91], v[24:27], v[176:191]
v_mfma_f32_32x32x16_bf16 v[192:207], v[88:91], v[28:31], v[192:207]
buffer_load_dwordx4 v[88:91], v1, s[8:11], s21 offen offset:2048
s_waitcnt vmcnt(19)
v_mfma_f32_32x32x16_bf16 v[208:223], v[92:95], v[24:27], v[208:223]
v_mfma_f32_32x32x16_bf16 v[224:239], v[92:95], v[28:31], v[224:239]
buffer_load_dwordx4 v[92:95], v1, s[8:11], s21 offen offset:3072
s_add_u32 s21, s21, 55296
s_waitcnt vmcnt(19)
s_waitcnt lgkmcnt(0)
v_mfma_f32_32x32x16_bf16 v[112:127], v[96:99], v[16:19], v[112:127]
ds_read_b128 v[24:27], v1 offset:35840
v_mfma_f32_32x32x16_bf16 v[128:143], v[96:99], v[20:23], v[128:143]
ds_read_b128 v[28:31], v2 offset:35840
buffer_load_dwordx4 v[96:99], v1, s[8:11], s21 offen offset:0
s_waitcnt vmcnt(19)
v_mfma_f32_32x32x16_bf16 v[144:159], v[100:103], v[16:19], v[144:159]
v_mfma_f32_32x32x16_bf16 v[160:175], v[100:103], v[20:23], v[160:175]
buffer_load_dwordx4 v[100:103], v1, s[8:11], s21 offen offset:1024
s_waitcnt vmcnt(19)
v_mfma_f32_32x32x16_bf16 v[176:191], v[104:107], v[16:19], v[176:191]
v_mfma_f32_32x32x16_bf16 v[192:207], v[104:107], v[20:23], v[192:207]
buffer_load_dwordx4 v[104:107], v1, s[8:11], s21 offen offset:2048
s_waitcnt vmcnt(19)
v_mfma_f32_32x32x16_bf16 v[208:223], v[108:111], v[16:19], v[208:223]
v_mfma_f32_32x32x16_bf16 v[224:239], v[108:111], v[20:23], v[224:239]
buffer_load_dwordx4 v[108:111], v1, s[8:11], s21 offen offset:3072
s_add_u32 s21, s21, 55296
s_waitcnt vmcnt(19)
s_waitcnt lgkmcnt(0)
v_mfma_f32_32x32x16_bf16 v[112:127], v[32:35], v[24:27], v[112:127]
ds_read_b128 v[16:19], v1 offset:36864
v_mfma_f32_32x32x16_bf16 v[128:143], v[32:35], v[28:31], v[128:143]
ds_read_b128 v[20:23], v2 offset:36864
s_add_u32 s21, s22, 0x1000
buffer_load_dwordx4 v[32:35], v1, s[8:11], s21 offen offset:0
s_waitcnt vmcnt(19)
v_mfma_f32_32x32x16_bf16 v[144:159], v[36:39], v[24:27], v[144:159]
v_mfma_f32_32x32x16_bf16 v[160:175], v[36:39], v[28:31], v[160:175]
buffer_load_dwordx4 v[36:39], v1, s[8:11], s21 offen offset:1024
s_waitcnt vmcnt(19)
v_mfma_f32_32x32x16_bf16 v[176:191], v[40:43], v[24:27], v[176:191]
v_mfma_f32_32x32x16_bf16 v[192:207], v[40:43], v[28:31], v[192:207]
buffer_load_dwordx4 v[40:43], v1, s[8:11], s21 offen offset:2048
s_add_u32 s21, s21, 55296
s_waitcnt vmcnt(19)
v_mfma_f32_32x32x16_bf16 v[208:223], v[44:47], v[24:27], v[208:223]
v_mfma_f32_32x32x16_bf16 v[224:239], v[44:47], v[28:31], v[224:239]
buffer_load_dwordx4 v[44:47], v1, s[8:11], s21 offen offset:0
s_waitcnt vmcnt(19)
s_waitcnt lgkmcnt(0)
v_mfma_f32_32x32x16_bf16 v[112:127], v[48:51], v[16:19], v[112:127]
ds_read_b128 v[24:27], v1 offset:37888
v_mfma_f32_32x32x16_bf16 v[128:143], v[48:51], v[20:23], v[128:143]
ds_read_b128 v[28:31], v2 offset:37888
buffer_load_dwordx4 v[48:51], v1, s[8:11], s21 offen offset:1024
s_waitcnt vmcnt(19)
v_mfma_f32_32x32x16_bf16 v[144:159], v[52:55], v[16:19], v[144:159]
v_mfma_f32_32x32x16_bf16 v[160:175], v[52:55], v[20:23], v[160:175]
buffer_load_dwordx4 v[52:55], v1, s[8:11], s21 offen offset:2048
s_add_u32 s21, s21, 55296
s_waitcnt vmcnt(19)
v_mfma_f32_32x32x16_bf16 v[176:191], v[56:59], v[16:19], v[176:191]
v_mfma_f32_32x32x16_bf16 v[192:207], v[56:59], v[20:23], v[192:207]
buffer_load_dwordx4 v[56:59], v1, s[8:11], s21 offen offset:0
s_waitcnt vmcnt(19)
v_mfma_f32_32x32x16_bf16 v[208:223], v[60:63], v[16:19], v[208:223]
v_mfma_f32_32x32x16_bf16 v[224:239], v[60:63], v[20:23], v[224:239]
buffer_load_dwordx4 v[60:63], v1, s[8:11], s21 offen offset:1024
s_waitcnt vmcnt(19)
s_waitcnt lgkmcnt(0)
v_mfma_f32_32x32x16_bf16 v[112:127], v[64:67], v[24:27], v[112:127]
ds_read_b128 v[16:19], v1 offset:38912
v_mfma_f32_32x32x16_bf16 v[128:143], v[64:67], v[28:31], v[128:143]
ds_read_b128 v[20:23], v2 offset:38912
buffer_load_dwordx4 v[64:67], v1, s[8:11], s21 offen offset:2048
s_add_u32 s21, s21, 55296
s_waitcnt vmcnt(19)
v_mfma_f32_32x32x16_bf16 v[144:159], v[68:71], v[24:27], v[144:159]
v_mfma_f32_32x32x16_bf16 v[160:175], v[68:71], v[28:31], v[160:175]
buffer_load_dwordx4 v[68:71], v1, s[8:11], s21 offen offset:0
s_waitcnt vmcnt(19)
v_mfma_f32_32x32x16_bf16 v[176:191], v[72:75], v[24:27], v[176:191]
v_mfma_f32_32x32x16_bf16 v[192:207], v[72:75], v[28:31], v[192:207]
buffer_load_dwordx4 v[72:75], v1, s[8:11], s21 offen offset:1024
s_waitcnt vmcnt(19)
v_mfma_f32_32x32x16_bf16 v[208:223], v[76:79], v[24:27], v[208:223]
v_mfma_f32_32x32x16_bf16 v[224:239], v[76:79], v[28:31], v[224:239]
buffer_load_dwordx4 v[76:79], v1, s[8:11], s21 offen offset:2048
s_add_u32 s21, s21, 55296
s_waitcnt vmcnt(19)
s_waitcnt lgkmcnt(0)
v_mfma_f32_32x32x16_bf16 v[112:127], v[80:83], v[16:19], v[112:127]
ds_read_b128 v[24:27], v1 offset:39936
v_mfma_f32_32x32x16_bf16 v[128:143], v[80:83], v[20:23], v[128:143]
ds_read_b128 v[28:31], v2 offset:39936
buffer_load_dwordx4 v[80:83], v1, s[8:11], s21 offen offset:0
s_waitcnt vmcnt(19)
v_mfma_f32_32x32x16_bf16 v[144:159], v[84:87], v[16:19], v[144:159]
v_mfma_f32_32x32x16_bf16 v[160:175], v[84:87], v[20:23], v[160:175]
buffer_load_dwordx4 v[84:87], v1, s[8:11], s21 offen offset:1024
s_waitcnt vmcnt(19)
v_mfma_f32_32x32x16_bf16 v[176:191], v[88:91], v[16:19], v[176:191]
v_mfma_f32_32x32x16_bf16 v[192:207], v[88:91], v[20:23], v[192:207]
buffer_load_dwordx4 v[88:91], v1, s[8:11], s21 offen offset:2048
s_add_u32 s21, s21, 55296
s_waitcnt vmcnt(19)
v_mfma_f32_32x32x16_bf16 v[208:223], v[92:95], v[16:19], v[208:223]
v_mfma_f32_32x32x16_bf16 v[224:239], v[92:95], v[20:23], v[224:239]
buffer_load_dwordx4 v[92:95], v1, s[8:11], s21 offen offset:0
s_waitcnt vmcnt(19)
s_waitcnt lgkmcnt(0)
v_mfma_f32_32x32x16_bf16 v[112:127], v[96:99], v[24:27], v[112:127]
v_mfma_f32_32x32x16_bf16 v[128:143], v[96:99], v[28:31], v[128:143]
buffer_load_dwordx4 v[96:99], v1, s[8:11], s21 offen offset:1024
s_waitcnt vmcnt(19)
v_mfma_f32_32x32x16_bf16 v[144:159], v[100:103], v[24:27], v[144:159]
v_mfma_f32_32x32x16_bf16 v[160:175], v[100:103], v[28:31], v[160:175]
buffer_load_dwordx4 v[100:103], v1, s[8:11], s21 offen offset:2048
s_add_u32 s21, s21, 55296
s_waitcnt vmcnt(19)
v_mfma_f32_32x32x16_bf16 v[176:191], v[104:107], v[24:27], v[176:191]
v_mfma_f32_32x32x16_bf16 v[192:207], v[104:107], v[28:31], v[192:207]
buffer_load_dwordx4 v[104:107], v1, s[8:11], s21 offen offset:0
s_waitcnt vmcnt(19)
v_mfma_f32_32x32x16_bf16 v[208:223], v[108:111], v[24:27], v[208:223]
v_mfma_f32_32x32x16_bf16 v[224:239], v[108:111], v[28:31], v[224:239]
buffer_load_dwordx4 v[108:111], v1, s[8:11], s21 offen offset:1024
v_pk_mul_f32 v[240:241], v[112:113], v[112:113]
v_pk_mul_f32 v[242:243], v[114:115], v[114:115]
v_pk_mul_f32 v[244:245], v[116:117], v[116:117]
v_pk_mul_f32 v[246:247], v[118:119], v[118:119]
v_pk_mul_f32 v[248:249], v[120:121], v[120:121]
v_pk_mul_f32 v[250:251], v[122:123], v[122:123]
v_pk_mul_f32 v[252:253], v[124:125], v[124:125]
v_pk_mul_f32 v[254:255], v[126:127], v[126:127]
v_pk_fma_f32 v[240:241], v[240:241], v[8:9], v[8:9] op_sel:[0,1,0] op_sel_hi:[1,1,0]
v_pk_fma_f32 v[242:243], v[242:243], v[8:9], v[8:9] op_sel:[0,1,0] op_sel_hi:[1,1,0]
v_pk_fma_f32 v[244:245], v[244:245], v[8:9], v[8:9] op_sel:[0,1,0] op_sel_hi:[1,1,0]
v_pk_fma_f32 v[246:247], v[246:247], v[8:9], v[8:9] op_sel:[0,1,0] op_sel_hi:[1,1,0]
v_pk_fma_f32 v[248:249], v[248:249], v[8:9], v[8:9] op_sel:[0,1,0] op_sel_hi:[1,1,0]
v_pk_fma_f32 v[250:251], v[250:251], v[8:9], v[8:9] op_sel:[0,1,0] op_sel_hi:[1,1,0]
v_pk_fma_f32 v[252:253], v[252:253], v[8:9], v[8:9] op_sel:[0,1,0] op_sel_hi:[1,1,0]
v_pk_fma_f32 v[254:255], v[254:255], v[8:9], v[8:9] op_sel:[0,1,0] op_sel_hi:[1,1,0]
v_pk_mul_f32 v[240:241], v[240:241], v[112:113]
v_pk_mul_f32 v[242:243], v[242:243], v[114:115]
v_pk_mul_f32 v[244:245], v[244:245], v[116:117]
v_pk_mul_f32 v[246:247], v[246:247], v[118:119]
v_pk_mul_f32 v[248:249], v[248:249], v[120:121]
v_pk_mul_f32 v[250:251], v[250:251], v[122:123]
v_pk_mul_f32 v[252:253], v[252:253], v[124:125]
v_pk_mul_f32 v[254:255], v[254:255], v[126:127]
v_exp_f32 v240, v240
v_exp_f32 v241, v241
v_exp_f32 v242, v242
v_exp_f32 v243, v243
v_exp_f32 v244, v244
v_exp_f32 v245, v245
v_exp_f32 v246, v246
v_exp_f32 v247, v247
v_exp_f32 v248, v248
v_exp_f32 v249, v249
v_exp_f32 v250, v250
v_exp_f32 v251, v251
v_exp_f32 v252, v252
v_exp_f32 v253, v253
v_exp_f32 v254, v254
v_exp_f32 v255, v255
v_pk_add_f32 v[240:241], v[240:241], 1.0 op_sel_hi:[1,0]
v_pk_add_f32 v[242:243], v[242:243], 1.0 op_sel_hi:[1,0]
v_pk_add_f32 v[244:245], v[244:245], 1.0 op_sel_hi:[1,0]
v_pk_add_f32 v[246:247], v[246:247], 1.0 op_sel_hi:[1,0]
v_pk_add_f32 v[248:249], v[248:249], 1.0 op_sel_hi:[1,0]
v_pk_add_f32 v[250:251], v[250:251], 1.0 op_sel_hi:[1,0]
v_pk_add_f32 v[252:253], v[252:253], 1.0 op_sel_hi:[1,0]
v_pk_add_f32 v[254:255], v[254:255], 1.0 op_sel_hi:[1,0]
v_rcp_f32 v240, v240
v_rcp_f32 v241, v241
v_rcp_f32 v242, v242
v_rcp_f32 v243, v243
v_rcp_f32 v244, v244
v_rcp_f32 v245, v245
v_rcp_f32 v246, v246
v_rcp_f32 v247, v247
v_rcp_f32 v248, v248
v_rcp_f32 v249, v249
v_rcp_f32 v250, v250
v_rcp_f32 v251, v251
v_rcp_f32 v252, v252
v_rcp_f32 v253, v253
v_rcp_f32 v254, v254
v_rcp_f32 v255, v255
v_pk_mul_f32 v[240:241], v[240:241], v[112:113]
v_pk_mul_f32 v[242:243], v[242:243], v[114:115]
v_pk_mul_f32 v[244:245], v[244:245], v[116:117]
v_pk_mul_f32 v[246:247], v[246:247], v[118:119]
v_pk_mul_f32 v[248:249], v[248:249], v[120:121]
v_pk_mul_f32 v[250:251], v[250:251], v[122:123]
v_pk_mul_f32 v[252:253], v[252:253], v[124:125]
v_pk_mul_f32 v[254:255], v[254:255], v[126:127]
v_cvt_pk_bf16_f32 v112, v240, v241
v_cvt_pk_bf16_f32 v113, v242, v243
v_cvt_pk_bf16_f32 v114, v244, v245
v_cvt_pk_bf16_f32 v115, v246, v247
v_cvt_pk_bf16_f32 v116, v248, v249
v_cvt_pk_bf16_f32 v117, v250, v251
v_cvt_pk_bf16_f32 v118, v252, v253
v_cvt_pk_bf16_f32 v119, v254, v255
buffer_store_dwordx4 v[112:115], v3, s[36:39], s40 offen offset:0 sc1
buffer_store_dwordx4 v[116:119], v3, s[36:39], s40 offen offset:1024 sc1
v_pk_mul_f32 v[240:241], v[128:129], v[128:129]
v_pk_mul_f32 v[242:243], v[130:131], v[130:131]
v_pk_mul_f32 v[244:245], v[132:133], v[132:133]
v_pk_mul_f32 v[246:247], v[134:135], v[134:135]
v_pk_mul_f32 v[248:249], v[136:137], v[136:137]
v_pk_mul_f32 v[250:251], v[138:139], v[138:139]
v_pk_mul_f32 v[252:253], v[140:141], v[140:141]
v_pk_mul_f32 v[254:255], v[142:143], v[142:143]
v_pk_fma_f32 v[240:241], v[240:241], v[8:9], v[8:9] op_sel:[0,1,0] op_sel_hi:[1,1,0]
v_pk_fma_f32 v[242:243], v[242:243], v[8:9], v[8:9] op_sel:[0,1,0] op_sel_hi:[1,1,0]
v_pk_fma_f32 v[244:245], v[244:245], v[8:9], v[8:9] op_sel:[0,1,0] op_sel_hi:[1,1,0]
v_pk_fma_f32 v[246:247], v[246:247], v[8:9], v[8:9] op_sel:[0,1,0] op_sel_hi:[1,1,0]
v_pk_fma_f32 v[248:249], v[248:249], v[8:9], v[8:9] op_sel:[0,1,0] op_sel_hi:[1,1,0]
v_pk_fma_f32 v[250:251], v[250:251], v[8:9], v[8:9] op_sel:[0,1,0] op_sel_hi:[1,1,0]
v_pk_fma_f32 v[252:253], v[252:253], v[8:9], v[8:9] op_sel:[0,1,0] op_sel_hi:[1,1,0]
v_pk_fma_f32 v[254:255], v[254:255], v[8:9], v[8:9] op_sel:[0,1,0] op_sel_hi:[1,1,0]
v_pk_mul_f32 v[240:241], v[240:241], v[128:129]
v_pk_mul_f32 v[242:243], v[242:243], v[130:131]
v_pk_mul_f32 v[244:245], v[244:245], v[132:133]
v_pk_mul_f32 v[246:247], v[246:247], v[134:135]
v_pk_mul_f32 v[248:249], v[248:249], v[136:137]
v_pk_mul_f32 v[250:251], v[250:251], v[138:139]
v_pk_mul_f32 v[252:253], v[252:253], v[140:141]
v_pk_mul_f32 v[254:255], v[254:255], v[142:143]
v_exp_f32 v240, v240
v_exp_f32 v241, v241
v_exp_f32 v242, v242
v_exp_f32 v243, v243
v_exp_f32 v244, v244
v_exp_f32 v245, v245
v_exp_f32 v246, v246
v_exp_f32 v247, v247
v_exp_f32 v248, v248
v_exp_f32 v249, v249
v_exp_f32 v250, v250
v_exp_f32 v251, v251
v_exp_f32 v252, v252
v_exp_f32 v253, v253
v_exp_f32 v254, v254
v_exp_f32 v255, v255
v_pk_add_f32 v[240:241], v[240:241], 1.0 op_sel_hi:[1,0]
v_pk_add_f32 v[242:243], v[242:243], 1.0 op_sel_hi:[1,0]
v_pk_add_f32 v[244:245], v[244:245], 1.0 op_sel_hi:[1,0]
v_pk_add_f32 v[246:247], v[246:247], 1.0 op_sel_hi:[1,0]
v_pk_add_f32 v[248:249], v[248:249], 1.0 op_sel_hi:[1,0]
v_pk_add_f32 v[250:251], v[250:251], 1.0 op_sel_hi:[1,0]
v_pk_add_f32 v[252:253], v[252:253], 1.0 op_sel_hi:[1,0]
v_pk_add_f32 v[254:255], v[254:255], 1.0 op_sel_hi:[1,0]
v_rcp_f32 v240, v240
v_rcp_f32 v241, v241
v_rcp_f32 v242, v242
v_rcp_f32 v243, v243
v_rcp_f32 v244, v244
v_rcp_f32 v245, v245
v_rcp_f32 v246, v246
v_rcp_f32 v247, v247
v_rcp_f32 v248, v248
v_rcp_f32 v249, v249
v_rcp_f32 v250, v250
v_rcp_f32 v251, v251
v_rcp_f32 v252, v252
v_rcp_f32 v253, v253
v_rcp_f32 v254, v254
v_rcp_f32 v255, v255
v_pk_mul_f32 v[240:241], v[240:241], v[128:129]
v_pk_mul_f32 v[242:243], v[242:243], v[130:131]
v_pk_mul_f32 v[244:245], v[244:245], v[132:133]
v_pk_mul_f32 v[246:247], v[246:247], v[134:135]
v_pk_mul_f32 v[248:249], v[248:249], v[136:137]
v_pk_mul_f32 v[250:251], v[250:251], v[138:139]
v_pk_mul_f32 v[252:253], v[252:253], v[140:141]
v_pk_mul_f32 v[254:255], v[254:255], v[142:143]
v_cvt_pk_bf16_f32 v128, v240, v241
v_cvt_pk_bf16_f32 v129, v242, v243
v_cvt_pk_bf16_f32 v130, v244, v245
v_cvt_pk_bf16_f32 v131, v246, v247
v_cvt_pk_bf16_f32 v132, v248, v249
v_cvt_pk_bf16_f32 v133, v250, v251
v_cvt_pk_bf16_f32 v134, v252, v253
v_cvt_pk_bf16_f32 v135, v254, v255
buffer_store_dwordx4 v[128:131], v4, s[36:39], s40 offen offset:0 sc1
buffer_store_dwordx4 v[132:135], v4, s[36:39], s40 offen offset:1024 sc1
s_add_u32 s40, s40, 0x800
v_pk_mul_f32 v[240:241], v[144:145], v[144:145]
v_pk_mul_f32 v[242:243], v[146:147], v[146:147]
v_pk_mul_f32 v[244:245], v[148:149], v[148:149]
v_pk_mul_f32 v[246:247], v[150:151], v[150:151]
v_pk_mul_f32 v[248:249], v[152:153], v[152:153]
v_pk_mul_f32 v[250:251], v[154:155], v[154:155]
v_pk_mul_f32 v[252:253], v[156:157], v[156:157]
v_pk_mul_f32 v[254:255], v[158:159], v[158:159]
v_pk_fma_f32 v[240:241], v[240:241], v[8:9], v[8:9] op_sel:[0,1,0] op_sel_hi:[1,1,0]
v_pk_fma_f32 v[242:243], v[242:243], v[8:9], v[8:9] op_sel:[0,1,0] op_sel_hi:[1,1,0]
v_pk_fma_f32 v[244:245], v[244:245], v[8:9], v[8:9] op_sel:[0,1,0] op_sel_hi:[1,1,0]
v_pk_fma_f32 v[246:247], v[246:247], v[8:9], v[8:9] op_sel:[0,1,0] op_sel_hi:[1,1,0]
v_pk_fma_f32 v[248:249], v[248:249], v[8:9], v[8:9] op_sel:[0,1,0] op_sel_hi:[1,1,0]
v_pk_fma_f32 v[250:251], v[250:251], v[8:9], v[8:9] op_sel:[0,1,0] op_sel_hi:[1,1,0]
v_pk_fma_f32 v[252:253], v[252:253], v[8:9], v[8:9] op_sel:[0,1,0] op_sel_hi:[1,1,0]
v_pk_fma_f32 v[254:255], v[254:255], v[8:9], v[8:9] op_sel:[0,1,0] op_sel_hi:[1,1,0]
v_pk_mul_f32 v[240:241], v[240:241], v[144:145]
v_pk_mul_f32 v[242:243], v[242:243], v[146:147]
v_pk_mul_f32 v[244:245], v[244:245], v[148:149]
v_pk_mul_f32 v[246:247], v[246:247], v[150:151]
v_pk_mul_f32 v[248:249], v[248:249], v[152:153]
v_pk_mul_f32 v[250:251], v[250:251], v[154:155]
v_pk_mul_f32 v[252:253], v[252:253], v[156:157]
v_pk_mul_f32 v[254:255], v[254:255], v[158:159]
v_exp_f32 v240, v240
v_exp_f32 v241, v241
v_exp_f32 v242, v242
v_exp_f32 v243, v243
v_exp_f32 v244, v244
v_exp_f32 v245, v245
v_exp_f32 v246, v246
v_exp_f32 v247, v247
v_exp_f32 v248, v248
v_exp_f32 v249, v249
v_exp_f32 v250, v250
v_exp_f32 v251, v251
v_exp_f32 v252, v252
v_exp_f32 v253, v253
v_exp_f32 v254, v254
v_exp_f32 v255, v255
v_pk_add_f32 v[240:241], v[240:241], 1.0 op_sel_hi:[1,0]
v_pk_add_f32 v[242:243], v[242:243], 1.0 op_sel_hi:[1,0]
v_pk_add_f32 v[244:245], v[244:245], 1.0 op_sel_hi:[1,0]
v_pk_add_f32 v[246:247], v[246:247], 1.0 op_sel_hi:[1,0]
v_pk_add_f32 v[248:249], v[248:249], 1.0 op_sel_hi:[1,0]
v_pk_add_f32 v[250:251], v[250:251], 1.0 op_sel_hi:[1,0]
v_pk_add_f32 v[252:253], v[252:253], 1.0 op_sel_hi:[1,0]
v_pk_add_f32 v[254:255], v[254:255], 1.0 op_sel_hi:[1,0]
v_rcp_f32 v240, v240
v_rcp_f32 v241, v241
v_rcp_f32 v242, v242
v_rcp_f32 v243, v243
v_rcp_f32 v244, v244
v_rcp_f32 v245, v245
v_rcp_f32 v246, v246
v_rcp_f32 v247, v247
v_rcp_f32 v248, v248
v_rcp_f32 v249, v249
v_rcp_f32 v250, v250
v_rcp_f32 v251, v251
v_rcp_f32 v252, v252
v_rcp_f32 v253, v253
v_rcp_f32 v254, v254
v_rcp_f32 v255, v255
v_pk_mul_f32 v[240:241], v[240:241], v[144:145]
v_pk_mul_f32 v[242:243], v[242:243], v[146:147]
v_pk_mul_f32 v[244:245], v[244:245], v[148:149]
v_pk_mul_f32 v[246:247], v[246:247], v[150:151]
v_pk_mul_f32 v[248:249], v[248:249], v[152:153]
v_pk_mul_f32 v[250:251], v[250:251], v[154:155]
v_pk_mul_f32 v[252:253], v[252:253], v[156:157]
v_pk_mul_f32 v[254:255], v[254:255], v[158:159]
v_cvt_pk_bf16_f32 v144, v240, v241
v_cvt_pk_bf16_f32 v145, v242, v243
v_cvt_pk_bf16_f32 v146, v244, v245
v_cvt_pk_bf16_f32 v147, v246, v247
v_cvt_pk_bf16_f32 v148, v248, v249
v_cvt_pk_bf16_f32 v149, v250, v251
v_cvt_pk_bf16_f32 v150, v252, v253
v_cvt_pk_bf16_f32 v151, v254, v255
buffer_store_dwordx4 v[144:147], v3, s[36:39], s40 offen offset:0 sc1
buffer_store_dwordx4 v[148:151], v3, s[36:39], s40 offen offset:1024 sc1
v_pk_mul_f32 v[240:241], v[160:161], v[160:161]
v_pk_mul_f32 v[242:243], v[162:163], v[162:163]
v_pk_mul_f32 v[244:245], v[164:165], v[164:165]
v_pk_mul_f32 v[246:247], v[166:167], v[166:167]
v_pk_mul_f32 v[248:249], v[168:169], v[168:169]
v_pk_mul_f32 v[250:251], v[170:171], v[170:171]
v_pk_mul_f32 v[252:253], v[172:173], v[172:173]
v_pk_mul_f32 v[254:255], v[174:175], v[174:175]
v_pk_fma_f32 v[240:241], v[240:241], v[8:9], v[8:9] op_sel:[0,1,0] op_sel_hi:[1,1,0]
v_pk_fma_f32 v[242:243], v[242:243], v[8:9], v[8:9] op_sel:[0,1,0] op_sel_hi:[1,1,0]
v_pk_fma_f32 v[244:245], v[244:245], v[8:9], v[8:9] op_sel:[0,1,0] op_sel_hi:[1,1,0]
v_pk_fma_f32 v[246:247], v[246:247], v[8:9], v[8:9] op_sel:[0,1,0] op_sel_hi:[1,1,0]
v_pk_fma_f32 v[248:249], v[248:249], v[8:9], v[8:9] op_sel:[0,1,0] op_sel_hi:[1,1,0]
v_pk_fma_f32 v[250:251], v[250:251], v[8:9], v[8:9] op_sel:[0,1,0] op_sel_hi:[1,1,0]
v_pk_fma_f32 v[252:253], v[252:253], v[8:9], v[8:9] op_sel:[0,1,0] op_sel_hi:[1,1,0]
v_pk_fma_f32 v[254:255], v[254:255], v[8:9], v[8:9] op_sel:[0,1,0] op_sel_hi:[1,1,0]
v_pk_mul_f32 v[240:241], v[240:241], v[160:161]
v_pk_mul_f32 v[242:243], v[242:243], v[162:163]
v_pk_mul_f32 v[244:245], v[244:245], v[164:165]
v_pk_mul_f32 v[246:247], v[246:247], v[166:167]
v_pk_mul_f32 v[248:249], v[248:249], v[168:169]
v_pk_mul_f32 v[250:251], v[250:251], v[170:171]
v_pk_mul_f32 v[252:253], v[252:253], v[172:173]
v_pk_mul_f32 v[254:255], v[254:255], v[174:175]
v_exp_f32 v240, v240
v_exp_f32 v241, v241
v_exp_f32 v242, v242
v_exp_f32 v243, v243
v_exp_f32 v244, v244
v_exp_f32 v245, v245
v_exp_f32 v246, v246
v_exp_f32 v247, v247
v_exp_f32 v248, v248
v_exp_f32 v249, v249
v_exp_f32 v250, v250
v_exp_f32 v251, v251
v_exp_f32 v252, v252
v_exp_f32 v253, v253
v_exp_f32 v254, v254
v_exp_f32 v255, v255
v_pk_add_f32 v[240:241], v[240:241], 1.0 op_sel_hi:[1,0]
v_pk_add_f32 v[242:243], v[242:243], 1.0 op_sel_hi:[1,0]
v_pk_add_f32 v[244:245], v[244:245], 1.0 op_sel_hi:[1,0]
v_pk_add_f32 v[246:247], v[246:247], 1.0 op_sel_hi:[1,0]
v_pk_add_f32 v[248:249], v[248:249], 1.0 op_sel_hi:[1,0]
v_pk_add_f32 v[250:251], v[250:251], 1.0 op_sel_hi:[1,0]
v_pk_add_f32 v[252:253], v[252:253], 1.0 op_sel_hi:[1,0]
v_pk_add_f32 v[254:255], v[254:255], 1.0 op_sel_hi:[1,0]
v_rcp_f32 v240, v240
v_rcp_f32 v241, v241
v_rcp_f32 v242, v242
v_rcp_f32 v243, v243
v_rcp_f32 v244, v244
v_rcp_f32 v245, v245
v_rcp_f32 v246, v246
v_rcp_f32 v247, v247
v_rcp_f32 v248, v248
v_rcp_f32 v249, v249
v_rcp_f32 v250, v250
v_rcp_f32 v251, v251
v_rcp_f32 v252, v252
v_rcp_f32 v253, v253
v_rcp_f32 v254, v254
v_rcp_f32 v255, v255
v_pk_mul_f32 v[240:241], v[240:241], v[160:161]
v_pk_mul_f32 v[242:243], v[242:243], v[162:163]
v_pk_mul_f32 v[244:245], v[244:245], v[164:165]
v_pk_mul_f32 v[246:247], v[246:247], v[166:167]
v_pk_mul_f32 v[248:249], v[248:249], v[168:169]
v_pk_mul_f32 v[250:251], v[250:251], v[170:171]
v_pk_mul_f32 v[252:253], v[252:253], v[172:173]
v_pk_mul_f32 v[254:255], v[254:255], v[174:175]
v_cvt_pk_bf16_f32 v160, v240, v241
v_cvt_pk_bf16_f32 v161, v242, v243
v_cvt_pk_bf16_f32 v162, v244, v245
v_cvt_pk_bf16_f32 v163, v246, v247
v_cvt_pk_bf16_f32 v164, v248, v249
v_cvt_pk_bf16_f32 v165, v250, v251
v_cvt_pk_bf16_f32 v166, v252, v253
v_cvt_pk_bf16_f32 v167, v254, v255
buffer_store_dwordx4 v[160:163], v4, s[36:39], s40 offen offset:0 sc1
buffer_store_dwordx4 v[164:167], v4, s[36:39], s40 offen offset:1024 sc1
s_add_u32 s40, s40, 0x800
v_pk_mul_f32 v[240:241], v[176:177], v[176:177]
v_pk_mul_f32 v[242:243], v[178:179], v[178:179]
v_pk_mul_f32 v[244:245], v[180:181], v[180:181]
v_pk_mul_f32 v[246:247], v[182:183], v[182:183]
v_pk_mul_f32 v[248:249], v[184:185], v[184:185]
v_pk_mul_f32 v[250:251], v[186:187], v[186:187]
v_pk_mul_f32 v[252:253], v[188:189], v[188:189]
v_pk_mul_f32 v[254:255], v[190:191], v[190:191]
v_pk_fma_f32 v[240:241], v[240:241], v[8:9], v[8:9] op_sel:[0,1,0] op_sel_hi:[1,1,0]
v_pk_fma_f32 v[242:243], v[242:243], v[8:9], v[8:9] op_sel:[0,1,0] op_sel_hi:[1,1,0]
v_pk_fma_f32 v[244:245], v[244:245], v[8:9], v[8:9] op_sel:[0,1,0] op_sel_hi:[1,1,0]
v_pk_fma_f32 v[246:247], v[246:247], v[8:9], v[8:9] op_sel:[0,1,0] op_sel_hi:[1,1,0]
v_pk_fma_f32 v[248:249], v[248:249], v[8:9], v[8:9] op_sel:[0,1,0] op_sel_hi:[1,1,0]
v_pk_fma_f32 v[250:251], v[250:251], v[8:9], v[8:9] op_sel:[0,1,0] op_sel_hi:[1,1,0]
v_pk_fma_f32 v[252:253], v[252:253], v[8:9], v[8:9] op_sel:[0,1,0] op_sel_hi:[1,1,0]
v_pk_fma_f32 v[254:255], v[254:255], v[8:9], v[8:9] op_sel:[0,1,0] op_sel_hi:[1,1,0]
v_pk_mul_f32 v[240:241], v[240:241], v[176:177]
v_pk_mul_f32 v[242:243], v[242:243], v[178:179]
v_pk_mul_f32 v[244:245], v[244:245], v[180:181]
v_pk_mul_f32 v[246:247], v[246:247], v[182:183]
v_pk_mul_f32 v[248:249], v[248:249], v[184:185]
v_pk_mul_f32 v[250:251], v[250:251], v[186:187]
v_pk_mul_f32 v[252:253], v[252:253], v[188:189]
v_pk_mul_f32 v[254:255], v[254:255], v[190:191]
v_exp_f32 v240, v240
v_exp_f32 v241, v241
v_exp_f32 v242, v242
v_exp_f32 v243, v243
v_exp_f32 v244, v244
v_exp_f32 v245, v245
v_exp_f32 v246, v246
v_exp_f32 v247, v247
v_exp_f32 v248, v248
v_exp_f32 v249, v249
v_exp_f32 v250, v250
v_exp_f32 v251, v251
v_exp_f32 v252, v252
v_exp_f32 v253, v253
v_exp_f32 v254, v254
v_exp_f32 v255, v255
v_pk_add_f32 v[240:241], v[240:241], 1.0 op_sel_hi:[1,0]
v_pk_add_f32 v[242:243], v[242:243], 1.0 op_sel_hi:[1,0]
v_pk_add_f32 v[244:245], v[244:245], 1.0 op_sel_hi:[1,0]
v_pk_add_f32 v[246:247], v[246:247], 1.0 op_sel_hi:[1,0]
v_pk_add_f32 v[248:249], v[248:249], 1.0 op_sel_hi:[1,0]
v_pk_add_f32 v[250:251], v[250:251], 1.0 op_sel_hi:[1,0]
v_pk_add_f32 v[252:253], v[252:253], 1.0 op_sel_hi:[1,0]
v_pk_add_f32 v[254:255], v[254:255], 1.0 op_sel_hi:[1,0]
v_rcp_f32 v240, v240
v_rcp_f32 v241, v241
v_rcp_f32 v242, v242
v_rcp_f32 v243, v243
v_rcp_f32 v244, v244
v_rcp_f32 v245, v245
v_rcp_f32 v246, v246
v_rcp_f32 v247, v247
v_rcp_f32 v248, v248
v_rcp_f32 v249, v249
v_rcp_f32 v250, v250
v_rcp_f32 v251, v251
v_rcp_f32 v252, v252
v_rcp_f32 v253, v253
v_rcp_f32 v254, v254
v_rcp_f32 v255, v255
v_pk_mul_f32 v[240:241], v[240:241], v[176:177]
v_pk_mul_f32 v[242:243], v[242:243], v[178:179]
v_pk_mul_f32 v[244:245], v[244:245], v[180:181]
v_pk_mul_f32 v[246:247], v[246:247], v[182:183]
v_pk_mul_f32 v[248:249], v[248:249], v[184:185]
v_pk_mul_f32 v[250:251], v[250:251], v[186:187]
v_pk_mul_f32 v[252:253], v[252:253], v[188:189]
v_pk_mul_f32 v[254:255], v[254:255], v[190:191]
v_cvt_pk_bf16_f32 v176, v240, v241
v_cvt_pk_bf16_f32 v177, v242, v243
v_cvt_pk_bf16_f32 v178, v244, v245
v_cvt_pk_bf16_f32 v179, v246, v247
v_cvt_pk_bf16_f32 v180, v248, v249
v_cvt_pk_bf16_f32 v181, v250, v251
v_cvt_pk_bf16_f32 v182, v252, v253
v_cvt_pk_bf16_f32 v183, v254, v255
buffer_store_dwordx4 v[176:179], v3, s[36:39], s40 offen offset:0 sc1
buffer_store_dwordx4 v[180:183], v3, s[36:39], s40 offen offset:1024 sc1
v_pk_mul_f32 v[240:241], v[192:193], v[192:193]
v_pk_mul_f32 v[242:243], v[194:195], v[194:195]
v_pk_mul_f32 v[244:245], v[196:197], v[196:197]
v_pk_mul_f32 v[246:247], v[198:199], v[198:199]
v_pk_mul_f32 v[248:249], v[200:201], v[200:201]
v_pk_mul_f32 v[250:251], v[202:203], v[202:203]
v_pk_mul_f32 v[252:253], v[204:205], v[204:205]
v_pk_mul_f32 v[254:255], v[206:207], v[206:207]
v_pk_fma_f32 v[240:241], v[240:241], v[8:9], v[8:9] op_sel:[0,1,0] op_sel_hi:[1,1,0]
v_pk_fma_f32 v[242:243], v[242:243], v[8:9], v[8:9] op_sel:[0,1,0] op_sel_hi:[1,1,0]
v_pk_fma_f32 v[244:245], v[244:245], v[8:9], v[8:9] op_sel:[0,1,0] op_sel_hi:[1,1,0]
v_pk_fma_f32 v[246:247], v[246:247], v[8:9], v[8:9] op_sel:[0,1,0] op_sel_hi:[1,1,0]
v_pk_fma_f32 v[248:249], v[248:249], v[8:9], v[8:9] op_sel:[0,1,0] op_sel_hi:[1,1,0]
v_pk_fma_f32 v[250:251], v[250:251], v[8:9], v[8:9] op_sel:[0,1,0] op_sel_hi:[1,1,0]
v_pk_fma_f32 v[252:253], v[252:253], v[8:9], v[8:9] op_sel:[0,1,0] op_sel_hi:[1,1,0]
v_pk_fma_f32 v[254:255], v[254:255], v[8:9], v[8:9] op_sel:[0,1,0] op_sel_hi:[1,1,0]
v_pk_mul_f32 v[240:241], v[240:241], v[192:193]
v_pk_mul_f32 v[242:243], v[242:243], v[194:195]
v_pk_mul_f32 v[244:245], v[244:245], v[196:197]
v_pk_mul_f32 v[246:247], v[246:247], v[198:199]
v_pk_mul_f32 v[248:249], v[248:249], v[200:201]
v_pk_mul_f32 v[250:251], v[250:251], v[202:203]
v_pk_mul_f32 v[252:253], v[252:253], v[204:205]
v_pk_mul_f32 v[254:255], v[254:255], v[206:207]
v_exp_f32 v240, v240
v_exp_f32 v241, v241
v_exp_f32 v242, v242
v_exp_f32 v243, v243
v_exp_f32 v244, v244
v_exp_f32 v245, v245
v_exp_f32 v246, v246
v_exp_f32 v247, v247
v_exp_f32 v248, v248
v_exp_f32 v249, v249
v_exp_f32 v250, v250
v_exp_f32 v251, v251
v_exp_f32 v252, v252
v_exp_f32 v253, v253
v_exp_f32 v254, v254
v_exp_f32 v255, v255
v_pk_add_f32 v[240:241], v[240:241], 1.0 op_sel_hi:[1,0]
v_pk_add_f32 v[242:243], v[242:243], 1.0 op_sel_hi:[1,0]
v_pk_add_f32 v[244:245], v[244:245], 1.0 op_sel_hi:[1,0]
v_pk_add_f32 v[246:247], v[246:247], 1.0 op_sel_hi:[1,0]
v_pk_add_f32 v[248:249], v[248:249], 1.0 op_sel_hi:[1,0]
v_pk_add_f32 v[250:251], v[250:251], 1.0 op_sel_hi:[1,0]
v_pk_add_f32 v[252:253], v[252:253], 1.0 op_sel_hi:[1,0]
v_pk_add_f32 v[254:255], v[254:255], 1.0 op_sel_hi:[1,0]
v_rcp_f32 v240, v240
v_rcp_f32 v241, v241
v_rcp_f32 v242, v242
v_rcp_f32 v243, v243
v_rcp_f32 v244, v244
v_rcp_f32 v245, v245
v_rcp_f32 v246, v246
v_rcp_f32 v247, v247
v_rcp_f32 v248, v248
v_rcp_f32 v249, v249
v_rcp_f32 v250, v250
v_rcp_f32 v251, v251
v_rcp_f32 v252, v252
v_rcp_f32 v253, v253
v_rcp_f32 v254, v254
v_rcp_f32 v255, v255
v_pk_mul_f32 v[240:241], v[240:241], v[192:193]
v_pk_mul_f32 v[242:243], v[242:243], v[194:195]
v_pk_mul_f32 v[244:245], v[244:245], v[196:197]
v_pk_mul_f32 v[246:247], v[246:247], v[198:199]
v_pk_mul_f32 v[248:249], v[248:249], v[200:201]
v_pk_mul_f32 v[250:251], v[250:251], v[202:203]
v_pk_mul_f32 v[252:253], v[252:253], v[204:205]
v_pk_mul_f32 v[254:255], v[254:255], v[206:207]
v_cvt_pk_bf16_f32 v192, v240, v241
v_cvt_pk_bf16_f32 v193, v242, v243
v_cvt_pk_bf16_f32 v194, v244, v245
v_cvt_pk_bf16_f32 v195, v246, v247
v_cvt_pk_bf16_f32 v196, v248, v249
v_cvt_pk_bf16_f32 v197, v250, v251
v_cvt_pk_bf16_f32 v198, v252, v253
v_cvt_pk_bf16_f32 v199, v254, v255
buffer_store_dwordx4 v[192:195], v4, s[36:39], s40 offen offset:0 sc1
buffer_store_dwordx4 v[196:199], v4, s[36:39], s40 offen offset:1024 sc1
s_add_u32 s40, s40, 0x800
v_pk_mul_f32 v[240:241], v[208:209], v[208:209]
v_pk_mul_f32 v[242:243], v[210:211], v[210:211]
v_pk_mul_f32 v[244:245], v[212:213], v[212:213]
v_pk_mul_f32 v[246:247], v[214:215], v[214:215]
v_pk_mul_f32 v[248:249], v[216:217], v[216:217]
v_pk_mul_f32 v[250:251], v[218:219], v[218:219]
v_pk_mul_f32 v[252:253], v[220:221], v[220:221]
v_pk_mul_f32 v[254:255], v[222:223], v[222:223]
v_pk_fma_f32 v[240:241], v[240:241], v[8:9], v[8:9] op_sel:[0,1,0] op_sel_hi:[1,1,0]
v_pk_fma_f32 v[242:243], v[242:243], v[8:9], v[8:9] op_sel:[0,1,0] op_sel_hi:[1,1,0]
v_pk_fma_f32 v[244:245], v[244:245], v[8:9], v[8:9] op_sel:[0,1,0] op_sel_hi:[1,1,0]
v_pk_fma_f32 v[246:247], v[246:247], v[8:9], v[8:9] op_sel:[0,1,0] op_sel_hi:[1,1,0]
v_pk_fma_f32 v[248:249], v[248:249], v[8:9], v[8:9] op_sel:[0,1,0] op_sel_hi:[1,1,0]
v_pk_fma_f32 v[250:251], v[250:251], v[8:9], v[8:9] op_sel:[0,1,0] op_sel_hi:[1,1,0]
v_pk_fma_f32 v[252:253], v[252:253], v[8:9], v[8:9] op_sel:[0,1,0] op_sel_hi:[1,1,0]
v_pk_fma_f32 v[254:255], v[254:255], v[8:9], v[8:9] op_sel:[0,1,0] op_sel_hi:[1,1,0]
v_pk_mul_f32 v[240:241], v[240:241], v[208:209]
v_pk_mul_f32 v[242:243], v[242:243], v[210:211]
v_pk_mul_f32 v[244:245], v[244:245], v[212:213]
v_pk_mul_f32 v[246:247], v[246:247], v[214:215]
v_pk_mul_f32 v[248:249], v[248:249], v[216:217]
v_pk_mul_f32 v[250:251], v[250:251], v[218:219]
v_pk_mul_f32 v[252:253], v[252:253], v[220:221]
v_pk_mul_f32 v[254:255], v[254:255], v[222:223]
v_exp_f32 v240, v240
v_exp_f32 v241, v241
v_exp_f32 v242, v242
v_exp_f32 v243, v243
v_exp_f32 v244, v244
v_exp_f32 v245, v245
v_exp_f32 v246, v246
v_exp_f32 v247, v247
v_exp_f32 v248, v248
v_exp_f32 v249, v249
v_exp_f32 v250, v250
v_exp_f32 v251, v251
v_exp_f32 v252, v252
v_exp_f32 v253, v253
v_exp_f32 v254, v254
v_exp_f32 v255, v255
v_pk_add_f32 v[240:241], v[240:241], 1.0 op_sel_hi:[1,0]
v_pk_add_f32 v[242:243], v[242:243], 1.0 op_sel_hi:[1,0]
v_pk_add_f32 v[244:245], v[244:245], 1.0 op_sel_hi:[1,0]
v_pk_add_f32 v[246:247], v[246:247], 1.0 op_sel_hi:[1,0]
v_pk_add_f32 v[248:249], v[248:249], 1.0 op_sel_hi:[1,0]
v_pk_add_f32 v[250:251], v[250:251], 1.0 op_sel_hi:[1,0]
v_pk_add_f32 v[252:253], v[252:253], 1.0 op_sel_hi:[1,0]
v_pk_add_f32 v[254:255], v[254:255], 1.0 op_sel_hi:[1,0]
v_rcp_f32 v240, v240
v_rcp_f32 v241, v241
v_rcp_f32 v242, v242
v_rcp_f32 v243, v243
v_rcp_f32 v244, v244
v_rcp_f32 v245, v245
v_rcp_f32 v246, v246
v_rcp_f32 v247, v247
v_rcp_f32 v248, v248
v_rcp_f32 v249, v249
v_rcp_f32 v250, v250
v_rcp_f32 v251, v251
v_rcp_f32 v252, v252
v_rcp_f32 v253, v253
v_rcp_f32 v254, v254
v_rcp_f32 v255, v255
v_pk_mul_f32 v[240:241], v[240:241], v[208:209]
v_pk_mul_f32 v[242:243], v[242:243], v[210:211]
v_pk_mul_f32 v[244:245], v[244:245], v[212:213]
v_pk_mul_f32 v[246:247], v[246:247], v[214:215]
v_pk_mul_f32 v[248:249], v[248:249], v[216:217]
v_pk_mul_f32 v[250:251], v[250:251], v[218:219]
v_pk_mul_f32 v[252:253], v[252:253], v[220:221]
v_pk_mul_f32 v[254:255], v[254:255], v[222:223]
v_cvt_pk_bf16_f32 v208, v240, v241
v_cvt_pk_bf16_f32 v209, v242, v243
v_cvt_pk_bf16_f32 v210, v244, v245
v_cvt_pk_bf16_f32 v211, v246, v247
v_cvt_pk_bf16_f32 v212, v248, v249
v_cvt_pk_bf16_f32 v213, v250, v251
v_cvt_pk_bf16_f32 v214, v252, v253
v_cvt_pk_bf16_f32 v215, v254, v255
buffer_store_dwordx4 v[208:211], v3, s[36:39], s40 offen offset:0 sc1
buffer_store_dwordx4 v[212:215], v3, s[36:39], s40 offen offset:1024 sc1
v_pk_mul_f32 v[240:241], v[224:225], v[224:225]
v_pk_mul_f32 v[242:243], v[226:227], v[226:227]
v_pk_mul_f32 v[244:245], v[228:229], v[228:229]
v_pk_mul_f32 v[246:247], v[230:231], v[230:231]
v_pk_mul_f32 v[248:249], v[232:233], v[232:233]
v_pk_mul_f32 v[250:251], v[234:235], v[234:235]
v_pk_mul_f32 v[252:253], v[236:237], v[236:237]
v_pk_mul_f32 v[254:255], v[238:239], v[238:239]
v_pk_fma_f32 v[240:241], v[240:241], v[8:9], v[8:9] op_sel:[0,1,0] op_sel_hi:[1,1,0]
v_pk_fma_f32 v[242:243], v[242:243], v[8:9], v[8:9] op_sel:[0,1,0] op_sel_hi:[1,1,0]
v_pk_fma_f32 v[244:245], v[244:245], v[8:9], v[8:9] op_sel:[0,1,0] op_sel_hi:[1,1,0]
v_pk_fma_f32 v[246:247], v[246:247], v[8:9], v[8:9] op_sel:[0,1,0] op_sel_hi:[1,1,0]
v_pk_fma_f32 v[248:249], v[248:249], v[8:9], v[8:9] op_sel:[0,1,0] op_sel_hi:[1,1,0]
v_pk_fma_f32 v[250:251], v[250:251], v[8:9], v[8:9] op_sel:[0,1,0] op_sel_hi:[1,1,0]
v_pk_fma_f32 v[252:253], v[252:253], v[8:9], v[8:9] op_sel:[0,1,0] op_sel_hi:[1,1,0]
v_pk_fma_f32 v[254:255], v[254:255], v[8:9], v[8:9] op_sel:[0,1,0] op_sel_hi:[1,1,0]
v_pk_mul_f32 v[240:241], v[240:241], v[224:225]
v_pk_mul_f32 v[242:243], v[242:243], v[226:227]
v_pk_mul_f32 v[244:245], v[244:245], v[228:229]
v_pk_mul_f32 v[246:247], v[246:247], v[230:231]
v_pk_mul_f32 v[248:249], v[248:249], v[232:233]
v_pk_mul_f32 v[250:251], v[250:251], v[234:235]
v_pk_mul_f32 v[252:253], v[252:253], v[236:237]
v_pk_mul_f32 v[254:255], v[254:255], v[238:239]
v_exp_f32 v240, v240
v_exp_f32 v241, v241
v_exp_f32 v242, v242
v_exp_f32 v243, v243
v_exp_f32 v244, v244
v_exp_f32 v245, v245
v_exp_f32 v246, v246
v_exp_f32 v247, v247
v_exp_f32 v248, v248
v_exp_f32 v249, v249
v_exp_f32 v250, v250
v_exp_f32 v251, v251
v_exp_f32 v252, v252
v_exp_f32 v253, v253
v_exp_f32 v254, v254
v_exp_f32 v255, v255
v_pk_add_f32 v[240:241], v[240:241], 1.0 op_sel_hi:[1,0]
v_pk_add_f32 v[242:243], v[242:243], 1.0 op_sel_hi:[1,0]
v_pk_add_f32 v[244:245], v[244:245], 1.0 op_sel_hi:[1,0]
v_pk_add_f32 v[246:247], v[246:247], 1.0 op_sel_hi:[1,0]
v_pk_add_f32 v[248:249], v[248:249], 1.0 op_sel_hi:[1,0]
v_pk_add_f32 v[250:251], v[250:251], 1.0 op_sel_hi:[1,0]
v_pk_add_f32 v[252:253], v[252:253], 1.0 op_sel_hi:[1,0]
v_pk_add_f32 v[254:255], v[254:255], 1.0 op_sel_hi:[1,0]
v_rcp_f32 v240, v240
v_rcp_f32 v241, v241
v_rcp_f32 v242, v242
v_rcp_f32 v243, v243
v_rcp_f32 v244, v244
v_rcp_f32 v245, v245
v_rcp_f32 v246, v246
v_rcp_f32 v247, v247
v_rcp_f32 v248, v248
v_rcp_f32 v249, v249
v_rcp_f32 v250, v250
v_rcp_f32 v251, v251
v_rcp_f32 v252, v252
v_rcp_f32 v253, v253
v_rcp_f32 v254, v254
v_rcp_f32 v255, v255
v_pk_mul_f32 v[240:241], v[240:241], v[224:225]
v_pk_mul_f32 v[242:243], v[242:243], v[226:227]
v_pk_mul_f32 v[244:245], v[244:245], v[228:229]
v_pk_mul_f32 v[246:247], v[246:247], v[230:231]
v_pk_mul_f32 v[248:249], v[248:249], v[232:233]
v_pk_mul_f32 v[250:251], v[250:251], v[234:235]
v_pk_mul_f32 v[252:253], v[252:253], v[236:237]
v_pk_mul_f32 v[254:255], v[254:255], v[238:239]
v_cvt_pk_bf16_f32 v224, v240, v241
v_cvt_pk_bf16_f32 v225, v242, v243
v_cvt_pk_bf16_f32 v226, v244, v245
v_cvt_pk_bf16_f32 v227, v246, v247
v_cvt_pk_bf16_f32 v228, v248, v249
v_cvt_pk_bf16_f32 v229, v250, v251
v_cvt_pk_bf16_f32 v230, v252, v253
v_cvt_pk_bf16_f32 v231, v254, v255
buffer_store_dwordx4 v[224:227], v4, s[36:39], s40 offen offset:0 sc1
buffer_store_dwordx4 v[228:231], v4, s[36:39], s40 offen offset:1024 sc1
s_add_u32 s40, s40, 0x800
ds_read_b128 v[16:19], v1
ds_read_b128 v[20:23], v2
s_setprio 2
s_waitcnt vmcnt(35)
s_waitcnt lgkmcnt(0)
v_mfma_f32_32x32x16_bf16 v[112:127], v[32:35], v[16:19], 0
ds_read_b128 v[24:27], v1 offset:1024
v_mfma_f32_32x32x16_bf16 v[128:143], v[32:35], v[20:23], 0
ds_read_b128 v[28:31], v2 offset:1024
buffer_load_dwordx4 v[32:35], v1, s[8:11], s21 offen offset:2048
s_add_u32 s21, s21, 55296
s_waitcnt vmcnt(35)
v_mfma_f32_32x32x16_bf16 v[144:159], v[36:39], v[16:19], 0
v_mfma_f32_32x32x16_bf16 v[160:175], v[36:39], v[20:23], 0
buffer_load_dwordx4 v[36:39], v1, s[8:11], s21 offen offset:0
s_waitcnt vmcnt(35)
v_mfma_f32_32x32x16_bf16 v[176:191], v[40:43], v[16:19], 0
v_mfma_f32_32x32x16_bf16 v[192:207], v[40:43], v[20:23], 0
buffer_load_dwordx4 v[40:43], v1, s[8:11], s21 offen offset:1024
s_waitcnt vmcnt(35)
s_waitcnt lgkmcnt(0)
v_mfma_f32_32x32x16_bf16 v[112:127], v[44:47], v[24:27], v[112:127]
ds_read_b128 v[16:19], v1 offset:2048
v_mfma_f32_32x32x16_bf16 v[128:143], v[44:47], v[28:31], v[128:143]
ds_read_b128 v[20:23], v2 offset:2048
buffer_load_dwordx4 v[44:47], v1, s[8:11], s21 offen offset:2048
s_add_u32 s21, s21, 55296
s_waitcnt vmcnt(35)
v_mfma_f32_32x32x16_bf16 v[144:159], v[48:51], v[24:27], v[144:159]
v_mfma_f32_32x32x16_bf16 v[160:175], v[48:51], v[28:31], v[160:175]
buffer_load_dwordx4 v[48:51], v1, s[8:11], s21 offen offset:0
s_waitcnt vmcnt(35)
v_mfma_f32_32x32x16_bf16 v[176:191], v[52:55], v[24:27], v[176:191]
v_mfma_f32_32x32x16_bf16 v[192:207], v[52:55], v[28:31], v[192:207]
buffer_load_dwordx4 v[52:55], v1, s[8:11], s21 offen offset:1024
s_waitcnt vmcnt(35)
s_waitcnt lgkmcnt(0)
v_mfma_f32_32x32x16_bf16 v[112:127], v[56:59], v[16:19], v[112:127]
ds_read_b128 v[24:27], v1 offset:3072
v_mfma_f32_32x32x16_bf16 v[128:143], v[56:59], v[20:23], v[128:143]
ds_read_b128 v[28:31], v2 offset:3072
buffer_load_dwordx4 v[56:59], v1, s[8:11], s21 offen offset:2048
s_add_u32 s21, s21, 55296
s_waitcnt vmcnt(35)
v_mfma_f32_32x32x16_bf16 v[144:159], v[60:63], v[16:19], v[144:159]
v_mfma_f32_32x32x16_bf16 v[160:175], v[60:63], v[20:23], v[160:175]
buffer_load_dwordx4 v[60:63], v1, s[8:11], s21 offen offset:0
s_waitcnt vmcnt(35)
v_mfma_f32_32x32x16_bf16 v[176:191], v[64:67], v[16:19], v[176:191]
v_mfma_f32_32x32x16_bf16 v[192:207], v[64:67], v[20:23], v[192:207]
buffer_load_dwordx4 v[64:67], v1, s[8:11], s21 offen offset:1024
s_waitcnt vmcnt(35)
s_waitcnt lgkmcnt(0)
v_mfma_f32_32x32x16_bf16 v[112:127], v[68:71], v[24:27], v[112:127]
ds_read_b128 v[16:19], v1 offset:4096
v_mfma_f32_32x32x16_bf16 v[128:143], v[68:71], v[28:31], v[128:143]
ds_read_b128 v[20:23], v2 offset:4096
buffer_load_dwordx4 v[68:71], v1, s[8:11], s21 offen offset:2048
s_add_u32 s21, s21, 55296
s_cmp_ge_u32 s21, s47
s_cselect_b32 s45, 2211840, 0
s_sub_u32 s21, s21, s45
s_waitcnt vmcnt(35)
v_mfma_f32_32x32x16_bf16 v[144:159], v[72:75], v[24:27], v[144:159]
v_mfma_f32_32x32x16_bf16 v[160:175], v[72:75], v[28:31], v[160:175]
buffer_load_dwordx4 v[72:75], v1, s[8:11], s21 offen offset:0
s_waitcnt vmcnt(35)
v_mfma_f32_32x32x16_bf16 v[176:191], v[76:79], v[24:27], v[176:191]
v_mfma_f32_32x32x16_bf16 v[192:207], v[76:79], v[28:31], v[192:207]
buffer_load_dwordx4 v[76:79], v1, s[8:11], s21 offen offset:1024
s_waitcnt vmcnt(35)
s_waitcnt lgkmcnt(0)
v_mfma_f32_32x32x16_bf16 v[112:127], v[80:83], v[16:19], v[112:127]
ds_read_b128 v[24:27], v1 offset:5120
v_mfma_f32_32x32x16_bf16 v[128:143], v[80:83], v[20:23], v[128:143]
ds_read_b128 v[28:31], v2 offset:5120
buffer_load_dwordx4 v[80:83], v1, s[8:11], s21 offen offset:2048
s_add_u32 s21, s21, 55296
s_waitcnt vmcnt(35)
v_mfma_f32_32x32x16_bf16 v[144:159], v[84:87], v[16:19], v[144:159]
v_mfma_f32_32x32x16_bf16 v[160:175], v[84:87], v[20:23], v[160:175]
buffer_load_dwordx4 v[84:87], v1, s[8:11], s21 offen offset:0
s_waitcnt vmcnt(35)
v_mfma_f32_32x32x16_bf16 v[176:191], v[88:91], v[16:19], v[176:191]
v_mfma_f32_32x32x16_bf16 v[192:207], v[88:91], v[20:23], v[192:207]
buffer_load_dwordx4 v[88:91], v1, s[8:11], s21 offen offset:1024
s_waitcnt vmcnt(35)
s_waitcnt lgkmcnt(0)
v_mfma_f32_32x32x16_bf16 v[112:127], v[92:95], v[24:27], v[112:127]
ds_read_b128 v[16:19], v1 offset:6144
v_mfma_f32_32x32x16_bf16 v[128:143], v[92:95], v[28:31], v[128:143]
ds_read_b128 v[20:23], v2 offset:6144
buffer_load_dwordx4 v[92:95], v1, s[8:11], s21 offen offset:2048
s_add_u32 s21, s21, 55296
s_waitcnt vmcnt(35)
v_mfma_f32_32x32x16_bf16 v[144:159], v[96:99], v[24:27], v[144:159]
v_mfma_f32_32x32x16_bf16 v[160:175], v[96:99], v[28:31], v[160:175]
buffer_load_dwordx4 v[96:99], v1, s[8:11], s21 offen offset:0
s_waitcnt vmcnt(35)
v_mfma_f32_32x32x16_bf16 v[176:191], v[100:103], v[24:27], v[176:191]
v_mfma_f32_32x32x16_bf16 v[192:207], v[100:103], v[28:31], v[192:207]
buffer_load_dwordx4 v[100:103], v1, s[8:11], s21 offen offset:1024
s_waitcnt vmcnt(35)
s_waitcnt lgkmcnt(0)
v_mfma_f32_32x32x16_bf16 v[112:127], v[104:107], v[16:19], v[112:127]
ds_read_b128 v[24:27], v1 offset:7168
v_mfma_f32_32x32x16_bf16 v[128:143], v[104:107], v[20:23], v[128:143]
ds_read_b128 v[28:31], v2 offset:7168
buffer_load_dwordx4 v[104:107], v1, s[8:11], s21 offen offset:2048
s_add_u32 s21, s21, 55296
s_waitcnt vmcnt(35)
v_mfma_f32_32x32x16_bf16 v[144:159], v[108:111], v[16:19], v[144:159]
v_mfma_f32_32x32x16_bf16 v[160:175], v[108:111], v[20:23], v[160:175]
buffer_load_dwordx4 v[108:111], v1, s[8:11], s21 offen offset:0
s_waitcnt vmcnt(19)
v_mfma_f32_32x32x16_bf16 v[176:191], v[32:35], v[16:19], v[176:191]
v_mfma_f32_32x32x16_bf16 v[192:207], v[32:35], v[20:23], v[192:207]
buffer_load_dwordx4 v[32:35], v1, s[8:11], s21 offen offset:1024
s_waitcnt vmcnt(19)
s_waitcnt lgkmcnt(0)
v_mfma_f32_32x32x16_bf16 v[112:127], v[36:39], v[24:27], v[112:127]
ds_read_b128 v[16:19], v1 offset:8192
v_mfma_f32_32x32x16_bf16 v[128:143], v[36:39], v[28:31], v[128:143]
ds_read_b128 v[20:23], v2 offset:8192
buffer_load_dwordx4 v[36:39], v1, s[8:11], s21 offen offset:2048
s_add_u32 s21, s21, 55296
s_waitcnt vmcnt(19)
v_mfma_f32_32x32x16_bf16 v[144:159], v[40:43], v[24:27], v[144:159]
v_mfma_f32_32x32x16_bf16 v[160:175], v[40:43], v[28:31], v[160:175]
buffer_load_dwordx4 v[40:43], v1, s[8:11], s21 offen offset:0
s_waitcnt vmcnt(19)
v_mfma_f32_32x32x16_bf16 v[176:191], v[44:47], v[24:27], v[176:191]
v_mfma_f32_32x32x16_bf16 v[192:207], v[44:47], v[28:31], v[192:207]
buffer_load_dwordx4 v[44:47], v1, s[8:11], s21 offen offset:1024
s_waitcnt vmcnt(19)
s_waitcnt lgkmcnt(0)
v_mfma_f32_32x32x16_bf16 v[112:127], v[48:51], v[16:19], v[112:127]
ds_read_b128 v[24:27], v1 offset:9216
v_mfma_f32_32x32x16_bf16 v[128:143], v[48:51], v[20:23], v[128:143]
ds_read_b128 v[28:31], v2 offset:9216
buffer_load_dwordx4 v[48:51], v1, s[8:11], s21 offen offset:2048
s_add_u32 s21, s21, 55296
s_waitcnt vmcnt(19)
v_mfma_f32_32x32x16_bf16 v[144:159], v[52:55], v[16:19], v[144:159]
v_mfma_f32_32x32x16_bf16 v[160:175], v[52:55], v[20:23], v[160:175]
buffer_load_dwordx4 v[52:55], v1, s[8:11], s21 offen offset:0
s_waitcnt vmcnt(19)
v_mfma_f32_32x32x16_bf16 v[176:191], v[56:59], v[16:19], v[176:191]
v_mfma_f32_32x32x16_bf16 v[192:207], v[56:59], v[20:23], v[192:207]
buffer_load_dwordx4 v[56:59], v1, s[8:11], s21 offen offset:1024
s_waitcnt vmcnt(19)
s_waitcnt lgkmcnt(0)
v_mfma_f32_32x32x16_bf16 v[112:127], v[60:63], v[24:27], v[112:127]
ds_read_b128 v[16:19], v1 offset:10240
v_mfma_f32_32x32x16_bf16 v[128:143], v[60:63], v[28:31], v[128:143]
ds_read_b128 v[20:23], v2 offset:10240
buffer_load_dwordx4 v[60:63], v1, s[8:11], s21 offen offset:2048
s_add_u32 s21, s21, 55296
s_waitcnt vmcnt(19)
v_mfma_f32_32x32x16_bf16 v[144:159], v[64:67], v[24:27], v[144:159]
v_mfma_f32_32x32x16_bf16 v[160:175], v[64:67], v[28:31], v[160:175]
buffer_load_dwordx4 v[64:67], v1, s[8:11], s21 offen offset:0
s_waitcnt vmcnt(19)
v_mfma_f32_32x32x16_bf16 v[176:191], v[68:71], v[24:27], v[176:191]
v_mfma_f32_32x32x16_bf16 v[192:207], v[68:71], v[28:31], v[192:207]
buffer_load_dwordx4 v[68:71], v1, s[8:11], s21 offen offset:1024
s_waitcnt vmcnt(19)
s_waitcnt lgkmcnt(0)
v_mfma_f32_32x32x16_bf16 v[112:127], v[72:75], v[16:19], v[112:127]
ds_read_b128 v[24:27], v1 offset:11264
v_mfma_f32_32x32x16_bf16 v[128:143], v[72:75], v[20:23], v[128:143]
ds_read_b128 v[28:31], v2 offset:11264
buffer_load_dwordx4 v[72:75], v1, s[8:11], s21 offen offset:2048
s_add_u32 s21, s21, 55296
s_waitcnt vmcnt(19)
v_mfma_f32_32x32x16_bf16 v[144:159], v[76:79], v[16:19], v[144:159]
v_mfma_f32_32x32x16_bf16 v[160:175], v[76:79], v[20:23], v[160:175]
buffer_load_dwordx4 v[76:79], v1, s[8:11], s21 offen offset:0
s_waitcnt vmcnt(19)
v_mfma_f32_32x32x16_bf16 v[176:191], v[80:83], v[16:19], v[176:191]
v_mfma_f32_32x32x16_bf16 v[192:207], v[80:83], v[20:23], v[192:207]
buffer_load_dwordx4 v[80:83], v1, s[8:11], s21 offen offset:1024
s_waitcnt vmcnt(19)
s_waitcnt lgkmcnt(0)
v_mfma_f32_32x32x16_bf16 v[112:127], v[84:87], v[24:27], v[112:127]
ds_read_b128 v[16:19], v1 offset:12288
v_mfma_f32_32x32x16_bf16 v[128:143], v[84:87], v[28:31], v[128:143]
ds_read_b128 v[20:23], v2 offset:12288
buffer_load_dwordx4 v[84:87], v1, s[8:11], s21 offen offset:2048
s_add_u32 s21, s21, 55296
s_waitcnt vmcnt(19)
v_mfma_f32_32x32x16_bf16 v[144:159], v[88:91], v[24:27], v[144:159]
v_mfma_f32_32x32x16_bf16 v[160:175], v[88:91], v[28:31], v[160:175]
buffer_load_dwordx4 v[88:91], v1, s[8:11], s21 offen offset:0
s_waitcnt vmcnt(19)
v_mfma_f32_32x32x16_bf16 v[176:191], v[92:95], v[24:27], v[176:191]
v_mfma_f32_32x32x16_bf16 v[192:207], v[92:95], v[28:31], v[192:207]
buffer_load_dwordx4 v[92:95], v1, s[8:11], s21 offen offset:1024
s_waitcnt vmcnt(19)
s_waitcnt lgkmcnt(0)
v_mfma_f32_32x32x16_bf16 v[112:127], v[96:99], v[16:19], v[112:127]
ds_read_b128 v[24:27], v1 offset:13312
v_mfma_f32_32x32x16_bf16 v[128:143], v[96:99], v[20:23], v[128:143]
ds_read_b128 v[28:31], v2 offset:13312
buffer_load_dwordx4 v[96:99], v1, s[8:11], s21 offen offset:2048
s_add_u32 s21, s21, 55296
s_waitcnt vmcnt(19)
v_mfma_f32_32x32x16_bf16 v[144:159], v[100:103], v[16:19], v[144:159]
v_mfma_f32_32x32x16_bf16 v[160:175], v[100:103], v[20:23], v[160:175]
buffer_load_dwordx4 v[100:103], v1, s[8:11], s21 offen offset:0
s_waitcnt vmcnt(19)
v_mfma_f32_32x32x16_bf16 v[176:191], v[104:107], v[16:19], v[176:191]
v_mfma_f32_32x32x16_bf16 v[192:207], v[104:107], v[20:23], v[192:207]
buffer_load_dwordx4 v[104:107], v1, s[8:11], s21 offen offset:1024
s_waitcnt vmcnt(19)
s_waitcnt lgkmcnt(0)
v_mfma_f32_32x32x16_bf16 v[112:127], v[108:111], v[24:27], v[112:127]
ds_read_b128 v[16:19], v1 offset:14336
v_mfma_f32_32x32x16_bf16 v[128:143], v[108:111], v[28:31], v[128:143]
ds_read_b128 v[20:23], v2 offset:14336
buffer_load_dwordx4 v[108:111], v1, s[8:11], s21 offen offset:2048
s_add_u32 s21, s21, 55296
s_cmp_ge_u32 s21, s47
s_cselect_b32 s45, 2211840, 0
s_sub_u32 s21, s21, s45
s_waitcnt vmcnt(19)
v_mfma_f32_32x32x16_bf16 v[144:159], v[32:35], v[24:27], v[144:159]
v_mfma_f32_32x32x16_bf16 v[160:175], v[32:35], v[28:31], v[160:175]
buffer_load_dwordx4 v[32:35], v1, s[8:11], s21 offen offset:0
s_waitcnt vmcnt(19)
v_mfma_f32_32x32x16_bf16 v[176:191], v[36:39], v[24:27], v[176:191]
v_mfma_f32_32x32x16_bf16 v[192:207], v[36:39], v[28:31], v[192:207]
buffer_load_dwordx4 v[36:39], v1, s[8:11], s21 offen offset:1024
s_waitcnt vmcnt(19)
s_waitcnt lgkmcnt(0)
v_mfma_f32_32x32x16_bf16 v[112:127], v[40:43], v[16:19], v[112:127]
ds_read_b128 v[24:27], v1 offset:15360
v_mfma_f32_32x32x16_bf16 v[128:143], v[40:43], v[20:23], v[128:143]
ds_read_b128 v[28:31], v2 offset:15360
buffer_load_dwordx4 v[40:43], v1, s[8:11], s21 offen offset:2048
s_add_u32 s21, s21, 55296
s_waitcnt vmcnt(19)
v_mfma_f32_32x32x16_bf16 v[144:159], v[44:47], v[16:19], v[144:159]
v_mfma_f32_32x32x16_bf16 v[160:175], v[44:47], v[20:23], v[160:175]
buffer_load_dwordx4 v[44:47], v1, s[8:11], s21 offen offset:0
s_waitcnt vmcnt(19)
v_mfma_f32_32x32x16_bf16 v[176:191], v[48:51], v[16:19], v[176:191]
v_mfma_f32_32x32x16_bf16 v[192:207], v[48:51], v[20:23], v[192:207]
buffer_load_dwordx4 v[48:51], v1, s[8:11], s21 offen offset:1024
s_waitcnt vmcnt(19)
s_waitcnt lgkmcnt(0)
v_mfma_f32_32x32x16_bf16 v[112:127], v[52:55], v[24:27], v[112:127]
ds_read_b128 v[16:19], v1 offset:16384
v_mfma_f32_32x32x16_bf16 v[128:143], v[52:55], v[28:31], v[128:143]
ds_read_b128 v[20:23], v2 offset:16384
buffer_load_dwordx4 v[52:55], v1, s[8:11], s21 offen offset:2048
s_add_u32 s21, s21, 55296
s_waitcnt vmcnt(19)
v_mfma_f32_32x32x16_bf16 v[144:159], v[56:59], v[24:27], v[144:159]
v_mfma_f32_32x32x16_bf16 v[160:175], v[56:59], v[28:31], v[160:175]
buffer_load_dwordx4 v[56:59], v1, s[8:11], s21 offen offset:0
s_waitcnt vmcnt(19)
v_mfma_f32_32x32x16_bf16 v[176:191], v[60:63], v[24:27], v[176:191]
v_mfma_f32_32x32x16_bf16 v[192:207], v[60:63], v[28:31], v[192:207]
buffer_load_dwordx4 v[60:63], v1, s[8:11], s21 offen offset:1024
s_waitcnt vmcnt(19)
s_waitcnt lgkmcnt(0)
v_mfma_f32_32x32x16_bf16 v[112:127], v[64:67], v[16:19], v[112:127]
ds_read_b128 v[24:27], v1 offset:17408
v_mfma_f32_32x32x16_bf16 v[128:143], v[64:67], v[20:23], v[128:143]
ds_read_b128 v[28:31], v2 offset:17408
buffer_load_dwordx4 v[64:67], v1, s[8:11], s21 offen offset:2048
s_add_u32 s21, s21, 55296
s_waitcnt vmcnt(19)
v_mfma_f32_32x32x16_bf16 v[144:159], v[68:71], v[16:19], v[144:159]
v_mfma_f32_32x32x16_bf16 v[160:175], v[68:71], v[20:23], v[160:175]
buffer_load_dwordx4 v[68:71], v1, s[8:11], s21 offen offset:0
s_waitcnt vmcnt(19)
v_mfma_f32_32x32x16_bf16 v[176:191], v[72:75], v[16:19], v[176:191]
v_mfma_f32_32x32x16_bf16 v[192:207], v[72:75], v[20:23], v[192:207]
buffer_load_dwordx4 v[72:75], v1, s[8:11], s21 offen offset:1024
s_waitcnt vmcnt(19)
s_waitcnt lgkmcnt(0)
v_mfma_f32_32x32x16_bf16 v[112:127], v[76:79], v[24:27], v[112:127]
ds_read_b128 v[16:19], v1 offset:18432
v_mfma_f32_32x32x16_bf16 v[128:143], v[76:79], v[28:31], v[128:143]
ds_read_b128 v[20:23], v2 offset:18432
buffer_load_dwordx4 v[76:79], v1, s[8:11], s21 offen offset:2048
s_add_u32 s21, s21, 55296
s_waitcnt vmcnt(19)
v_mfma_f32_32x32x16_bf16 v[144:159], v[80:83], v[24:27], v[144:159]
v_mfma_f32_32x32x16_bf16 v[160:175], v[80:83], v[28:31], v[160:175]
buffer_load_dwordx4 v[80:83], v1, s[8:11], s21 offen offset:0
s_waitcnt vmcnt(19)
v_mfma_f32_32x32x16_bf16 v[176:191], v[84:87], v[24:27], v[176:191]
v_mfma_f32_32x32x16_bf16 v[192:207], v[84:87], v[28:31], v[192:207]
buffer_load_dwordx4 v[84:87], v1, s[8:11], s21 offen offset:1024
s_waitcnt vmcnt(19)
s_waitcnt lgkmcnt(0)
v_mfma_f32_32x32x16_bf16 v[112:127], v[88:91], v[16:19], v[112:127]
ds_read_b128 v[24:27], v1 offset:19456
v_mfma_f32_32x32x16_bf16 v[128:143], v[88:91], v[20:23], v[128:143]
ds_read_b128 v[28:31], v2 offset:19456
buffer_load_dwordx4 v[88:91], v1, s[8:11], s21 offen offset:2048
s_add_u32 s21, s21, 55296
s_waitcnt vmcnt(19)
v_mfma_f32_32x32x16_bf16 v[144:159], v[92:95], v[16:19], v[144:159]
v_mfma_f32_32x32x16_bf16 v[160:175], v[92:95], v[20:23], v[160:175]
buffer_load_dwordx4 v[92:95], v1, s[8:11], s21 offen offset:0
s_waitcnt vmcnt(19)
v_mfma_f32_32x32x16_bf16 v[176:191], v[96:99], v[16:19], v[176:191]
v_mfma_f32_32x32x16_bf16 v[192:207], v[96:99], v[20:23], v[192:207]
buffer_load_dwordx4 v[96:99], v1, s[8:11], s21 offen offset:1024
s_waitcnt vmcnt(19)
s_waitcnt lgkmcnt(0)
v_mfma_f32_32x32x16_bf16 v[112:127], v[100:103], v[24:27], v[112:127]
ds_read_b128 v[16:19], v1 offset:20480
v_mfma_f32_32x32x16_bf16 v[128:143], v[100:103], v[28:31], v[128:143]
ds_read_b128 v[20:23], v2 offset:20480
buffer_load_dwordx4 v[100:103], v1, s[8:11], s21 offen offset:2048
s_add_u32 s21, s21, 55296
s_waitcnt vmcnt(19)
v_mfma_f32_32x32x16_bf16 v[144:159], v[104:107], v[24:27], v[144:159]
v_mfma_f32_32x32x16_bf16 v[160:175], v[104:107], v[28:31], v[160:175]
buffer_load_dwordx4 v[104:107], v1, s[8:11], s21 offen offset:0
s_waitcnt vmcnt(19)
v_mfma_f32_32x32x16_bf16 v[176:191], v[108:111], v[24:27], v[176:191]
v_mfma_f32_32x32x16_bf16 v[192:207], v[108:111], v[28:31], v[192:207]
buffer_load_dwordx4 v[108:111], v1, s[8:11], s21 offen offset:1024
s_waitcnt vmcnt(19)
s_waitcnt lgkmcnt(0)
v_mfma_f32_32x32x16_bf16 v[112:127], v[32:35], v[16:19], v[112:127]
ds_read_b128 v[24:27], v1 offset:21504
v_mfma_f32_32x32x16_bf16 v[128:143], v[32:35], v[20:23], v[128:143]
ds_read_b128 v[28:31], v2 offset:21504
buffer_load_dwordx4 v[32:35], v1, s[8:11], s21 offen offset:2048
s_add_u32 s21, s21, 55296
s_waitcnt vmcnt(19)
v_mfma_f32_32x32x16_bf16 v[144:159], v[36:39], v[16:19], v[144:159]
v_mfma_f32_32x32x16_bf16 v[160:175], v[36:39], v[20:23], v[160:175]
buffer_load_dwordx4 v[36:39], v1, s[8:11], s21 offen offset:0
s_waitcnt vmcnt(19)
v_mfma_f32_32x32x16_bf16 v[176:191], v[40:43], v[16:19], v[176:191]
v_mfma_f32_32x32x16_bf16 v[192:207], v[40:43], v[20:23], v[192:207]
buffer_load_dwordx4 v[40:43], v1, s[8:11], s21 offen offset:1024
s_waitcnt vmcnt(19)
s_waitcnt lgkmcnt(0)
v_mfma_f32_32x32x16_bf16 v[112:127], v[44:47], v[24:27], v[112:127]
ds_read_b128 v[16:19], v1 offset:22528
v_mfma_f32_32x32x16_bf16 v[128:143], v[44:47], v[28:31], v[128:143]
ds_read_b128 v[20:23], v2 offset:22528
buffer_load_dwordx4 v[44:47], v1, s[8:11], s21 offen offset:2048
s_add_u32 s21, s21, 55296
s_waitcnt vmcnt(19)
v_mfma_f32_32x32x16_bf16 v[144:159], v[48:51], v[24:27], v[144:159]
v_mfma_f32_32x32x16_bf16 v[160:175], v[48:51], v[28:31], v[160:175]
buffer_load_dwordx4 v[48:51], v1, s[8:11], s21 offen offset:0
s_waitcnt vmcnt(19)
v_mfma_f32_32x32x16_bf16 v[176:191], v[52:55], v[24:27], v[176:191]
v_mfma_f32_32x32x16_bf16 v[192:207], v[52:55], v[28:31], v[192:207]
buffer_load_dwordx4 v[52:55], v1, s[8:11], s21 offen offset:1024
s_waitcnt vmcnt(19)
s_waitcnt lgkmcnt(0)
v_mfma_f32_32x32x16_bf16 v[112:127], v[56:59], v[16:19], v[112:127]
ds_read_b128 v[24:27], v1 offset:23552
v_mfma_f32_32x32x16_bf16 v[128:143], v[56:59], v[20:23], v[128:143]
ds_read_b128 v[28:31], v2 offset:23552
buffer_load_dwordx4 v[56:59], v1, s[8:11], s21 offen offset:2048
s_add_u32 s21, s21, 55296
s_waitcnt vmcnt(19)
v_mfma_f32_32x32x16_bf16 v[144:159], v[60:63], v[16:19], v[144:159]
v_mfma_f32_32x32x16_bf16 v[160:175], v[60:63], v[20:23], v[160:175]
buffer_load_dwordx4 v[60:63], v1, s[8:11], s21 offen offset:0
s_waitcnt vmcnt(19)
v_mfma_f32_32x32x16_bf16 v[176:191], v[64:67], v[16:19], v[176:191]
v_mfma_f32_32x32x16_bf16 v[192:207], v[64:67], v[20:23], v[192:207]
buffer_load_dwordx4 v[64:67], v1, s[8:11], s21 offen offset:1024
s_waitcnt vmcnt(19)
s_waitcnt lgkmcnt(0)
v_mfma_f32_32x32x16_bf16 v[112:127], v[68:71], v[24:27], v[112:127]
ds_read_b128 v[16:19], v1 offset:24576
v_mfma_f32_32x32x16_bf16 v[128:143], v[68:71], v[28:31], v[128:143]
ds_read_b128 v[20:23], v2 offset:24576
buffer_load_dwordx4 v[68:71], v1, s[8:11], s21 offen offset:2048
s_add_u32 s21, s21, 55296
s_cmp_ge_u32 s21, s47
s_cselect_b32 s45, 2211840, 0
s_sub_u32 s21, s21, s45
s_waitcnt vmcnt(19)
v_mfma_f32_32x32x16_bf16 v[144:159], v[72:75], v[24:27], v[144:159]
v_mfma_f32_32x32x16_bf16 v[160:175], v[72:75], v[28:31], v[160:175]
buffer_load_dwordx4 v[72:75], v1, s[8:11], s21 offen offset:0
s_waitcnt vmcnt(19)
v_mfma_f32_32x32x16_bf16 v[176:191], v[76:79], v[24:27], v[176:191]
v_mfma_f32_32x32x16_bf16 v[192:207], v[76:79], v[28:31], v[192:207]
buffer_load_dwordx4 v[76:79], v1, s[8:11], s21 offen offset:1024
s_waitcnt vmcnt(19)
s_waitcnt lgkmcnt(0)
v_mfma_f32_32x32x16_bf16 v[112:127], v[80:83], v[16:19], v[112:127]
ds_read_b128 v[24:27], v1 offset:25600
v_mfma_f32_32x32x16_bf16 v[128:143], v[80:83], v[20:23], v[128:143]
ds_read_b128 v[28:31], v2 offset:25600
buffer_load_dwordx4 v[80:83], v1, s[8:11], s21 offen offset:2048
s_add_u32 s21, s21, 55296
s_waitcnt vmcnt(19)
v_mfma_f32_32x32x16_bf16 v[144:159], v[84:87], v[16:19], v[144:159]
v_mfma_f32_32x32x16_bf16 v[160:175], v[84:87], v[20:23], v[160:175]
buffer_load_dwordx4 v[84:87], v1, s[8:11], s21 offen offset:0
s_waitcnt vmcnt(19)
v_mfma_f32_32x32x16_bf16 v[176:191], v[88:91], v[16:19], v[176:191]
v_mfma_f32_32x32x16_bf16 v[192:207], v[88:91], v[20:23], v[192:207]
buffer_load_dwordx4 v[88:91], v1, s[8:11], s21 offen offset:1024
s_waitcnt vmcnt(19)
s_waitcnt lgkmcnt(0)
v_mfma_f32_32x32x16_bf16 v[112:127], v[92:95], v[24:27], v[112:127]
ds_read_b128 v[16:19], v1 offset:26624
v_mfma_f32_32x32x16_bf16 v[128:143], v[92:95], v[28:31], v[128:143]
ds_read_b128 v[20:23], v2 offset:26624
buffer_load_dwordx4 v[92:95], v1, s[8:11], s21 offen offset:2048
s_add_u32 s21, s21, 55296
s_waitcnt vmcnt(19)
v_mfma_f32_32x32x16_bf16 v[144:159], v[96:99], v[24:27], v[144:159]
v_mfma_f32_32x32x16_bf16 v[160:175], v[96:99], v[28:31], v[160:175]
buffer_load_dwordx4 v[96:99], v1, s[8:11], s21 offen offset:0
s_waitcnt vmcnt(19)
v_mfma_f32_32x32x16_bf16 v[176:191], v[100:103], v[24:27], v[176:191]
v_mfma_f32_32x32x16_bf16 v[192:207], v[100:103], v[28:31], v[192:207]
buffer_load_dwordx4 v[100:103], v1, s[8:11], s21 offen offset:1024
s_waitcnt vmcnt(19)
s_waitcnt lgkmcnt(0)
v_mfma_f32_32x32x16_bf16 v[112:127], v[104:107], v[16:19], v[112:127]
ds_read_b128 v[24:27], v1 offset:27648
v_mfma_f32_32x32x16_bf16 v[128:143], v[104:107], v[20:23], v[128:143]
ds_read_b128 v[28:31], v2 offset:27648
buffer_load_dwordx4 v[104:107], v1, s[8:11], s21 offen offset:2048
s_add_u32 s21, s21, 55296
s_waitcnt vmcnt(19)
v_mfma_f32_32x32x16_bf16 v[144:159], v[108:111], v[16:19], v[144:159]
v_mfma_f32_32x32x16_bf16 v[160:175], v[108:111], v[20:23], v[160:175]
buffer_load_dwordx4 v[108:111], v1, s[8:11], s21 offen offset:0
s_waitcnt vmcnt(19)
v_mfma_f32_32x32x16_bf16 v[176:191], v[32:35], v[16:19], v[176:191]
v_mfma_f32_32x32x16_bf16 v[192:207], v[32:35], v[20:23], v[192:207]
buffer_load_dwordx4 v[32:35], v1, s[8:11], s21 offen offset:1024
s_waitcnt vmcnt(19)
s_waitcnt lgkmcnt(0)
v_mfma_f32_32x32x16_bf16 v[112:127], v[36:39], v[24:27], v[112:127]
ds_read_b128 v[16:19], v1 offset:28672
v_mfma_f32_32x32x16_bf16 v[128:143], v[36:39], v[28:31], v[128:143]
ds_read_b128 v[20:23], v2 offset:28672
buffer_load_dwordx4 v[36:39], v1, s[8:11], s21 offen offset:2048
s_add_u32 s21, s21, 55296
s_waitcnt vmcnt(19)
v_mfma_f32_32x32x16_bf16 v[144:159], v[40:43], v[24:27], v[144:159]
v_mfma_f32_32x32x16_bf16 v[160:175], v[40:43], v[28:31], v[160:175]
buffer_load_dwordx4 v[40:43], v1, s[8:11], s21 offen offset:0
s_waitcnt vmcnt(19)
v_mfma_f32_32x32x16_bf16 v[176:191], v[44:47], v[24:27], v[176:191]
v_mfma_f32_32x32x16_bf16 v[192:207], v[44:47], v[28:31], v[192:207]
buffer_load_dwordx4 v[44:47], v1, s[8:11], s21 offen offset:1024
s_waitcnt vmcnt(19)
s_waitcnt lgkmcnt(0)
v_mfma_f32_32x32x16_bf16 v[112:127], v[48:51], v[16:19], v[112:127]
ds_read_b128 v[24:27], v1 offset:29696
v_mfma_f32_32x32x16_bf16 v[128:143], v[48:51], v[20:23], v[128:143]
ds_read_b128 v[28:31], v2 offset:29696
buffer_load_dwordx4 v[48:51], v1, s[8:11], s21 offen offset:2048
s_add_u32 s21, s21, 55296
s_waitcnt vmcnt(19)
v_mfma_f32_32x32x16_bf16 v[144:159], v[52:55], v[16:19], v[144:159]
v_mfma_f32_32x32x16_bf16 v[160:175], v[52:55], v[20:23], v[160:175]
buffer_load_dwordx4 v[52:55], v1, s[8:11], s21 offen offset:0
s_waitcnt vmcnt(19)
v_mfma_f32_32x32x16_bf16 v[176:191], v[56:59], v[16:19], v[176:191]
v_mfma_f32_32x32x16_bf16 v[192:207], v[56:59], v[20:23], v[192:207]
buffer_load_dwordx4 v[56:59], v1, s[8:11], s21 offen offset:1024
s_waitcnt vmcnt(19)
s_waitcnt lgkmcnt(0)
v_mfma_f32_32x32x16_bf16 v[112:127], v[60:63], v[24:27], v[112:127]
ds_read_b128 v[16:19], v1 offset:30720
v_mfma_f32_32x32x16_bf16 v[128:143], v[60:63], v[28:31], v[128:143]
ds_read_b128 v[20:23], v2 offset:30720
buffer_load_dwordx4 v[60:63], v1, s[8:11], s21 offen offset:2048
s_add_u32 s21, s21, 55296
s_waitcnt vmcnt(19)
v_mfma_f32_32x32x16_bf16 v[144:159], v[64:67], v[24:27], v[144:159]
v_mfma_f32_32x32x16_bf16 v[160:175], v[64:67], v[28:31], v[160:175]
buffer_load_dwordx4 v[64:67], v1, s[8:11], s21 offen offset:0
s_waitcnt vmcnt(19)
v_mfma_f32_32x32x16_bf16 v[176:191], v[68:71], v[24:27], v[176:191]
v_mfma_f32_32x32x16_bf16 v[192:207], v[68:71], v[28:31], v[192:207]
buffer_load_dwordx4 v[68:71], v1, s[8:11], s21 offen offset:1024
s_waitcnt vmcnt(19)
s_waitcnt lgkmcnt(0)
v_mfma_f32_32x32x16_bf16 v[112:127], v[72:75], v[16:19], v[112:127]
ds_read_b128 v[24:27], v1 offset:31744
v_mfma_f32_32x32x16_bf16 v[128:143], v[72:75], v[20:23], v[128:143]
ds_read_b128 v[28:31], v2 offset:31744
buffer_load_dwordx4 v[72:75], v1, s[8:11], s21 offen offset:2048
s_add_u32 s21, s21, 55296
s_waitcnt vmcnt(19)
v_mfma_f32_32x32x16_bf16 v[144:159], v[76:79], v[16:19], v[144:159]
v_mfma_f32_32x32x16_bf16 v[160:175], v[76:79], v[20:23], v[160:175]
buffer_load_dwordx4 v[76:79], v1, s[8:11], s21 offen offset:0
s_waitcnt vmcnt(19)
v_mfma_f32_32x32x16_bf16 v[176:191], v[80:83], v[16:19], v[176:191]
v_mfma_f32_32x32x16_bf16 v[192:207], v[80:83], v[20:23], v[192:207]
buffer_load_dwordx4 v[80:83], v1, s[8:11], s21 offen offset:1024
s_waitcnt vmcnt(19)
s_waitcnt lgkmcnt(0)
v_mfma_f32_32x32x16_bf16 v[112:127], v[84:87], v[24:27], v[112:127]
ds_read_b128 v[16:19], v1 offset:32768
v_mfma_f32_32x32x16_bf16 v[128:143], v[84:87], v[28:31], v[128:143]
ds_read_b128 v[20:23], v2 offset:32768
buffer_load_dwordx4 v[84:87], v1, s[8:11], s21 offen offset:2048
s_add_u32 s21, s21, 55296
s_waitcnt vmcnt(19)
v_mfma_f32_32x32x16_bf16 v[144:159], v[88:91], v[24:27], v[144:159]
v_mfma_f32_32x32x16_bf16 v[160:175], v[88:91], v[28:31], v[160:175]
buffer_load_dwordx4 v[88:91], v1, s[8:11], s21 offen offset:0
s_waitcnt vmcnt(19)
v_mfma_f32_32x32x16_bf16 v[176:191], v[92:95], v[24:27], v[176:191]
v_mfma_f32_32x32x16_bf16 v[192:207], v[92:95], v[28:31], v[192:207]
buffer_load_dwordx4 v[92:95], v1, s[8:11], s21 offen offset:1024
s_waitcnt vmcnt(19)
s_waitcnt lgkmcnt(0)
v_mfma_f32_32x32x16_bf16 v[112:127], v[96:99], v[16:19], v[112:127]
ds_read_b128 v[24:27], v1 offset:33792
v_mfma_f32_32x32x16_bf16 v[128:143], v[96:99], v[20:23], v[128:143]
ds_read_b128 v[28:31], v2 offset:33792
buffer_load_dwordx4 v[96:99], v1, s[8:11], s21 offen offset:2048
s_add_u32 s21, s21, 55296
s_waitcnt vmcnt(19)
v_mfma_f32_32x32x16_bf16 v[144:159], v[100:103], v[16:19], v[144:159]
v_mfma_f32_32x32x16_bf16 v[160:175], v[100:103], v[20:23], v[160:175]
buffer_load_dwordx4 v[100:103], v1, s[8:11], s21 offen offset:0
s_waitcnt vmcnt(19)
v_mfma_f32_32x32x16_bf16 v[176:191], v[104:107], v[16:19], v[176:191]
v_mfma_f32_32x32x16_bf16 v[192:207], v[104:107], v[20:23], v[192:207]
buffer_load_dwordx4 v[104:107], v1, s[8:11], s21 offen offset:1024
s_waitcnt vmcnt(19)
s_waitcnt lgkmcnt(0)
v_mfma_f32_32x32x16_bf16 v[112:127], v[108:111], v[24:27], v[112:127]
ds_read_b128 v[16:19], v1 offset:34816
v_mfma_f32_32x32x16_bf16 v[128:143], v[108:111], v[28:31], v[128:143]
ds_read_b128 v[20:23], v2 offset:34816
buffer_load_dwordx4 v[108:111], v1, s[8:11], s21 offen offset:2048
s_add_u32 s21, s21, 55296
s_waitcnt vmcnt(19)
v_mfma_f32_32x32x16_bf16 v[144:159], v[32:35], v[24:27], v[144:159]
v_mfma_f32_32x32x16_bf16 v[160:175], v[32:35], v[28:31], v[160:175]
s_waitcnt vmcnt(18)
v_mfma_f32_32x32x16_bf16 v[176:191], v[36:39], v[24:27], v[176:191]
v_mfma_f32_32x32x16_bf16 v[192:207], v[36:39], v[28:31], v[192:207]
s_waitcnt vmcnt(17)
s_waitcnt lgkmcnt(0)
v_mfma_f32_32x32x16_bf16 v[112:127], v[40:43], v[16:19], v[112:127]
ds_read_b128 v[24:27], v1 offset:35840
v_mfma_f32_32x32x16_bf16 v[128:143], v[40:43], v[20:23], v[128:143]
ds_read_b128 v[28:31], v2 offset:35840
s_waitcnt vmcnt(16)
v_mfma_f32_32x32x16_bf16 v[144:159], v[44:47], v[16:19], v[144:159]
v_mfma_f32_32x32x16_bf16 v[160:175], v[44:47], v[20:23], v[160:175]
s_waitcnt vmcnt(15)
v_mfma_f32_32x32x16_bf16 v[176:191], v[48:51], v[16:19], v[176:191]
v_mfma_f32_32x32x16_bf16 v[192:207], v[48:51], v[20:23], v[192:207]
s_waitcnt vmcnt(14)
s_waitcnt lgkmcnt(0)
v_mfma_f32_32x32x16_bf16 v[112:127], v[52:55], v[24:27], v[112:127]
ds_read_b128 v[16:19], v1 offset:36864
v_mfma_f32_32x32x16_bf16 v[128:143], v[52:55], v[28:31], v[128:143]
ds_read_b128 v[20:23], v2 offset:36864
s_waitcnt vmcnt(13)
v_mfma_f32_32x32x16_bf16 v[144:159], v[56:59], v[24:27], v[144:159]
v_mfma_f32_32x32x16_bf16 v[160:175], v[56:59], v[28:31], v[160:175]
s_waitcnt vmcnt(12)
v_mfma_f32_32x32x16_bf16 v[176:191], v[60:63], v[24:27], v[176:191]
v_mfma_f32_32x32x16_bf16 v[192:207], v[60:63], v[28:31], v[192:207]
s_waitcnt vmcnt(11)
s_waitcnt lgkmcnt(0)
v_mfma_f32_32x32x16_bf16 v[112:127], v[64:67], v[16:19], v[112:127]
ds_read_b128 v[24:27], v1 offset:37888
v_mfma_f32_32x32x16_bf16 v[128:143], v[64:67], v[20:23], v[128:143]
ds_read_b128 v[28:31], v2 offset:37888
s_waitcnt vmcnt(10)
v_mfma_f32_32x32x16_bf16 v[144:159], v[68:71], v[16:19], v[144:159]
v_mfma_f32_32x32x16_bf16 v[160:175], v[68:71], v[20:23], v[160:175]
s_waitcnt vmcnt(9)
v_mfma_f32_32x32x16_bf16 v[176:191], v[72:75], v[16:19], v[176:191]
v_mfma_f32_32x32x16_bf16 v[192:207], v[72:75], v[20:23], v[192:207]
s_waitcnt vmcnt(8)
s_waitcnt lgkmcnt(0)
v_mfma_f32_32x32x16_bf16 v[112:127], v[76:79], v[24:27], v[112:127]
ds_read_b128 v[16:19], v1 offset:38912
v_mfma_f32_32x32x16_bf16 v[128:143], v[76:79], v[28:31], v[128:143]
ds_read_b128 v[20:23], v2 offset:38912
s_waitcnt vmcnt(7)
v_mfma_f32_32x32x16_bf16 v[144:159], v[80:83], v[24:27], v[144:159]
v_mfma_f32_32x32x16_bf16 v[160:175], v[80:83], v[28:31], v[160:175]
s_waitcnt vmcnt(6)
v_mfma_f32_32x32x16_bf16 v[176:191], v[84:87], v[24:27], v[176:191]
v_mfma_f32_32x32x16_bf16 v[192:207], v[84:87], v[28:31], v[192:207]
s_waitcnt vmcnt(5)
s_waitcnt lgkmcnt(0)
v_mfma_f32_32x32x16_bf16 v[112:127], v[88:91], v[16:19], v[112:127]
ds_read_b128 v[24:27], v1 offset:39936
v_mfma_f32_32x32x16_bf16 v[128:143], v[88:91], v[20:23], v[128:143]
ds_read_b128 v[28:31], v2 offset:39936
s_waitcnt vmcnt(4)
v_mfma_f32_32x32x16_bf16 v[144:159], v[92:95], v[16:19], v[144:159]
v_mfma_f32_32x32x16_bf16 v[160:175], v[92:95], v[20:23], v[160:175]
s_waitcnt vmcnt(3)
v_mfma_f32_32x32x16_bf16 v[176:191], v[96:99], v[16:19], v[176:191]
v_mfma_f32_32x32x16_bf16 v[192:207], v[96:99], v[20:23], v[192:207]
s_waitcnt vmcnt(2)
s_waitcnt lgkmcnt(0)
v_mfma_f32_32x32x16_bf16 v[112:127], v[100:103], v[24:27], v[112:127]
v_mfma_f32_32x32x16_bf16 v[128:143], v[100:103], v[28:31], v[128:143]
s_waitcnt vmcnt(1)
v_mfma_f32_32x32x16_bf16 v[144:159], v[104:107], v[24:27], v[144:159]
v_mfma_f32_32x32x16_bf16 v[160:175], v[104:107], v[28:31], v[160:175]
s_waitcnt vmcnt(0)
v_mfma_f32_32x32x16_bf16 v[176:191], v[108:111], v[24:27], v[176:191]
v_mfma_f32_32x32x16_bf16 v[192:207], v[108:111], v[28:31], v[192:207]
s_nop 4
v_pk_mul_f32 v[240:241], v[112:113], v[112:113]
v_pk_mul_f32 v[242:243], v[114:115], v[114:115]
v_pk_mul_f32 v[244:245], v[116:117], v[116:117]
v_pk_mul_f32 v[246:247], v[118:119], v[118:119]
v_pk_mul_f32 v[248:249], v[120:121], v[120:121]
v_pk_mul_f32 v[250:251], v[122:123], v[122:123]
v_pk_mul_f32 v[252:253], v[124:125], v[124:125]
v_pk_mul_f32 v[254:255], v[126:127], v[126:127]
v_pk_fma_f32 v[240:241], v[240:241], v[8:9], v[8:9] op_sel:[0,1,0] op_sel_hi:[1,1,0]
v_pk_fma_f32 v[242:243], v[242:243], v[8:9], v[8:9] op_sel:[0,1,0] op_sel_hi:[1,1,0]
v_pk_fma_f32 v[244:245], v[244:245], v[8:9], v[8:9] op_sel:[0,1,0] op_sel_hi:[1,1,0]
v_pk_fma_f32 v[246:247], v[246:247], v[8:9], v[8:9] op_sel:[0,1,0] op_sel_hi:[1,1,0]
v_pk_fma_f32 v[248:249], v[248:249], v[8:9], v[8:9] op_sel:[0,1,0] op_sel_hi:[1,1,0]
v_pk_fma_f32 v[250:251], v[250:251], v[8:9], v[8:9] op_sel:[0,1,0] op_sel_hi:[1,1,0]
v_pk_fma_f32 v[252:253], v[252:253], v[8:9], v[8:9] op_sel:[0,1,0] op_sel_hi:[1,1,0]
v_pk_fma_f32 v[254:255], v[254:255], v[8:9], v[8:9] op_sel:[0,1,0] op_sel_hi:[1,1,0]
v_pk_mul_f32 v[240:241], v[240:241], v[112:113]
v_pk_mul_f32 v[242:243], v[242:243], v[114:115]
v_pk_mul_f32 v[244:245], v[244:245], v[116:117]
v_pk_mul_f32 v[246:247], v[246:247], v[118:119]
v_pk_mul_f32 v[248:249], v[248:249], v[120:121]
v_pk_mul_f32 v[250:251], v[250:251], v[122:123]
v_pk_mul_f32 v[252:253], v[252:253], v[124:125]
v_pk_mul_f32 v[254:255], v[254:255], v[126:127]
v_exp_f32 v240, v240
v_exp_f32 v241, v241
v_exp_f32 v242, v242
v_exp_f32 v243, v243
v_exp_f32 v244, v244
v_exp_f32 v245, v245
v_exp_f32 v246, v246
v_exp_f32 v247, v247
v_exp_f32 v248, v248
v_exp_f32 v249, v249
v_exp_f32 v250, v250
v_exp_f32 v251, v251
v_exp_f32 v252, v252
v_exp_f32 v253, v253
v_exp_f32 v254, v254
v_exp_f32 v255, v255
v_pk_add_f32 v[240:241], v[240:241], 1.0 op_sel_hi:[1,0]
v_pk_add_f32 v[242:243], v[242:243], 1.0 op_sel_hi:[1,0]
v_pk_add_f32 v[244:245], v[244:245], 1.0 op_sel_hi:[1,0]
v_pk_add_f32 v[246:247], v[246:247], 1.0 op_sel_hi:[1,0]
v_pk_add_f32 v[248:249], v[248:249], 1.0 op_sel_hi:[1,0]
v_pk_add_f32 v[250:251], v[250:251], 1.0 op_sel_hi:[1,0]
v_pk_add_f32 v[252:253], v[252:253], 1.0 op_sel_hi:[1,0]
v_pk_add_f32 v[254:255], v[254:255], 1.0 op_sel_hi:[1,0]
v_rcp_f32 v240, v240
v_rcp_f32 v241, v241
v_rcp_f32 v242, v242
v_rcp_f32 v243, v243
v_rcp_f32 v244, v244
v_rcp_f32 v245, v245
v_rcp_f32 v246, v246
v_rcp_f32 v247, v247
v_rcp_f32 v248, v248
v_rcp_f32 v249, v249
v_rcp_f32 v250, v250
v_rcp_f32 v251, v251
v_rcp_f32 v252, v252
v_rcp_f32 v253, v253
v_rcp_f32 v254, v254
v_rcp_f32 v255, v255
v_pk_mul_f32 v[240:241], v[240:241], v[112:113]
v_pk_mul_f32 v[242:243], v[242:243], v[114:115]
v_pk_mul_f32 v[244:245], v[244:245], v[116:117]
v_pk_mul_f32 v[246:247], v[246:247], v[118:119]
v_pk_mul_f32 v[248:249], v[248:249], v[120:121]
v_pk_mul_f32 v[250:251], v[250:251], v[122:123]
v_pk_mul_f32 v[252:253], v[252:253], v[124:125]
v_pk_mul_f32 v[254:255], v[254:255], v[126:127]
v_cvt_pk_bf16_f32 v112, v240, v241
v_cvt_pk_bf16_f32 v113, v242, v243
v_cvt_pk_bf16_f32 v114, v244, v245
v_cvt_pk_bf16_f32 v115, v246, v247
v_cvt_pk_bf16_f32 v116, v248, v249
v_cvt_pk_bf16_f32 v117, v250, v251
v_cvt_pk_bf16_f32 v118, v252, v253
v_cvt_pk_bf16_f32 v119, v254, v255
buffer_store_dwordx4 v[112:115], v3, s[36:39], s40 offen offset:0 sc1
buffer_store_dwordx4 v[116:119], v3, s[36:39], s40 offen offset:1024 sc1
v_pk_mul_f32 v[240:241], v[128:129], v[128:129]
v_pk_mul_f32 v[242:243], v[130:131], v[130:131]
v_pk_mul_f32 v[244:245], v[132:133], v[132:133]
v_pk_mul_f32 v[246:247], v[134:135], v[134:135]
v_pk_mul_f32 v[248:249], v[136:137], v[136:137]
v_pk_mul_f32 v[250:251], v[138:139], v[138:139]
v_pk_mul_f32 v[252:253], v[140:141], v[140:141]
v_pk_mul_f32 v[254:255], v[142:143], v[142:143]
v_pk_fma_f32 v[240:241], v[240:241], v[8:9], v[8:9] op_sel:[0,1,0] op_sel_hi:[1,1,0]
v_pk_fma_f32 v[242:243], v[242:243], v[8:9], v[8:9] op_sel:[0,1,0] op_sel_hi:[1,1,0]
v_pk_fma_f32 v[244:245], v[244:245], v[8:9], v[8:9] op_sel:[0,1,0] op_sel_hi:[1,1,0]
v_pk_fma_f32 v[246:247], v[246:247], v[8:9], v[8:9] op_sel:[0,1,0] op_sel_hi:[1,1,0]
v_pk_fma_f32 v[248:249], v[248:249], v[8:9], v[8:9] op_sel:[0,1,0] op_sel_hi:[1,1,0]
v_pk_fma_f32 v[250:251], v[250:251], v[8:9], v[8:9] op_sel:[0,1,0] op_sel_hi:[1,1,0]
v_pk_fma_f32 v[252:253], v[252:253], v[8:9], v[8:9] op_sel:[0,1,0] op_sel_hi:[1,1,0]
v_pk_fma_f32 v[254:255], v[254:255], v[8:9], v[8:9] op_sel:[0,1,0] op_sel_hi:[1,1,0]
v_pk_mul_f32 v[240:241], v[240:241], v[128:129]
v_pk_mul_f32 v[242:243], v[242:243], v[130:131]
v_pk_mul_f32 v[244:245], v[244:245], v[132:133]
v_pk_mul_f32 v[246:247], v[246:247], v[134:135]
v_pk_mul_f32 v[248:249], v[248:249], v[136:137]
v_pk_mul_f32 v[250:251], v[250:251], v[138:139]
v_pk_mul_f32 v[252:253], v[252:253], v[140:141]
v_pk_mul_f32 v[254:255], v[254:255], v[142:143]
v_exp_f32 v240, v240
v_exp_f32 v241, v241
v_exp_f32 v242, v242
v_exp_f32 v243, v243
v_exp_f32 v244, v244
v_exp_f32 v245, v245
v_exp_f32 v246, v246
v_exp_f32 v247, v247
v_exp_f32 v248, v248
v_exp_f32 v249, v249
v_exp_f32 v250, v250
v_exp_f32 v251, v251
v_exp_f32 v252, v252
v_exp_f32 v253, v253
v_exp_f32 v254, v254
v_exp_f32 v255, v255
v_pk_add_f32 v[240:241], v[240:241], 1.0 op_sel_hi:[1,0]
v_pk_add_f32 v[242:243], v[242:243], 1.0 op_sel_hi:[1,0]
v_pk_add_f32 v[244:245], v[244:245], 1.0 op_sel_hi:[1,0]
v_pk_add_f32 v[246:247], v[246:247], 1.0 op_sel_hi:[1,0]
v_pk_add_f32 v[248:249], v[248:249], 1.0 op_sel_hi:[1,0]
v_pk_add_f32 v[250:251], v[250:251], 1.0 op_sel_hi:[1,0]
v_pk_add_f32 v[252:253], v[252:253], 1.0 op_sel_hi:[1,0]
v_pk_add_f32 v[254:255], v[254:255], 1.0 op_sel_hi:[1,0]
v_rcp_f32 v240, v240
v_rcp_f32 v241, v241
v_rcp_f32 v242, v242
v_rcp_f32 v243, v243
v_rcp_f32 v244, v244
v_rcp_f32 v245, v245
v_rcp_f32 v246, v246
v_rcp_f32 v247, v247
v_rcp_f32 v248, v248
v_rcp_f32 v249, v249
v_rcp_f32 v250, v250
v_rcp_f32 v251, v251
v_rcp_f32 v252, v252
v_rcp_f32 v253, v253
v_rcp_f32 v254, v254
v_rcp_f32 v255, v255
v_pk_mul_f32 v[240:241], v[240:241], v[128:129]
v_pk_mul_f32 v[242:243], v[242:243], v[130:131]
v_pk_mul_f32 v[244:245], v[244:245], v[132:133]
v_pk_mul_f32 v[246:247], v[246:247], v[134:135]
v_pk_mul_f32 v[248:249], v[248:249], v[136:137]
v_pk_mul_f32 v[250:251], v[250:251], v[138:139]
v_pk_mul_f32 v[252:253], v[252:253], v[140:141]
v_pk_mul_f32 v[254:255], v[254:255], v[142:143]
v_cvt_pk_bf16_f32 v128, v240, v241
v_cvt_pk_bf16_f32 v129, v242, v243
v_cvt_pk_bf16_f32 v130, v244, v245
v_cvt_pk_bf16_f32 v131, v246, v247
v_cvt_pk_bf16_f32 v132, v248, v249
v_cvt_pk_bf16_f32 v133, v250, v251
v_cvt_pk_bf16_f32 v134, v252, v253
v_cvt_pk_bf16_f32 v135, v254, v255
buffer_store_dwordx4 v[128:131], v4, s[36:39], s40 offen offset:0 sc1
buffer_store_dwordx4 v[132:135], v4, s[36:39], s40 offen offset:1024 sc1
s_add_u32 s40, s40, 0x800
s_cmp_eq_u32 s20, 7
s_cselect_b32 s40, 1073741824, s40
v_pk_mul_f32 v[240:241], v[144:145], v[144:145]
v_pk_mul_f32 v[242:243], v[146:147], v[146:147]
v_pk_mul_f32 v[244:245], v[148:149], v[148:149]
v_pk_mul_f32 v[246:247], v[150:151], v[150:151]
v_pk_mul_f32 v[248:249], v[152:153], v[152:153]
v_pk_mul_f32 v[250:251], v[154:155], v[154:155]
v_pk_mul_f32 v[252:253], v[156:157], v[156:157]
v_pk_mul_f32 v[254:255], v[158:159], v[158:159]
v_pk_fma_f32 v[240:241], v[240:241], v[8:9], v[8:9] op_sel:[0,1,0] op_sel_hi:[1,1,0]
v_pk_fma_f32 v[242:243], v[242:243], v[8:9], v[8:9] op_sel:[0,1,0] op_sel_hi:[1,1,0]
v_pk_fma_f32 v[244:245], v[244:245], v[8:9], v[8:9] op_sel:[0,1,0] op_sel_hi:[1,1,0]
v_pk_fma_f32 v[246:247], v[246:247], v[8:9], v[8:9] op_sel:[0,1,0] op_sel_hi:[1,1,0]
v_pk_fma_f32 v[248:249], v[248:249], v[8:9], v[8:9] op_sel:[0,1,0] op_sel_hi:[1,1,0]
v_pk_fma_f32 v[250:251], v[250:251], v[8:9], v[8:9] op_sel:[0,1,0] op_sel_hi:[1,1,0]
v_pk_fma_f32 v[252:253], v[252:253], v[8:9], v[8:9] op_sel:[0,1,0] op_sel_hi:[1,1,0]
v_pk_fma_f32 v[254:255], v[254:255], v[8:9], v[8:9] op_sel:[0,1,0] op_sel_hi:[1,1,0]
v_pk_mul_f32 v[240:241], v[240:241], v[144:145]
v_pk_mul_f32 v[242:243], v[242:243], v[146:147]
v_pk_mul_f32 v[244:245], v[244:245], v[148:149]
v_pk_mul_f32 v[246:247], v[246:247], v[150:151]
v_pk_mul_f32 v[248:249], v[248:249], v[152:153]
v_pk_mul_f32 v[250:251], v[250:251], v[154:155]
v_pk_mul_f32 v[252:253], v[252:253], v[156:157]
v_pk_mul_f32 v[254:255], v[254:255], v[158:159]
v_exp_f32 v240, v240
v_exp_f32 v241, v241
v_exp_f32 v242, v242
v_exp_f32 v243, v243
v_exp_f32 v244, v244
v_exp_f32 v245, v245
v_exp_f32 v246, v246
v_exp_f32 v247, v247
v_exp_f32 v248, v248
v_exp_f32 v249, v249
v_exp_f32 v250, v250
v_exp_f32 v251, v251
v_exp_f32 v252, v252
v_exp_f32 v253, v253
v_exp_f32 v254, v254
v_exp_f32 v255, v255
v_pk_add_f32 v[240:241], v[240:241], 1.0 op_sel_hi:[1,0]
v_pk_add_f32 v[242:243], v[242:243], 1.0 op_sel_hi:[1,0]
v_pk_add_f32 v[244:245], v[244:245], 1.0 op_sel_hi:[1,0]
v_pk_add_f32 v[246:247], v[246:247], 1.0 op_sel_hi:[1,0]
v_pk_add_f32 v[248:249], v[248:249], 1.0 op_sel_hi:[1,0]
v_pk_add_f32 v[250:251], v[250:251], 1.0 op_sel_hi:[1,0]
v_pk_add_f32 v[252:253], v[252:253], 1.0 op_sel_hi:[1,0]
v_pk_add_f32 v[254:255], v[254:255], 1.0 op_sel_hi:[1,0]
v_rcp_f32 v240, v240
v_rcp_f32 v241, v241
v_rcp_f32 v242, v242
v_rcp_f32 v243, v243
v_rcp_f32 v244, v244
v_rcp_f32 v245, v245
v_rcp_f32 v246, v246
v_rcp_f32 v247, v247
v_rcp_f32 v248, v248
v_rcp_f32 v249, v249
v_rcp_f32 v250, v250
v_rcp_f32 v251, v251
v_rcp_f32 v252, v252
v_rcp_f32 v253, v253
v_rcp_f32 v254, v254
v_rcp_f32 v255, v255
v_pk_mul_f32 v[240:241], v[240:241], v[144:145]
v_pk_mul_f32 v[242:243], v[242:243], v[146:147]
v_pk_mul_f32 v[244:245], v[244:245], v[148:149]
v_pk_mul_f32 v[246:247], v[246:247], v[150:151]
v_pk_mul_f32 v[248:249], v[248:249], v[152:153]
v_pk_mul_f32 v[250:251], v[250:251], v[154:155]
v_pk_mul_f32 v[252:253], v[252:253], v[156:157]
v_pk_mul_f32 v[254:255], v[254:255], v[158:159]
v_cvt_pk_bf16_f32 v144, v240, v241
v_cvt_pk_bf16_f32 v145, v242, v243
v_cvt_pk_bf16_f32 v146, v244, v245
v_cvt_pk_bf16_f32 v147, v246, v247
v_cvt_pk_bf16_f32 v148, v248, v249
v_cvt_pk_bf16_f32 v149, v250, v251
v_cvt_pk_bf16_f32 v150, v252, v253
v_cvt_pk_bf16_f32 v151, v254, v255
buffer_store_dwordx4 v[144:147], v3, s[36:39], s40 offen offset:0 sc1
buffer_store_dwordx4 v[148:151], v3, s[36:39], s40 offen offset:1024 sc1
v_pk_mul_f32 v[240:241], v[160:161], v[160:161]
v_pk_mul_f32 v[242:243], v[162:163], v[162:163]
v_pk_mul_f32 v[244:245], v[164:165], v[164:165]
v_pk_mul_f32 v[246:247], v[166:167], v[166:167]
v_pk_mul_f32 v[248:249], v[168:169], v[168:169]
v_pk_mul_f32 v[250:251], v[170:171], v[170:171]
v_pk_mul_f32 v[252:253], v[172:173], v[172:173]
v_pk_mul_f32 v[254:255], v[174:175], v[174:175]
v_pk_fma_f32 v[240:241], v[240:241], v[8:9], v[8:9] op_sel:[0,1,0] op_sel_hi:[1,1,0]
v_pk_fma_f32 v[242:243], v[242:243], v[8:9], v[8:9] op_sel:[0,1,0] op_sel_hi:[1,1,0]
v_pk_fma_f32 v[244:245], v[244:245], v[8:9], v[8:9] op_sel:[0,1,0] op_sel_hi:[1,1,0]
v_pk_fma_f32 v[246:247], v[246:247], v[8:9], v[8:9] op_sel:[0,1,0] op_sel_hi:[1,1,0]
v_pk_fma_f32 v[248:249], v[248:249], v[8:9], v[8:9] op_sel:[0,1,0] op_sel_hi:[1,1,0]
v_pk_fma_f32 v[250:251], v[250:251], v[8:9], v[8:9] op_sel:[0,1,0] op_sel_hi:[1,1,0]
v_pk_fma_f32 v[252:253], v[252:253], v[8:9], v[8:9] op_sel:[0,1,0] op_sel_hi:[1,1,0]
v_pk_fma_f32 v[254:255], v[254:255], v[8:9], v[8:9] op_sel:[0,1,0] op_sel_hi:[1,1,0]
v_pk_mul_f32 v[240:241], v[240:241], v[160:161]
v_pk_mul_f32 v[242:243], v[242:243], v[162:163]
v_pk_mul_f32 v[244:245], v[244:245], v[164:165]
v_pk_mul_f32 v[246:247], v[246:247], v[166:167]
v_pk_mul_f32 v[248:249], v[248:249], v[168:169]
v_pk_mul_f32 v[250:251], v[250:251], v[170:171]
v_pk_mul_f32 v[252:253], v[252:253], v[172:173]
v_pk_mul_f32 v[254:255], v[254:255], v[174:175]
v_exp_f32 v240, v240
v_exp_f32 v241, v241
v_exp_f32 v242, v242
v_exp_f32 v243, v243
v_exp_f32 v244, v244
v_exp_f32 v245, v245
v_exp_f32 v246, v246
v_exp_f32 v247, v247
v_exp_f32 v248, v248
v_exp_f32 v249, v249
v_exp_f32 v250, v250
v_exp_f32 v251, v251
v_exp_f32 v252, v252
v_exp_f32 v253, v253
v_exp_f32 v254, v254
v_exp_f32 v255, v255
v_pk_add_f32 v[240:241], v[240:241], 1.0 op_sel_hi:[1,0]
v_pk_add_f32 v[242:243], v[242:243], 1.0 op_sel_hi:[1,0]
v_pk_add_f32 v[244:245], v[244:245], 1.0 op_sel_hi:[1,0]
v_pk_add_f32 v[246:247], v[246:247], 1.0 op_sel_hi:[1,0]
v_pk_add_f32 v[248:249], v[248:249], 1.0 op_sel_hi:[1,0]
v_pk_add_f32 v[250:251], v[250:251], 1.0 op_sel_hi:[1,0]
v_pk_add_f32 v[252:253], v[252:253], 1.0 op_sel_hi:[1,0]
v_pk_add_f32 v[254:255], v[254:255], 1.0 op_sel_hi:[1,0]
v_rcp_f32 v240, v240
v_rcp_f32 v241, v241
v_rcp_f32 v242, v242
v_rcp_f32 v243, v243
v_rcp_f32 v244, v244
v_rcp_f32 v245, v245
v_rcp_f32 v246, v246
v_rcp_f32 v247, v247
v_rcp_f32 v248, v248
v_rcp_f32 v249, v249
v_rcp_f32 v250, v250
v_rcp_f32 v251, v251
v_rcp_f32 v252, v252
v_rcp_f32 v253, v253
v_rcp_f32 v254, v254
v_rcp_f32 v255, v255
v_pk_mul_f32 v[240:241], v[240:241], v[160:161]
v_pk_mul_f32 v[242:243], v[242:243], v[162:163]
v_pk_mul_f32 v[244:245], v[244:245], v[164:165]
v_pk_mul_f32 v[246:247], v[246:247], v[166:167]
v_pk_mul_f32 v[248:249], v[248:249], v[168:169]
v_pk_mul_f32 v[250:251], v[250:251], v[170:171]
v_pk_mul_f32 v[252:253], v[252:253], v[172:173]
v_pk_mul_f32 v[254:255], v[254:255], v[174:175]
v_cvt_pk_bf16_f32 v160, v240, v241
v_cvt_pk_bf16_f32 v161, v242, v243
v_cvt_pk_bf16_f32 v162, v244, v245
v_cvt_pk_bf16_f32 v163, v246, v247
v_cvt_pk_bf16_f32 v164, v248, v249
v_cvt_pk_bf16_f32 v165, v250, v251
v_cvt_pk_bf16_f32 v166, v252, v253
v_cvt_pk_bf16_f32 v167, v254, v255
buffer_store_dwordx4 v[160:163], v4, s[36:39], s40 offen offset:0 sc1
buffer_store_dwordx4 v[164:167], v4, s[36:39], s40 offen offset:1024 sc1
s_add_u32 s40, s40, 0x800
v_pk_mul_f32 v[240:241], v[176:177], v[176:177]
v_pk_mul_f32 v[242:243], v[178:179], v[178:179]
v_pk_mul_f32 v[244:245], v[180:181], v[180:181]
v_pk_mul_f32 v[246:247], v[182:183], v[182:183]
v_pk_mul_f32 v[248:249], v[184:185], v[184:185]
v_pk_mul_f32 v[250:251], v[186:187], v[186:187]
v_pk_mul_f32 v[252:253], v[188:189], v[188:189]
v_pk_mul_f32 v[254:255], v[190:191], v[190:191]
v_pk_fma_f32 v[240:241], v[240:241], v[8:9], v[8:9] op_sel:[0,1,0] op_sel_hi:[1,1,0]
v_pk_fma_f32 v[242:243], v[242:243], v[8:9], v[8:9] op_sel:[0,1,0] op_sel_hi:[1,1,0]
v_pk_fma_f32 v[244:245], v[244:245], v[8:9], v[8:9] op_sel:[0,1,0] op_sel_hi:[1,1,0]
v_pk_fma_f32 v[246:247], v[246:247], v[8:9], v[8:9] op_sel:[0,1,0] op_sel_hi:[1,1,0]
v_pk_fma_f32 v[248:249], v[248:249], v[8:9], v[8:9] op_sel:[0,1,0] op_sel_hi:[1,1,0]
v_pk_fma_f32 v[250:251], v[250:251], v[8:9], v[8:9] op_sel:[0,1,0] op_sel_hi:[1,1,0]
v_pk_fma_f32 v[252:253], v[252:253], v[8:9], v[8:9] op_sel:[0,1,0] op_sel_hi:[1,1,0]
v_pk_fma_f32 v[254:255], v[254:255], v[8:9], v[8:9] op_sel:[0,1,0] op_sel_hi:[1,1,0]
v_pk_mul_f32 v[240:241], v[240:241], v[176:177]
v_pk_mul_f32 v[242:243], v[242:243], v[178:179]
v_pk_mul_f32 v[244:245], v[244:245], v[180:181]
v_pk_mul_f32 v[246:247], v[246:247], v[182:183]
v_pk_mul_f32 v[248:249], v[248:249], v[184:185]
v_pk_mul_f32 v[250:251], v[250:251], v[186:187]
v_pk_mul_f32 v[252:253], v[252:253], v[188:189]
v_pk_mul_f32 v[254:255], v[254:255], v[190:191]
v_exp_f32 v240, v240
v_exp_f32 v241, v241
v_exp_f32 v242, v242
v_exp_f32 v243, v243
v_exp_f32 v244, v244
v_exp_f32 v245, v245
v_exp_f32 v246, v246
v_exp_f32 v247, v247
v_exp_f32 v248, v248
v_exp_f32 v249, v249
v_exp_f32 v250, v250
v_exp_f32 v251, v251
v_exp_f32 v252, v252
v_exp_f32 v253, v253
v_exp_f32 v254, v254
v_exp_f32 v255, v255
v_pk_add_f32 v[240:241], v[240:241], 1.0 op_sel_hi:[1,0]
v_pk_add_f32 v[242:243], v[242:243], 1.0 op_sel_hi:[1,0]
v_pk_add_f32 v[244:245], v[244:245], 1.0 op_sel_hi:[1,0]
v_pk_add_f32 v[246:247], v[246:247], 1.0 op_sel_hi:[1,0]
v_pk_add_f32 v[248:249], v[248:249], 1.0 op_sel_hi:[1,0]
v_pk_add_f32 v[250:251], v[250:251], 1.0 op_sel_hi:[1,0]
v_pk_add_f32 v[252:253], v[252:253], 1.0 op_sel_hi:[1,0]
v_pk_add_f32 v[254:255], v[254:255], 1.0 op_sel_hi:[1,0]
v_rcp_f32 v240, v240
v_rcp_f32 v241, v241
v_rcp_f32 v242, v242
v_rcp_f32 v243, v243
v_rcp_f32 v244, v244
v_rcp_f32 v245, v245
v_rcp_f32 v246, v246
v_rcp_f32 v247, v247
v_rcp_f32 v248, v248
v_rcp_f32 v249, v249
v_rcp_f32 v250, v250
v_rcp_f32 v251, v251
v_rcp_f32 v252, v252
v_rcp_f32 v253, v253
v_rcp_f32 v254, v254
v_rcp_f32 v255, v255
v_pk_mul_f32 v[240:241], v[240:241], v[176:177]
v_pk_mul_f32 v[242:243], v[242:243], v[178:179]
v_pk_mul_f32 v[244:245], v[244:245], v[180:181]
v_pk_mul_f32 v[246:247], v[246:247], v[182:183]
v_pk_mul_f32 v[248:249], v[248:249], v[184:185]
v_pk_mul_f32 v[250:251], v[250:251], v[186:187]
v_pk_mul_f32 v[252:253], v[252:253], v[188:189]
v_pk_mul_f32 v[254:255], v[254:255], v[190:191]
v_cvt_pk_bf16_f32 v176, v240, v241
v_cvt_pk_bf16_f32 v177, v242, v243
v_cvt_pk_bf16_f32 v178, v244, v245
v_cvt_pk_bf16_f32 v179, v246, v247
v_cvt_pk_bf16_f32 v180, v248, v249
v_cvt_pk_bf16_f32 v181, v250, v251
v_cvt_pk_bf16_f32 v182, v252, v253
v_cvt_pk_bf16_f32 v183, v254, v255
buffer_store_dwordx4 v[176:179], v3, s[36:39], s40 offen offset:0 sc1
buffer_store_dwordx4 v[180:183], v3, s[36:39], s40 offen offset:1024 sc1
v_pk_mul_f32 v[240:241], v[192:193], v[192:193]
v_pk_mul_f32 v[242:243], v[194:195], v[194:195]
v_pk_mul_f32 v[244:245], v[196:197], v[196:197]
v_pk_mul_f32 v[246:247], v[198:199], v[198:199]
v_pk_mul_f32 v[248:249], v[200:201], v[200:201]
v_pk_mul_f32 v[250:251], v[202:203], v[202:203]
v_pk_mul_f32 v[252:253], v[204:205], v[204:205]
v_pk_mul_f32 v[254:255], v[206:207], v[206:207]
v_pk_fma_f32 v[240:241], v[240:241], v[8:9], v[8:9] op_sel:[0,1,0] op_sel_hi:[1,1,0]
v_pk_fma_f32 v[242:243], v[242:243], v[8:9], v[8:9] op_sel:[0,1,0] op_sel_hi:[1,1,0]
v_pk_fma_f32 v[244:245], v[244:245], v[8:9], v[8:9] op_sel:[0,1,0] op_sel_hi:[1,1,0]
v_pk_fma_f32 v[246:247], v[246:247], v[8:9], v[8:9] op_sel:[0,1,0] op_sel_hi:[1,1,0]
v_pk_fma_f32 v[248:249], v[248:249], v[8:9], v[8:9] op_sel:[0,1,0] op_sel_hi:[1,1,0]
v_pk_fma_f32 v[250:251], v[250:251], v[8:9], v[8:9] op_sel:[0,1,0] op_sel_hi:[1,1,0]
v_pk_fma_f32 v[252:253], v[252:253], v[8:9], v[8:9] op_sel:[0,1,0] op_sel_hi:[1,1,0]
v_pk_fma_f32 v[254:255], v[254:255], v[8:9], v[8:9] op_sel:[0,1,0] op_sel_hi:[1,1,0]
v_pk_mul_f32 v[240:241], v[240:241], v[192:193]
v_pk_mul_f32 v[242:243], v[242:243], v[194:195]
v_pk_mul_f32 v[244:245], v[244:245], v[196:197]
v_pk_mul_f32 v[246:247], v[246:247], v[198:199]
v_pk_mul_f32 v[248:249], v[248:249], v[200:201]
v_pk_mul_f32 v[250:251], v[250:251], v[202:203]
v_pk_mul_f32 v[252:253], v[252:253], v[204:205]
v_pk_mul_f32 v[254:255], v[254:255], v[206:207]
v_exp_f32 v240, v240
v_exp_f32 v241, v241
v_exp_f32 v242, v242
v_exp_f32 v243, v243
v_exp_f32 v244, v244
v_exp_f32 v245, v245
v_exp_f32 v246, v246
v_exp_f32 v247, v247
v_exp_f32 v248, v248
v_exp_f32 v249, v249
v_exp_f32 v250, v250
v_exp_f32 v251, v251
v_exp_f32 v252, v252
v_exp_f32 v253, v253
v_exp_f32 v254, v254
v_exp_f32 v255, v255
v_pk_add_f32 v[240:241], v[240:241], 1.0 op_sel_hi:[1,0]
v_pk_add_f32 v[242:243], v[242:243], 1.0 op_sel_hi:[1,0]
v_pk_add_f32 v[244:245], v[244:245], 1.0 op_sel_hi:[1,0]
v_pk_add_f32 v[246:247], v[246:247], 1.0 op_sel_hi:[1,0]
v_pk_add_f32 v[248:249], v[248:249], 1.0 op_sel_hi:[1,0]
v_pk_add_f32 v[250:251], v[250:251], 1.0 op_sel_hi:[1,0]
v_pk_add_f32 v[252:253], v[252:253], 1.0 op_sel_hi:[1,0]
v_pk_add_f32 v[254:255], v[254:255], 1.0 op_sel_hi:[1,0]
v_rcp_f32 v240, v240
v_rcp_f32 v241, v241
v_rcp_f32 v242, v242
v_rcp_f32 v243, v243
v_rcp_f32 v244, v244
v_rcp_f32 v245, v245
v_rcp_f32 v246, v246
v_rcp_f32 v247, v247
v_rcp_f32 v248, v248
v_rcp_f32 v249, v249
v_rcp_f32 v250, v250
v_rcp_f32 v251, v251
v_rcp_f32 v252, v252
v_rcp_f32 v253, v253
v_rcp_f32 v254, v254
v_rcp_f32 v255, v255
v_pk_mul_f32 v[240:241], v[240:241], v[192:193]
v_pk_mul_f32 v[242:243], v[242:243], v[194:195]
v_pk_mul_f32 v[244:245], v[244:245], v[196:197]
v_pk_mul_f32 v[246:247], v[246:247], v[198:199]
v_pk_mul_f32 v[248:249], v[248:249], v[200:201]
v_pk_mul_f32 v[250:251], v[250:251], v[202:203]
v_pk_mul_f32 v[252:253], v[252:253], v[204:205]
v_pk_mul_f32 v[254:255], v[254:255], v[206:207]
v_cvt_pk_bf16_f32 v192, v240, v241
v_cvt_pk_bf16_f32 v193, v242, v243
v_cvt_pk_bf16_f32 v194, v244, v245
v_cvt_pk_bf16_f32 v195, v246, v247
v_cvt_pk_bf16_f32 v196, v248, v249
v_cvt_pk_bf16_f32 v197, v250, v251
v_cvt_pk_bf16_f32 v198, v252, v253
v_cvt_pk_bf16_f32 v199, v254, v255
buffer_store_dwordx4 v[192:195], v4, s[36:39], s40 offen offset:0 sc1
buffer_store_dwordx4 v[196:199], v4, s[36:39], s40 offen offset:1024 sc1
s_add_u32 s40, s40, 0x800
.b2_end_1107:
v_mov_b32 v10, 163836
v_mov_b32 v11, 1
v_lshlrev_b32 v12, 12, v0
v_mov_b32 v13, -1
s_waitcnt vmcnt(0) lgkmcnt(0)
s_mov_b64 exec, 1
ds_add_rtn_u32 v11, v10, v11
s_mov_b64 exec, -1
s_waitcnt lgkmcnt(0)
v_readfirstlane_b32 s17, v11
s_and_b32 s17, s17, 255
s_cmp_lg_u32 s17, 7
s_cbranch_scc1 .urel_1120
buffer_store_byte v13, v12, s[56:59], s16 offen offset:144 sc0 sc1
.urel_1120:
s_setprio 0
.kf3_1003:
s_load_dwordx2 s[32:33], s[0:1], 104
s_load_dwordx2 s[8:9], s[0:1], 0
s_load_dwordx2 s[12:13], s[0:1], 88
s_and_b32 s21, s2, 31
s_lshr_b32 s22, s2, 5
v_and_b32 v7, 15, v0
v_lshrrev_b32 v1, 4, v0
v_lshlrev_b32 v1, 9, v1
v_lshl_add_u32 v1, v7, 4, v1
s_mul_i32 s23, s20, 23
s_cmp_eq_u32 s20, 7
s_cselect_b32 s23, 160, s23
s_mul_i32 s24, s23, 40960
s_mul_i32 s25, s22, 5120
s_add_u32 s24, s24, s25
s_add_u32 s24, s24, 65273856
s_mul_i32 s28, s21, 221184
s_add_u32 s28, s28, 7864320
s_add_u32 s29, s28, 110592
s_lshl_b32 s26, s21, 19
s_add_u32 s26, s26, 48496640
s_add_u32 s27, s26, 0x40000
s_lshl_b32 s25, s23, 11
s_sub_u32 s30, s25, 0x40000
s_cmp_lt_u32 s20, 6
s_cselect_b32 s26, s26, s28
s_cselect_b32 s27, s27, s29
s_cselect_b32 s25, s25, s30
s_add_u32 s26, s26, s25
s_add_u32 s27, s27, s25
s_cmp_lt_u32 s20, 5
s_cselect_b32 s31, s20, 0
v_lshlrev_b32 v7, 4, v0
s_add_u32 s40, s31, 0
s_sub_u32 s34, s40, 5
s_cmp_ge_u32 s40, 5
s_cselect_b32 s40, s34, s40
v_lshl_add_u32 v2, s40, 10, v7
s_add_u32 s41, s31, 1
s_sub_u32 s34, s41, 5
s_cmp_ge_u32 s41, 5
s_cselect_b32 s41, s34, s41
v_lshl_add_u32 v3, s41, 10, v7
s_add_u32 s42, s31, 2
s_sub_u32 s34, s42, 5
s_cmp_ge_u32 s42, 5
s_cselect_b32 s42, s34, s42
v_lshl_add_u32 v4, s42, 10, v7
s_add_u32 s43, s31, 3
s_sub_u32 s34, s43, 5
s_cmp_ge_u32 s43, 5
s_cselect_b32 s43, s34, s43
v_lshl_add_u32 v5, s43, 10, v7
s_add_u32 s44, s31, 4
s_sub_u32 s34, s44, 5
s_cmp_ge_u32 s44, 5
s_cselect_b32 s44, s34, s44
v_lshl_add_u32 v6, s44, 10, v7
s_waitcnt lgkmcnt(0)
s_add_u32 s4, s32, 0
s_addc_u32 s5, s33, 0
s_mov_b32 s6, 81002496
s_mov_b32 s7, 0x00020000
s_mov_b32 s10, 2621440
s_mov_b32 s11, 0x00020000
s_mov_b32 s14, 2621440
s_mov_b32 s15, 0x00020000
s_lshr_b32 s60, s21, 1
s_add_u32 s61, s21, 16
s_cmp_lt_u32 s20, 6
s_cselect_b32 s60, s60, s61
s_lshl_b32 s63, s60, 3
s_lshl_b32 s63, 0xff, s63
s_not_b32 s63, s63
s_lshr_b32 s60, s60, 2
s_lshl_b32 s61, 1, s60
s_mov_b32 s60, 0
s_add_u32 s64, s20, 2
s_and_b32 s64, s64, 7
s_cmp_ge_u32 s2, 224
s_cselect_b32 s64, 0, s64
s_cmp_lt_u32 s64, 3
s_cselect_b32 s64, 0, 1073741824
v_lshlrev_b32 v253, 2, v0
v_mov_b32 v252, 0
s_mov_b64 exec, s[60:61]
buffer_load_dword v252, v253, s[56:59], s64 offen sc0 sc1
s_mov_b64 exec, -1
buffer_load_dwordx4 v[24:27], v2, s[4:7], s24 offen
buffer_load_dwordx4 v[28:31], v3, s[4:7], s24 offen
buffer_load_dwordx4 v[32:35], v4, s[4:7], s24 offen
buffer_load_dwordx4 v[36:39], v5, s[4:7], s24 offen
buffer_load_dwordx4 v[40:43], v6, s[4:7], s24 offen
s_add_u32 s24, s24, 40960
buffer_load_dwordx4 v[60:63], v2, s[4:7], s24 offen
buffer_load_dwordx4 v[64:67], v3, s[4:7], s24 offen
buffer_load_dwordx4 v[68:71], v4, s[4:7], s24 offen
buffer_load_dwordx4 v[72:75], v5, s[4:7], s24 offen
buffer_load_dwordx4 v[76:79], v6, s[4:7], s24 offen
s_add_u32 s24, s24, 40960
buffer_load_dwordx4 v[96:99], v2, s[4:7], s24 offen
buffer_load_dwordx4 v[100:103], v3, s[4:7], s24 offen
buffer_load_dwordx4 v[104:107], v4, s[4:7], s24 offen
buffer_load_dwordx4 v[108:111], v5, s[4:7], s24 offen
buffer_load_dwordx4 v[112:115], v6, s[4:7], s24 offen
s_add_u32 s24, s24, 40960
buffer_load_dwordx4 v[132:135], v2, s[4:7], s24 offen
buffer_load_dwordx4 v[136:139], v3, s[4:7], s24 offen
buffer_load_dwordx4 v[140:143], v4, s[4:7], s24 offen
buffer_load_dwordx4 v[144:147], v5, s[4:7], s24 offen
buffer_load_dwordx4 v[148:151], v6, s[4:7], s24 offen
s_add_u32 s24, s24, 40960
s_cmp_lt_u32 s2, 224
s_cbranch_scc1 .lwg_1123
s_cmp_lt_u32 s20, 4
s_cbranch_scc1 .lwg_1123
s_mov_b32 s62, 30000
v_mov_b32 v250, 163836
.lw_1122:
ds_read_b32 v251, v250
s_sub_u32 s62, s62, 1
s_cbranch_scc1 .lwg_1123
s_waitcnt lgkmcnt(0)
v_readfirstlane_b32 s34, v251
s_and_b32 s34, s34, 255
s_cmp_lt_u32 s34, 8
s_cbranch_scc1 .lw_1122
.lwg_1123:
s_waitcnt lgkmcnt(0)
s_xor_b32 s65, s20, 4
s_mul_i32 s65, s65, 19456
s_cmp_lt_u32 s20, 4
s_cselect_b32 s66, 4096, 0
s_add_u32 s65, s65, s66
v_lshl_add_u32 v254, v0, 4, s65
s_mov_b32 s66, s24
s_add_u32 m0, s65, 0
s_nop 0
buffer_load_dwordx4 v2, s[4:7], s66 offen lds
s_add_u32 m0, s65, 1024
s_nop 0
buffer_load_dwordx4 v3, s[4:7], s66 offen lds
s_add_u32 m0, s65, 2048
s_nop 0
buffer_load_dwordx4 v4, s[4:7], s66 offen lds
s_add_u32 m0, s65, 3072
s_nop 0
buffer_load_dwordx4 v5, s[4:7], s66 offen lds
s_add_u32 m0, s65, 4096
s_nop 0
buffer_load_dwordx4 v6, s[4:7], s66 offen lds
s_add_u32 m0, s65, 5120
s_add_u32 s66, s66, 40960
buffer_load_dwordx4 v2, s[4:7], s66 offen lds
s_add_u32 m0, s65, 6144
s_nop 0
buffer_load_dwordx4 v3, s[4:7], s66 offen lds
s_add_u32 m0, s65, 7168
s_nop 0
buffer_load_dwordx4 v4, s[4:7], s66 offen lds
s_add_u32 m0, s65, 8192
s_nop 0
buffer_load_dwordx4 v5, s[4:7], s66 offen lds
s_add_u32 m0, s65, 9216
s_nop 0
buffer_load_dwordx4 v6, s[4:7], s66 offen lds
s_cmp_eq_u32 s20, 5
s_cselect_b32 s64, 0, 1073741824
s_waitcnt vmcnt(30)
s_cmp_ge_u32 s2, 224
s_cselect_b32 s34, s20, 0
s_cmp_ge_u32 s34, 6
s_cbranch_scc1 .k3pg_1125
s_cmp_ge_u32 s2, 224
s_cbranch_scc1 .k3pb_1124
v_mov_b32 v250, 163836
v_mov_b32 v251, 0
ds_write_b32 v250, v251
s_cmp_lg_u32 s20, 0
s_cbranch_scc1 .pw_1126
v_or_b32 v252, s63, v252
v_cmp_ne_u32 vcc, -1, v252
s_and_b64 vcc, vcc, s[60:61]
s_cbranch_scc1 .pslow_1127
.pret_1128:
.pw_1126:
s_waitcnt lgkmcnt(0)
s_barrier
s_cmp_lt_u32 s20, 6
s_cbranch_scc1 .k3pg_1125
.k3pb_1124:
v_or_b32 v252, s63, v252
v_cmp_ne_u32 vcc, -1, v252
s_and_b64 vcc, vcc, s[60:61]
s_cbranch_scc1 .pslow_1130
.pret_1131:
.k3pg_1125:
s_add_u32 s60, s21, 16
s_lshl_b32 s63, s60, 3
s_lshl_b32 s63, 0xff, s63
s_not_b32 s63, s63
s_lshr_b32 s60, s60, 2
s_lshl_b32 s61, 1, s60
s_mov_b32 s60, 0
buffer_load_dwordx4 v[44:47], v1, s[4:7], s26 offen offset:0
buffer_load_dwordx4 v[48:51], v1, s[4:7], s26 offen offset:256
buffer_load_dwordx4 v[52:55], v1, s[4:7], s27 offen offset:0
buffer_load_dwordx4 v[56:59], v1, s[4:7], s27 offen offset:256
s_add_u32 s26, s26, 0x800
s_add_u32 s27, s27, 0x800
buffer_load_dwordx4 v[80:83], v1, s[4:7], s26 offen offset:0
buffer_load_dwordx4 v[84:87], v1, s[4:7], s26 offen offset:256
buffer_load_dwordx4 v[88:91], v1, s[4:7], s27 offen offset:0
buffer_load_dwordx4 v[92:95], v1, s[4:7], s27 offen offset:256
s_add_u32 s26, s26, 0x800
s_add_u32 s27, s27, 0x800
buffer_load_dwordx4 v[116:119], v1, s[4:7], s26 offen offset:0
buffer_load_dwordx4 v[120:123], v1, s[4:7], s26 offen offset:256
buffer_load_dwordx4 v[124:127], v1, s[4:7], s27 offen offset:0
buffer_load_dwordx4 v[128:131], v1, s[4:7], s27 offen offset:256
s_add_u32 s26, s26, 0x800
s_add_u32 s27, s27, 0x800
buffer_load_dwordx4 v[152:155], v1, s[4:7], s26 offen offset:0
buffer_load_dwordx4 v[156:159], v1, s[4:7], s26 offen offset:256
buffer_load_dwordx4 v[160:163], v1, s[4:7], s27 offen offset:0
buffer_load_dwordx4 v[164:167], v1, s[4:7], s27 offen offset:256
s_add_u32 s26, s26, 0x800
s_add_u32 s27, s27, 0x800
s_min_u32 s35, s20, 4
s_mul_i32 s36, s22, 5
s_add_u32 s35, s35, s36
v_and_b32 v7, 15, v0
v_lshrrev_b32 v249, 4, v0
v_mul_u32_u24 v248, 1280, v7
v_lshl_add_u32 v248, v249, 3, v248
s_mul_i32 s36, s21, 81920
s_lshl_b32 s37, s35, 5
s_add_u32 s36, s36, s37
v_lshlrev_b32 v7, 4, v7
v_and_b32 v250, 1, v249
v_lshl_add_u32 v7, v250, 9, v7
v_lshrrev_b32 v249, 1, v249
v_lshl_add_u32 v249, v249, 3, v7
s_mul_i32 s37, s21, 81920
s_lshl_b32 s38, s35, 10
s_add_u32 s37, s37, s38
s_add_u32 s37, s37, 5242880
s_add_u32 s38, s37, 40960
s_add_u32 s46, s36, 0
s_add_u32 s47, s36, 20480
s_add_u32 s48, s36, 40960
s_add_u32 s49, s36, 61440
buffer_load_dwordx2 v[8:9], v248, s[8:11], s46 offen
buffer_load_dwordx2 v[16:17], v249, s[4:7], s37 offen offset:0
buffer_load_dwordx2 v[10:11], v248, s[8:11], s47 offen
buffer_load_dwordx2 v[18:19], v249, s[4:7], s37 offen offset:256
buffer_load_dwordx2 v[12:13], v248, s[8:11], s48 offen
buffer_load_dwordx2 v[20:21], v249, s[4:7], s38 offen offset:0
buffer_load_dwordx2 v[14:15], v248, s[8:11], s49 offen
buffer_load_dwordx2 v[22:23], v249, s[4:7], s38 offen offset:256
s_waitcnt vmcnt(53)
s_waitcnt vmcnt(23)
v_mfma_f32_16x16x32_bf16 v[168:171], v[24:27], v[44:47], 0
s_waitcnt vmcnt(22)
v_mfma_f32_16x16x32_bf16 v[172:175], v[24:27], v[48:51], 0
s_waitcnt vmcnt(21)
v_mfma_f32_16x16x32_bf16 v[176:179], v[24:27], v[52:55], 0
s_waitcnt vmcnt(20)
v_mfma_f32_16x16x32_bf16 v[180:183], v[24:27], v[56:59], 0
ds_read_b128 v[24:27], v254 offset:0
v_mfma_f32_16x16x32_bf16 v[184:187], v[28:31], v[44:47], 0
v_mfma_f32_16x16x32_bf16 v[188:191], v[28:31], v[48:51], 0
v_mfma_f32_16x16x32_bf16 v[192:195], v[28:31], v[52:55], 0
v_mfma_f32_16x16x32_bf16 v[196:199], v[28:31], v[56:59], 0
ds_read_b128 v[28:31], v254 offset:1024
v_mfma_f32_16x16x32_bf16 v[200:203], v[32:35], v[44:47], 0
v_mfma_f32_16x16x32_bf16 v[204:207], v[32:35], v[48:51], 0
v_mfma_f32_16x16x32_bf16 v[208:211], v[32:35], v[52:55], 0
v_mfma_f32_16x16x32_bf16 v[212:215], v[32:35], v[56:59], 0
ds_read_b128 v[32:35], v254 offset:2048
v_mfma_f32_16x16x32_bf16 v[216:219], v[36:39], v[44:47], 0
v_mfma_f32_16x16x32_bf16 v[220:223], v[36:39], v[48:51], 0
v_mfma_f32_16x16x32_bf16 v[224:227], v[36:39], v[52:55], 0
v_mfma_f32_16x16x32_bf16 v[228:231], v[36:39], v[56:59], 0
ds_read_b128 v[36:39], v254 offset:3072
v_mfma_f32_16x16x32_bf16 v[232:235], v[40:43], v[44:47], 0
buffer_load_dwordx4 v[44:47], v1, s[4:7], s26 offen offset:0
v_mfma_f32_16x16x32_bf16 v[236:239], v[40:43], v[48:51], 0
buffer_load_dwordx4 v[48:51], v1, s[4:7], s26 offen offset:256
v_mfma_f32_16x16x32_bf16 v[240:243], v[40:43], v[52:55], 0
buffer_load_dwordx4 v[52:55], v1, s[4:7], s27 offen offset:0
v_mfma_f32_16x16x32_bf16 v[244:247], v[40:43], v[56:59], 0
buffer_load_dwordx4 v[56:59], v1, s[4:7], s27 offen offset:256
ds_read_b128 v[40:43], v254 offset:4096
s_add_u32 s24, s24, 40960
s_add_u32 s26, s26, 0x800
s_add_u32 s27, s27, 0x800
s_waitcnt vmcnt(23)
v_mfma_f32_16x16x32_bf16 v[168:171], v[60:63], v[80:83], v[168:171]
s_waitcnt vmcnt(22)
v_mfma_f32_16x16x32_bf16 v[172:175], v[60:63], v[84:87], v[172:175]
s_waitcnt vmcnt(21)
v_mfma_f32_16x16x32_bf16 v[176:179], v[60:63], v[88:91], v[176:179]
s_waitcnt vmcnt(20)
v_mfma_f32_16x16x32_bf16 v[180:183], v[60:63], v[92:95], v[180:183]
ds_read_b128 v[60:63], v254 offset:5120
v_mfma_f32_16x16x32_bf16 v[184:187], v[64:67], v[80:83], v[184:187]
v_mfma_f32_16x16x32_bf16 v[188:191], v[64:67], v[84:87], v[188:191]
v_mfma_f32_16x16x32_bf16 v[192:195], v[64:67], v[88:91], v[192:195]
v_mfma_f32_16x16x32_bf16 v[196:199], v[64:67], v[92:95], v[196:199]
ds_read_b128 v[64:67], v254 offset:6144
v_mfma_f32_16x16x32_bf16 v[200:203], v[68:71], v[80:83], v[200:203]
v_mfma_f32_16x16x32_bf16 v[204:207], v[68:71], v[84:87], v[204:207]
v_mfma_f32_16x16x32_bf16 v[208:211], v[68:71], v[88:91], v[208:211]
v_mfma_f32_16x16x32_bf16 v[212:215], v[68:71], v[92:95], v[212:215]
ds_read_b128 v[68:71], v254 offset:7168
v_mfma_f32_16x16x32_bf16 v[216:219], v[72:75], v[80:83], v[216:219]
v_mfma_f32_16x16x32_bf16 v[220:223], v[72:75], v[84:87], v[220:223]
v_mfma_f32_16x16x32_bf16 v[224:227], v[72:75], v[88:91], v[224:227]
v_mfma_f32_16x16x32_bf16 v[228:231], v[72:75], v[92:95], v[228:231]
ds_read_b128 v[72:75], v254 offset:8192
v_mfma_f32_16x16x32_bf16 v[232:235], v[76:79], v[80:83], v[232:235]
buffer_load_dwordx4 v[80:83], v1, s[4:7], s26 offen offset:0
v_mfma_f32_16x16x32_bf16 v[236:239], v[76:79], v[84:87], v[236:239]
buffer_load_dwordx4 v[84:87], v1, s[4:7], s26 offen offset:256
v_mfma_f32_16x16x32_bf16 v[240:243], v[76:79], v[88:91], v[240:243]
buffer_load_dwordx4 v[88:91], v1, s[4:7], s27 offen offset:0
v_mfma_f32_16x16x32_bf16 v[244:247], v[76:79], v[92:95], v[244:247]
buffer_load_dwordx4 v[92:95], v1, s[4:7], s27 offen offset:256
ds_read_b128 v[76:79], v254 offset:9216
s_add_u32 s24, s24, 40960
s_add_u32 s26, s26, 0x800
s_add_u32 s27, s27, 0x800
s_waitcnt vmcnt(23)
v_mfma_f32_16x16x32_bf16 v[168:171], v[96:99], v[116:119], v[168:171]
s_waitcnt vmcnt(22)
v_mfma_f32_16x16x32_bf16 v[172:175], v[96:99], v[120:123], v[172:175]
s_waitcnt vmcnt(21)
v_mfma_f32_16x16x32_bf16 v[176:179], v[96:99], v[124:127], v[176:179]
s_waitcnt vmcnt(20)
v_mfma_f32_16x16x32_bf16 v[180:183], v[96:99], v[128:131], v[180:183]
buffer_load_dwordx4 v[96:99], v2, s[4:7], s24 offen
v_mfma_f32_16x16x32_bf16 v[184:187], v[100:103], v[116:119], v[184:187]
v_mfma_f32_16x16x32_bf16 v[188:191], v[100:103], v[120:123], v[188:191]
v_mfma_f32_16x16x32_bf16 v[192:195], v[100:103], v[124:127], v[192:195]
v_mfma_f32_16x16x32_bf16 v[196:199], v[100:103], v[128:131], v[196:199]
buffer_load_dwordx4 v[100:103], v3, s[4:7], s24 offen
v_mfma_f32_16x16x32_bf16 v[200:203], v[104:107], v[116:119], v[200:203]
v_mfma_f32_16x16x32_bf16 v[204:207], v[104:107], v[120:123], v[204:207]
v_mfma_f32_16x16x32_bf16 v[208:211], v[104:107], v[124:127], v[208:211]
v_mfma_f32_16x16x32_bf16 v[212:215], v[104:107], v[128:131], v[212:215]
buffer_load_dwordx4 v[104:107], v4, s[4:7], s24 offen
v_mfma_f32_16x16x32_bf16 v[216:219], v[108:111], v[116:119], v[216:219]
v_mfma_f32_16x16x32_bf16 v[220:223], v[108:111], v[120:123], v[220:223]
v_mfma_f32_16x16x32_bf16 v[224:227], v[108:111], v[124:127], v[224:227]
v_mfma_f32_16x16x32_bf16 v[228:231], v[108:111], v[128:131], v[228:231]
buffer_load_dwordx4 v[108:111], v5, s[4:7], s24 offen
v_mfma_f32_16x16x32_bf16 v[232:235], v[112:115], v[116:119], v[232:235]
buffer_load_dwordx4 v[116:119], v1, s[4:7], s26 offen offset:0
v_mfma_f32_16x16x32_bf16 v[236:239], v[112:115], v[120:123], v[236:239]
buffer_load_dwordx4 v[120:123], v1, s[4:7], s26 offen offset:256
v_mfma_f32_16x16x32_bf16 v[240:243], v[112:115], v[124:127], v[240:243]
buffer_load_dwordx4 v[124:127], v1, s[4:7], s27 offen offset:0
v_mfma_f32_16x16x32_bf16 v[244:247], v[112:115], v[128:131], v[244:247]
buffer_load_dwordx4 v[128:131], v1, s[4:7], s27 offen offset:256
buffer_load_dwordx4 v[112:115], v6, s[4:7], s24 offen
s_add_u32 s24, s24, 40960
s_add_u32 s26, s26, 0x800
s_add_u32 s27, s27, 0x800
s_waitcnt vmcnt(28)
v_mfma_f32_16x16x32_bf16 v[168:171], v[132:135], v[152:155], v[168:171]
s_waitcnt vmcnt(27)
v_mfma_f32_16x16x32_bf16 v[172:175], v[132:135], v[156:159], v[172:175]
s_waitcnt vmcnt(26)
v_mfma_f32_16x16x32_bf16 v[176:179], v[132:135], v[160:163], v[176:179]
s_waitcnt vmcnt(25)
v_mfma_f32_16x16x32_bf16 v[180:183], v[132:135], v[164:167], v[180:183]
buffer_load_dwordx4 v[132:135], v2, s[4:7], s24 offen
v_mfma_f32_16x16x32_bf16 v[184:187], v[136:139], v[152:155], v[184:187]
v_mfma_f32_16x16x32_bf16 v[188:191], v[136:139], v[156:159], v[188:191]
v_mfma_f32_16x16x32_bf16 v[192:195], v[136:139], v[160:163], v[192:195]
v_mfma_f32_16x16x32_bf16 v[196:199], v[136:139], v[164:167], v[196:199]
buffer_load_dwordx4 v[136:139], v3, s[4:7], s24 offen
v_mfma_f32_16x16x32_bf16 v[200:203], v[140:143], v[152:155], v[200:203]
v_mfma_f32_16x16x32_bf16 v[204:207], v[140:143], v[156:159], v[204:207]
v_mfma_f32_16x16x32_bf16 v[208:211], v[140:143], v[160:163], v[208:211]
v_mfma_f32_16x16x32_bf16 v[212:215], v[140:143], v[164:167], v[212:215]
buffer_load_dwordx4 v[140:143], v4, s[4:7], s24 offen
v_mfma_f32_16x16x32_bf16 v[216:219], v[144:147], v[152:155], v[216:219]
v_mfma_f32_16x16x32_bf16 v[220:223], v[144:147], v[156:159], v[220:223]
v_mfma_f32_16x16x32_bf16 v[224:227], v[144:147], v[160:163], v[224:227]
v_mfma_f32_16x16x32_bf16 v[228:231], v[144:147], v[164:167], v[228:231]
buffer_load_dwordx4 v[144:147], v5, s[4:7], s24 offen
v_mfma_f32_16x16x32_bf16 v[232:235], v[148:151], v[152:155], v[232:235]
buffer_load_dwordx4 v[152:155], v1, s[4:7], s26 offen offset:0
v_mfma_f32_16x16x32_bf16 v[236:239], v[148:151], v[156:159], v[236:239]
buffer_load_dwordx4 v[156:159], v1, s[4:7], s26 offen offset:256
v_mfma_f32_16x16x32_bf16 v[240:243], v[148:151], v[160:163], v[240:243]
buffer_load_dwordx4 v[160:163], v1, s[4:7], s27 offen offset:0
v_mfma_f32_16x16x32_bf16 v[244:247], v[148:151], v[164:167], v[244:247]
buffer_load_dwordx4 v[164:167], v1, s[4:7], s27 offen offset:256
buffer_load_dwordx4 v[148:151], v6, s[4:7], s24 offen
s_add_u32 s24, s24, 40960
s_add_u32 s26, s26, 0x800
s_add_u32 s27, s27, 0x800
v_mov_b32 v250, 163836
v_mov_b32 v251, 0x100
s_waitcnt lgkmcnt(0)
s_mov_b64 exec, 1
ds_add_u32 v250, v251
s_mov_b64 exec, -1
s_waitcnt vmcnt(25)
v_mfma_f32_16x16x32_bf16 v[168:171], v[24:27], v[44:47], v[168:171]
s_waitcnt vmcnt(24)
v_mfma_f32_16x16x32_bf16 v[172:175], v[24:27], v[48:51], v[172:175]
s_waitcnt vmcnt(23)
v_mfma_f32_16x16x32_bf16 v[176:179], v[24:27], v[52:55], v[176:179]
s_waitcnt vmcnt(22)
v_mfma_f32_16x16x32_bf16 v[180:183], v[24:27], v[56:59], v[180:183]
buffer_load_dwordx4 v[24:27], v2, s[4:7], s24 offen
v_mfma_f32_16x16x32_bf16 v[184:187], v[28:31], v[44:47], v[184:187]
v_mfma_f32_16x16x32_bf16 v[188:191], v[28:31], v[48:51], v[188:191]
v_mfma_f32_16x16x32_bf16 v[192:195], v[28:31], v[52:55], v[192:195]
v_mfma_f32_16x16x32_bf16 v[196:199], v[28:31], v[56:59], v[196:199]
buffer_load_dwordx4 v[28:31], v3, s[4:7], s24 offen
v_mfma_f32_16x16x32_bf16 v[200:203], v[32:35], v[44:47], v[200:203]
v_mfma_f32_16x16x32_bf16 v[204:207], v[32:35], v[48:51], v[204:207]
v_mfma_f32_16x16x32_bf16 v[208:211], v[32:35], v[52:55], v[208:211]
v_mfma_f32_16x16x32_bf16 v[212:215], v[32:35], v[56:59], v[212:215]
buffer_load_dwordx4 v[32:35], v4, s[4:7], s24 offen
v_mfma_f32_16x16x32_bf16 v[216:219], v[36:39], v[44:47], v[216:219]
v_mfma_f32_16x16x32_bf16 v[220:223], v[36:39], v[48:51], v[220:223]
v_mfma_f32_16x16x32_bf16 v[224:227], v[36:39], v[52:55], v[224:227]
v_mfma_f32_16x16x32_bf16 v[228:231], v[36:39], v[56:59], v[228:231]
buffer_load_dwordx4 v[36:39], v5, s[4:7], s24 offen
v_mfma_f32_16x16x32_bf16 v[232:235], v[40:43], v[44:47], v[232:235]
buffer_load_dwordx4 v[44:47], v1, s[4:7], s26 offen offset:0
v_mfma_f32_16x16x32_bf16 v[236:239], v[40:43], v[48:51], v[236:239]
buffer_load_dwordx4 v[48:51], v1, s[4:7], s26 offen offset:256
v_mfma_f32_16x16x32_bf16 v[240:243], v[40:43], v[52:55], v[240:243]
buffer_load_dwordx4 v[52:55], v1, s[4:7], s27 offen offset:0
v_mfma_f32_16x16x32_bf16 v[244:247], v[40:43], v[56:59], v[244:247]
buffer_load_dwordx4 v[56:59], v1, s[4:7], s27 offen offset:256
buffer_load_dwordx4 v[40:43], v6, s[4:7], s24 offen
s_add_u32 s24, s24, 40960
s_add_u32 s26, s26, 0x800
s_add_u32 s27, s27, 0x800
v_lshlrev_b32 v253, 2, v0
v_mov_b32 v252, 0
s_mov_b64 exec, s[60:61]
buffer_load_dword v252, v253, s[56:59], s64 offen sc0 sc1
s_mov_b64 exec, -1
s_waitcnt vmcnt(31)
v_mfma_f32_16x16x32_bf16 v[168:171], v[60:63], v[80:83], v[168:171]
s_waitcnt vmcnt(30)
v_mfma_f32_16x16x32_bf16 v[172:175], v[60:63], v[84:87], v[172:175]
s_waitcnt vmcnt(29)
v_mfma_f32_16x16x32_bf16 v[176:179], v[60:63], v[88:91], v[176:179]
s_waitcnt vmcnt(28)
v_mfma_f32_16x16x32_bf16 v[180:183], v[60:63], v[92:95], v[180:183]
buffer_load_dwordx4 v[60:63], v2, s[4:7], s24 offen
v_mfma_f32_16x16x32_bf16 v[184:187], v[64:67], v[80:83], v[184:187]
v_mfma_f32_16x16x32_bf16 v[188:191], v[64:67], v[84:87], v[188:191]
v_mfma_f32_16x16x32_bf16 v[192:195], v[64:67], v[88:91], v[192:195]
v_mfma_f32_16x16x32_bf16 v[196:199], v[64:67], v[92:95], v[196:199]
buffer_load_dwordx4 v[64:67], v3, s[4:7], s24 offen
v_mfma_f32_16x16x32_bf16 v[200:203], v[68:71], v[80:83], v[200:203]
v_mfma_f32_16x16x32_bf16 v[204:207], v[68:71], v[84:87], v[204:207]
v_mfma_f32_16x16x32_bf16 v[208:211], v[68:71], v[88:91], v[208:211]
v_mfma_f32_16x16x32_bf16 v[212:215], v[68:71], v[92:95], v[212:215]
buffer_load_dwordx4 v[68:71], v4, s[4:7], s24 offen
v_mfma_f32_16x16x32_bf16 v[216:219], v[72:75], v[80:83], v[216:219]
v_mfma_f32_16x16x32_bf16 v[220:223], v[72:75], v[84:87], v[220:223]
v_mfma_f32_16x16x32_bf16 v[224:227], v[72:75], v[88:91], v[224:227]
v_mfma_f32_16x16x32_bf16 v[228:231], v[72:75], v[92:95], v[228:231]
buffer_load_dwordx4 v[72:75], v5, s[4:7], s24 offen
v_mfma_f32_16x16x32_bf16 v[232:235], v[76:79], v[80:83], v[232:235]
buffer_load_dwordx4 v[80:83], v1, s[4:7], s26 offen offset:0
v_mfma_f32_16x16x32_bf16 v[236:239], v[76:79], v[84:87], v[236:239]
buffer_load_dwordx4 v[84:87], v1, s[4:7], s26 offen offset:256
v_mfma_f32_16x16x32_bf16 v[240:243], v[76:79], v[88:91], v[240:243]
buffer_load_dwordx4 v[88:91], v1, s[4:7], s27 offen offset:0
v_mfma_f32_16x16x32_bf16 v[244:247], v[76:79], v[92:95], v[244:247]
buffer_load_dwordx4 v[92:95], v1, s[4:7], s27 offen offset:256
buffer_load_dwordx4 v[76:79], v6, s[4:7], s24 offen
s_add_u32 s24, s24, 40960
s_add_u32 s26, s26, 0x800
s_add_u32 s27, s27, 0x800
s_waitcnt vmcnt(36)
s_waitcnt vmcnt(32)
v_mfma_f32_16x16x32_bf16 v[168:171], v[96:99], v[116:119], v[168:171]
s_waitcnt vmcnt(31)
v_mfma_f32_16x16x32_bf16 v[172:175], v[96:99], v[120:123], v[172:175]
s_waitcnt vmcnt(30)
v_mfma_f32_16x16x32_bf16 v[176:179], v[96:99], v[124:127], v[176:179]
s_waitcnt vmcnt(29)
v_mfma_f32_16x16x32_bf16 v[180:183], v[96:99], v[128:131], v[180:183]
buffer_load_dwordx4 v[96:99], v2, s[4:7], s24 offen
v_mfma_f32_16x16x32_bf16 v[184:187], v[100:103], v[116:119], v[184:187]
v_mfma_f32_16x16x32_bf16 v[188:191], v[100:103], v[120:123], v[188:191]
v_mfma_f32_16x16x32_bf16 v[192:195], v[100:103], v[124:127], v[192:195]
v_mfma_f32_16x16x32_bf16 v[196:199], v[100:103], v[128:131], v[196:199]
buffer_load_dwordx4 v[100:103], v3, s[4:7], s24 offen
v_mfma_f32_16x16x32_bf16 v[200:203], v[104:107], v[116:119], v[200:203]
v_mfma_f32_16x16x32_bf16 v[204:207], v[104:107], v[120:123], v[204:207]
v_mfma_f32_16x16x32_bf16 v[208:211], v[104:107], v[124:127], v[208:211]
v_mfma_f32_16x16x32_bf16 v[212:215], v[104:107], v[128:131], v[212:215]
buffer_load_dwordx4 v[104:107], v4, s[4:7], s24 offen
v_mfma_f32_16x16x32_bf16 v[216:219], v[108:111], v[116:119], v[216:219]
v_mfma_f32_16x16x32_bf16 v[220:223], v[108:111], v[120:123], v[220:223]
v_mfma_f32_16x16x32_bf16 v[224:227], v[108:111], v[124:127], v[224:227]
v_mfma_f32_16x16x32_bf16 v[228:231], v[108:111], v[128:131], v[228:231]
buffer_load_dwordx4 v[108:111], v5, s[4:7], s24 offen
s_waitcnt vmcnt(32)
v_mfma_f32_16x16x32_bf16 v[232:235], v[112:115], v[116:119], v[232:235]
buffer_load_dwordx4 v[116:119], v1, s[4:7], s26 offen offset:0
v_mfma_f32_16x16x32_bf16 v[236:239], v[112:115], v[120:123], v[236:239]
buffer_load_dwordx4 v[120:123], v1, s[4:7], s26 offen offset:256
v_mfma_f32_16x16x32_bf16 v[240:243], v[112:115], v[124:127], v[240:243]
buffer_load_dwordx4 v[124:127], v1, s[4:7], s27 offen offset:0
v_mfma_f32_16x16x32_bf16 v[244:247], v[112:115], v[128:131], v[244:247]
buffer_load_dwordx4 v[128:131], v1, s[4:7], s27 offen offset:256
buffer_load_dwordx4 v[112:115], v6, s[4:7], s24 offen
s_add_u32 s24, s24, 40960
s_add_u32 s26, s26, 0x800
s_add_u32 s27, s27, 0x800
s_waitcnt vmcnt(36)
s_waitcnt vmcnt(32)
v_mfma_f32_16x16x32_bf16 v[168:171], v[132:135], v[152:155], v[168:171]
s_waitcnt vmcnt(31)
v_mfma_f32_16x16x32_bf16 v[172:175], v[132:135], v[156:159], v[172:175]
s_waitcnt vmcnt(30)
v_mfma_f32_16x16x32_bf16 v[176:179], v[132:135], v[160:163], v[176:179]
s_waitcnt vmcnt(29)
v_mfma_f32_16x16x32_bf16 v[180:183], v[132:135], v[164:167], v[180:183]
buffer_load_dwordx4 v[132:135], v2, s[4:7], s24 offen
v_mfma_f32_16x16x32_bf16 v[184:187], v[136:139], v[152:155], v[184:187]
v_mfma_f32_16x16x32_bf16 v[188:191], v[136:139], v[156:159], v[188:191]
v_mfma_f32_16x16x32_bf16 v[192:195], v[136:139], v[160:163], v[192:195]
v_mfma_f32_16x16x32_bf16 v[196:199], v[136:139], v[164:167], v[196:199]
buffer_load_dwordx4 v[136:139], v3, s[4:7], s24 offen
v_mfma_f32_16x16x32_bf16 v[200:203], v[140:143], v[152:155], v[200:203]
v_mfma_f32_16x16x32_bf16 v[204:207], v[140:143], v[156:159], v[204:207]
v_mfma_f32_16x16x32_bf16 v[208:211], v[140:143], v[160:163], v[208:211]
v_mfma_f32_16x16x32_bf16 v[212:215], v[140:143], v[164:167], v[212:215]
buffer_load_dwordx4 v[140:143], v4, s[4:7], s24 offen
v_mfma_f32_16x16x32_bf16 v[216:219], v[144:147], v[152:155], v[216:219]
v_mfma_f32_16x16x32_bf16 v[220:223], v[144:147], v[156:159], v[220:223]
v_mfma_f32_16x16x32_bf16 v[224:227], v[144:147], v[160:163], v[224:227]
v_mfma_f32_16x16x32_bf16 v[228:231], v[144:147], v[164:167], v[228:231]
buffer_load_dwordx4 v[144:147], v5, s[4:7], s24 offen
s_waitcnt vmcnt(32)
v_mfma_f32_16x16x32_bf16 v[232:235], v[148:151], v[152:155], v[232:235]
buffer_load_dwordx4 v[152:155], v1, s[4:7], s26 offen offset:0
v_mfma_f32_16x16x32_bf16 v[236:239], v[148:151], v[156:159], v[236:239]
buffer_load_dwordx4 v[156:159], v1, s[4:7], s26 offen offset:256
v_mfma_f32_16x16x32_bf16 v[240:243], v[148:151], v[160:163], v[240:243]
buffer_load_dwordx4 v[160:163], v1, s[4:7], s27 offen offset:0
v_mfma_f32_16x16x32_bf16 v[244:247], v[148:151], v[164:167], v[244:247]
buffer_load_dwordx4 v[164:167], v1, s[4:7], s27 offen offset:256
buffer_load_dwordx4 v[148:151], v6, s[4:7], s24 offen
s_add_u32 s24, s24, 40960
s_add_u32 s26, s26, 0x800
s_add_u32 s27, s27, 0x800
s_waitcnt vmcnt(36)
s_waitcnt vmcnt(32)
v_mfma_f32_16x16x32_bf16 v[168:171], v[24:27], v[44:47], v[168:171]
s_waitcnt vmcnt(31)
v_mfma_f32_16x16x32_bf16 v[172:175], v[24:27], v[48:51], v[172:175]
s_waitcnt vmcnt(30)
v_mfma_f32_16x16x32_bf16 v[176:179], v[24:27], v[52:55], v[176:179]
s_waitcnt vmcnt(29)
v_mfma_f32_16x16x32_bf16 v[180:183], v[24:27], v[56:59], v[180:183]
buffer_load_dwordx4 v[24:27], v2, s[4:7], s24 offen
v_mfma_f32_16x16x32_bf16 v[184:187], v[28:31], v[44:47], v[184:187]
v_mfma_f32_16x16x32_bf16 v[188:191], v[28:31], v[48:51], v[188:191]
v_mfma_f32_16x16x32_bf16 v[192:195], v[28:31], v[52:55], v[192:195]
v_mfma_f32_16x16x32_bf16 v[196:199], v[28:31], v[56:59], v[196:199]
buffer_load_dwordx4 v[28:31], v3, s[4:7], s24 offen
v_mfma_f32_16x16x32_bf16 v[200:203], v[32:35], v[44:47], v[200:203]
v_mfma_f32_16x16x32_bf16 v[204:207], v[32:35], v[48:51], v[204:207]
v_mfma_f32_16x16x32_bf16 v[208:211], v[32:35], v[52:55], v[208:211]
v_mfma_f32_16x16x32_bf16 v[212:215], v[32:35], v[56:59], v[212:215]
buffer_load_dwordx4 v[32:35], v4, s[4:7], s24 offen
v_mfma_f32_16x16x32_bf16 v[216:219], v[36:39], v[44:47], v[216:219]
v_mfma_f32_16x16x32_bf16 v[220:223], v[36:39], v[48:51], v[220:223]
v_mfma_f32_16x16x32_bf16 v[224:227], v[36:39], v[52:55], v[224:227]
v_mfma_f32_16x16x32_bf16 v[228:231], v[36:39], v[56:59], v[228:231]
buffer_load_dwordx4 v[36:39], v5, s[4:7], s24 offen
s_waitcnt vmcnt(32)
v_mfma_f32_16x16x32_bf16 v[232:235], v[40:43], v[44:47], v[232:235]
buffer_load_dwordx4 v[44:47], v1, s[4:7], s26 offen offset:0
v_mfma_f32_16x16x32_bf16 v[236:239], v[40:43], v[48:51], v[236:239]
buffer_load_dwordx4 v[48:51], v1, s[4:7], s26 offen offset:256
v_mfma_f32_16x16x32_bf16 v[240:243], v[40:43], v[52:55], v[240:243]
buffer_load_dwordx4 v[52:55], v1, s[4:7], s27 offen offset:0
v_mfma_f32_16x16x32_bf16 v[244:247], v[40:43], v[56:59], v[244:247]
buffer_load_dwordx4 v[56:59], v1, s[4:7], s27 offen offset:256
buffer_load_dwordx4 v[40:43], v6, s[4:7], s24 offen
s_add_u32 s24, s24, 40960
s_add_u32 s26, s26, 0x800
s_add_u32 s27, s27, 0x800
s_waitcnt vmcnt(36)
s_cmp_lg_u32 s20, 5
s_cbranch_scc1 .pw_1135
v_or_b32 v252, s63, v252
v_cmp_ne_u32 vcc, -1, v252
s_and_b64 vcc, vcc, s[60:61]
s_cbranch_scc1 .pslow_1136
.pret_1137:
.pw_1135:
s_cmp_eq_u32 s20, 5
s_cselect_b32 s26, s28, s26
s_cselect_b32 s27, s29, s27
s_waitcnt vmcnt(35)
s_waitcnt vmcnt(31)
v_mfma_f32_16x16x32_bf16 v[168:171], v[60:63], v[80:83], v[168:171]
s_waitcnt vmcnt(30)
v_mfma_f32_16x16x32_bf16 v[172:175], v[60:63], v[84:87], v[172:175]
s_waitcnt vmcnt(29)
v_mfma_f32_16x16x32_bf16 v[176:179], v[60:63], v[88:91], v[176:179]
s_waitcnt vmcnt(28)
v_mfma_f32_16x16x32_bf16 v[180:183], v[60:63], v[92:95], v[180:183]
buffer_load_dwordx4 v[60:63], v2, s[4:7], s24 offen
v_mfma_f32_16x16x32_bf16 v[184:187], v[64:67], v[80:83], v[184:187]
v_mfma_f32_16x16x32_bf16 v[188:191], v[64:67], v[84:87], v[188:191]
v_mfma_f32_16x16x32_bf16 v[192:195], v[64:67], v[88:91], v[192:195]
v_mfma_f32_16x16x32_bf16 v[196:199], v[64:67], v[92:95], v[196:199]
buffer_load_dwordx4 v[64:67], v3, s[4:7], s24 offen
v_mfma_f32_16x16x32_bf16 v[200:203], v[68:71], v[80:83], v[200:203]
v_mfma_f32_16x16x32_bf16 v[204:207], v[68:71], v[84:87], v[204:207]
v_mfma_f32_16x16x32_bf16 v[208:211], v[68:71], v[88:91], v[208:211]
v_mfma_f32_16x16x32_bf16 v[212:215], v[68:71], v[92:95], v[212:215]
buffer_load_dwordx4 v[68:71], v4, s[4:7], s24 offen
v_mfma_f32_16x16x32_bf16 v[216:219], v[72:75], v[80:83], v[216:219]
v_mfma_f32_16x16x32_bf16 v[220:223], v[72:75], v[84:87], v[220:223]
v_mfma_f32_16x16x32_bf16 v[224:227], v[72:75], v[88:91], v[224:227]
v_mfma_f32_16x16x32_bf16 v[228:231], v[72:75], v[92:95], v[228:231]
buffer_load_dwordx4 v[72:75], v5, s[4:7], s24 offen
s_waitcnt vmcnt(31)
v_mfma_f32_16x16x32_bf16 v[232:235], v[76:79], v[80:83], v[232:235]
buffer_load_dwordx4 v[80:83], v1, s[4:7], s26 offen offset:0
v_mfma_f32_16x16x32_bf16 v[236:239], v[76:79], v[84:87], v[236:239]
buffer_load_dwordx4 v[84:87], v1, s[4:7], s26 offen offset:256
v_mfma_f32_16x16x32_bf16 v[240:243], v[76:79], v[88:91], v[240:243]
buffer_load_dwordx4 v[88:91], v1, s[4:7], s27 offen offset:0
v_mfma_f32_16x16x32_bf16 v[244:247], v[76:79], v[92:95], v[244:247]
buffer_load_dwordx4 v[92:95], v1, s[4:7], s27 offen offset:256
buffer_load_dwordx4 v[76:79], v6, s[4:7], s24 offen
s_add_u32 s24, s24, 40960
s_add_u32 s26, s26, 0x800
s_add_u32 s27, s27, 0x800
s_waitcnt vmcnt(35)
s_waitcnt vmcnt(31)
v_mfma_f32_16x16x32_bf16 v[168:171], v[96:99], v[116:119], v[168:171]
s_waitcnt vmcnt(30)
v_mfma_f32_16x16x32_bf16 v[172:175], v[96:99], v[120:123], v[172:175]
s_waitcnt vmcnt(29)
v_mfma_f32_16x16x32_bf16 v[176:179], v[96:99], v[124:127], v[176:179]
s_waitcnt vmcnt(28)
v_mfma_f32_16x16x32_bf16 v[180:183], v[96:99], v[128:131], v[180:183]
buffer_load_dwordx4 v[96:99], v2, s[4:7], s24 offen
v_mfma_f32_16x16x32_bf16 v[184:187], v[100:103], v[116:119], v[184:187]
v_mfma_f32_16x16x32_bf16 v[188:191], v[100:103], v[120:123], v[188:191]
v_mfma_f32_16x16x32_bf16 v[192:195], v[100:103], v[124:127], v[192:195]
v_mfma_f32_16x16x32_bf16 v[196:199], v[100:103], v[128:131], v[196:199]
buffer_load_dwordx4 v[100:103], v3, s[4:7], s24 offen
v_mfma_f32_16x16x32_bf16 v[200:203], v[104:107], v[116:119], v[200:203]
v_mfma_f32_16x16x32_bf16 v[204:207], v[104:107], v[120:123], v[204:207]
v_mfma_f32_16x16x32_bf16 v[208:211], v[104:107], v[124:127], v[208:211]
v_mfma_f32_16x16x32_bf16 v[212:215], v[104:107], v[128:131], v[212:215]
buffer_load_dwordx4 v[104:107], v4, s[4:7], s24 offen
v_mfma_f32_16x16x32_bf16 v[216:219], v[108:111], v[116:119], v[216:219]
v_mfma_f32_16x16x32_bf16 v[220:223], v[108:111], v[120:123], v[220:223]
v_mfma_f32_16x16x32_bf16 v[224:227], v[108:111], v[124:127], v[224:227]
v_mfma_f32_16x16x32_bf16 v[228:231], v[108:111], v[128:131], v[228:231]
buffer_load_dwordx4 v[108:111], v5, s[4:7], s24 offen
s_waitcnt vmcnt(31)
v_mfma_f32_16x16x32_bf16 v[232:235], v[112:115], v[116:119], v[232:235]
buffer_load_dwordx4 v[116:119], v1, s[4:7], s26 offen offset:0
v_mfma_f32_16x16x32_bf16 v[236:239], v[112:115], v[120:123], v[236:239]
buffer_load_dwordx4 v[120:123], v1, s[4:7], s26 offen offset:256
v_mfma_f32_16x16x32_bf16 v[240:243], v[112:115], v[124:127], v[240:243]
buffer_load_dwordx4 v[124:127], v1, s[4:7], s27 offen offset:0
v_mfma_f32_16x16x32_bf16 v[244:247], v[112:115], v[128:131], v[244:247]
buffer_load_dwordx4 v[128:131], v1, s[4:7], s27 offen offset:256
buffer_load_dwordx4 v[112:115], v6, s[4:7], s24 offen
s_add_u32 s24, s24, 40960
s_add_u32 s26, s26, 0x800
s_add_u32 s27, s27, 0x800
s_waitcnt vmcnt(35)
s_waitcnt vmcnt(31)
v_mfma_f32_16x16x32_bf16 v[168:171], v[132:135], v[152:155], v[168:171]
s_waitcnt vmcnt(30)
v_mfma_f32_16x16x32_bf16 v[172:175], v[132:135], v[156:159], v[172:175]
s_waitcnt vmcnt(29)
v_mfma_f32_16x16x32_bf16 v[176:179], v[132:135], v[160:163], v[176:179]
s_waitcnt vmcnt(28)
v_mfma_f32_16x16x32_bf16 v[180:183], v[132:135], v[164:167], v[180:183]
buffer_load_dwordx4 v[132:135], v2, s[4:7], s24 offen
v_mfma_f32_16x16x32_bf16 v[184:187], v[136:139], v[152:155], v[184:187]
v_mfma_f32_16x16x32_bf16 v[188:191], v[136:139], v[156:159], v[188:191]
v_mfma_f32_16x16x32_bf16 v[192:195], v[136:139], v[160:163], v[192:195]
v_mfma_f32_16x16x32_bf16 v[196:199], v[136:139], v[164:167], v[196:199]
buffer_load_dwordx4 v[136:139], v3, s[4:7], s24 offen
v_mfma_f32_16x16x32_bf16 v[200:203], v[140:143], v[152:155], v[200:203]
v_mfma_f32_16x16x32_bf16 v[204:207], v[140:143], v[156:159], v[204:207]
v_mfma_f32_16x16x32_bf16 v[208:211], v[140:143], v[160:163], v[208:211]
v_mfma_f32_16x16x32_bf16 v[212:215], v[140:143], v[164:167], v[212:215]
buffer_load_dwordx4 v[140:143], v4, s[4:7], s24 offen
v_mfma_f32_16x16x32_bf16 v[216:219], v[144:147], v[152:155], v[216:219]
v_mfma_f32_16x16x32_bf16 v[220:223], v[144:147], v[156:159], v[220:223]
v_mfma_f32_16x16x32_bf16 v[224:227], v[144:147], v[160:163], v[224:227]
v_mfma_f32_16x16x32_bf16 v[228:231], v[144:147], v[164:167], v[228:231]
buffer_load_dwordx4 v[144:147], v5, s[4:7], s24 offen
s_waitcnt vmcnt(31)
v_mfma_f32_16x16x32_bf16 v[232:235], v[148:151], v[152:155], v[232:235]
buffer_load_dwordx4 v[152:155], v1, s[4:7], s26 offen offset:0
v_mfma_f32_16x16x32_bf16 v[236:239], v[148:151], v[156:159], v[236:239]
buffer_load_dwordx4 v[156:159], v1, s[4:7], s26 offen offset:256
v_mfma_f32_16x16x32_bf16 v[240:243], v[148:151], v[160:163], v[240:243]
buffer_load_dwordx4 v[160:163], v1, s[4:7], s27 offen offset:0
v_mfma_f32_16x16x32_bf16 v[244:247], v[148:151], v[164:167], v[244:247]
buffer_load_dwordx4 v[164:167], v1, s[4:7], s27 offen offset:256
buffer_load_dwordx4 v[148:151], v6, s[4:7], s24 offen
s_add_u32 s24, s24, 40960
s_add_u32 s26, s26, 0x800
s_add_u32 s27, s27, 0x800
s_waitcnt vmcnt(35)
s_waitcnt vmcnt(31)
v_mfma_f32_16x16x32_bf16 v[168:171], v[24:27], v[44:47], v[168:171]
s_waitcnt vmcnt(30)
v_mfma_f32_16x16x32_bf16 v[172:175], v[24:27], v[48:51], v[172:175]
s_waitcnt vmcnt(29)
v_mfma_f32_16x16x32_bf16 v[176:179], v[24:27], v[52:55], v[176:179]
s_waitcnt vmcnt(28)
v_mfma_f32_16x16x32_bf16 v[180:183], v[24:27], v[56:59], v[180:183]
buffer_load_dwordx4 v[24:27], v2, s[4:7], s24 offen
v_mfma_f32_16x16x32_bf16 v[184:187], v[28:31], v[44:47], v[184:187]
v_mfma_f32_16x16x32_bf16 v[188:191], v[28:31], v[48:51], v[188:191]
v_mfma_f32_16x16x32_bf16 v[192:195], v[28:31], v[52:55], v[192:195]
v_mfma_f32_16x16x32_bf16 v[196:199], v[28:31], v[56:59], v[196:199]
buffer_load_dwordx4 v[28:31], v3, s[4:7], s24 offen
v_mfma_f32_16x16x32_bf16 v[200:203], v[32:35], v[44:47], v[200:203]
v_mfma_f32_16x16x32_bf16 v[204:207], v[32:35], v[48:51], v[204:207]
v_mfma_f32_16x16x32_bf16 v[208:211], v[32:35], v[52:55], v[208:211]
v_mfma_f32_16x16x32_bf16 v[212:215], v[32:35], v[56:59], v[212:215]
buffer_load_dwordx4 v[32:35], v4, s[4:7], s24 offen
v_mfma_f32_16x16x32_bf16 v[216:219], v[36:39], v[44:47], v[216:219]
v_mfma_f32_16x16x32_bf16 v[220:223], v[36:39], v[48:51], v[220:223]
v_mfma_f32_16x16x32_bf16 v[224:227], v[36:39], v[52:55], v[224:227]
v_mfma_f32_16x16x32_bf16 v[228:231], v[36:39], v[56:59], v[228:231]
buffer_load_dwordx4 v[36:39], v5, s[4:7], s24 offen
s_waitcnt vmcnt(31)
v_mfma_f32_16x16x32_bf16 v[232:235], v[40:43], v[44:47], v[232:235]
buffer_load_dwordx4 v[44:47], v1, s[4:7], s26 offen offset:0
v_mfma_f32_16x16x32_bf16 v[236:239], v[40:43], v[48:51], v[236:239]
buffer_load_dwordx4 v[48:51], v1, s[4:7], s26 offen offset:256
v_mfma_f32_16x16x32_bf16 v[240:243], v[40:43], v[52:55], v[240:243]
buffer_load_dwordx4 v[52:55], v1, s[4:7], s27 offen offset:0
v_mfma_f32_16x16x32_bf16 v[244:247], v[40:43], v[56:59], v[244:247]
buffer_load_dwordx4 v[56:59], v1, s[4:7], s27 offen offset:256
buffer_load_dwordx4 v[40:43], v6, s[4:7], s24 offen
s_add_u32 s24, s24, 40960
s_add_u32 s26, s26, 0x800
s_add_u32 s27, s27, 0x800
s_cmp_eq_u32 s20, 5
s_cbranch_scc1 .flush_1133
.flushr_1134:
s_waitcnt vmcnt(35)
s_waitcnt vmcnt(31)
v_mfma_f32_16x16x32_bf16 v[168:171], v[60:63], v[80:83], v[168:171]
s_waitcnt vmcnt(30)
v_mfma_f32_16x16x32_bf16 v[172:175], v[60:63], v[84:87], v[172:175]
s_waitcnt vmcnt(29)
v_mfma_f32_16x16x32_bf16 v[176:179], v[60:63], v[88:91], v[176:179]
s_waitcnt vmcnt(28)
v_mfma_f32_16x16x32_bf16 v[180:183], v[60:63], v[92:95], v[180:183]
buffer_load_dwordx4 v[60:63], v2, s[4:7], s24 offen
v_mfma_f32_16x16x32_bf16 v[184:187], v[64:67], v[80:83], v[184:187]
v_mfma_f32_16x16x32_bf16 v[188:191], v[64:67], v[84:87], v[188:191]
v_mfma_f32_16x16x32_bf16 v[192:195], v[64:67], v[88:91], v[192:195]
v_mfma_f32_16x16x32_bf16 v[196:199], v[64:67], v[92:95], v[196:199]
buffer_load_dwordx4 v[64:67], v3, s[4:7], s24 offen
v_mfma_f32_16x16x32_bf16 v[200:203], v[68:71], v[80:83], v[200:203]
v_mfma_f32_16x16x32_bf16 v[204:207], v[68:71], v[84:87], v[204:207]
v_mfma_f32_16x16x32_bf16 v[208:211], v[68:71], v[88:91], v[208:211]
v_mfma_f32_16x16x32_bf16 v[212:215], v[68:71], v[92:95], v[212:215]
buffer_load_dwordx4 v[68:71], v4, s[4:7], s24 offen
v_mfma_f32_16x16x32_bf16 v[216:219], v[72:75], v[80:83], v[216:219]
v_mfma_f32_16x16x32_bf16 v[220:223], v[72:75], v[84:87], v[220:223]
v_mfma_f32_16x16x32_bf16 v[224:227], v[72:75], v[88:91], v[224:227]
v_mfma_f32_16x16x32_bf16 v[228:231], v[72:75], v[92:95], v[228:231]
buffer_load_dwordx4 v[72:75], v5, s[4:7], s24 offen
s_waitcnt vmcnt(31)
v_mfma_f32_16x16x32_bf16 v[232:235], v[76:79], v[80:83], v[232:235]
buffer_load_dwordx4 v[80:83], v1, s[4:7], s26 offen offset:0
v_mfma_f32_16x16x32_bf16 v[236:239], v[76:79], v[84:87], v[236:239]
buffer_load_dwordx4 v[84:87], v1, s[4:7], s26 offen offset:256
v_mfma_f32_16x16x32_bf16 v[240:243], v[76:79], v[88:91], v[240:243]
buffer_load_dwordx4 v[88:91], v1, s[4:7], s27 offen offset:0
v_mfma_f32_16x16x32_bf16 v[244:247], v[76:79], v[92:95], v[244:247]
buffer_load_dwordx4 v[92:95], v1, s[4:7], s27 offen offset:256
buffer_load_dwordx4 v[76:79], v6, s[4:7], s24 offen
s_add_u32 s24, s24, 40960
s_add_u32 s26, s26, 0x800
s_add_u32 s27, s27, 0x800
s_waitcnt vmcnt(35)
s_waitcnt vmcnt(31)
v_mfma_f32_16x16x32_bf16 v[168:171], v[96:99], v[116:119], v[168:171]
s_waitcnt vmcnt(30)
v_mfma_f32_16x16x32_bf16 v[172:175], v[96:99], v[120:123], v[172:175]
s_waitcnt vmcnt(29)
v_mfma_f32_16x16x32_bf16 v[176:179], v[96:99], v[124:127], v[176:179]
s_waitcnt vmcnt(28)
v_mfma_f32_16x16x32_bf16 v[180:183], v[96:99], v[128:131], v[180:183]
buffer_load_dwordx4 v[96:99], v2, s[4:7], s24 offen
v_mfma_f32_16x16x32_bf16 v[184:187], v[100:103], v[116:119], v[184:187]
v_mfma_f32_16x16x32_bf16 v[188:191], v[100:103], v[120:123], v[188:191]
v_mfma_f32_16x16x32_bf16 v[192:195], v[100:103], v[124:127], v[192:195]
v_mfma_f32_16x16x32_bf16 v[196:199], v[100:103], v[128:131], v[196:199]
buffer_load_dwordx4 v[100:103], v3, s[4:7], s24 offen
v_mfma_f32_16x16x32_bf16 v[200:203], v[104:107], v[116:119], v[200:203]
v_mfma_f32_16x16x32_bf16 v[204:207], v[104:107], v[120:123], v[204:207]
v_mfma_f32_16x16x32_bf16 v[208:211], v[104:107], v[124:127], v[208:211]
v_mfma_f32_16x16x32_bf16 v[212:215], v[104:107], v[128:131], v[212:215]
buffer_load_dwordx4 v[104:107], v4, s[4:7], s24 offen
v_mfma_f32_16x16x32_bf16 v[216:219], v[108:111], v[116:119], v[216:219]
v_mfma_f32_16x16x32_bf16 v[220:223], v[108:111], v[120:123], v[220:223]
v_mfma_f32_16x16x32_bf16 v[224:227], v[108:111], v[124:127], v[224:227]
v_mfma_f32_16x16x32_bf16 v[228:231], v[108:111], v[128:131], v[228:231]
buffer_load_dwordx4 v[108:111], v5, s[4:7], s24 offen
s_waitcnt vmcnt(31)
v_mfma_f32_16x16x32_bf16 v[232:235], v[112:115], v[116:119], v[232:235]
buffer_load_dwordx4 v[116:119], v1, s[4:7], s26 offen offset:0
v_mfma_f32_16x16x32_bf16 v[236:239], v[112:115], v[120:123], v[236:239]
buffer_load_dwordx4 v[120:123], v1, s[4:7], s26 offen offset:256
v_mfma_f32_16x16x32_bf16 v[240:243], v[112:115], v[124:127], v[240:243]
buffer_load_dwordx4 v[124:127], v1, s[4:7], s27 offen offset:0
v_mfma_f32_16x16x32_bf16 v[244:247], v[112:115], v[128:131], v[244:247]
buffer_load_dwordx4 v[128:131], v1, s[4:7], s27 offen offset:256
buffer_load_dwordx4 v[112:115], v6, s[4:7], s24 offen
s_add_u32 s24, s24, 40960
s_add_u32 s26, s26, 0x800
s_add_u32 s27, s27, 0x800
s_waitcnt vmcnt(35)
s_waitcnt vmcnt(31)
v_mfma_f32_16x16x32_bf16 v[168:171], v[132:135], v[152:155], v[168:171]
s_waitcnt vmcnt(30)
v_mfma_f32_16x16x32_bf16 v[172:175], v[132:135], v[156:159], v[172:175]
s_waitcnt vmcnt(29)
v_mfma_f32_16x16x32_bf16 v[176:179], v[132:135], v[160:163], v[176:179]
s_waitcnt vmcnt(28)
v_mfma_f32_16x16x32_bf16 v[180:183], v[132:135], v[164:167], v[180:183]
buffer_load_dwordx4 v[132:135], v2, s[4:7], s24 offen
v_mfma_f32_16x16x32_bf16 v[184:187], v[136:139], v[152:155], v[184:187]
v_mfma_f32_16x16x32_bf16 v[188:191], v[136:139], v[156:159], v[188:191]
v_mfma_f32_16x16x32_bf16 v[192:195], v[136:139], v[160:163], v[192:195]
v_mfma_f32_16x16x32_bf16 v[196:199], v[136:139], v[164:167], v[196:199]
buffer_load_dwordx4 v[136:139], v3, s[4:7], s24 offen
v_mfma_f32_16x16x32_bf16 v[200:203], v[140:143], v[152:155], v[200:203]
v_mfma_f32_16x16x32_bf16 v[204:207], v[140:143], v[156:159], v[204:207]
v_mfma_f32_16x16x32_bf16 v[208:211], v[140:143], v[160:163], v[208:211]
v_mfma_f32_16x16x32_bf16 v[212:215], v[140:143], v[164:167], v[212:215]
buffer_load_dwordx4 v[140:143], v4, s[4:7], s24 offen
v_mfma_f32_16x16x32_bf16 v[216:219], v[144:147], v[152:155], v[216:219]
v_mfma_f32_16x16x32_bf16 v[220:223], v[144:147], v[156:159], v[220:223]
v_mfma_f32_16x16x32_bf16 v[224:227], v[144:147], v[160:163], v[224:227]
v_mfma_f32_16x16x32_bf16 v[228:231], v[144:147], v[164:167], v[228:231]
buffer_load_dwordx4 v[144:147], v5, s[4:7], s24 offen
s_waitcnt vmcnt(31)
v_mfma_f32_16x16x32_bf16 v[232:235], v[148:151], v[152:155], v[232:235]
buffer_load_dwordx4 v[152:155], v1, s[4:7], s26 offen offset:0
v_mfma_f32_16x16x32_bf16 v[236:239], v[148:151], v[156:159], v[236:239]
buffer_load_dwordx4 v[156:159], v1, s[4:7], s26 offen offset:256
v_mfma_f32_16x16x32_bf16 v[240:243], v[148:151], v[160:163], v[240:243]
buffer_load_dwordx4 v[160:163], v1, s[4:7], s27 offen offset:0
v_mfma_f32_16x16x32_bf16 v[244:247], v[148:151], v[164:167], v[244:247]
buffer_load_dwordx4 v[164:167], v1, s[4:7], s27 offen offset:256
buffer_load_dwordx4 v[148:151], v6, s[4:7], s24 offen
s_add_u32 s24, s24, 40960
s_add_u32 s26, s26, 0x800
s_add_u32 s27, s27, 0x800
s_waitcnt vmcnt(35)
s_waitcnt vmcnt(31)
v_mfma_f32_16x16x32_bf16 v[168:171], v[24:27], v[44:47], v[168:171]
s_waitcnt vmcnt(30)
v_mfma_f32_16x16x32_bf16 v[172:175], v[24:27], v[48:51], v[172:175]
s_waitcnt vmcnt(29)
v_mfma_f32_16x16x32_bf16 v[176:179], v[24:27], v[52:55], v[176:179]
s_waitcnt vmcnt(28)
v_mfma_f32_16x16x32_bf16 v[180:183], v[24:27], v[56:59], v[180:183]
buffer_load_dwordx4 v[24:27], v2, s[4:7], s24 offen
v_mfma_f32_16x16x32_bf16 v[184:187], v[28:31], v[44:47], v[184:187]
v_mfma_f32_16x16x32_bf16 v[188:191], v[28:31], v[48:51], v[188:191]
v_mfma_f32_16x16x32_bf16 v[192:195], v[28:31], v[52:55], v[192:195]
v_mfma_f32_16x16x32_bf16 v[196:199], v[28:31], v[56:59], v[196:199]
buffer_load_dwordx4 v[28:31], v3, s[4:7], s24 offen
v_mfma_f32_16x16x32_bf16 v[200:203], v[32:35], v[44:47], v[200:203]
v_mfma_f32_16x16x32_bf16 v[204:207], v[32:35], v[48:51], v[204:207]
v_mfma_f32_16x16x32_bf16 v[208:211], v[32:35], v[52:55], v[208:211]
v_mfma_f32_16x16x32_bf16 v[212:215], v[32:35], v[56:59], v[212:215]
buffer_load_dwordx4 v[32:35], v4, s[4:7], s24 offen
v_mfma_f32_16x16x32_bf16 v[216:219], v[36:39], v[44:47], v[216:219]
v_mfma_f32_16x16x32_bf16 v[220:223], v[36:39], v[48:51], v[220:223]
v_mfma_f32_16x16x32_bf16 v[224:227], v[36:39], v[52:55], v[224:227]
v_mfma_f32_16x16x32_bf16 v[228:231], v[36:39], v[56:59], v[228:231]
buffer_load_dwordx4 v[36:39], v5, s[4:7], s24 offen
s_waitcnt vmcnt(31)
v_mfma_f32_16x16x32_bf16 v[232:235], v[40:43], v[44:47], v[232:235]
buffer_load_dwordx4 v[44:47], v1, s[4:7], s26 offen offset:0
v_mfma_f32_16x16x32_bf16 v[236:239], v[40:43], v[48:51], v[236:239]
buffer_load_dwordx4 v[48:51], v1, s[4:7], s26 offen offset:256
v_mfma_f32_16x16x32_bf16 v[240:243], v[40:43], v[52:55], v[240:243]
buffer_load_dwordx4 v[52:55], v1, s[4:7], s27 offen offset:0
v_mfma_f32_16x16x32_bf16 v[244:247], v[40:43], v[56:59], v[244:247]
buffer_load_dwordx4 v[56:59], v1, s[4:7], s27 offen offset:256
buffer_load_dwordx4 v[40:43], v6, s[4:7], s24 offen
s_add_u32 s24, s24, 40960
s_add_u32 s26, s26, 0x800
s_add_u32 s27, s27, 0x800
s_waitcnt vmcnt(35)
s_waitcnt vmcnt(31)
v_mfma_f32_16x16x32_bf16 v[168:171], v[60:63], v[80:83], v[168:171]
s_waitcnt vmcnt(30)
v_mfma_f32_16x16x32_bf16 v[172:175], v[60:63], v[84:87], v[172:175]
s_waitcnt vmcnt(29)
v_mfma_f32_16x16x32_bf16 v[176:179], v[60:63], v[88:91], v[176:179]
s_waitcnt vmcnt(28)
v_mfma_f32_16x16x32_bf16 v[180:183], v[60:63], v[92:95], v[180:183]
buffer_load_dwordx4 v[60:63], v2, s[4:7], s24 offen
v_mfma_f32_16x16x32_bf16 v[184:187], v[64:67], v[80:83], v[184:187]
v_mfma_f32_16x16x32_bf16 v[188:191], v[64:67], v[84:87], v[188:191]
v_mfma_f32_16x16x32_bf16 v[192:195], v[64:67], v[88:91], v[192:195]
v_mfma_f32_16x16x32_bf16 v[196:199], v[64:67], v[92:95], v[196:199]
buffer_load_dwordx4 v[64:67], v3, s[4:7], s24 offen
v_mfma_f32_16x16x32_bf16 v[200:203], v[68:71], v[80:83], v[200:203]
v_mfma_f32_16x16x32_bf16 v[204:207], v[68:71], v[84:87], v[204:207]
v_mfma_f32_16x16x32_bf16 v[208:211], v[68:71], v[88:91], v[208:211]
v_mfma_f32_16x16x32_bf16 v[212:215], v[68:71], v[92:95], v[212:215]
buffer_load_dwordx4 v[68:71], v4, s[4:7], s24 offen
v_mfma_f32_16x16x32_bf16 v[216:219], v[72:75], v[80:83], v[216:219]
v_mfma_f32_16x16x32_bf16 v[220:223], v[72:75], v[84:87], v[220:223]
v_mfma_f32_16x16x32_bf16 v[224:227], v[72:75], v[88:91], v[224:227]
v_mfma_f32_16x16x32_bf16 v[228:231], v[72:75], v[92:95], v[228:231]
buffer_load_dwordx4 v[72:75], v5, s[4:7], s24 offen
s_waitcnt vmcnt(31)
v_mfma_f32_16x16x32_bf16 v[232:235], v[76:79], v[80:83], v[232:235]
buffer_load_dwordx4 v[80:83], v1, s[4:7], s26 offen offset:0
v_mfma_f32_16x16x32_bf16 v[236:239], v[76:79], v[84:87], v[236:239]
buffer_load_dwordx4 v[84:87], v1, s[4:7], s26 offen offset:256
v_mfma_f32_16x16x32_bf16 v[240:243], v[76:79], v[88:91], v[240:243]
buffer_load_dwordx4 v[88:91], v1, s[4:7], s27 offen offset:0
v_mfma_f32_16x16x32_bf16 v[244:247], v[76:79], v[92:95], v[244:247]
buffer_load_dwordx4 v[92:95], v1, s[4:7], s27 offen offset:256
buffer_load_dwordx4 v[76:79], v6, s[4:7], s24 offen
s_add_u32 s24, s24, 40960
s_add_u32 s26, s26, 0x800
s_add_u32 s27, s27, 0x800
s_cmp_ge_u32 s20, 6
s_cselect_b32 s24, 1073741824, s24
s_cselect_b32 s26, 1073741824, s26
s_cselect_b32 s27, 1073741824, s27
s_waitcnt vmcnt(35)
s_waitcnt vmcnt(31)
v_mfma_f32_16x16x32_bf16 v[168:171], v[96:99], v[116:119], v[168:171]
s_waitcnt vmcnt(30)
v_mfma_f32_16x16x32_bf16 v[172:175], v[96:99], v[120:123], v[172:175]
s_waitcnt vmcnt(29)
v_mfma_f32_16x16x32_bf16 v[176:179], v[96:99], v[124:127], v[176:179]
s_waitcnt vmcnt(28)
v_mfma_f32_16x16x32_bf16 v[180:183], v[96:99], v[128:131], v[180:183]
buffer_load_dwordx4 v[96:99], v2, s[4:7], s24 offen
v_mfma_f32_16x16x32_bf16 v[184:187], v[100:103], v[116:119], v[184:187]
v_mfma_f32_16x16x32_bf16 v[188:191], v[100:103], v[120:123], v[188:191]
v_mfma_f32_16x16x32_bf16 v[192:195], v[100:103], v[124:127], v[192:195]
v_mfma_f32_16x16x32_bf16 v[196:199], v[100:103], v[128:131], v[196:199]
buffer_load_dwordx4 v[100:103], v3, s[4:7], s24 offen
v_mfma_f32_16x16x32_bf16 v[200:203], v[104:107], v[116:119], v[200:203]
v_mfma_f32_16x16x32_bf16 v[204:207], v[104:107], v[120:123], v[204:207]
v_mfma_f32_16x16x32_bf16 v[208:211], v[104:107], v[124:127], v[208:211]
v_mfma_f32_16x16x32_bf16 v[212:215], v[104:107], v[128:131], v[212:215]
buffer_load_dwordx4 v[104:107], v4, s[4:7], s24 offen
v_mfma_f32_16x16x32_bf16 v[216:219], v[108:111], v[116:119], v[216:219]
v_mfma_f32_16x16x32_bf16 v[220:223], v[108:111], v[120:123], v[220:223]
v_mfma_f32_16x16x32_bf16 v[224:227], v[108:111], v[124:127], v[224:227]
v_mfma_f32_16x16x32_bf16 v[228:231], v[108:111], v[128:131], v[228:231]
buffer_load_dwordx4 v[108:111], v5, s[4:7], s24 offen
s_waitcnt vmcnt(31)
v_mfma_f32_16x16x32_bf16 v[232:235], v[112:115], v[116:119], v[232:235]
buffer_load_dwordx4 v[116:119], v1, s[4:7], s26 offen offset:0
v_mfma_f32_16x16x32_bf16 v[236:239], v[112:115], v[120:123], v[236:239]
buffer_load_dwordx4 v[120:123], v1, s[4:7], s26 offen offset:256
v_mfma_f32_16x16x32_bf16 v[240:243], v[112:115], v[124:127], v[240:243]
buffer_load_dwordx4 v[124:127], v1, s[4:7], s27 offen offset:0
v_mfma_f32_16x16x32_bf16 v[244:247], v[112:115], v[128:131], v[244:247]
buffer_load_dwordx4 v[128:131], v1, s[4:7], s27 offen offset:256
buffer_load_dwordx4 v[112:115], v6, s[4:7], s24 offen
s_waitcnt vmcnt(35)
s_waitcnt vmcnt(31)
v_mfma_f32_16x16x32_bf16 v[168:171], v[132:135], v[152:155], v[168:171]
s_waitcnt vmcnt(30)
v_mfma_f32_16x16x32_bf16 v[172:175], v[132:135], v[156:159], v[172:175]
s_waitcnt vmcnt(29)
v_mfma_f32_16x16x32_bf16 v[176:179], v[132:135], v[160:163], v[176:179]
s_waitcnt vmcnt(28)
v_mfma_f32_16x16x32_bf16 v[180:183], v[132:135], v[164:167], v[180:183]
v_mfma_f32_16x16x32_bf16 v[184:187], v[136:139], v[152:155], v[184:187]
v_mfma_f32_16x16x32_bf16 v[188:191], v[136:139], v[156:159], v[188:191]
v_mfma_f32_16x16x32_bf16 v[192:195], v[136:139], v[160:163], v[192:195]
v_mfma_f32_16x16x32_bf16 v[196:199], v[136:139], v[164:167], v[196:199]
v_mfma_f32_16x16x32_bf16 v[200:203], v[140:143], v[152:155], v[200:203]
v_mfma_f32_16x16x32_bf16 v[204:207], v[140:143], v[156:159], v[204:207]
v_mfma_f32_16x16x32_bf16 v[208:211], v[140:143], v[160:163], v[208:211]
v_mfma_f32_16x16x32_bf16 v[212:215], v[140:143], v[164:167], v[212:215]
v_mfma_f32_16x16x32_bf16 v[216:219], v[144:147], v[152:155], v[216:219]
v_mfma_f32_16x16x32_bf16 v[220:223], v[144:147], v[156:159], v[220:223]
v_mfma_f32_16x16x32_bf16 v[224:227], v[144:147], v[160:163], v[224:227]
v_mfma_f32_16x16x32_bf16 v[228:231], v[144:147], v[164:167], v[228:231]
s_waitcnt vmcnt(27)
v_mfma_f32_16x16x32_bf16 v[232:235], v[148:151], v[152:155], v[232:235]
v_mfma_f32_16x16x32_bf16 v[236:239], v[148:151], v[156:159], v[236:239]
v_mfma_f32_16x16x32_bf16 v[240:243], v[148:151], v[160:163], v[240:243]
v_mfma_f32_16x16x32_bf16 v[244:247], v[148:151], v[164:167], v[244:247]
s_waitcnt vmcnt(26)
s_waitcnt vmcnt(22)
v_mfma_f32_16x16x32_bf16 v[168:171], v[24:27], v[44:47], v[168:171]
s_waitcnt vmcnt(21)
v_mfma_f32_16x16x32_bf16 v[172:175], v[24:27], v[48:51], v[172:175]
s_waitcnt vmcnt(20)
v_mfma_f32_16x16x32_bf16 v[176:179], v[24:27], v[52:55], v[176:179]
s_waitcnt vmcnt(19)
v_mfma_f32_16x16x32_bf16 v[180:183], v[24:27], v[56:59], v[180:183]
v_mfma_f32_16x16x32_bf16 v[184:187], v[28:31], v[44:47], v[184:187]
v_mfma_f32_16x16x32_bf16 v[188:191], v[28:31], v[48:51], v[188:191]
v_mfma_f32_16x16x32_bf16 v[192:195], v[28:31], v[52:55], v[192:195]
v_mfma_f32_16x16x32_bf16 v[196:199], v[28:31], v[56:59], v[196:199]
v_mfma_f32_16x16x32_bf16 v[200:203], v[32:35], v[44:47], v[200:203]
v_mfma_f32_16x16x32_bf16 v[204:207], v[32:35], v[48:51], v[204:207]
v_mfma_f32_16x16x32_bf16 v[208:211], v[32:35], v[52:55], v[208:211]
v_mfma_f32_16x16x32_bf16 v[212:215], v[32:35], v[56:59], v[212:215]
v_mfma_f32_16x16x32_bf16 v[216:219], v[36:39], v[44:47], v[216:219]
v_mfma_f32_16x16x32_bf16 v[220:223], v[36:39], v[48:51], v[220:223]
v_mfma_f32_16x16x32_bf16 v[224:227], v[36:39], v[52:55], v[224:227]
v_mfma_f32_16x16x32_bf16 v[228:231], v[36:39], v[56:59], v[228:231]
s_waitcnt vmcnt(18)
v_mfma_f32_16x16x32_bf16 v[232:235], v[40:43], v[44:47], v[232:235]
v_mfma_f32_16x16x32_bf16 v[236:239], v[40:43], v[48:51], v[236:239]
v_mfma_f32_16x16x32_bf16 v[240:243], v[40:43], v[52:55], v[240:243]
v_mfma_f32_16x16x32_bf16 v[244:247], v[40:43], v[56:59], v[244:247]
s_waitcnt vmcnt(17)
s_waitcnt vmcnt(13)
v_mfma_f32_16x16x32_bf16 v[168:171], v[60:63], v[80:83], v[168:171]
s_waitcnt vmcnt(12)
v_mfma_f32_16x16x32_bf16 v[172:175], v[60:63], v[84:87], v[172:175]
s_waitcnt vmcnt(11)
v_mfma_f32_16x16x32_bf16 v[176:179], v[60:63], v[88:91], v[176:179]
s_waitcnt vmcnt(10)
v_mfma_f32_16x16x32_bf16 v[180:183], v[60:63], v[92:95], v[180:183]
v_mfma_f32_16x16x32_bf16 v[184:187], v[64:67], v[80:83], v[184:187]
v_mfma_f32_16x16x32_bf16 v[188:191], v[64:67], v[84:87], v[188:191]
v_mfma_f32_16x16x32_bf16 v[192:195], v[64:67], v[88:91], v[192:195]
v_mfma_f32_16x16x32_bf16 v[196:199], v[64:67], v[92:95], v[196:199]
v_mfma_f32_16x16x32_bf16 v[200:203], v[68:71], v[80:83], v[200:203]
v_mfma_f32_16x16x32_bf16 v[204:207], v[68:71], v[84:87], v[204:207]
v_mfma_f32_16x16x32_bf16 v[208:211], v[68:71], v[88:91], v[208:211]
v_mfma_f32_16x16x32_bf16 v[212:215], v[68:71], v[92:95], v[212:215]
v_mfma_f32_16x16x32_bf16 v[216:219], v[72:75], v[80:83], v[216:219]
v_mfma_f32_16x16x32_bf16 v[220:223], v[72:75], v[84:87], v[220:223]
v_mfma_f32_16x16x32_bf16 v[224:227], v[72:75], v[88:91], v[224:227]
v_mfma_f32_16x16x32_bf16 v[228:231], v[72:75], v[92:95], v[228:231]
s_waitcnt vmcnt(9)
v_mfma_f32_16x16x32_bf16 v[232:235], v[76:79], v[80:83], v[232:235]
v_mfma_f32_16x16x32_bf16 v[236:239], v[76:79], v[84:87], v[236:239]
v_mfma_f32_16x16x32_bf16 v[240:243], v[76:79], v[88:91], v[240:243]
v_mfma_f32_16x16x32_bf16 v[244:247], v[76:79], v[92:95], v[244:247]
s_waitcnt vmcnt(8)
s_waitcnt vmcnt(4)
v_mfma_f32_16x16x32_bf16 v[168:171], v[96:99], v[116:119], v[168:171]
s_waitcnt vmcnt(3)
v_mfma_f32_16x16x32_bf16 v[172:175], v[96:99], v[120:123], v[172:175]
s_waitcnt vmcnt(2)
v_mfma_f32_16x16x32_bf16 v[176:179], v[96:99], v[124:127], v[176:179]
s_waitcnt vmcnt(1)
v_mfma_f32_16x16x32_bf16 v[180:183], v[96:99], v[128:131], v[180:183]
v_mfma_f32_16x16x32_bf16 v[184:187], v[100:103], v[116:119], v[184:187]
v_mfma_f32_16x16x32_bf16 v[188:191], v[100:103], v[120:123], v[188:191]
v_mfma_f32_16x16x32_bf16 v[192:195], v[100:103], v[124:127], v[192:195]
v_mfma_f32_16x16x32_bf16 v[196:199], v[100:103], v[128:131], v[196:199]
v_mfma_f32_16x16x32_bf16 v[200:203], v[104:107], v[116:119], v[200:203]
v_mfma_f32_16x16x32_bf16 v[204:207], v[104:107], v[120:123], v[204:207]
v_mfma_f32_16x16x32_bf16 v[208:211], v[104:107], v[124:127], v[208:211]
v_mfma_f32_16x16x32_bf16 v[212:215], v[104:107], v[128:131], v[212:215]
v_mfma_f32_16x16x32_bf16 v[216:219], v[108:111], v[116:119], v[216:219]
v_mfma_f32_16x16x32_bf16 v[220:223], v[108:111], v[120:123], v[220:223]
v_mfma_f32_16x16x32_bf16 v[224:227], v[108:111], v[124:127], v[224:227]
v_mfma_f32_16x16x32_bf16 v[228:231], v[108:111], v[128:131], v[228:231]
s_waitcnt vmcnt(0)
v_mfma_f32_16x16x32_bf16 v[232:235], v[112:115], v[116:119], v[232:235]
v_mfma_f32_16x16x32_bf16 v[236:239], v[112:115], v[120:123], v[236:239]
v_mfma_f32_16x16x32_bf16 v[240:243], v[112:115], v[124:127], v[240:243]
v_mfma_f32_16x16x32_bf16 v[244:247], v[112:115], v[128:131], v[244:247]
s_mov_b32 s62, 30000
v_mov_b32 v250, 163836
.lw_1139:
ds_read_b32 v251, v250
s_sub_u32 s62, s62, 1
s_cbranch_scc1 .lwg_1140
s_waitcnt lgkmcnt(0)
v_readfirstlane_b32 s34, v251
s_cmp_lt_u32 s34, 2048
s_cbranch_scc1 .lw_1139
.lwg_1140:
s_waitcnt lgkmcnt(0)
v_lshlrev_b32 v7, 4, v0
s_lshl_b32 s34, s40, 3
s_cmp_lt_u32 s20, 5
s_cselect_b32 s35, 0, s20
s_add_u32 s34, s34, s35
v_lshl_add_u32 v2, s34, 12, v7
s_lshl_b32 s34, s41, 3
s_cmp_lt_u32 s20, 5
s_cselect_b32 s35, 0, s20
s_add_u32 s34, s34, s35
v_lshl_add_u32 v3, s34, 12, v7
s_lshl_b32 s34, s42, 3
s_cmp_lt_u32 s20, 5
s_cselect_b32 s35, 1, s20
s_add_u32 s34, s34, s35
v_lshl_add_u32 v4, s34, 12, v7
s_lshl_b32 s34, s43, 3
s_cmp_lt_u32 s20, 5
s_cselect_b32 s35, 2, s20
s_add_u32 s34, s34, s35
v_lshl_add_u32 v5, s34, 12, v7
s_lshl_b32 s34, s44, 3
s_cmp_lt_u32 s20, 5
s_cselect_b32 s35, 3, s20
s_add_u32 s34, s34, s35
v_lshl_add_u32 v6, s34, 12, v7
ds_write_b128 v3, v[184:187] offset:0
ds_write_b128 v3, v[188:191] offset:1024
ds_write_b128 v3, v[192:195] offset:2048
ds_write_b128 v3, v[196:199] offset:3072
ds_write_b128 v4, v[200:203] offset:0
ds_write_b128 v4, v[204:207] offset:1024
ds_write_b128 v4, v[208:211] offset:2048
ds_write_b128 v4, v[212:215] offset:3072
ds_write_b128 v5, v[216:219] offset:0
ds_write_b128 v5, v[220:223] offset:1024
ds_write_b128 v5, v[224:227] offset:2048
ds_write_b128 v5, v[228:231] offset:3072
ds_write_b128 v6, v[232:235] offset:0
ds_write_b128 v6, v[236:239] offset:1024
ds_write_b128 v6, v[240:243] offset:2048
ds_write_b128 v6, v[244:247] offset:3072
s_cmp_lt_u32 s20, 5
s_cbranch_scc1 .own_1141
ds_write_b128 v2, v[168:171] offset:0
ds_write_b128 v2, v[172:175] offset:1024
ds_write_b128 v2, v[176:179] offset:2048
ds_write_b128 v2, v[180:183] offset:3072
s_waitcnt lgkmcnt(0)
s_barrier
s_branch .fin_1142
.flush_1133:
s_mov_b32 s62, 30000
v_mov_b32 v250, 163836
.lw_1143:
ds_read_b32 v251, v250
s_sub_u32 s62, s62, 1
s_cbranch_scc1 .lwg_1144
s_waitcnt lgkmcnt(0)
v_readfirstlane_b32 s34, v251
s_cmp_lt_u32 s34, 2048
s_cbranch_scc1 .lw_1143
.lwg_1144:
s_waitcnt lgkmcnt(0)
v_lshlrev_b32 v7, 4, v0
v_add_u32 v250, 0x10000, v7
v_add_u32 v251, 0x20000, v7
ds_write_b128 v7, v[168:171] offset:16384
ds_write_b128 v7, v[172:175] offset:17408
ds_write_b128 v7, v[176:179] offset:18432
ds_write_b128 v7, v[180:183] offset:19456
ds_write_b128 v7, v[184:187] offset:49152
ds_write_b128 v7, v[188:191] offset:50176
ds_write_b128 v7, v[192:195] offset:51200
ds_write_b128 v7, v[196:199] offset:52224
ds_write_b128 v250, v[200:203] offset:16384
ds_write_b128 v250, v[204:207] offset:17408
ds_write_b128 v250, v[208:211] offset:18432
ds_write_b128 v250, v[212:215] offset:19456
ds_write_b128 v250, v[216:219] offset:49152
ds_write_b128 v250, v[220:223] offset:50176
ds_write_b128 v250, v[224:227] offset:51200
ds_write_b128 v250, v[228:231] offset:52224
ds_write_b128 v251, v[232:235] offset:16384
ds_write_b128 v251, v[236:239] offset:17408
ds_write_b128 v251, v[240:243] offset:18432
ds_write_b128 v251, v[244:247] offset:19456
s_waitcnt lgkmcnt(0)
v_mov_b32 v168, 0
v_mov_b32 v169, 0
v_mov_b32 v170, 0
v_mov_b32 v171, 0
v_mov_b32 v172, 0
v_mov_b32 v173, 0
v_mov_b32 v174, 0
v_mov_b32 v175, 0
v_mov_b32 v176, 0
v_mov_b32 v177, 0
v_mov_b32 v178, 0
v_mov_b32 v179, 0
v_mov_b32 v180, 0
v_mov_b32 v181, 0
v_mov_b32 v182, 0
v_mov_b32 v183, 0
v_mov_b32 v184, 0
v_mov_b32 v185, 0
v_mov_b32 v186, 0
v_mov_b32 v187, 0
v_mov_b32 v188, 0
v_mov_b32 v189, 0
v_mov_b32 v190, 0
v_mov_b32 v191, 0
v_mov_b32 v192, 0
v_mov_b32 v193, 0
v_mov_b32 v194, 0
v_mov_b32 v195, 0
v_mov_b32 v196, 0
v_mov_b32 v197, 0
v_mov_b32 v198, 0
v_mov_b32 v199, 0
v_mov_b32 v200, 0
v_mov_b32 v201, 0
v_mov_b32 v202, 0
v_mov_b32 v203, 0
v_mov_b32 v204, 0
v_mov_b32 v205, 0
v_mov_b32 v206, 0
v_mov_b32 v207, 0
v_mov_b32 v208, 0
v_mov_b32 v209, 0
v_mov_b32 v210, 0
v_mov_b32 v211, 0
v_mov_b32 v212, 0
v_mov_b32 v213, 0
v_mov_b32 v214, 0
v_mov_b32 v215, 0
v_mov_b32 v216, 0
v_mov_b32 v217, 0
v_mov_b32 v218, 0
v_mov_b32 v219, 0
v_mov_b32 v220, 0
v_mov_b32 v221, 0
v_mov_b32 v222, 0
v_mov_b32 v223, 0
v_mov_b32 v224, 0
v_mov_b32 v225, 0
v_mov_b32 v226, 0
v_mov_b32 v227, 0
v_mov_b32 v228, 0
v_mov_b32 v229, 0
v_mov_b32 v230, 0
v_mov_b32 v231, 0
v_mov_b32 v232, 0
v_mov_b32 v233, 0
v_mov_b32 v234, 0
v_mov_b32 v235, 0
v_mov_b32 v236, 0
v_mov_b32 v237, 0
v_mov_b32 v238, 0
v_mov_b32 v239, 0
v_mov_b32 v240, 0
v_mov_b32 v241, 0
v_mov_b32 v242, 0
v_mov_b32 v243, 0
v_mov_b32 v244, 0
v_mov_b32 v245, 0
v_mov_b32 v246, 0
v_mov_b32 v247, 0
s_branch .flushr_1134
.own_1141:
v_lshl_add_u32 v7, s20, 15, v7
s_waitcnt lgkmcnt(0)
s_barrier
ds_read_b128 v[24:27], v7 offset:0
ds_read_b128 v[28:31], v7 offset:4096
ds_read_b128 v[32:35], v7 offset:8192
ds_read_b128 v[36:39], v7 offset:12288
ds_read_b128 v[40:43], v7 offset:16384
ds_read_b128 v[44:47], v7 offset:20480
ds_read_b128 v[48:51], v7 offset:24576
ds_read_b128 v[52:55], v7 offset:28672
ds_read_b128 v[56:59], v7 offset:1024
ds_read_b128 v[60:63], v7 offset:5120
ds_read_b128 v[64:67], v7 offset:9216
ds_read_b128 v[68:71], v7 offset:13312
ds_read_b128 v[72:75], v7 offset:17408
ds_read_b128 v[76:79], v7 offset:21504
ds_read_b128 v[80:83], v7 offset:25600
ds_read_b128 v[84:87], v7 offset:29696
ds_read_b128 v[88:91], v7 offset:2048
ds_read_b128 v[92:95], v7 offset:6144
ds_read_b128 v[96:99], v7 offset:10240
ds_read_b128 v[100:103], v7 offset:14336
ds_read_b128 v[104:107], v7 offset:18432
ds_read_b128 v[108:111], v7 offset:22528
ds_read_b128 v[112:115], v7 offset:26624
ds_read_b128 v[116:119], v7 offset:30720
ds_read_b128 v[120:123], v7 offset:3072
ds_read_b128 v[124:127], v7 offset:7168
ds_read_b128 v[128:131], v7 offset:11264
ds_read_b128 v[132:135], v7 offset:15360
ds_read_b128 v[136:139], v7 offset:19456
ds_read_b128 v[140:143], v7 offset:23552
ds_read_b128 v[144:147], v7 offset:27648
ds_read_b128 v[148:151], v7 offset:31744
s_mov_b32 s34, 0xbfb8aa3b
s_waitcnt vmcnt(0)
s_waitcnt lgkmcnt(15)
v_add_f32 v24, v24, v28
v_add_f32 v32, v32, v36
v_add_f32 v168, v168, v40
v_add_f32 v44, v44, v48
v_add_f32 v24, v24, v32
v_lshlrev_b32 v28, 16, v16
v_add_f32 v44, v44, v52
v_add_f32 v24, v24, v168
v_add_f32 v44, v44, v28
v_mul_f32 v48, s34, v44
v_exp_f32 v48, v48
v_lshlrev_b32 v28, 16, v8
v_mul_f32 v24, v24, v44
v_add_f32 v48, 1.0, v48
v_rcp_f32 v48, v48
v_add_f32 v25, v25, v29
v_add_f32 v33, v33, v37
v_add_f32 v169, v169, v41
v_add_f32 v45, v45, v49
v_add_f32 v25, v25, v33
v_and_b32 v29, 0xffff0000, v16
v_add_f32 v45, v45, v53
v_add_f32 v25, v25, v169
v_add_f32 v45, v45, v29
v_mul_f32 v49, s34, v45
v_exp_f32 v49, v49
v_and_b32 v29, 0xffff0000, v8
v_mul_f32 v25, v25, v45
v_add_f32 v49, 1.0, v49
v_rcp_f32 v49, v49
v_add_f32 v26, v26, v30
v_add_f32 v34, v34, v38
v_add_f32 v170, v170, v42
v_add_f32 v46, v46, v50
v_add_f32 v26, v26, v34
v_lshlrev_b32 v30, 16, v17
v_add_f32 v46, v46, v54
v_add_f32 v26, v26, v170
v_add_f32 v46, v46, v30
v_mul_f32 v50, s34, v46
v_exp_f32 v50, v50
v_lshlrev_b32 v30, 16, v9
v_mul_f32 v26, v26, v46
v_add_f32 v50, 1.0, v50
v_rcp_f32 v50, v50
v_add_f32 v27, v27, v31
v_add_f32 v35, v35, v39
v_add_f32 v171, v171, v43
v_add_f32 v47, v47, v51
v_add_f32 v27, v27, v35
v_and_b32 v31, 0xffff0000, v17
v_add_f32 v47, v47, v55
v_add_f32 v27, v27, v171
v_add_f32 v47, v47, v31
v_mul_f32 v51, s34, v47
v_exp_f32 v51, v51
v_and_b32 v31, 0xffff0000, v9
v_mul_f32 v27, v27, v47
v_add_f32 v51, 1.0, v51
v_rcp_f32 v51, v51
v_fma_f32 v24, v24, v48, v28
v_fma_f32 v25, v25, v49, v29
v_fma_f32 v26, v26, v50, v30
v_fma_f32 v27, v27, v51, v31
v_cvt_pk_bf16_f32 v32, v24, v25
v_cvt_pk_bf16_f32 v33, v26, v27
buffer_store_dwordx2 v[32:33], v248, s[12:15], s46 offen
s_waitcnt lgkmcnt(15)
v_add_f32 v56, v56, v60
v_add_f32 v64, v64, v68
v_add_f32 v172, v172, v72
v_add_f32 v76, v76, v80
v_add_f32 v56, v56, v64
v_lshlrev_b32 v60, 16, v18
v_add_f32 v76, v76, v84
v_add_f32 v56, v56, v172
v_add_f32 v76, v76, v60
v_mul_f32 v80, s34, v76
v_exp_f32 v80, v80
v_lshlrev_b32 v60, 16, v10
v_mul_f32 v56, v56, v76
v_add_f32 v80, 1.0, v80
v_rcp_f32 v80, v80
v_add_f32 v57, v57, v61
v_add_f32 v65, v65, v69
v_add_f32 v173, v173, v73
v_add_f32 v77, v77, v81
v_add_f32 v57, v57, v65
v_and_b32 v61, 0xffff0000, v18
v_add_f32 v77, v77, v85
v_add_f32 v57, v57, v173
v_add_f32 v77, v77, v61
v_mul_f32 v81, s34, v77
v_exp_f32 v81, v81
v_and_b32 v61, 0xffff0000, v10
v_mul_f32 v57, v57, v77
v_add_f32 v81, 1.0, v81
v_rcp_f32 v81, v81
v_add_f32 v58, v58, v62
v_add_f32 v66, v66, v70
v_add_f32 v174, v174, v74
v_add_f32 v78, v78, v82
v_add_f32 v58, v58, v66
v_lshlrev_b32 v62, 16, v19
v_add_f32 v78, v78, v86
v_add_f32 v58, v58, v174
v_add_f32 v78, v78, v62
v_mul_f32 v82, s34, v78
v_exp_f32 v82, v82
v_lshlrev_b32 v62, 16, v11
v_mul_f32 v58, v58, v78
v_add_f32 v82, 1.0, v82
v_rcp_f32 v82, v82
v_add_f32 v59, v59, v63
v_add_f32 v67, v67, v71
v_add_f32 v175, v175, v75
v_add_f32 v79, v79, v83
v_add_f32 v59, v59, v67
v_and_b32 v63, 0xffff0000, v19
v_add_f32 v79, v79, v87
v_add_f32 v59, v59, v175
v_add_f32 v79, v79, v63
v_mul_f32 v83, s34, v79
v_exp_f32 v83, v83
v_and_b32 v63, 0xffff0000, v11
v_mul_f32 v59, v59, v79
v_add_f32 v83, 1.0, v83
v_rcp_f32 v83, v83
v_fma_f32 v56, v56, v80, v60
v_fma_f32 v57, v57, v81, v61
v_fma_f32 v58, v58, v82, v62
v_fma_f32 v59, v59, v83, v63
v_cvt_pk_bf16_f32 v64, v56, v57
v_cvt_pk_bf16_f32 v65, v58, v59
buffer_store_dwordx2 v[64:65], v248, s[12:15], s47 offen
s_waitcnt lgkmcnt(8)
v_add_f32 v88, v88, v92
v_add_f32 v96, v96, v100
v_add_f32 v176, v176, v104
v_add_f32 v108, v108, v112
v_add_f32 v88, v88, v96
v_lshlrev_b32 v92, 16, v20
v_add_f32 v108, v108, v116
v_add_f32 v88, v88, v176
v_add_f32 v108, v108, v92
v_mul_f32 v112, s34, v108
v_exp_f32 v112, v112
v_lshlrev_b32 v92, 16, v12
v_mul_f32 v88, v88, v108
v_add_f32 v112, 1.0, v112
v_rcp_f32 v112, v112
v_add_f32 v89, v89, v93
v_add_f32 v97, v97, v101
v_add_f32 v177, v177, v105
v_add_f32 v109, v109, v113
v_add_f32 v89, v89, v97
v_and_b32 v93, 0xffff0000, v20
v_add_f32 v109, v109, v117
v_add_f32 v89, v89, v177
v_add_f32 v109, v109, v93
v_mul_f32 v113, s34, v109
v_exp_f32 v113, v113
v_and_b32 v93, 0xffff0000, v12
v_mul_f32 v89, v89, v109
v_add_f32 v113, 1.0, v113
v_rcp_f32 v113, v113
v_add_f32 v90, v90, v94
v_add_f32 v98, v98, v102
v_add_f32 v178, v178, v106
v_add_f32 v110, v110, v114
v_add_f32 v90, v90, v98
v_lshlrev_b32 v94, 16, v21
v_add_f32 v110, v110, v118
v_add_f32 v90, v90, v178
v_add_f32 v110, v110, v94
v_mul_f32 v114, s34, v110
v_exp_f32 v114, v114
v_lshlrev_b32 v94, 16, v13
v_mul_f32 v90, v90, v110
v_add_f32 v114, 1.0, v114
v_rcp_f32 v114, v114
v_add_f32 v91, v91, v95
v_add_f32 v99, v99, v103
v_add_f32 v179, v179, v107
v_add_f32 v111, v111, v115
v_add_f32 v91, v91, v99
v_and_b32 v95, 0xffff0000, v21
v_add_f32 v111, v111, v119
v_add_f32 v91, v91, v179
v_add_f32 v111, v111, v95
v_mul_f32 v115, s34, v111
v_exp_f32 v115, v115
v_and_b32 v95, 0xffff0000, v13
v_mul_f32 v91, v91, v111
v_add_f32 v115, 1.0, v115
v_rcp_f32 v115, v115
v_fma_f32 v88, v88, v112, v92
v_fma_f32 v89, v89, v113, v93
v_fma_f32 v90, v90, v114, v94
v_fma_f32 v91, v91, v115, v95
v_cvt_pk_bf16_f32 v96, v88, v89
v_cvt_pk_bf16_f32 v97, v90, v91
buffer_store_dwordx2 v[96:97], v248, s[12:15], s48 offen
s_waitcnt lgkmcnt(0)
v_add_f32 v120, v120, v124
v_add_f32 v128, v128, v132
v_add_f32 v180, v180, v136
v_add_f32 v140, v140, v144
v_add_f32 v120, v120, v128
v_lshlrev_b32 v124, 16, v22
v_add_f32 v140, v140, v148
v_add_f32 v120, v120, v180
v_add_f32 v140, v140, v124
v_mul_f32 v144, s34, v140
v_exp_f32 v144, v144
v_lshlrev_b32 v124, 16, v14
v_mul_f32 v120, v120, v140
v_add_f32 v144, 1.0, v144
v_rcp_f32 v144, v144
v_add_f32 v121, v121, v125
v_add_f32 v129, v129, v133
v_add_f32 v181, v181, v137
v_add_f32 v141, v141, v145
v_add_f32 v121, v121, v129
v_and_b32 v125, 0xffff0000, v22
v_add_f32 v141, v141, v149
v_add_f32 v121, v121, v181
v_add_f32 v141, v141, v125
v_mul_f32 v145, s34, v141
v_exp_f32 v145, v145
v_and_b32 v125, 0xffff0000, v14
v_mul_f32 v121, v121, v141
v_add_f32 v145, 1.0, v145
v_rcp_f32 v145, v145
v_add_f32 v122, v122, v126
v_add_f32 v130, v130, v134
v_add_f32 v182, v182, v138
v_add_f32 v142, v142, v146
v_add_f32 v122, v122, v130
v_lshlrev_b32 v126, 16, v23
v_add_f32 v142, v142, v150
v_add_f32 v122, v122, v182
v_add_f32 v142, v142, v126
v_mul_f32 v146, s34, v142
v_exp_f32 v146, v146
v_lshlrev_b32 v126, 16, v15
v_mul_f32 v122, v122, v142
v_add_f32 v146, 1.0, v146
v_rcp_f32 v146, v146
v_add_f32 v123, v123, v127
v_add_f32 v131, v131, v135
v_add_f32 v183, v183, v139
v_add_f32 v143, v143, v147
v_add_f32 v123, v123, v131
v_and_b32 v127, 0xffff0000, v23
v_add_f32 v143, v143, v151
v_add_f32 v123, v123, v183
v_add_f32 v143, v143, v127
v_mul_f32 v147, s34, v143
v_exp_f32 v147, v147
v_and_b32 v127, 0xffff0000, v15
v_mul_f32 v123, v123, v143
v_add_f32 v147, 1.0, v147
v_rcp_f32 v147, v147
v_fma_f32 v120, v120, v144, v124
v_fma_f32 v121, v121, v145, v125
v_fma_f32 v122, v122, v146, v126
v_fma_f32 v123, v123, v147, v127
v_cvt_pk_bf16_f32 v128, v120, v121
v_cvt_pk_bf16_f32 v129, v122, v123
buffer_store_dwordx2 v[128:129], v248, s[12:15], s49 offen
.fin_1142:
s_waitcnt vmcnt(0) lgkmcnt(0)
.k3end_1121:
s_endpgm
.pslow_1102:
s_mov_b32 s62, 30000
.ploop_1104:
s_sleep 6
v_lshlrev_b32 v173, 2, v0
v_mov_b32 v172, 0
s_mov_b64 exec, s[60:61]
buffer_atomic_or v172, v173, s[56:59], 0 offen sc0 sc1
s_mov_b64 exec, -1
s_sub_u32 s62, s62, 1
s_waitcnt vmcnt(0)
s_cbranch_scc1 .pret_1103
v_or_b32 v172, s63, v172
v_cmp_ne_u32 vcc, -1, v172
s_and_b64 vcc, vcc, s[60:61]
s_cbranch_scc1 .ploop_1104
s_branch .pret_1103
.pslow_1111:
s_mov_b32 s62, 30000
.ploop_1113:
s_sleep 6
v_lshlrev_b32 v8, 2, v0
v_mov_b32 v7, 0
s_mov_b64 exec, s[60:61]
buffer_atomic_or v7, v8, s[56:59], 0 offen sc0 sc1
s_mov_b64 exec, -1
s_sub_u32 s62, s62, 1
s_waitcnt vmcnt(0)
s_cbranch_scc1 .pret_1112
v_or_b32 v7, s63, v7
v_cmp_ne_u32 vcc, -1, v7
s_and_b64 vcc, vcc, s[60:61]
s_cbranch_scc1 .ploop_1113
s_branch .pret_1112
.pslow_1116:
s_mov_b32 s62, 30000
.ploop_1118:
s_sleep 6
v_lshlrev_b32 v255, 2, v0
v_mov_b32 v254, 0
s_mov_b64 exec, s[60:61]
buffer_atomic_or v254, v255, s[56:59], 0 offen sc0 sc1
s_mov_b64 exec, -1
s_sub_u32 s62, s62, 1
s_waitcnt vmcnt(0)
s_cbranch_scc1 .pret_1117
v_or_b32 v254, s63, v254
v_cmp_ne_u32 vcc, -1, v254
s_and_b64 vcc, vcc, s[60:61]
s_cbranch_scc1 .ploop_1118
s_branch .pret_1117
.pslow_1127:
s_mov_b32 s62, 30000
.ploop_1129:
s_sleep 6
v_lshlrev_b32 v253, 2, v0
v_mov_b32 v252, 0
s_mov_b64 exec, s[60:61]
buffer_load_dword v252, v253, s[56:59], 0 offen sc0 sc1
s_mov_b64 exec, -1
s_sub_u32 s62, s62, 1
s_waitcnt vmcnt(0)
s_cbranch_scc1 .pret_1128
v_or_b32 v252, s63, v252
v_cmp_ne_u32 vcc, -1, v252
s_and_b64 vcc, vcc, s[60:61]
s_cbranch_scc1 .ploop_1129
s_branch .pret_1128
.pslow_1130:
s_mov_b32 s62, 30000
.ploop_1132:
s_sleep 6
v_lshlrev_b32 v253, 2, v0
v_mov_b32 v252, 0
s_mov_b64 exec, s[60:61]
buffer_load_dword v252, v253, s[56:59], 0 offen sc0 sc1
s_mov_b64 exec, -1
s_sub_u32 s62, s62, 1
s_waitcnt vmcnt(0)
s_cbranch_scc1 .pret_1131
v_or_b32 v252, s63, v252
v_cmp_ne_u32 vcc, -1, v252
s_and_b64 vcc, vcc, s[60:61]
s_cbranch_scc1 .ploop_1132
s_branch .pret_1131
.pslow_1136:
s_mov_b32 s62, 30000
.ploop_1138:
s_sleep 6
v_lshlrev_b32 v253, 2, v0
v_mov_b32 v252, 0
s_mov_b64 exec, s[60:61]
buffer_load_dword v252, v253, s[56:59], 0 offen sc0 sc1
s_mov_b64 exec, -1
s_sub_u32 s62, s62, 1
s_waitcnt vmcnt(0)
s_cbranch_scc1 .pret_1137
v_or_b32 v252, s63, v252
v_cmp_ne_u32 vcc, -1, v252
s_and_b64 vcc, vcc, s[60:61]
s_cbranch_scc1 .ploop_1138
s_branch .pret_1137
.section .rodata,"a"
.p2align 6
.amdhsa_kernel rs_kf_kernel
  .amdhsa_next_free_vgpr 256
  .amdhsa_next_free_sgpr 102
  .amdhsa_accum_offset 256
  .amdhsa_group_segment_fixed_size 0
  .amdhsa_kernarg_size 112
  .amdhsa_user_sgpr_count 2
  .amdhsa_user_sgpr_kernarg_segment_ptr 1
  .amdhsa_system_sgpr_workgroup_id_x 1
.end_amdhsa_kernel
```
